```python
import torch

def _softmax(x, axis=-1):
    return torch.softmax(x, dim=axis)
def _gelu(x):
    return torch.nn.functional.gelu(x, approximate="tanh")
def _silu(x):
    return torch.nn.functional.silu(x)
def _sigmoid(x):
    return torch.sigmoid(x)
def _layernorm(x, axis=-1, eps=1e-5):
    m = x.mean(dim=axis, keepdim=True)
    v = x.var(dim=axis, keepdim=True, unbiased=False)
    return (x - m) / torch.sqrt(v + eps)
def _scatter_add(tgt, idx, src, axis=0):
    return tgt.clone().index_add_(axis, idx, src)
def _segment_sum(src, seg, n):
    out = torch.zeros((n,) + src.shape[1:], dtype=src.dtype)
    return out.index_add_(0, seg, src)
def _pad(x, pw):
    flat = tuple(v for pair in reversed(pw) for v in pair)
    return torch.nn.functional.pad(x, flat)

kernel_name = 'gated_mix__spectral_gfnet__mha_block__prompt'

def setup_inputs():

    _w = (lambda a: (lambda t: t.to(torch.bfloat16) if t.is_floating_point() else t)(torch.as_tensor(a)))
    def _A_setup():
        B, S, D = 1, 2048, 448
        Df = D // 2 + 1
        return {
            "x": _w((lambda *s: torch.randn(*s, dtype=torch.bfloat16) * 0.05)(B, S, D)),
            "w_r": _w((lambda *s: torch.randn(*s, dtype=torch.bfloat16) * 6.4)(S, Df) * 0.02),
            "w_i": _w((lambda *s: torch.randn(*s, dtype=torch.bfloat16) * 6.4)(S, Df) * 0.02),
        }
    _A_in = _A_setup()

    def _B_setup():
        B, S, D, H = 1, 2048, 448, 16
        return {
            "x": _w((lambda *s: torch.randn(*s, dtype=torch.bfloat16) * 0.05)(B, S, D)),
            "wqkv": _w((lambda *s: torch.randn(*s, dtype=torch.bfloat16) * 0.8)(D, 3 * D)),
            "wo": _w((lambda *s: torch.randn(*s, dtype=torch.bfloat16) * 0.05)(D, D)),
        }
    _B_in = _B_setup()

    return {
        "A_x": _A_in["x"],
        "A_w_r": _A_in["w_r"],
        "A_w_i": _A_in["w_i"],
        "B_x": _B_in["x"],
        "B_wqkv": _B_in["wqkv"],
        "B_wo": _B_in["wo"],
        "gate_w": _w((lambda *s: torch.randn(*s, dtype=torch.bfloat16) * 0.05)(448) * 16.0),
    }

def reference(A_x, A_w_r, A_w_i, B_x, B_wqkv, B_wo, gate_w):
    def _A_ref(x, w_r, w_i):
        B, S, D = x.shape
        X = (lambda x, axes=(-2,-1): torch.fft.rfft2(x.float(), dim=axes))(x, axes=(-2, -1))
        W = w_r + 1j * w_i
        X = X * W
        y = (lambda x, s, axes=(-2,-1): torch.fft.irfft2(x, s=s, dim=axes).to(torch.bfloat16))(X, (S, D), axes=(-2, -1))
        return y

    def _B_ref(x, wqkv, wo):
        B, S, D = x.shape
        H = 16
        Dh = D // H
        qkv = (lambda x, *d: x.permute(*d))((x @ wqkv).reshape(B, S, 3, H, Dh), 2, 0, 3, 1, 4)
        q, k, v = qkv[0], qkv[1], qkv[2]
        scores = torch.einsum("bhqd,bhkd->bhqk", q, k) * (Dh ** -0.5)
        p = _softmax(scores, axis=-1)
        o = torch.einsum("bhqk,bhkd->bhqd", p, v)
        return (lambda x, *d: x.permute(*d))(o, 0, 2, 1, 3).reshape(B, S, D) @ wo

    x = A_x
    g = _sigmoid((x * gate_w).sum(-1, keepdims=True))
    a = _A_ref(x, A_w_r, A_w_i)
    b = _B_ref(x, B_wqkv, B_wo)
    return g * a + (1 - g) * b
```

```asm
; @launch kernel=k1_kernel grid=(256,1,1) block=(768,1,1) lds=158784
; @launch kernel=k2_kernel grid=(256,1,1) block=(768,1,1) lds=157824
; @launch kernel=k3_kernel grid=(224,1,1) block=(512,1,1) lds=131200
.amdgcn_target "amdgcn-amd-amdhsa--gfx950"
.text

.globl k1_kernel
.p2align 8
.type k1_kernel,@function
k1_kernel:

    s_cmp_ge_u32 s2, 256
    s_cbranch_scc1 L_k1_end
    s_load_dwordx4 s[24:27], s[0:1], 0
    s_load_dwordx2 s[28:29], s[0:1], 16
    s_load_dwordx2 s[30:31], s[0:1], 32
    s_load_dwordx2 s[32:33], s[0:1], 72
    s_getpc_b64 s[58:59]
    s_add_u32 s58, s58, tbl_fd@rel32@lo+4
    s_addc_u32 s59, s59, tbl_fd@rel32@hi+12
    v_and_b32 v1, 63, v0
    v_lshrrev_b32 v2, 6, v0
    s_and_b32 s40, s2, 7
    s_lshr_b32 s41, s2, 3
    v_readfirstlane_b32 s37, v2
    s_lshr_b32 s36, s40, 1
    s_and_b32 s42, s40, 1
    s_lshl_b32 s42, s42, 3
    s_and_b32 s34, s41, 7
    s_add_u32 s34, s34, s42
    s_lshr_b32 s35, s41, 3
    s_and_b32 s38, s37, 3
    v_mov_b32 v6, 158720
    v_mov_b32 v8, 1
    s_cmp_ge_u32 s37, 8
    s_cbranch_scc0 L_k1_compute
    s_lshr_b32 s55, s34, 2
    s_lshl_b32 s55, s55, 9
    s_and_b32 s42, s34, 3
    s_lshl_b32 s42, s42, 4
    s_add_u32 s55, s55, s42
    s_mul_i32 s55, s55, 896
    v_lshrrev_b32 v2, 3, v1
    v_and_b32 v3, 7, v1
    v_xor_b32 v3, v3, v2
    v_lshlrev_b32 v3, 4, v3
    v_mul_u32_u24 v4, 57344, v2
    v_and_b32 v5, 3, v2
    v_mul_u32_u24 v5, 57344, v5
    v_lshrrev_b32 v2, 2, v2
    v_mul_u32_u24 v2, 896, v2
    v_add_u32 v5, v5, v2
    s_cmp_eq_u32 s35, 3
    s_cselect_b64 vcc, -1, 0
    s_nop 1
    v_cndmask_b32 v4, v4, v5, vcc
    v_add3_u32 v9, v4, v3, s55
    v_mul_u32_u24 v2, 4682, v1
    v_lshrrev_b32 v2, 16, v2
    v_mul_u32_u24 v3, 14, v2
    v_sub_u32 v3, v1, v3
    v_lshlrev_b32 v3, 4, v3
    v_cmp_gt_u32 vcc, 56, v1
    s_mov_b64 s[48:49], vcc
    s_mov_b32 s44, 2688
    s_cmp_eq_u32 s35, 3
    s_cselect_b32 s44, 896, s44
    s_cselect_b32 s56, 0, s35
    s_lshl_b32 s56, s56, 2
    s_add_u32 s56, s56, s36
    s_mul_i32 s56, s56, 224
    v_mul_lo_u32 v2, v2, s44
    v_add3_u32 v10, v2, v3, s56
    s_lshl_b32 s50, s44, 6
    s_lshl_b32 s51, s44, 2
    s_lshl_b32 s54, s35, 1
    s_add_u32 s54, s54, s34
    s_and_b32 s54, s2, 7
    s_bfe_u32 s42, s2, 0x10003
    s_mul_i32 s42, s42, 3
    s_add_u32 s54, s54, s42
    s_add_u32 s54, s54, s38
    s_waitcnt lgkmcnt(0)
    s_mov_b32 s4, s24
    s_and_b32 s5, s25, 0xffff
    s_mov_b32 s6, 1835008
    s_mov_b32 s7, 0x20000
    s_mov_b32 s10, 1204224
    s_cmp_eq_u32 s35, 3
    s_cselect_b32 s8, s58, s30
    s_cselect_b32 s9, s59, s31
    s_cselect_b32 s10, 401408, s10
    s_mov_b32 s11, 0x20000
    s_and_b32 s9, s9, 0xffff
    s_mul_i32 s42, s38, 3584
    s_mov_b32 s43, 0
    s_cmp_eq_u32 s35, 3
    s_cselect_b32 s43, 0, s43
    s_add_u32 s60, s43, s42
    s_mov_b32 s43, 896
    s_cmp_eq_u32 s35, 3
    s_cselect_b32 s43, 1792, s43
    s_add_u32 s61, s43, s42
    s_mov_b32 s43, 1792
    s_cmp_eq_u32 s35, 3
    s_cselect_b32 s43, 229376, s43
    s_add_u32 s62, s43, s42
    s_mov_b32 s43, 2688
    s_cmp_eq_u32 s35, 3
    s_cselect_b32 s43, 231168, s43
    s_add_u32 s63, s43, s42
    s_lshl_b32 s57, s38, 12
    s_mul_i32 s39, s38, 3840
    s_add_u32 s39, s39, 16384
    s_lshl_b32 s42, s51, 2
    s_mul_i32 s22, s42, s38
    s_sub_u32 s54, s54, s38
    s_mul_i32 s43, s54, 37
    s_lshr_b32 s43, s43, 8
    s_mul_i32 s43, s43, 7
    s_sub_u32 s43, s54, s43
    s_lshl_b32 s45, s43, 7
    s_mul_i32 s46, s43, s50
    s_add_u32 m0, s57, 0
    s_add_u32 s42, s60, s45
    buffer_load_dwordx4 v9, s[4:7], s42 offen lds
    s_add_u32 m0, s57, 1024
    s_add_u32 s42, s61, s45
    buffer_load_dwordx4 v9, s[4:7], s42 offen lds
    s_add_u32 m0, s57, 2048
    s_add_u32 s42, s62, s45
    buffer_load_dwordx4 v9, s[4:7], s42 offen lds
    s_add_u32 m0, s57, 3072
    s_add_u32 s42, s63, s45
    buffer_load_dwordx4 v9, s[4:7], s42 offen lds
    s_mov_b64 exec, s[48:49]
    s_add_u32 s42, s46, s22
    s_add_u32 m0, s39, 0
    s_nop 0
    buffer_load_dwordx4 v10, s[8:11], s42 offen lds
    s_add_u32 m0, s39, 896
    s_add_u32 s42, s42, s51
    buffer_load_dwordx4 v10, s[8:11], s42 offen lds
    s_add_u32 m0, s39, 1920
    s_add_u32 s42, s42, s51
    buffer_load_dwordx4 v10, s[8:11], s42 offen lds
    s_add_u32 m0, s39, 2816
    s_add_u32 s42, s42, s51
    buffer_load_dwordx4 v10, s[8:11], s42 offen lds
    s_mov_b64 exec, -1
    s_add_u32 s45, s45, 128
    s_add_u32 s46, s46, s50
    s_cmp_eq_u32 s45, 896
    s_cselect_b32 s45, 0, s45
    s_cselect_b32 s46, 0, s46
    s_barrier
    s_add_u32 m0, s57, 31744
    s_add_u32 s42, s60, s45
    buffer_load_dwordx4 v9, s[4:7], s42 offen lds
    s_add_u32 m0, s57, 32768
    s_add_u32 s42, s61, s45
    buffer_load_dwordx4 v9, s[4:7], s42 offen lds
    s_add_u32 m0, s57, 33792
    s_add_u32 s42, s62, s45
    buffer_load_dwordx4 v9, s[4:7], s42 offen lds
    s_add_u32 m0, s57, 34816
    s_add_u32 s42, s63, s45
    buffer_load_dwordx4 v9, s[4:7], s42 offen lds
    s_mov_b64 exec, s[48:49]
    s_add_u32 s42, s46, s22
    s_add_u32 m0, s39, 31744
    s_nop 0
    buffer_load_dwordx4 v10, s[8:11], s42 offen lds
    s_add_u32 m0, s39, 32640
    s_add_u32 s42, s42, s51
    buffer_load_dwordx4 v10, s[8:11], s42 offen lds
    s_add_u32 m0, s39, 33664
    s_add_u32 s42, s42, s51
    buffer_load_dwordx4 v10, s[8:11], s42 offen lds
    s_add_u32 m0, s39, 34560
    s_add_u32 s42, s42, s51
    buffer_load_dwordx4 v10, s[8:11], s42 offen lds
    s_mov_b64 exec, -1
    s_add_u32 s45, s45, 128
    s_add_u32 s46, s46, s50
    s_cmp_eq_u32 s45, 896
    s_cselect_b32 s45, 0, s45
    s_cselect_b32 s46, 0, s46
    s_waitcnt vmcnt(8)
    s_mov_b64 exec, 1
    ds_add_u32 v6, v8 offset:4
    s_mov_b64 exec, -1
    s_add_u32 m0, s57, 63488
    s_add_u32 s42, s60, s45
    buffer_load_dwordx4 v9, s[4:7], s42 offen lds
    s_add_u32 m0, s57, 64512
    s_add_u32 s42, s61, s45
    buffer_load_dwordx4 v9, s[4:7], s42 offen lds
    s_add_u32 m0, s57, 65536
    s_add_u32 s42, s62, s45
    buffer_load_dwordx4 v9, s[4:7], s42 offen lds
    s_add_u32 m0, s57, 66560
    s_add_u32 s42, s63, s45
    buffer_load_dwordx4 v9, s[4:7], s42 offen lds
    s_mov_b64 exec, s[48:49]
    s_add_u32 s42, s46, s22
    s_add_u32 m0, s39, 63488
    s_nop 0
    buffer_load_dwordx4 v10, s[8:11], s42 offen lds
    s_add_u32 m0, s39, 64384
    s_add_u32 s42, s42, s51
    buffer_load_dwordx4 v10, s[8:11], s42 offen lds
    s_add_u32 m0, s39, 65408
    s_add_u32 s42, s42, s51
    buffer_load_dwordx4 v10, s[8:11], s42 offen lds
    s_add_u32 m0, s39, 66304
    s_add_u32 s42, s42, s51
    buffer_load_dwordx4 v10, s[8:11], s42 offen lds
    s_mov_b64 exec, -1
    s_add_u32 s45, s45, 128
    s_add_u32 s46, s46, s50
    s_cmp_eq_u32 s45, 896
    s_cselect_b32 s45, 0, s45
    s_cselect_b32 s46, 0, s46
    s_waitcnt vmcnt(8)
    s_mov_b64 exec, 1
    ds_add_u32 v6, v8 offset:8
    s_mov_b64 exec, -1
    s_add_u32 m0, s57, 95232
    s_add_u32 s42, s60, s45
    buffer_load_dwordx4 v9, s[4:7], s42 offen lds
    s_add_u32 m0, s57, 96256
    s_add_u32 s42, s61, s45
    buffer_load_dwordx4 v9, s[4:7], s42 offen lds
    s_add_u32 m0, s57, 97280
    s_add_u32 s42, s62, s45
    buffer_load_dwordx4 v9, s[4:7], s42 offen lds
    s_add_u32 m0, s57, 98304
    s_add_u32 s42, s63, s45
    buffer_load_dwordx4 v9, s[4:7], s42 offen lds
    s_mov_b64 exec, s[48:49]
    s_add_u32 s42, s46, s22
    s_add_u32 m0, s39, 95232
    s_nop 0
    buffer_load_dwordx4 v10, s[8:11], s42 offen lds
    s_add_u32 m0, s39, 96128
    s_add_u32 s42, s42, s51
    buffer_load_dwordx4 v10, s[8:11], s42 offen lds
    s_add_u32 m0, s39, 97152
    s_add_u32 s42, s42, s51
    buffer_load_dwordx4 v10, s[8:11], s42 offen lds
    s_add_u32 m0, s39, 98048
    s_add_u32 s42, s42, s51
    buffer_load_dwordx4 v10, s[8:11], s42 offen lds
    s_mov_b64 exec, -1
    s_add_u32 s45, s45, 128
    s_add_u32 s46, s46, s50
    s_cmp_eq_u32 s45, 896
    s_cselect_b32 s45, 0, s45
    s_cselect_b32 s46, 0, s46
    s_waitcnt vmcnt(8)
    s_mov_b64 exec, 1
    ds_add_u32 v6, v8 offset:12
    s_mov_b64 exec, -1
    s_add_u32 m0, s57, 126976
    s_add_u32 s42, s60, s45
    buffer_load_dwordx4 v9, s[4:7], s42 offen lds
    s_add_u32 m0, s57, 128000
    s_add_u32 s42, s61, s45
    buffer_load_dwordx4 v9, s[4:7], s42 offen lds
    s_add_u32 m0, s57, 129024
    s_add_u32 s42, s62, s45
    buffer_load_dwordx4 v9, s[4:7], s42 offen lds
    s_add_u32 m0, s57, 130048
    s_add_u32 s42, s63, s45
    buffer_load_dwordx4 v9, s[4:7], s42 offen lds
    s_mov_b64 exec, s[48:49]
    s_add_u32 s42, s46, s22
    s_add_u32 m0, s39, 126976
    s_nop 0
    buffer_load_dwordx4 v10, s[8:11], s42 offen lds
    s_add_u32 m0, s39, 127872
    s_add_u32 s42, s42, s51
    buffer_load_dwordx4 v10, s[8:11], s42 offen lds
    s_add_u32 m0, s39, 128896
    s_add_u32 s42, s42, s51
    buffer_load_dwordx4 v10, s[8:11], s42 offen lds
    s_add_u32 m0, s39, 129792
    s_add_u32 s42, s42, s51
    buffer_load_dwordx4 v10, s[8:11], s42 offen lds
    s_mov_b64 exec, -1
    s_add_u32 s45, s45, 128
    s_add_u32 s46, s46, s50
    s_cmp_eq_u32 s45, 896
    s_cselect_b32 s45, 0, s45
    s_cselect_b32 s46, 0, s46
    s_waitcnt vmcnt(8)
    s_mov_b64 exec, 1
    ds_add_u32 v6, v8 offset:16
    s_mov_b64 exec, -1
    s_mov_b32 vcc_lo, 0
L_sp_1:
    ds_read_b32 v7, v6 offset:36
    s_waitcnt lgkmcnt(0)
    v_readfirstlane_b32 s47, v7
    s_cmp_ge_u32 s47, 8
    s_cbranch_scc1 L_ok_2
    s_sleep 1
    s_add_u32 vcc_lo, vcc_lo, 1
    s_cmp_lt_u32 vcc_lo, 0x400000
    s_cbranch_scc1 L_sp_1
L_ok_2:
    s_add_u32 m0, s57, 0
    s_add_u32 s42, s60, s45
    buffer_load_dwordx4 v9, s[4:7], s42 offen lds
    s_add_u32 m0, s57, 1024
    s_add_u32 s42, s61, s45
    buffer_load_dwordx4 v9, s[4:7], s42 offen lds
    s_add_u32 m0, s57, 2048
    s_add_u32 s42, s62, s45
    buffer_load_dwordx4 v9, s[4:7], s42 offen lds
    s_add_u32 m0, s57, 3072
    s_add_u32 s42, s63, s45
    buffer_load_dwordx4 v9, s[4:7], s42 offen lds
    s_mov_b64 exec, s[48:49]
    s_add_u32 s42, s46, s22
    s_add_u32 m0, s39, 0
    s_nop 0
    buffer_load_dwordx4 v10, s[8:11], s42 offen lds
    s_add_u32 m0, s39, 896
    s_add_u32 s42, s42, s51
    buffer_load_dwordx4 v10, s[8:11], s42 offen lds
    s_add_u32 m0, s39, 1920
    s_add_u32 s42, s42, s51
    buffer_load_dwordx4 v10, s[8:11], s42 offen lds
    s_add_u32 m0, s39, 2816
    s_add_u32 s42, s42, s51
    buffer_load_dwordx4 v10, s[8:11], s42 offen lds
    s_mov_b64 exec, -1
    s_add_u32 s45, s45, 128
    s_add_u32 s46, s46, s50
    s_cmp_eq_u32 s45, 896
    s_cselect_b32 s45, 0, s45
    s_cselect_b32 s46, 0, s46
    s_waitcnt vmcnt(8)
    s_mov_b64 exec, 1
    ds_add_u32 v6, v8 offset:20
    s_mov_b64 exec, -1
    s_mov_b32 vcc_lo, 0
L_sp_3:
    ds_read_b32 v7, v6 offset:40
    s_waitcnt lgkmcnt(0)
    v_readfirstlane_b32 s47, v7
    s_cmp_ge_u32 s47, 8
    s_cbranch_scc1 L_ok_4
    s_sleep 1
    s_add_u32 vcc_lo, vcc_lo, 1
    s_cmp_lt_u32 vcc_lo, 0x400000
    s_cbranch_scc1 L_sp_3
L_ok_4:
    s_add_u32 m0, s57, 31744
    s_add_u32 s42, s60, s45
    buffer_load_dwordx4 v9, s[4:7], s42 offen lds
    s_add_u32 m0, s57, 32768
    s_add_u32 s42, s61, s45
    buffer_load_dwordx4 v9, s[4:7], s42 offen lds
    s_add_u32 m0, s57, 33792
    s_add_u32 s42, s62, s45
    buffer_load_dwordx4 v9, s[4:7], s42 offen lds
    s_add_u32 m0, s57, 34816
    s_add_u32 s42, s63, s45
    buffer_load_dwordx4 v9, s[4:7], s42 offen lds
    s_mov_b64 exec, s[48:49]
    s_add_u32 s42, s46, s22
    s_add_u32 m0, s39, 31744
    s_nop 0
    buffer_load_dwordx4 v10, s[8:11], s42 offen lds
    s_add_u32 m0, s39, 32640
    s_add_u32 s42, s42, s51
    buffer_load_dwordx4 v10, s[8:11], s42 offen lds
    s_add_u32 m0, s39, 33664
    s_add_u32 s42, s42, s51
    buffer_load_dwordx4 v10, s[8:11], s42 offen lds
    s_add_u32 m0, s39, 34560
    s_add_u32 s42, s42, s51
    buffer_load_dwordx4 v10, s[8:11], s42 offen lds
    s_mov_b64 exec, -1
    s_add_u32 s45, s45, 128
    s_add_u32 s46, s46, s50
    s_cmp_eq_u32 s45, 896
    s_cselect_b32 s45, 0, s45
    s_cselect_b32 s46, 0, s46
    s_mov_b32 s16, s26
    s_and_b32 s17, s27, 0xffff
    s_mov_b32 s18, 921600
    s_mov_b32 s19, 0x20000
    s_mov_b32 s20, s28
    s_and_b32 s21, s29, 0xffff
    s_mov_b32 s22, 921600
    s_mov_b32 s23, 0x20000
    s_mov_b32 s12, s32
    s_and_b32 s13, s33, 0xffff
    s_mov_b32 s14, 15728640
    s_mov_b32 s15, 0x20000
    s_and_b32 s40, s2, 7
    s_lshr_b32 s41, s2, 3
    s_lshl_b32 s42, s40, 5
    s_add_u32 s42, s42, s41
    s_lshl_b32 s42, s42, 3
    s_mul_i32 s43, s42, 450
    v_and_b32 v2, 255, v0
    v_lshlrev_b32 v11, 1, v2
    v_lshlrev_b32 v12, 5, v2
    s_mul_i32 s42, s42, 912
    s_add_u32 s42, s42, 8388608
    v_add_u32 v12, s42, v12
    v_mov_b32 v3, 0x7fffffff
    v_cmp_gt_u32 vcc, 225, v2
    s_nop 1
    v_cndmask_b32 v12, v3, v12, vcc
    buffer_load_ushort v16, v11, s[16:19], s43 offen offset:0
    buffer_load_ushort v24, v11, s[20:23], s43 offen offset:0
    buffer_load_ushort v17, v11, s[16:19], s43 offen offset:450
    buffer_load_ushort v25, v11, s[20:23], s43 offen offset:450
    buffer_load_ushort v18, v11, s[16:19], s43 offen offset:900
    buffer_load_ushort v26, v11, s[20:23], s43 offen offset:900
    buffer_load_ushort v19, v11, s[16:19], s43 offen offset:1350
    buffer_load_ushort v27, v11, s[20:23], s43 offen offset:1350
    buffer_load_ushort v20, v11, s[16:19], s43 offen offset:1800
    buffer_load_ushort v28, v11, s[20:23], s43 offen offset:1800
    buffer_load_ushort v21, v11, s[16:19], s43 offen offset:2250
    buffer_load_ushort v29, v11, s[20:23], s43 offen offset:2250
    buffer_load_ushort v22, v11, s[16:19], s43 offen offset:2700
    buffer_load_ushort v30, v11, s[20:23], s43 offen offset:2700
    buffer_load_ushort v23, v11, s[16:19], s43 offen offset:3150
    buffer_load_ushort v31, v11, s[20:23], s43 offen offset:3150
    s_load_dwordx2 s[62:63], s[0:1], 48
    s_lshl_b32 s40, s2, 3
    s_lshl_b32 s41, s38, 1
    s_add_u32 s39, s40, s41
    s_and_b32 s41, s39, 7
    s_lshl_b32 s41, s41, 6
    s_bfe_u32 s42, s39, 0x60003
    s_add_u32 s41, s41, s42
    s_lshr_b32 s42, s39, 9
    s_lshl_b32 s42, s42, 9
    s_add_u32 s41, s41, s42
    s_mul_i32 s41, s41, 896
    s_add_u32 s42, s41, 57344
    v_lshlrev_b32 v4, 4, v1
    v_mov_b32 v3, 0x7fffffff
    v_cndmask_b32 v3, v3, v4, s[48:49]
    s_waitcnt lgkmcnt(0)
    s_mov_b32 s8, s62
    s_and_b32 s9, s63, 0xffff
    s_mov_b32 s10, 896
    s_mov_b32 s11, 0x20000
    buffer_load_dwordx4 v[44:47], v3, s[4:7], s41 offen
    buffer_load_dwordx4 v[48:51], v3, s[4:7], s42 offen
    buffer_load_dwordx4 v[52:55], v3, s[8:11], 0 offen
    s_getpc_b64 s[60:61]
    s_add_u32 s60, s60, tbl_fft@rel32@lo+4
    s_addc_u32 s61, s61, tbl_fft@rel32@hi+12
    s_getpc_b64 s[62:63]
    s_add_u32 s62, s62, k2_kernel@rel32@lo+4
    s_addc_u32 s63, s63, k2_kernel@rel32@hi+12
    s_lshr_b32 s40, s2, 3
    s_lshl_b32 s40, s40, 2
    s_add_u32 s40, s40, s38
    s_mul_i32 s41, s40, 576
    v_lshlrev_b32 v3, 7, v1
    v_min_u32 v4, 640, v3
    s_mov_b32 s8, s60
    s_and_b32 s9, s61, 0xffff
    s_mov_b32 s10, 73728
    s_mov_b32 s11, 0x20000
    buffer_load_dword v15, v4, s[8:11], s41 offen
    s_mov_b32 s8, s62
    s_and_b32 s9, s63, 0xffff
    s_mov_b32 s10, L_k2_end-k2_kernel
    s_mov_b32 s11, 0x20000
    s_lshl_b32 s41, s38, 13
    buffer_load_dword v15, v3, s[8:11], s41 offen
    s_waitcnt vmcnt(29)
    s_mov_b64 exec, 1
    ds_add_u32 v6, v8 offset:24
    s_mov_b64 exec, -1
    s_waitcnt vmcnt(21)
    s_mov_b64 exec, 1
    ds_add_u32 v6, v8 offset:28
    s_mov_b64 exec, -1
    s_cmp_eq_u32 s35, 3
    s_cbranch_scc1 L_k1_paddone
    s_cmp_eq_u32 s35, 2
    s_cbranch_scc1 L_k1_padv
    v_lshrrev_b32 v4, 7, v2
    s_lshl_b32 s43, s36, 2
    v_add_u32 v4, s43, v4
    v_lshlrev_b32 v4, 6, v4
    v_bfe_u32 v5, v2, 5, 2
    s_lshl_b32 s43, s34, 2
    v_add3_u32 v4, v4, v5, s43
    s_add_u32 s43, s35, 11
    v_lshlrev_b32 v4, s43, v4
    v_and_b32 v5, 31, v2
    v_lshl_add_u32 v4, v5, 4, v4
    s_mul_i32 s43, s35, 2097152
    s_add_u32 s43, s43, 1544
    s_lshl_b32 s42, 0x40000, s35
    s_add_u32 s42, s42, s43
    v_mov_b32 v40, 0
    v_mov_b32 v41, 0
    buffer_store_dwordx2 v[40:41], v4, s[12:15], s43 offen
    buffer_store_dwordx2 v[40:41], v4, s[12:15], s42 offen
    s_branch L_k1_paddone
L_k1_padv:
    v_lshrrev_b32 v4, 4, v1
    s_lshl_b32 s43, s36, 2
    v_add_u32 v4, s43, v4
    v_lshlrev_b32 v4, 6, v4
    v_bfe_u32 v5, v1, 2, 2
    s_lshl_b32 s43, s34, 2
    v_add3_u32 v4, v4, v5, s43
    v_lshlrev_b32 v4, 12, v4
    v_and_b32 v5, 3, v1
    v_lshl_add_u32 v4, v5, 9, v4
    s_cmp_eq_u32 s38, 0
    s_cselect_b32 s43, 0x3f803f80, 0
    v_mov_b32 v40, s43
    v_mov_b32 v41, s43
    v_mov_b32 v42, s43
    v_mov_b32 v43, s43
    s_lshl_b32 s43, s38, 4
    s_add_u32 s43, s43, 2099648
    buffer_store_dwordx4 v[40:43], v4, s[12:15], s43 offen
L_k1_paddone:
    s_waitcnt vmcnt(0)
    v_lshl_or_b32 v16, v24, 16, v16
    v_lshl_or_b32 v17, v25, 16, v17
    v_lshl_or_b32 v18, v26, 16, v18
    v_lshl_or_b32 v19, v27, 16, v19
    v_lshl_or_b32 v20, v28, 16, v20
    v_lshl_or_b32 v21, v29, 16, v21
    v_lshl_or_b32 v22, v30, 16, v22
    v_lshl_or_b32 v23, v31, 16, v23
    buffer_store_dwordx4 v[16:19], v12, s[12:15], 0 offen
    buffer_store_dwordx4 v[20:23], v12, s[12:15], 0 offen offset:16
    v_lshlrev_b32 v56, 16, v52
    v_and_b32 v57, 0xffff0000, v52
    v_lshlrev_b32 v58, 16, v53
    v_and_b32 v59, 0xffff0000, v53
    v_lshlrev_b32 v60, 16, v54
    v_and_b32 v61, 0xffff0000, v54
    v_lshlrev_b32 v62, 16, v55
    v_and_b32 v63, 0xffff0000, v55
    v_lshlrev_b32 v13, 16, v44
    v_and_b32 v14, 0xffff0000, v44
    v_mul_f32 v13, v13, v56
    v_mul_f32 v14, v14, v57
    v_cvt_pk_bf16_f32 v13, v13, v14
    v_lshlrev_b32 v14, 16, v13
    v_and_b32 v13, 0xffff0000, v13
    v_add_f32 v4, v13, v14
    v_lshlrev_b32 v13, 16, v45
    v_and_b32 v14, 0xffff0000, v45
    v_mul_f32 v13, v13, v58
    v_mul_f32 v14, v14, v59
    v_cvt_pk_bf16_f32 v13, v13, v14
    v_lshlrev_b32 v14, 16, v13
    v_and_b32 v13, 0xffff0000, v13
    v_add_f32 v4, v4, v13
    v_add_f32 v4, v4, v14
    v_lshlrev_b32 v13, 16, v46
    v_and_b32 v14, 0xffff0000, v46
    v_mul_f32 v13, v13, v60
    v_mul_f32 v14, v14, v61
    v_cvt_pk_bf16_f32 v13, v13, v14
    v_lshlrev_b32 v14, 16, v13
    v_and_b32 v13, 0xffff0000, v13
    v_add_f32 v4, v4, v13
    v_add_f32 v4, v4, v14
    v_lshlrev_b32 v13, 16, v47
    v_and_b32 v14, 0xffff0000, v47
    v_mul_f32 v13, v13, v62
    v_mul_f32 v14, v14, v63
    v_cvt_pk_bf16_f32 v13, v13, v14
    v_lshlrev_b32 v14, 16, v13
    v_and_b32 v13, 0xffff0000, v13
    v_add_f32 v4, v4, v13
    v_add_f32 v4, v4, v14
    v_lshlrev_b32 v13, 16, v48
    v_and_b32 v14, 0xffff0000, v48
    v_mul_f32 v13, v13, v56
    v_mul_f32 v14, v14, v57
    v_cvt_pk_bf16_f32 v13, v13, v14
    v_lshlrev_b32 v14, 16, v13
    v_and_b32 v13, 0xffff0000, v13
    v_add_f32 v5, v13, v14
    v_lshlrev_b32 v13, 16, v49
    v_and_b32 v14, 0xffff0000, v49
    v_mul_f32 v13, v13, v58
    v_mul_f32 v14, v14, v59
    v_cvt_pk_bf16_f32 v13, v13, v14
    v_lshlrev_b32 v14, 16, v13
    v_and_b32 v13, 0xffff0000, v13
    v_add_f32 v5, v5, v13
    v_add_f32 v5, v5, v14
    v_lshlrev_b32 v13, 16, v50
    v_and_b32 v14, 0xffff0000, v50
    v_mul_f32 v13, v13, v60
    v_mul_f32 v14, v14, v61
    v_cvt_pk_bf16_f32 v13, v13, v14
    v_lshlrev_b32 v14, 16, v13
    v_and_b32 v13, 0xffff0000, v13
    v_add_f32 v5, v5, v13
    v_add_f32 v5, v5, v14
    v_lshlrev_b32 v13, 16, v51
    v_and_b32 v14, 0xffff0000, v51
    v_mul_f32 v13, v13, v62
    v_mul_f32 v14, v14, v63
    v_cvt_pk_bf16_f32 v13, v13, v14
    v_lshlrev_b32 v14, 16, v13
    v_and_b32 v13, 0xffff0000, v13
    v_add_f32 v5, v5, v13
    v_add_f32 v5, v5, v14
    s_nop 1
    v_add_f32_dpp v4, v4, v4 row_shr:1 bound_ctrl:0
    v_add_f32_dpp v5, v5, v5 row_shr:1 bound_ctrl:0
    s_nop 1
    v_add_f32_dpp v4, v4, v4 row_shr:2 bound_ctrl:0
    v_add_f32_dpp v5, v5, v5 row_shr:2 bound_ctrl:0
    s_nop 1
    v_add_f32_dpp v4, v4, v4 row_shr:4 bound_ctrl:0
    v_add_f32_dpp v5, v5, v5 row_shr:4 bound_ctrl:0
    s_nop 1
    v_add_f32_dpp v4, v4, v4 row_shr:8 bound_ctrl:0
    v_add_f32_dpp v5, v5, v5 row_shr:8 bound_ctrl:0
    s_nop 1
    v_add_f32_dpp v4, v4, v4 row_bcast:15 row_mask:0xa
    v_add_f32_dpp v5, v5, v5 row_bcast:15 row_mask:0xa
    s_nop 1
    v_add_f32_dpp v4, v4, v4 row_bcast:31 row_mask:0xc
    v_add_f32_dpp v5, v5, v5 row_bcast:31 row_mask:0xc
    v_cvt_pk_bf16_f32 v13, v4, v5
    v_lshlrev_b32 v4, 16, v13
    v_and_b32 v5, 0xffff0000, v13
    v_mul_f32 v4, 3216550459, v4
    v_mul_f32 v5, 3216550459, v5
    v_exp_f32 v4, v4
    v_exp_f32 v5, v5
    s_nop 0
    v_add_f32 v4, 1.0, v4
    v_add_f32 v5, 1.0, v5
    v_rcp_f32 v4, v4
    v_rcp_f32 v5, v5
    s_nop 0
    v_cvt_pk_bf16_f32 v13, v4, v5
    v_lshlrev_b32 v56, 16, v13
    v_and_b32 v58, 0xffff0000, v13
    v_sub_f32 v4, 1.0, v56
    v_sub_f32 v5, 1.0, v58
    v_cvt_pk_bf16_f32 v13, v4, v5
    v_lshlrev_b32 v57, 16, v13
    v_and_b32 v59, 0xffff0000, v13
    v_mov_b32 v3, 0x7fffffff
    v_cmp_eq_u32 vcc, 63, v1
    s_lshl_b32 s39, s39, 3
    s_add_u32 s39, s39, 14680064
    v_cndmask_b32 v3, v3, 0, vcc
    buffer_store_dwordx4 v[56:59], v3, s[12:15], s39 offen
    s_endpgm
L_k1_compute:
    v_and_b32 v2, 15, v1
    v_lshl_add_u32 v3, v2, 2, v6
    v_cmp_eq_u32 vcc, 8, v2
    v_mov_b32 v4, 0
    v_mov_b32 v5, 4
    v_cndmask_b32 v4, v4, v5, vcc
    ds_write_b32 v3, v4
    v_lshrrev_b32 v3, 4, v1
    v_and_b32 v4, 7, v2
    v_xor_b32 v4, v4, v3
    v_lshlrev_b32 v4, 4, v4
    v_lshl_add_u32 v4, v2, 7, v4
    s_lshl_b32 s43, s38, 12
    v_add_u32 v9, s43, v4
    v_xor_b32 v10, 64, v9
    v_add_u32 v11, 63488, v9
    v_add_u32 v12, 63488, v10
    v_add_u32 v13, 126976, v9
    v_add_u32 v14, 126976, v10
    v_mul_u32_u24 v4, 1920, v3
    v_lshrrev_b32 v5, 2, v2
    v_mul_u32_u24 v5, 224, v5
    v_add_u32 v4, v4, v5
    v_and_b32 v5, 3, v1
    v_lshl_add_u32 v15, v5, 3, v4
    v_add_u32 v16, 63488, v15
    v_add_u32 v17, 126976, v15
    s_waitcnt lgkmcnt(0)
    s_barrier
    s_mov_b32 s12, s32
    s_and_b32 s13, s33, 0xffff
    s_mov_b32 s14, 15728640
    s_mov_b32 s15, 0x20000
    v_mov_b32 v20, 0
    v_mov_b32 v21, 0
    v_mov_b32 v22, 0
    v_mov_b32 v23, 0
    s_lshr_b32 s48, s37, 2
    s_lshl_b32 s43, s48, 7
    v_add_u32 v15, s43, v15
    s_mov_b32 s53, 1.0
    s_cmp_eq_u32 s35, 2
    s_cbranch_scc1 L_k1_v
    s_cmp_eq_u32 s48, 1
    s_cbranch_scc1 L_k1_t01
    s_cmp_eq_u32 s35, 3
    s_cbranch_scc1 L_k1dfto_5
    s_add_u32 s42, s35, 17
    v_lshlrev_b32 v4, 2, v3
    v_add_u32 v4, 0, v4
    v_mul_u32_u24 v5, 2341, v4
    v_lshrrev_b32 v5, 16, v5
    v_mul_u32_u24 v18, 28, v5
    v_sub_u32 v4, v4, v18
    v_lshlrev_b32 v5, s42, v5
    v_lshrrev_b32 v18, 3, v4
    v_lshl_add_u32 v5, v18, 9, v5
    v_and_b32 v4, 4, v4
    v_lshl_add_u32 v5, v4, 1, v5
    v_lshl_add_u32 v20, v2, 4, v5
    v_lshlrev_b32 v4, 2, v3
    v_add_u32 v4, 16, v4
    v_mul_u32_u24 v5, 2341, v4
    v_lshrrev_b32 v5, 16, v5
    v_mul_u32_u24 v18, 28, v5
    v_sub_u32 v4, v4, v18
    v_lshlrev_b32 v5, s42, v5
    v_lshrrev_b32 v18, 3, v4
    v_lshl_add_u32 v5, v18, 9, v5
    v_and_b32 v4, 4, v4
    v_lshl_add_u32 v5, v4, 1, v5
    v_lshl_add_u32 v21, v2, 4, v5
    v_lshlrev_b32 v4, 2, v3
    v_add_u32 v4, 32, v4
    v_mul_u32_u24 v5, 2341, v4
    v_lshrrev_b32 v5, 16, v5
    v_mul_u32_u24 v18, 28, v5
    v_sub_u32 v4, v4, v18
    v_lshlrev_b32 v5, s42, v5
    v_lshrrev_b32 v18, 3, v4
    v_lshl_add_u32 v5, v18, 9, v5
    v_and_b32 v4, 4, v4
    v_lshl_add_u32 v5, v4, 1, v5
    v_lshl_add_u32 v22, v2, 4, v5
    v_lshlrev_b32 v4, 2, v3
    v_add_u32 v4, 48, v4
    v_mul_u32_u24 v5, 2341, v4
    v_lshrrev_b32 v5, 16, v5
    v_mul_u32_u24 v18, 28, v5
    v_sub_u32 v4, v4, v18
    v_lshlrev_b32 v5, s42, v5
    v_lshrrev_b32 v18, 3, v4
    v_lshl_add_u32 v5, v18, 9, v5
    v_and_b32 v4, 4, v4
    v_lshl_add_u32 v5, v4, 1, v5
    v_lshl_add_u32 v23, v2, 4, v5
    s_lshl_b32 s52, s36, 8
    s_lshl_b32 s43, s34, 2
    s_add_u32 s52, s52, s43
    s_add_u32 s52, s52, s38
    s_add_u32 s43, s35, 11
    s_lshl_b32 s52, s52, s43
    s_mul_i32 s43, s35, 2097152
    s_add_u32 s52, s52, s43
    s_cmp_eq_u32 s35, 0
    s_cselect_b32 s53, 1049335798, 1.0
    s_branch L_k1eod_6
L_k1dfto_5:
    v_mul_u32_u24 v4, 16640, v3
    v_lshl_add_u32 v20, v2, 2, v4
    v_add_u32 v21, 8320, v20
    s_mul_i32 s52, s36, 465920
    s_bfe_u32 s43, s34, 0x10001
    s_lshl_b32 s43, s43, 12
    s_add_u32 s52, s52, s43
    s_lshr_b32 s43, s34, 2
    s_lshl_b32 s43, s43, 10
    s_add_u32 s52, s52, s43
    s_and_b32 s43, s34, 1
    s_lshl_b32 s43, s43, 8
    s_add_u32 s52, s52, s43
    s_lshl_b32 s43, s38, 6
    s_add_u32 s52, s52, s43
    s_add_u32 s52, s52, 6291456
L_k1eod_6:
    v_mov_b32 v32, 0
    v_mov_b32 v33, 0
    v_mov_b32 v34, 0
    v_mov_b32 v35, 0
    v_mov_b32 v36, 0
    v_mov_b32 v37, 0
    v_mov_b32 v38, 0
    v_mov_b32 v39, 0
    v_mov_b32 v40, 0
    v_mov_b32 v41, 0
    v_mov_b32 v42, 0
    v_mov_b32 v43, 0
    v_mov_b32 v44, 0
    v_mov_b32 v45, 0
    v_mov_b32 v46, 0
    v_mov_b32 v47, 0
    v_mov_b32 v48, 0
    v_mov_b32 v49, 0
    v_mov_b32 v50, 0
    v_mov_b32 v51, 0
    v_mov_b32 v52, 0
    v_mov_b32 v53, 0
    v_mov_b32 v54, 0
    v_mov_b32 v55, 0
    v_mov_b32 v56, 0
    v_mov_b32 v57, 0
    v_mov_b32 v58, 0
    v_mov_b32 v59, 0
    v_mov_b32 v60, 0
    v_mov_b32 v61, 0
    v_mov_b32 v62, 0
    v_mov_b32 v63, 0
    v_mov_b32 v12, v10
    v_mov_b32 v13, v15
    v_mov_b32 v17, v6
    s_mov_b32 s57, 0
    s_mov_b32 s39, 0
    s_mov_b32 vcc_lo, 0
L_sp_7:
    ds_read_b32 v7, v6 offset:4
    s_waitcnt lgkmcnt(0)
    v_readfirstlane_b32 s47, v7
    s_cmp_ge_u32 s47, 4
    s_cbranch_scc1 L_ok_8
    s_sleep 1
    s_add_u32 vcc_lo, vcc_lo, 1
    s_cmp_lt_u32 vcc_lo, 0x400000
    s_cbranch_scc1 L_sp_7
L_ok_8:
    ds_read_b128 v[64:67], v9 offset:0
    ds_read_b128 v[68:71], v9 offset:2048
    ds_read_b64_tr_b16 v[80:81], v15 offset:16384
    ds_read_b64_tr_b16 v[82:83], v15 offset:17280
    ds_read_b64_tr_b16 v[84:85], v15 offset:16416
    ds_read_b64_tr_b16 v[86:87], v15 offset:17312
    ds_read_b64_tr_b16 v[88:89], v15 offset:16448
    ds_read_b64_tr_b16 v[90:91], v15 offset:17344
    ds_read_b64_tr_b16 v[92:93], v15 offset:16480
    ds_read_b64_tr_b16 v[94:95], v15 offset:17376
    s_mov_b64 exec, 1
    ds_add_u32 v6, v8 offset:60
    s_mov_b64 exec, -1
    .p2align 6
L_k1_loop00:
    s_add_u32 s57, s57, 31744
    s_cmp_eq_u32 s57, 158720
    s_cselect_b32 s57, 0, s57
    v_add_u32 v14, s57, v9
    v_add_u32 v16, s57, v15
    s_waitcnt lgkmcnt(7)
    v_mfma_f32_16x16x32_bf16 v[32:35], v[80:83], v[64:67], v[32:35]
    ds_read_b32 v7, v17 offset:8
    ds_read_b128 v[72:75], v12 offset:0
    v_mfma_f32_16x16x32_bf16 v[48:51], v[80:83], v[68:71], v[48:51]
    ds_read_b128 v[76:79], v12 offset:2048
    ds_read_b64_tr_b16 v[96:97], v13 offset:24064
    s_waitcnt lgkmcnt(9)
    v_mfma_f32_16x16x32_bf16 v[36:39], v[84:87], v[64:67], v[36:39]
    ds_read_b64_tr_b16 v[98:99], v13 offset:24960
    ds_read_b64_tr_b16 v[100:101], v13 offset:24096
    v_mfma_f32_16x16x32_bf16 v[52:55], v[84:87], v[68:71], v[52:55]
    ds_read_b64_tr_b16 v[102:103], v13 offset:24992
    ds_read_b64_tr_b16 v[104:105], v13 offset:24128
    s_waitcnt lgkmcnt(11)
    v_mfma_f32_16x16x32_bf16 v[40:43], v[88:91], v[64:67], v[40:43]
    ds_read_b64_tr_b16 v[106:107], v13 offset:25024
    ds_read_b64_tr_b16 v[108:109], v13 offset:24160
    v_mfma_f32_16x16x32_bf16 v[56:59], v[88:91], v[68:71], v[56:59]
    ds_read_b64_tr_b16 v[110:111], v13 offset:25056
    s_waitcnt lgkmcnt(12)
    v_mfma_f32_16x16x32_bf16 v[44:47], v[92:95], v[64:67], v[44:47]
    v_mfma_f32_16x16x32_bf16 v[60:63], v[92:95], v[68:71], v[60:63]
    s_waitcnt lgkmcnt(10)
    v_readfirstlane_b32 s47, v7
    v_add_u32 v12, s57, v10
    v_mov_b32 v13, v16
    s_cmp_ge_u32 s47, 4
    s_cbranch_scc0 L_k1_slow00
    s_waitcnt lgkmcnt(6)
    v_mfma_f32_16x16x32_bf16 v[32:35], v[96:99], v[72:75], v[32:35]
    ds_read_b128 v[64:67], v14 offset:0
    ds_read_b128 v[68:71], v14 offset:2048
    v_mfma_f32_16x16x32_bf16 v[48:51], v[96:99], v[76:79], v[48:51]
    ds_read_b64_tr_b16 v[80:81], v16 offset:16384
    ds_read_b64_tr_b16 v[82:83], v16 offset:17280
    s_waitcnt lgkmcnt(8)
    v_mfma_f32_16x16x32_bf16 v[36:39], v[100:103], v[72:75], v[36:39]
    ds_read_b64_tr_b16 v[84:85], v16 offset:16416
    ds_read_b64_tr_b16 v[86:87], v16 offset:17312
    v_mfma_f32_16x16x32_bf16 v[52:55], v[100:103], v[76:79], v[52:55]
    ds_read_b64_tr_b16 v[88:89], v16 offset:16448
    ds_read_b64_tr_b16 v[90:91], v16 offset:17344
    s_waitcnt lgkmcnt(10)
    v_mfma_f32_16x16x32_bf16 v[40:43], v[104:107], v[72:75], v[40:43]
    ds_read_b64_tr_b16 v[92:93], v16 offset:16480
    ds_read_b64_tr_b16 v[94:95], v16 offset:17376
    v_mfma_f32_16x16x32_bf16 v[56:59], v[104:107], v[76:79], v[56:59]
    s_waitcnt lgkmcnt(10)
    v_mfma_f32_16x16x32_bf16 v[44:47], v[108:111], v[72:75], v[44:47]
    v_mfma_f32_16x16x32_bf16 v[60:63], v[108:111], v[76:79], v[60:63]
    s_mov_b64 exec, 1
    ds_add_u32 v17, v8 offset:36
    s_mov_b64 exec, -1
L_k1_join00:
    v_add_u32 v17, 4, v17
    s_add_u32 s39, s39, 1
    s_cmp_lt_u32 s39, 7
    s_cbranch_scc1 L_k1_loop00
    s_branch L_k1_done00
L_k1_slow00:
    s_waitcnt lgkmcnt(6)
    v_mfma_f32_16x16x32_bf16 v[32:35], v[96:99], v[72:75], v[32:35]
    v_mfma_f32_16x16x32_bf16 v[48:51], v[96:99], v[76:79], v[48:51]
    s_waitcnt lgkmcnt(4)
    v_mfma_f32_16x16x32_bf16 v[36:39], v[100:103], v[72:75], v[36:39]
    v_mfma_f32_16x16x32_bf16 v[52:55], v[100:103], v[76:79], v[52:55]
    s_waitcnt lgkmcnt(2)
    v_mfma_f32_16x16x32_bf16 v[40:43], v[104:107], v[72:75], v[40:43]
    v_mfma_f32_16x16x32_bf16 v[56:59], v[104:107], v[76:79], v[56:59]
    s_waitcnt lgkmcnt(0)
    v_mfma_f32_16x16x32_bf16 v[44:47], v[108:111], v[72:75], v[44:47]
    v_mfma_f32_16x16x32_bf16 v[60:63], v[108:111], v[76:79], v[60:63]
    s_mov_b64 exec, 1
    ds_add_u32 v17, v8 offset:36
    s_mov_b64 exec, -1
    s_mov_b32 vcc_lo, 0
L_sp_9:
    ds_read_b32 v7, v17 offset:8
    s_waitcnt lgkmcnt(0)
    v_readfirstlane_b32 s47, v7
    s_cmp_ge_u32 s47, 4
    s_cbranch_scc1 L_ok_10
    s_sleep 1
    s_add_u32 vcc_lo, vcc_lo, 1
    s_cmp_lt_u32 vcc_lo, 0x400000
    s_cbranch_scc1 L_sp_9
L_ok_10:
    ds_read_b128 v[64:67], v14 offset:0
    ds_read_b128 v[68:71], v14 offset:2048
    ds_read_b64_tr_b16 v[80:81], v16 offset:16384
    ds_read_b64_tr_b16 v[82:83], v16 offset:17280
    ds_read_b64_tr_b16 v[84:85], v16 offset:16416
    ds_read_b64_tr_b16 v[86:87], v16 offset:17312
    ds_read_b64_tr_b16 v[88:89], v16 offset:16448
    ds_read_b64_tr_b16 v[90:91], v16 offset:17344
    ds_read_b64_tr_b16 v[92:93], v16 offset:16480
    ds_read_b64_tr_b16 v[94:95], v16 offset:17376
    s_mov_b64 exec, 1
    ds_add_u32 v6, v8 offset:60
    s_mov_b64 exec, -1
    s_branch L_k1_join00
L_k1_done00:
    s_nop 7
    s_cmp_eq_u32 s35, 3
    s_cbranch_scc1 L_k1dft_11
    v_mul_f32 v32, s53, v32
    v_mul_f32 v33, s53, v33
    v_mul_f32 v34, s53, v34
    v_mul_f32 v35, s53, v35
    v_cvt_pk_bf16_f32 v32, v32, v33
    v_cvt_pk_bf16_f32 v33, v34, v35
    buffer_store_dwordx2 v[32:33], v20, s[12:15], s52 offen offset:0
    v_mul_f32 v48, s53, v48
    v_mul_f32 v49, s53, v49
    v_mul_f32 v50, s53, v50
    v_mul_f32 v51, s53, v51
    v_cvt_pk_bf16_f32 v48, v48, v49
    v_cvt_pk_bf16_f32 v49, v50, v51
    buffer_store_dwordx2 v[48:49], v20, s[12:15], s52 offen offset:256
    v_mul_f32 v36, s53, v36
    v_mul_f32 v37, s53, v37
    v_mul_f32 v38, s53, v38
    v_mul_f32 v39, s53, v39
    v_cvt_pk_bf16_f32 v36, v36, v37
    v_cvt_pk_bf16_f32 v37, v38, v39
    buffer_store_dwordx2 v[36:37], v21, s[12:15], s52 offen offset:0
    v_mul_f32 v52, s53, v52
    v_mul_f32 v53, s53, v53
    v_mul_f32 v54, s53, v54
    v_mul_f32 v55, s53, v55
    v_cvt_pk_bf16_f32 v52, v52, v53
    v_cvt_pk_bf16_f32 v53, v54, v55
    buffer_store_dwordx2 v[52:53], v21, s[12:15], s52 offen offset:256
    v_mul_f32 v40, s53, v40
    v_mul_f32 v41, s53, v41
    v_mul_f32 v42, s53, v42
    v_mul_f32 v43, s53, v43
    v_cvt_pk_bf16_f32 v40, v40, v41
    v_cvt_pk_bf16_f32 v41, v42, v43
    buffer_store_dwordx2 v[40:41], v22, s[12:15], s52 offen offset:0
    v_mul_f32 v56, s53, v56
    v_mul_f32 v57, s53, v57
    v_mul_f32 v58, s53, v58
    v_mul_f32 v59, s53, v59
    v_cvt_pk_bf16_f32 v56, v56, v57
    v_cvt_pk_bf16_f32 v57, v58, v59
    buffer_store_dwordx2 v[56:57], v22, s[12:15], s52 offen offset:256
    v_mul_f32 v44, s53, v44
    v_mul_f32 v45, s53, v45
    v_mul_f32 v46, s53, v46
    v_mul_f32 v47, s53, v47
    v_cvt_pk_bf16_f32 v44, v44, v45
    v_cvt_pk_bf16_f32 v45, v46, v47
    buffer_store_dwordx2 v[44:45], v23, s[12:15], s52 offen offset:0
    v_mul_f32 v60, s53, v60
    v_mul_f32 v61, s53, v61
    v_mul_f32 v62, s53, v62
    v_mul_f32 v63, s53, v63
    v_cvt_pk_bf16_f32 v60, v60, v61
    v_cvt_pk_bf16_f32 v61, v62, v63
    buffer_store_dwordx2 v[60:61], v23, s[12:15], s52 offen offset:256
    s_endpgm
L_k1dft_11:
    v_cvt_pk_bf16_f32 v32, v32, v33
    v_cvt_pk_bf16_f32 v33, v34, v35
    buffer_store_dword v32, v20, s[12:15], s52 offen offset:0
    buffer_store_dword v33, v21, s[12:15], s52 offen offset:0
    v_cvt_pk_bf16_f32 v48, v48, v49
    v_cvt_pk_bf16_f32 v49, v50, v51
    buffer_store_dword v48, v20, s[12:15], s52 offen offset:512
    buffer_store_dword v49, v21, s[12:15], s52 offen offset:512
    s_add_u32 s52, s52, 66560
    v_cvt_pk_bf16_f32 v36, v36, v37
    v_cvt_pk_bf16_f32 v37, v38, v39
    buffer_store_dword v36, v20, s[12:15], s52 offen offset:0
    buffer_store_dword v37, v21, s[12:15], s52 offen offset:0
    v_cvt_pk_bf16_f32 v52, v52, v53
    v_cvt_pk_bf16_f32 v53, v54, v55
    buffer_store_dword v52, v20, s[12:15], s52 offen offset:512
    buffer_store_dword v53, v21, s[12:15], s52 offen offset:512
    s_add_u32 s52, s52, 66560
    v_cvt_pk_bf16_f32 v40, v40, v41
    v_cvt_pk_bf16_f32 v41, v42, v43
    buffer_store_dword v40, v20, s[12:15], s52 offen offset:0
    buffer_store_dword v41, v21, s[12:15], s52 offen offset:0
    v_cvt_pk_bf16_f32 v56, v56, v57
    v_cvt_pk_bf16_f32 v57, v58, v59
    buffer_store_dword v56, v20, s[12:15], s52 offen offset:512
    buffer_store_dword v57, v21, s[12:15], s52 offen offset:512
    s_add_u32 s52, s52, 66560
    v_cvt_pk_bf16_f32 v44, v44, v45
    v_cvt_pk_bf16_f32 v45, v46, v47
    buffer_store_dword v44, v20, s[12:15], s52 offen offset:0
    buffer_store_dword v45, v21, s[12:15], s52 offen offset:0
    v_cvt_pk_bf16_f32 v60, v60, v61
    v_cvt_pk_bf16_f32 v61, v62, v63
    buffer_store_dword v60, v20, s[12:15], s52 offen offset:512
    buffer_store_dword v61, v21, s[12:15], s52 offen offset:512
    s_add_u32 s52, s52, 66560
    s_endpgm
L_k1_t01:
    s_cmp_eq_u32 s35, 3
    s_cbranch_scc1 L_k1dfto_12
    s_add_u32 s42, s35, 17
    v_lshlrev_b32 v4, 2, v3
    v_add_u32 v4, 64, v4
    v_mul_u32_u24 v5, 2341, v4
    v_lshrrev_b32 v5, 16, v5
    v_mul_u32_u24 v18, 28, v5
    v_sub_u32 v4, v4, v18
    v_lshlrev_b32 v5, s42, v5
    v_lshrrev_b32 v18, 3, v4
    v_lshl_add_u32 v5, v18, 9, v5
    v_and_b32 v4, 4, v4
    v_lshl_add_u32 v5, v4, 1, v5
    v_lshl_add_u32 v20, v2, 4, v5
    v_lshlrev_b32 v4, 2, v3
    v_add_u32 v4, 80, v4
    v_mul_u32_u24 v5, 2341, v4
    v_lshrrev_b32 v5, 16, v5
    v_mul_u32_u24 v18, 28, v5
    v_sub_u32 v4, v4, v18
    v_lshlrev_b32 v5, s42, v5
    v_lshrrev_b32 v18, 3, v4
    v_lshl_add_u32 v5, v18, 9, v5
    v_and_b32 v4, 4, v4
    v_lshl_add_u32 v5, v4, 1, v5
    v_lshl_add_u32 v21, v2, 4, v5
    v_lshlrev_b32 v4, 2, v3
    v_add_u32 v4, 96, v4
    v_mul_u32_u24 v5, 2341, v4
    v_lshrrev_b32 v5, 16, v5
    v_mul_u32_u24 v18, 28, v5
    v_sub_u32 v4, v4, v18
    v_lshlrev_b32 v5, s42, v5
    v_lshrrev_b32 v18, 3, v4
    v_lshl_add_u32 v5, v18, 9, v5
    v_and_b32 v4, 4, v4
    v_lshl_add_u32 v5, v4, 1, v5
    v_lshl_add_u32 v22, v2, 4, v5
    s_lshl_b32 s52, s36, 8
    s_lshl_b32 s43, s34, 2
    s_add_u32 s52, s52, s43
    s_add_u32 s52, s52, s38
    s_add_u32 s43, s35, 11
    s_lshl_b32 s52, s52, s43
    s_mul_i32 s43, s35, 2097152
    s_add_u32 s52, s52, s43
    s_cmp_eq_u32 s35, 0
    s_cselect_b32 s53, 1049335798, 1.0
    s_branch L_k1eod_13
L_k1dfto_12:
    v_mul_u32_u24 v4, 16640, v3
    v_lshl_add_u32 v20, v2, 2, v4
    v_add_u32 v21, 8320, v20
    s_mul_i32 s52, s36, 465920
    s_bfe_u32 s43, s34, 0x10001
    s_lshl_b32 s43, s43, 12
    s_add_u32 s52, s52, s43
    s_lshr_b32 s43, s34, 2
    s_lshl_b32 s43, s43, 10
    s_add_u32 s52, s52, s43
    s_and_b32 s43, s34, 1
    s_lshl_b32 s43, s43, 8
    s_add_u32 s52, s52, s43
    s_lshl_b32 s43, s38, 6
    s_add_u32 s52, s52, s43
    s_add_u32 s52, s52, 6557696
L_k1eod_13:
    v_mov_b32 v32, 0
    v_mov_b32 v33, 0
    v_mov_b32 v34, 0
    v_mov_b32 v35, 0
    v_mov_b32 v36, 0
    v_mov_b32 v37, 0
    v_mov_b32 v38, 0
    v_mov_b32 v39, 0
    v_mov_b32 v40, 0
    v_mov_b32 v41, 0
    v_mov_b32 v42, 0
    v_mov_b32 v43, 0
    v_mov_b32 v44, 0
    v_mov_b32 v45, 0
    v_mov_b32 v46, 0
    v_mov_b32 v47, 0
    v_mov_b32 v48, 0
    v_mov_b32 v49, 0
    v_mov_b32 v50, 0
    v_mov_b32 v51, 0
    v_mov_b32 v52, 0
    v_mov_b32 v53, 0
    v_mov_b32 v54, 0
    v_mov_b32 v55, 0
    v_mov_b32 v56, 0
    v_mov_b32 v57, 0
    v_mov_b32 v58, 0
    v_mov_b32 v59, 0
    v_mov_b32 v60, 0
    v_mov_b32 v61, 0
    v_mov_b32 v62, 0
    v_mov_b32 v63, 0
    v_mov_b32 v12, v10
    v_mov_b32 v13, v15
    v_mov_b32 v17, v6
    s_mov_b32 s57, 0
    s_mov_b32 s39, 0
    s_mov_b32 vcc_lo, 0
L_sp_14:
    ds_read_b32 v7, v6 offset:4
    s_waitcnt lgkmcnt(0)
    v_readfirstlane_b32 s47, v7
    s_cmp_ge_u32 s47, 4
    s_cbranch_scc1 L_ok_15
    s_sleep 1
    s_add_u32 vcc_lo, vcc_lo, 1
    s_cmp_lt_u32 vcc_lo, 0x400000
    s_cbranch_scc1 L_sp_14
L_ok_15:
    ds_read_b128 v[64:67], v9 offset:0
    ds_read_b128 v[68:71], v9 offset:2048
    ds_read_b64_tr_b16 v[80:81], v15 offset:16384
    ds_read_b64_tr_b16 v[82:83], v15 offset:17280
    ds_read_b64_tr_b16 v[84:85], v15 offset:16416
    ds_read_b64_tr_b16 v[86:87], v15 offset:17312
    ds_read_b64_tr_b16 v[88:89], v15 offset:16448
    ds_read_b64_tr_b16 v[90:91], v15 offset:17344
    s_mov_b64 exec, 1
    ds_add_u32 v6, v8 offset:60
    s_mov_b64 exec, -1
    .p2align 6
L_k1_loop01:
    s_add_u32 s57, s57, 31744
    s_cmp_eq_u32 s57, 158720
    s_cselect_b32 s57, 0, s57
    v_add_u32 v14, s57, v9
    v_add_u32 v16, s57, v15
    s_waitcnt lgkmcnt(5)
    v_mfma_f32_16x16x32_bf16 v[32:35], v[80:83], v[64:67], v[32:35]
    ds_read_b32 v7, v17 offset:8
    ds_read_b128 v[72:75], v12 offset:0
    v_mfma_f32_16x16x32_bf16 v[48:51], v[80:83], v[68:71], v[48:51]
    ds_read_b128 v[76:79], v12 offset:2048
    ds_read_b64_tr_b16 v[96:97], v13 offset:24064
    s_waitcnt lgkmcnt(7)
    v_mfma_f32_16x16x32_bf16 v[36:39], v[84:87], v[64:67], v[36:39]
    ds_read_b64_tr_b16 v[98:99], v13 offset:24960
    ds_read_b64_tr_b16 v[100:101], v13 offset:24096
    v_mfma_f32_16x16x32_bf16 v[52:55], v[84:87], v[68:71], v[52:55]
    ds_read_b64_tr_b16 v[102:103], v13 offset:24992
    ds_read_b64_tr_b16 v[104:105], v13 offset:24128
    s_waitcnt lgkmcnt(9)
    v_mfma_f32_16x16x32_bf16 v[40:43], v[88:91], v[64:67], v[40:43]
    v_mfma_f32_16x16x32_bf16 v[56:59], v[88:91], v[68:71], v[56:59]
    ds_read_b64_tr_b16 v[106:107], v13 offset:25024
    s_waitcnt lgkmcnt(8)
    v_readfirstlane_b32 s47, v7
    v_add_u32 v12, s57, v10
    v_mov_b32 v13, v16
    s_cmp_ge_u32 s47, 4
    s_cbranch_scc0 L_k1_slow01
    s_waitcnt lgkmcnt(4)
    v_mfma_f32_16x16x32_bf16 v[32:35], v[96:99], v[72:75], v[32:35]
    ds_read_b128 v[64:67], v14 offset:0
    ds_read_b128 v[68:71], v14 offset:2048
    v_mfma_f32_16x16x32_bf16 v[48:51], v[96:99], v[76:79], v[48:51]
    ds_read_b64_tr_b16 v[80:81], v16 offset:16384
    ds_read_b64_tr_b16 v[82:83], v16 offset:17280
    s_waitcnt lgkmcnt(6)
    v_mfma_f32_16x16x32_bf16 v[36:39], v[100:103], v[72:75], v[36:39]
    ds_read_b64_tr_b16 v[84:85], v16 offset:16416
    ds_read_b64_tr_b16 v[86:87], v16 offset:17312
    v_mfma_f32_16x16x32_bf16 v[52:55], v[100:103], v[76:79], v[52:55]
    ds_read_b64_tr_b16 v[88:89], v16 offset:16448
    ds_read_b64_tr_b16 v[90:91], v16 offset:17344
    s_waitcnt lgkmcnt(8)
    v_mfma_f32_16x16x32_bf16 v[40:43], v[104:107], v[72:75], v[40:43]
    v_mfma_f32_16x16x32_bf16 v[56:59], v[104:107], v[76:79], v[56:59]
    s_mov_b64 exec, 1
    ds_add_u32 v17, v8 offset:36
    s_mov_b64 exec, -1
L_k1_join01:
    v_add_u32 v17, 4, v17
    s_add_u32 s39, s39, 1
    s_cmp_lt_u32 s39, 7
    s_cbranch_scc1 L_k1_loop01
    s_branch L_k1_done01
L_k1_slow01:
    s_waitcnt lgkmcnt(4)
    v_mfma_f32_16x16x32_bf16 v[32:35], v[96:99], v[72:75], v[32:35]
    v_mfma_f32_16x16x32_bf16 v[48:51], v[96:99], v[76:79], v[48:51]
    s_waitcnt lgkmcnt(2)
    v_mfma_f32_16x16x32_bf16 v[36:39], v[100:103], v[72:75], v[36:39]
    v_mfma_f32_16x16x32_bf16 v[52:55], v[100:103], v[76:79], v[52:55]
    s_waitcnt lgkmcnt(0)
    v_mfma_f32_16x16x32_bf16 v[40:43], v[104:107], v[72:75], v[40:43]
    v_mfma_f32_16x16x32_bf16 v[56:59], v[104:107], v[76:79], v[56:59]
    s_mov_b64 exec, 1
    ds_add_u32 v17, v8 offset:36
    s_mov_b64 exec, -1
    s_mov_b32 vcc_lo, 0
L_sp_16:
    ds_read_b32 v7, v17 offset:8
    s_waitcnt lgkmcnt(0)
    v_readfirstlane_b32 s47, v7
    s_cmp_ge_u32 s47, 4
    s_cbranch_scc1 L_ok_17
    s_sleep 1
    s_add_u32 vcc_lo, vcc_lo, 1
    s_cmp_lt_u32 vcc_lo, 0x400000
    s_cbranch_scc1 L_sp_16
L_ok_17:
    ds_read_b128 v[64:67], v14 offset:0
    ds_read_b128 v[68:71], v14 offset:2048
    ds_read_b64_tr_b16 v[80:81], v16 offset:16384
    ds_read_b64_tr_b16 v[82:83], v16 offset:17280
    ds_read_b64_tr_b16 v[84:85], v16 offset:16416
    ds_read_b64_tr_b16 v[86:87], v16 offset:17312
    ds_read_b64_tr_b16 v[88:89], v16 offset:16448
    ds_read_b64_tr_b16 v[90:91], v16 offset:17344
    s_mov_b64 exec, 1
    ds_add_u32 v6, v8 offset:60
    s_mov_b64 exec, -1
    s_branch L_k1_join01
L_k1_done01:
    s_nop 7
    s_cmp_eq_u32 s35, 3
    s_cbranch_scc1 L_k1dft_18
    v_mul_f32 v32, s53, v32
    v_mul_f32 v33, s53, v33
    v_mul_f32 v34, s53, v34
    v_mul_f32 v35, s53, v35
    v_cvt_pk_bf16_f32 v32, v32, v33
    v_cvt_pk_bf16_f32 v33, v34, v35
    buffer_store_dwordx2 v[32:33], v20, s[12:15], s52 offen offset:0
    v_mul_f32 v48, s53, v48
    v_mul_f32 v49, s53, v49
    v_mul_f32 v50, s53, v50
    v_mul_f32 v51, s53, v51
    v_cvt_pk_bf16_f32 v48, v48, v49
    v_cvt_pk_bf16_f32 v49, v50, v51
    buffer_store_dwordx2 v[48:49], v20, s[12:15], s52 offen offset:256
    v_mul_f32 v36, s53, v36
    v_mul_f32 v37, s53, v37
    v_mul_f32 v38, s53, v38
    v_mul_f32 v39, s53, v39
    v_cvt_pk_bf16_f32 v36, v36, v37
    v_cvt_pk_bf16_f32 v37, v38, v39
    buffer_store_dwordx2 v[36:37], v21, s[12:15], s52 offen offset:0
    v_mul_f32 v52, s53, v52
    v_mul_f32 v53, s53, v53
    v_mul_f32 v54, s53, v54
    v_mul_f32 v55, s53, v55
    v_cvt_pk_bf16_f32 v52, v52, v53
    v_cvt_pk_bf16_f32 v53, v54, v55
    buffer_store_dwordx2 v[52:53], v21, s[12:15], s52 offen offset:256
    v_mul_f32 v40, s53, v40
    v_mul_f32 v41, s53, v41
    v_mul_f32 v42, s53, v42
    v_mul_f32 v43, s53, v43
    v_cvt_pk_bf16_f32 v40, v40, v41
    v_cvt_pk_bf16_f32 v41, v42, v43
    buffer_store_dwordx2 v[40:41], v22, s[12:15], s52 offen offset:0
    v_mul_f32 v56, s53, v56
    v_mul_f32 v57, s53, v57
    v_mul_f32 v58, s53, v58
    v_mul_f32 v59, s53, v59
    v_cvt_pk_bf16_f32 v56, v56, v57
    v_cvt_pk_bf16_f32 v57, v58, v59
    buffer_store_dwordx2 v[56:57], v22, s[12:15], s52 offen offset:256
    s_endpgm
L_k1dft_18:
    v_cvt_pk_bf16_f32 v32, v32, v33
    v_cvt_pk_bf16_f32 v33, v34, v35
    buffer_store_dword v32, v20, s[12:15], s52 offen offset:0
    buffer_store_dword v33, v21, s[12:15], s52 offen offset:0
    v_cvt_pk_bf16_f32 v48, v48, v49
    v_cvt_pk_bf16_f32 v49, v50, v51
    buffer_store_dword v48, v20, s[12:15], s52 offen offset:512
    buffer_store_dword v49, v21, s[12:15], s52 offen offset:512
    s_add_u32 s52, s52, 66560
    v_cvt_pk_bf16_f32 v36, v36, v37
    v_cvt_pk_bf16_f32 v37, v38, v39
    buffer_store_dword v36, v20, s[12:15], s52 offen offset:0
    buffer_store_dword v37, v21, s[12:15], s52 offen offset:0
    v_cvt_pk_bf16_f32 v52, v52, v53
    v_cvt_pk_bf16_f32 v53, v54, v55
    buffer_store_dword v52, v20, s[12:15], s52 offen offset:512
    buffer_store_dword v53, v21, s[12:15], s52 offen offset:512
    s_add_u32 s52, s52, 66560
    v_cvt_pk_bf16_f32 v40, v40, v41
    v_cvt_pk_bf16_f32 v41, v42, v43
    buffer_store_dword v40, v20, s[12:15], s52 offen offset:0
    buffer_store_dword v41, v21, s[12:15], s52 offen offset:0
    v_cvt_pk_bf16_f32 v56, v56, v57
    v_cvt_pk_bf16_f32 v57, v58, v59
    buffer_store_dword v56, v20, s[12:15], s52 offen offset:512
    buffer_store_dword v57, v21, s[12:15], s52 offen offset:512
    s_add_u32 s52, s52, 66560
    s_endpgm
L_k1_v:
    s_cmp_eq_u32 s48, 1
    s_cbranch_scc1 L_k1_t11
    v_bfe_u32 v3, v1, 4, 1
    v_lshlrev_b32 v3, 9, v3
    v_lshrrev_b32 v4, 5, v1
    v_lshl_add_u32 v3, v4, 3, v3
    v_add_u32 v4, 0, v2
    v_mul_u32_u24 v5, 2341, v4
    v_lshrrev_b32 v5, 16, v5
    v_mul_u32_u24 v18, 28, v5
    v_sub_u32 v4, v4, v18
    v_lshl_add_u32 v5, v5, 18, v3
    v_lshl_add_u32 v20, v4, 4, v5
    v_add_u32 v4, 16, v2
    v_mul_u32_u24 v5, 2341, v4
    v_lshrrev_b32 v5, 16, v5
    v_mul_u32_u24 v18, 28, v5
    v_sub_u32 v4, v4, v18
    v_lshl_add_u32 v5, v5, 18, v3
    v_lshl_add_u32 v21, v4, 4, v5
    v_add_u32 v4, 32, v2
    v_mul_u32_u24 v5, 2341, v4
    v_lshrrev_b32 v5, 16, v5
    v_mul_u32_u24 v18, 28, v5
    v_sub_u32 v4, v4, v18
    v_lshl_add_u32 v5, v5, 18, v3
    v_lshl_add_u32 v22, v4, 4, v5
    v_add_u32 v4, 48, v2
    v_mul_u32_u24 v5, 2341, v4
    v_lshrrev_b32 v5, 16, v5
    v_mul_u32_u24 v18, 28, v5
    v_sub_u32 v4, v4, v18
    v_lshl_add_u32 v5, v5, 18, v3
    v_lshl_add_u32 v23, v4, 4, v5
    s_lshl_b32 s52, s36, 8
    s_lshl_b32 s43, s34, 2
    s_add_u32 s52, s52, s43
    s_add_u32 s52, s52, s38
    s_lshl_b32 s52, s52, 12
    s_add_u32 s52, s52, 2099200
    v_mov_b32 v32, 0
    v_mov_b32 v33, 0
    v_mov_b32 v34, 0
    v_mov_b32 v35, 0
    v_mov_b32 v36, 0
    v_mov_b32 v37, 0
    v_mov_b32 v38, 0
    v_mov_b32 v39, 0
    v_mov_b32 v40, 0
    v_mov_b32 v41, 0
    v_mov_b32 v42, 0
    v_mov_b32 v43, 0
    v_mov_b32 v44, 0
    v_mov_b32 v45, 0
    v_mov_b32 v46, 0
    v_mov_b32 v47, 0
    v_mov_b32 v48, 0
    v_mov_b32 v49, 0
    v_mov_b32 v50, 0
    v_mov_b32 v51, 0
    v_mov_b32 v52, 0
    v_mov_b32 v53, 0
    v_mov_b32 v54, 0
    v_mov_b32 v55, 0
    v_mov_b32 v56, 0
    v_mov_b32 v57, 0
    v_mov_b32 v58, 0
    v_mov_b32 v59, 0
    v_mov_b32 v60, 0
    v_mov_b32 v61, 0
    v_mov_b32 v62, 0
    v_mov_b32 v63, 0
    v_mov_b32 v12, v10
    v_mov_b32 v13, v15
    v_mov_b32 v17, v6
    s_mov_b32 s57, 0
    s_mov_b32 s39, 0
    s_mov_b32 vcc_lo, 0
L_sp_19:
    ds_read_b32 v7, v6 offset:4
    s_waitcnt lgkmcnt(0)
    v_readfirstlane_b32 s47, v7
    s_cmp_ge_u32 s47, 4
    s_cbranch_scc1 L_ok_20
    s_sleep 1
    s_add_u32 vcc_lo, vcc_lo, 1
    s_cmp_lt_u32 vcc_lo, 0x400000
    s_cbranch_scc1 L_sp_19
L_ok_20:
    ds_read_b128 v[64:67], v9 offset:0
    ds_read_b128 v[68:71], v9 offset:2048
    ds_read_b64_tr_b16 v[80:81], v15 offset:16384
    ds_read_b64_tr_b16 v[82:83], v15 offset:17280
    ds_read_b64_tr_b16 v[84:85], v15 offset:16416
    ds_read_b64_tr_b16 v[86:87], v15 offset:17312
    ds_read_b64_tr_b16 v[88:89], v15 offset:16448
    ds_read_b64_tr_b16 v[90:91], v15 offset:17344
    ds_read_b64_tr_b16 v[92:93], v15 offset:16480
    ds_read_b64_tr_b16 v[94:95], v15 offset:17376
    s_mov_b64 exec, 1
    ds_add_u32 v6, v8 offset:60
    s_mov_b64 exec, -1
    .p2align 6
L_k1_loop10:
    s_add_u32 s57, s57, 31744
    s_cmp_eq_u32 s57, 158720
    s_cselect_b32 s57, 0, s57
    v_add_u32 v14, s57, v9
    v_add_u32 v16, s57, v15
    s_waitcnt lgkmcnt(7)
    v_mfma_f32_16x16x32_bf16 v[32:35], v[64:67], v[80:83], v[32:35]
    ds_read_b32 v7, v17 offset:8
    ds_read_b128 v[72:75], v12 offset:0
    v_mfma_f32_16x16x32_bf16 v[48:51], v[68:71], v[80:83], v[48:51]
    ds_read_b128 v[76:79], v12 offset:2048
    ds_read_b64_tr_b16 v[96:97], v13 offset:24064
    s_waitcnt lgkmcnt(9)
    v_mfma_f32_16x16x32_bf16 v[36:39], v[64:67], v[84:87], v[36:39]
    ds_read_b64_tr_b16 v[98:99], v13 offset:24960
    ds_read_b64_tr_b16 v[100:101], v13 offset:24096
    v_mfma_f32_16x16x32_bf16 v[52:55], v[68:71], v[84:87], v[52:55]
    ds_read_b64_tr_b16 v[102:103], v13 offset:24992
    ds_read_b64_tr_b16 v[104:105], v13 offset:24128
    s_waitcnt lgkmcnt(11)
    v_mfma_f32_16x16x32_bf16 v[40:43], v[64:67], v[88:91], v[40:43]
    ds_read_b64_tr_b16 v[106:107], v13 offset:25024
    ds_read_b64_tr_b16 v[108:109], v13 offset:24160
    v_mfma_f32_16x16x32_bf16 v[56:59], v[68:71], v[88:91], v[56:59]
    ds_read_b64_tr_b16 v[110:111], v13 offset:25056
    s_waitcnt lgkmcnt(12)
    v_mfma_f32_16x16x32_bf16 v[44:47], v[64:67], v[92:95], v[44:47]
    v_mfma_f32_16x16x32_bf16 v[60:63], v[68:71], v[92:95], v[60:63]
    s_waitcnt lgkmcnt(10)
    v_readfirstlane_b32 s47, v7
    v_add_u32 v12, s57, v10
    v_mov_b32 v13, v16
    s_cmp_ge_u32 s47, 4
    s_cbranch_scc0 L_k1_slow10
    s_waitcnt lgkmcnt(6)
    v_mfma_f32_16x16x32_bf16 v[32:35], v[72:75], v[96:99], v[32:35]
    ds_read_b128 v[64:67], v14 offset:0
    ds_read_b128 v[68:71], v14 offset:2048
    v_mfma_f32_16x16x32_bf16 v[48:51], v[76:79], v[96:99], v[48:51]
    ds_read_b64_tr_b16 v[80:81], v16 offset:16384
    ds_read_b64_tr_b16 v[82:83], v16 offset:17280
    s_waitcnt lgkmcnt(8)
    v_mfma_f32_16x16x32_bf16 v[36:39], v[72:75], v[100:103], v[36:39]
    ds_read_b64_tr_b16 v[84:85], v16 offset:16416
    ds_read_b64_tr_b16 v[86:87], v16 offset:17312
    v_mfma_f32_16x16x32_bf16 v[52:55], v[76:79], v[100:103], v[52:55]
    ds_read_b64_tr_b16 v[88:89], v16 offset:16448
    ds_read_b64_tr_b16 v[90:91], v16 offset:17344
    s_waitcnt lgkmcnt(10)
    v_mfma_f32_16x16x32_bf16 v[40:43], v[72:75], v[104:107], v[40:43]
    ds_read_b64_tr_b16 v[92:93], v16 offset:16480
    ds_read_b64_tr_b16 v[94:95], v16 offset:17376
    v_mfma_f32_16x16x32_bf16 v[56:59], v[76:79], v[104:107], v[56:59]
    s_waitcnt lgkmcnt(10)
    v_mfma_f32_16x16x32_bf16 v[44:47], v[72:75], v[108:111], v[44:47]
    v_mfma_f32_16x16x32_bf16 v[60:63], v[76:79], v[108:111], v[60:63]
    s_mov_b64 exec, 1
    ds_add_u32 v17, v8 offset:36
    s_mov_b64 exec, -1
L_k1_join10:
    v_add_u32 v17, 4, v17
    s_add_u32 s39, s39, 1
    s_cmp_lt_u32 s39, 7
    s_cbranch_scc1 L_k1_loop10
    s_branch L_k1_done10
L_k1_slow10:
    s_waitcnt lgkmcnt(6)
    v_mfma_f32_16x16x32_bf16 v[32:35], v[72:75], v[96:99], v[32:35]
    v_mfma_f32_16x16x32_bf16 v[48:51], v[76:79], v[96:99], v[48:51]
    s_waitcnt lgkmcnt(4)
    v_mfma_f32_16x16x32_bf16 v[36:39], v[72:75], v[100:103], v[36:39]
    v_mfma_f32_16x16x32_bf16 v[52:55], v[76:79], v[100:103], v[52:55]
    s_waitcnt lgkmcnt(2)
    v_mfma_f32_16x16x32_bf16 v[40:43], v[72:75], v[104:107], v[40:43]
    v_mfma_f32_16x16x32_bf16 v[56:59], v[76:79], v[104:107], v[56:59]
    s_waitcnt lgkmcnt(0)
    v_mfma_f32_16x16x32_bf16 v[44:47], v[72:75], v[108:111], v[44:47]
    v_mfma_f32_16x16x32_bf16 v[60:63], v[76:79], v[108:111], v[60:63]
    s_mov_b64 exec, 1
    ds_add_u32 v17, v8 offset:36
    s_mov_b64 exec, -1
    s_mov_b32 vcc_lo, 0
L_sp_21:
    ds_read_b32 v7, v17 offset:8
    s_waitcnt lgkmcnt(0)
    v_readfirstlane_b32 s47, v7
    s_cmp_ge_u32 s47, 4
    s_cbranch_scc1 L_ok_22
    s_sleep 1
    s_add_u32 vcc_lo, vcc_lo, 1
    s_cmp_lt_u32 vcc_lo, 0x400000
    s_cbranch_scc1 L_sp_21
L_ok_22:
    ds_read_b128 v[64:67], v14 offset:0
    ds_read_b128 v[68:71], v14 offset:2048
    ds_read_b64_tr_b16 v[80:81], v16 offset:16384
    ds_read_b64_tr_b16 v[82:83], v16 offset:17280
    ds_read_b64_tr_b16 v[84:85], v16 offset:16416
    ds_read_b64_tr_b16 v[86:87], v16 offset:17312
    ds_read_b64_tr_b16 v[88:89], v16 offset:16448
    ds_read_b64_tr_b16 v[90:91], v16 offset:17344
    ds_read_b64_tr_b16 v[92:93], v16 offset:16480
    ds_read_b64_tr_b16 v[94:95], v16 offset:17376
    s_mov_b64 exec, 1
    ds_add_u32 v6, v8 offset:60
    s_mov_b64 exec, -1
    s_branch L_k1_join10
L_k1_done10:
    s_nop 7
    v_cvt_pk_bf16_f32 v32, v32, v33
    v_cvt_pk_bf16_f32 v33, v34, v35
    buffer_store_dwordx2 v[32:33], v20, s[12:15], s52 offen offset:0
    v_cvt_pk_bf16_f32 v48, v48, v49
    v_cvt_pk_bf16_f32 v49, v50, v51
    buffer_store_dwordx2 v[48:49], v20, s[12:15], s52 offen offset:1024
    v_cvt_pk_bf16_f32 v36, v36, v37
    v_cvt_pk_bf16_f32 v37, v38, v39
    buffer_store_dwordx2 v[36:37], v21, s[12:15], s52 offen offset:0
    v_cvt_pk_bf16_f32 v52, v52, v53
    v_cvt_pk_bf16_f32 v53, v54, v55
    buffer_store_dwordx2 v[52:53], v21, s[12:15], s52 offen offset:1024
    v_cvt_pk_bf16_f32 v40, v40, v41
    v_cvt_pk_bf16_f32 v41, v42, v43
    buffer_store_dwordx2 v[40:41], v22, s[12:15], s52 offen offset:0
    v_cvt_pk_bf16_f32 v56, v56, v57
    v_cvt_pk_bf16_f32 v57, v58, v59
    buffer_store_dwordx2 v[56:57], v22, s[12:15], s52 offen offset:1024
    v_cvt_pk_bf16_f32 v44, v44, v45
    v_cvt_pk_bf16_f32 v45, v46, v47
    buffer_store_dwordx2 v[44:45], v23, s[12:15], s52 offen offset:0
    v_cvt_pk_bf16_f32 v60, v60, v61
    v_cvt_pk_bf16_f32 v61, v62, v63
    buffer_store_dwordx2 v[60:61], v23, s[12:15], s52 offen offset:1024
    s_endpgm
L_k1_t11:
    v_bfe_u32 v3, v1, 4, 1
    v_lshlrev_b32 v3, 9, v3
    v_lshrrev_b32 v4, 5, v1
    v_lshl_add_u32 v3, v4, 3, v3
    v_add_u32 v4, 64, v2
    v_mul_u32_u24 v5, 2341, v4
    v_lshrrev_b32 v5, 16, v5
    v_mul_u32_u24 v18, 28, v5
    v_sub_u32 v4, v4, v18
    v_lshl_add_u32 v5, v5, 18, v3
    v_lshl_add_u32 v20, v4, 4, v5
    v_add_u32 v4, 80, v2
    v_mul_u32_u24 v5, 2341, v4
    v_lshrrev_b32 v5, 16, v5
    v_mul_u32_u24 v18, 28, v5
    v_sub_u32 v4, v4, v18
    v_lshl_add_u32 v5, v5, 18, v3
    v_lshl_add_u32 v21, v4, 4, v5
    v_add_u32 v4, 96, v2
    v_mul_u32_u24 v5, 2341, v4
    v_lshrrev_b32 v5, 16, v5
    v_mul_u32_u24 v18, 28, v5
    v_sub_u32 v4, v4, v18
    v_lshl_add_u32 v5, v5, 18, v3
    v_lshl_add_u32 v22, v4, 4, v5
    s_lshl_b32 s52, s36, 8
    s_lshl_b32 s43, s34, 2
    s_add_u32 s52, s52, s43
    s_add_u32 s52, s52, s38
    s_lshl_b32 s52, s52, 12
    s_add_u32 s52, s52, 2099200
    v_mov_b32 v32, 0
    v_mov_b32 v33, 0
    v_mov_b32 v34, 0
    v_mov_b32 v35, 0
    v_mov_b32 v36, 0
    v_mov_b32 v37, 0
    v_mov_b32 v38, 0
    v_mov_b32 v39, 0
    v_mov_b32 v40, 0
    v_mov_b32 v41, 0
    v_mov_b32 v42, 0
    v_mov_b32 v43, 0
    v_mov_b32 v44, 0
    v_mov_b32 v45, 0
    v_mov_b32 v46, 0
    v_mov_b32 v47, 0
    v_mov_b32 v48, 0
    v_mov_b32 v49, 0
    v_mov_b32 v50, 0
    v_mov_b32 v51, 0
    v_mov_b32 v52, 0
    v_mov_b32 v53, 0
    v_mov_b32 v54, 0
    v_mov_b32 v55, 0
    v_mov_b32 v56, 0
    v_mov_b32 v57, 0
    v_mov_b32 v58, 0
    v_mov_b32 v59, 0
    v_mov_b32 v60, 0
    v_mov_b32 v61, 0
    v_mov_b32 v62, 0
    v_mov_b32 v63, 0
    v_mov_b32 v12, v10
    v_mov_b32 v13, v15
    v_mov_b32 v17, v6
    s_mov_b32 s57, 0
    s_mov_b32 s39, 0
    s_mov_b32 vcc_lo, 0
L_sp_23:
    ds_read_b32 v7, v6 offset:4
    s_waitcnt lgkmcnt(0)
    v_readfirstlane_b32 s47, v7
    s_cmp_ge_u32 s47, 4
    s_cbranch_scc1 L_ok_24
    s_sleep 1
    s_add_u32 vcc_lo, vcc_lo, 1
    s_cmp_lt_u32 vcc_lo, 0x400000
    s_cbranch_scc1 L_sp_23
L_ok_24:
    ds_read_b128 v[64:67], v9 offset:0
    ds_read_b128 v[68:71], v9 offset:2048
    ds_read_b64_tr_b16 v[80:81], v15 offset:16384
    ds_read_b64_tr_b16 v[82:83], v15 offset:17280
    ds_read_b64_tr_b16 v[84:85], v15 offset:16416
    ds_read_b64_tr_b16 v[86:87], v15 offset:17312
    ds_read_b64_tr_b16 v[88:89], v15 offset:16448
    ds_read_b64_tr_b16 v[90:91], v15 offset:17344
    s_mov_b64 exec, 1
    ds_add_u32 v6, v8 offset:60
    s_mov_b64 exec, -1
    .p2align 6
L_k1_loop11:
    s_add_u32 s57, s57, 31744
    s_cmp_eq_u32 s57, 158720
    s_cselect_b32 s57, 0, s57
    v_add_u32 v14, s57, v9
    v_add_u32 v16, s57, v15
    s_waitcnt lgkmcnt(5)
    v_mfma_f32_16x16x32_bf16 v[32:35], v[64:67], v[80:83], v[32:35]
    ds_read_b32 v7, v17 offset:8
    ds_read_b128 v[72:75], v12 offset:0
    v_mfma_f32_16x16x32_bf16 v[48:51], v[68:71], v[80:83], v[48:51]
    ds_read_b128 v[76:79], v12 offset:2048
    ds_read_b64_tr_b16 v[96:97], v13 offset:24064
    s_waitcnt lgkmcnt(7)
    v_mfma_f32_16x16x32_bf16 v[36:39], v[64:67], v[84:87], v[36:39]
    ds_read_b64_tr_b16 v[98:99], v13 offset:24960
    ds_read_b64_tr_b16 v[100:101], v13 offset:24096
    v_mfma_f32_16x16x32_bf16 v[52:55], v[68:71], v[84:87], v[52:55]
    ds_read_b64_tr_b16 v[102:103], v13 offset:24992
    ds_read_b64_tr_b16 v[104:105], v13 offset:24128
    s_waitcnt lgkmcnt(9)
    v_mfma_f32_16x16x32_bf16 v[40:43], v[64:67], v[88:91], v[40:43]
    v_mfma_f32_16x16x32_bf16 v[56:59], v[68:71], v[88:91], v[56:59]
    ds_read_b64_tr_b16 v[106:107], v13 offset:25024
    s_waitcnt lgkmcnt(8)
    v_readfirstlane_b32 s47, v7
    v_add_u32 v12, s57, v10
    v_mov_b32 v13, v16
    s_cmp_ge_u32 s47, 4
    s_cbranch_scc0 L_k1_slow11
    s_waitcnt lgkmcnt(4)
    v_mfma_f32_16x16x32_bf16 v[32:35], v[72:75], v[96:99], v[32:35]
    ds_read_b128 v[64:67], v14 offset:0
    ds_read_b128 v[68:71], v14 offset:2048
    v_mfma_f32_16x16x32_bf16 v[48:51], v[76:79], v[96:99], v[48:51]
    ds_read_b64_tr_b16 v[80:81], v16 offset:16384
    ds_read_b64_tr_b16 v[82:83], v16 offset:17280
    s_waitcnt lgkmcnt(6)
    v_mfma_f32_16x16x32_bf16 v[36:39], v[72:75], v[100:103], v[36:39]
    ds_read_b64_tr_b16 v[84:85], v16 offset:16416
    ds_read_b64_tr_b16 v[86:87], v16 offset:17312
    v_mfma_f32_16x16x32_bf16 v[52:55], v[76:79], v[100:103], v[52:55]
    ds_read_b64_tr_b16 v[88:89], v16 offset:16448
    ds_read_b64_tr_b16 v[90:91], v16 offset:17344
    s_waitcnt lgkmcnt(8)
    v_mfma_f32_16x16x32_bf16 v[40:43], v[72:75], v[104:107], v[40:43]
    v_mfma_f32_16x16x32_bf16 v[56:59], v[76:79], v[104:107], v[56:59]
    s_mov_b64 exec, 1
    ds_add_u32 v17, v8 offset:36
    s_mov_b64 exec, -1
L_k1_join11:
    v_add_u32 v17, 4, v17
    s_add_u32 s39, s39, 1
    s_cmp_lt_u32 s39, 7
    s_cbranch_scc1 L_k1_loop11
    s_branch L_k1_done11
L_k1_slow11:
    s_waitcnt lgkmcnt(4)
    v_mfma_f32_16x16x32_bf16 v[32:35], v[72:75], v[96:99], v[32:35]
    v_mfma_f32_16x16x32_bf16 v[48:51], v[76:79], v[96:99], v[48:51]
    s_waitcnt lgkmcnt(2)
    v_mfma_f32_16x16x32_bf16 v[36:39], v[72:75], v[100:103], v[36:39]
    v_mfma_f32_16x16x32_bf16 v[52:55], v[76:79], v[100:103], v[52:55]
    s_waitcnt lgkmcnt(0)
    v_mfma_f32_16x16x32_bf16 v[40:43], v[72:75], v[104:107], v[40:43]
    v_mfma_f32_16x16x32_bf16 v[56:59], v[76:79], v[104:107], v[56:59]
    s_mov_b64 exec, 1
    ds_add_u32 v17, v8 offset:36
    s_mov_b64 exec, -1
    s_mov_b32 vcc_lo, 0
L_sp_25:
    ds_read_b32 v7, v17 offset:8
    s_waitcnt lgkmcnt(0)
    v_readfirstlane_b32 s47, v7
    s_cmp_ge_u32 s47, 4
    s_cbranch_scc1 L_ok_26
    s_sleep 1
    s_add_u32 vcc_lo, vcc_lo, 1
    s_cmp_lt_u32 vcc_lo, 0x400000
    s_cbranch_scc1 L_sp_25
L_ok_26:
    ds_read_b128 v[64:67], v14 offset:0
    ds_read_b128 v[68:71], v14 offset:2048
    ds_read_b64_tr_b16 v[80:81], v16 offset:16384
    ds_read_b64_tr_b16 v[82:83], v16 offset:17280
    ds_read_b64_tr_b16 v[84:85], v16 offset:16416
    ds_read_b64_tr_b16 v[86:87], v16 offset:17312
    ds_read_b64_tr_b16 v[88:89], v16 offset:16448
    ds_read_b64_tr_b16 v[90:91], v16 offset:17344
    s_mov_b64 exec, 1
    ds_add_u32 v6, v8 offset:60
    s_mov_b64 exec, -1
    s_branch L_k1_join11
L_k1_done11:
    s_nop 7
    v_cvt_pk_bf16_f32 v32, v32, v33
    v_cvt_pk_bf16_f32 v33, v34, v35
    buffer_store_dwordx2 v[32:33], v20, s[12:15], s52 offen offset:0
    v_cvt_pk_bf16_f32 v48, v48, v49
    v_cvt_pk_bf16_f32 v49, v50, v51
    buffer_store_dwordx2 v[48:49], v20, s[12:15], s52 offen offset:1024
    v_cvt_pk_bf16_f32 v36, v36, v37
    v_cvt_pk_bf16_f32 v37, v38, v39
    buffer_store_dwordx2 v[36:37], v21, s[12:15], s52 offen offset:0
    v_cvt_pk_bf16_f32 v52, v52, v53
    v_cvt_pk_bf16_f32 v53, v54, v55
    buffer_store_dwordx2 v[52:53], v21, s[12:15], s52 offen offset:1024
    v_cvt_pk_bf16_f32 v40, v40, v41
    v_cvt_pk_bf16_f32 v41, v42, v43
    buffer_store_dwordx2 v[40:41], v22, s[12:15], s52 offen offset:0
    v_cvt_pk_bf16_f32 v56, v56, v57
    v_cvt_pk_bf16_f32 v57, v58, v59
    buffer_store_dwordx2 v[56:57], v22, s[12:15], s52 offen offset:1024
    s_endpgm
L_k1_end:
    s_endpgm

.globl k2_kernel
.p2align 8
.type k2_kernel,@function
k2_kernel:

    s_cmp_ge_u32 s2, 256
    s_cbranch_scc1 L_k2_end
    s_load_dwordx2 s[24:25], s[0:1], 72
    s_load_dwordx2 s[26:27], s[0:1], 0
    s_load_dwordx2 s[28:29], s[0:1], 48
    s_getpc_b64 s[20:21]
    s_add_u32 s20, s20, tbl_fft@rel32@lo+4
    s_addc_u32 s21, s21, tbl_fft@rel32@hi+12
    v_and_b32 v1, 63, v0
    v_lshrrev_b32 v2, 6, v0
    s_and_b32 s33, s2, 7
    s_lshl_b32 s33, s33, 1
    v_readfirstlane_b32 s30, v2
    s_bfe_u32 s34, s2, 0x10003
    s_add_u32 s31, s33, s34
    s_lshr_b32 s32, s2, 4
    s_waitcnt lgkmcnt(0)
    s_mov_b32 s4, s24
    s_and_b32 s5, s25, 0xffff
    s_mov_b32 s6, 15728640
    s_mov_b32 s7, 0x20000
    s_mov_b32 s8, s20
    s_and_b32 s9, s21, 0xffff
    s_mov_b32 s10, 73728
    s_mov_b32 s11, 0x20000
    s_mov_b32 s12, s26
    s_and_b32 s13, s27, 0xffff
    s_mov_b32 s14, 1835008
    s_mov_b32 s15, 0x20000
    s_mov_b32 s16, s28
    s_and_b32 s17, s29, 0xffff
    s_mov_b32 s18, 896
    s_mov_b32 s19, 0x20000
    s_cmp_ge_u32 s30, 8
    s_cbranch_scc1 L_k2_fft
    v_lshlrev_b32 v2, 4, v1
    s_lshl_b32 s38, s30, 11
    v_add_u32 v6, s38, v2
    s_lshl_b32 s44, s31, 18
    s_add_u32 s44, s44, 2097152
    s_and_b32 s37, s2, 0
    s_lshl_b32 s37, s37, 17
    s_mov_b32 s47, s38
    s_mov_b32 m0, s47
    s_add_u32 s36, s44, s37
    buffer_load_dwordx4 v6, s[4:7], s36 offen lds
    buffer_load_dwordx4 v6, s[4:7], s36 offen offset:1024 lds
    s_add_u32 s37, s37, 16384
    s_and_b32 s37, s37, 0x3ffff
    s_add_u32 s47, s47, 16384
    s_and_b32 s47, s47, 131071
    s_lshl_b32 s34, s31, 6
    s_lshl_b32 s33, s32, 2
    s_add_u32 s34, s34, s33
    s_lshl_b32 s34, s34, 11
    s_lshl_b32 s35, s30, 10
    s_add_u32 s34, s34, s35
    s_add_u32 m0, s35, 114688
    s_and_b32 s48, s30, 1
    buffer_load_dwordx4 v2, s[4:7], s34 offen lds
    s_mov_b32 m0, s47
    s_add_u32 s36, s44, s37
    buffer_load_dwordx4 v6, s[4:7], s36 offen lds
    buffer_load_dwordx4 v6, s[4:7], s36 offen offset:1024 lds
    s_add_u32 s37, s37, 16384
    s_and_b32 s37, s37, 0x3ffff
    s_add_u32 s47, s47, 16384
    s_and_b32 s47, s47, 131071
    s_add_u32 s37, s37, 65536
    s_and_b32 s37, s37, 0x3ffff
    s_add_u32 s47, s47, 65536
    s_lshr_b32 s40, s30, 1
    s_add_u32 s40, s40, 2
    s_and_b32 s40, s40, 3
    s_lshl_b32 s34, s40, 12
    v_add_u32 v8, s34, v2
    v_add_u32 v7, 32768, v8
    v_mov_b32 v9, 157696
    v_mov_b32 v14, 1
    v_and_b32 v4, 31, v1
    v_lshlrev_b32 v3, 2, v4
    v_add_u32 v3, 157696, v3
    v_add_u32 v4, -2, v4
    v_cmp_gt_u32 vcc, 6, v4
    v_mov_b32 v4, 0
    v_mov_b32 v15, 8
    v_cndmask_b32 v4, v4, v15, vcc
    ds_write_b32 v3, v4
    s_waitcnt lgkmcnt(0)
    s_barrier
    s_lshl_b32 s34, s48, 12
    s_add_u32 s34, s34, 114688
    v_add_u32 v3, s34, v2
    s_lshl_b32 s39, s32, 2
    s_lshl_b32 s34, s48, 1
    s_add_u32 s39, s39, s34
    v_mov_b32 v112, 0
    v_mov_b32 v113, 0
    v_mov_b32 v114, 0
    v_mov_b32 v115, 0
    v_mov_b32 v116, 0
    v_mov_b32 v117, 0
    v_mov_b32 v118, 0
    v_mov_b32 v119, 0
    v_mov_b32 v120, 0
    v_mov_b32 v121, 0
    v_mov_b32 v122, 0
    v_mov_b32 v123, 0
    v_mov_b32 v124, 0
    v_mov_b32 v125, 0
    v_mov_b32 v126, 0
    v_mov_b32 v127, 0
    v_mov_b32 v128, 0
    v_mov_b32 v129, 0
    v_mov_b32 v130, 0
    v_mov_b32 v131, 0
    v_mov_b32 v132, 0
    v_mov_b32 v133, 0
    v_mov_b32 v134, 0
    v_mov_b32 v135, 0
    v_mov_b32 v136, 0
    v_mov_b32 v137, 0
    v_mov_b32 v138, 0
    v_mov_b32 v139, 0
    v_mov_b32 v140, 0
    v_mov_b32 v141, 0
    v_mov_b32 v142, 0
    v_mov_b32 v143, 0
    v_mov_b32 v104, 0
    v_mov_b32 v105, 0
    v_mov_b32 v106, 0
    v_mov_b32 v107, 0
    v_mov_b32 v108, 0
    v_mov_b32 v109, 0
    v_mov_b32 v110, 0
    v_mov_b32 v111, 0
    v_mov_b32 v56, 0
    v_mov_b32 v57, 0
    v_mov_b32 v58, 0
    v_mov_b32 v59, 0
    v_mov_b32 v60, 0
    v_mov_b32 v61, 0
    v_mov_b32 v62, 0
    v_mov_b32 v63, 0
    s_waitcnt vmcnt(0)
    s_mov_b64 exec, 1
    ds_add_u32 v9, v14 offset:64
    s_mov_b64 exec, -1
L_k2_b0:
    ds_read_b32 v15, v9 offset:64
    s_waitcnt lgkmcnt(0)
    v_readfirstlane_b32 s45, v15
    s_cmp_ge_u32 s45, 8
    s_cbranch_scc0 L_k2_b0
    ds_read_b128 v[32:35], v8 offset:0
    ds_read_b128 v[36:39], v8 offset:1024
    ds_read_b128 v[16:19], v3 offset:0
    ds_read_b128 v[20:23], v3 offset:1024
    ds_read_b128 v[24:27], v3 offset:2048
    ds_read_b128 v[28:31], v3 offset:3072
    s_mov_b32 s46, 0
    s_waitcnt lgkmcnt(0)
    v_mfma_f32_32x32x16_bf16 v[64:79], v[32:35], v[16:19], 0
    v_mfma_f32_32x32x16_bf16 v[64:79], v[36:39], v[20:23], v[64:79]
    s_nop 7
    .p2align 6
L_k2_loop0:
    ds_read_b128 v[40:43], v8 offset:16384
    ds_read_b128 v[44:47], v8 offset:17408
    ds_read_b128 v[48:51], v8 offset:2048
    ds_read_b128 v[52:55], v8 offset:3072
    v_exp_f32 v64, v64
    v_mfma_f32_32x32x16_bf16 v[80:95], v[32:35], v[24:27], 0
    v_exp_f32 v65, v65
    v_exp_f32 v66, v66
    v_exp_f32 v67, v67
    v_cvt_pk_bf16_f32 v96, v64, v65
    v_cvt_pk_bf16_f32 v97, v66, v67
    v_exp_f32 v68, v68
    v_mfma_f32_32x32x16_bf16 v[128:143], v[56:59], v[104:107], v[128:143]
    v_exp_f32 v69, v69
    v_exp_f32 v70, v70
    v_exp_f32 v71, v71
    v_cvt_pk_bf16_f32 v98, v68, v69
    v_cvt_pk_bf16_f32 v99, v70, v71
    v_exp_f32 v72, v72
    v_mfma_f32_32x32x16_bf16 v[80:95], v[36:39], v[28:31], v[80:95]
    v_exp_f32 v73, v73
    v_exp_f32 v74, v74
    v_exp_f32 v75, v75
    v_cvt_pk_bf16_f32 v100, v72, v73
    v_cvt_pk_bf16_f32 v101, v74, v75
    v_exp_f32 v76, v76
    v_mfma_f32_32x32x16_bf16 v[128:143], v[60:63], v[108:111], v[128:143]
    v_exp_f32 v77, v77
    v_exp_f32 v78, v78
    v_exp_f32 v79, v79
    v_cvt_pk_bf16_f32 v102, v76, v77
    v_cvt_pk_bf16_f32 v103, v78, v79
    s_waitcnt vmcnt(4)
    s_mov_b64 exec, 1
    ds_add_u32 v9, v14
    s_mov_b64 exec, -1
    s_waitcnt lgkmcnt(1)
    v_exp_f32 v80, v80
    v_mfma_f32_32x32x16_bf16 v[64:79], v[40:43], v[16:19], 0
    v_exp_f32 v81, v81
    v_exp_f32 v82, v82
    v_exp_f32 v83, v83
    v_cvt_pk_bf16_f32 v104, v80, v81
    v_cvt_pk_bf16_f32 v105, v82, v83
    v_exp_f32 v84, v84
    v_mfma_f32_32x32x16_bf16 v[112:127], v[48:51], v[96:99], v[112:127]
    v_exp_f32 v85, v85
    v_exp_f32 v86, v86
    v_exp_f32 v87, v87
    v_cvt_pk_bf16_f32 v106, v84, v85
    v_cvt_pk_bf16_f32 v107, v86, v87
    ds_read_b32 v15, v9
    v_exp_f32 v88, v88
    v_mfma_f32_32x32x16_bf16 v[64:79], v[44:47], v[20:23], v[64:79]
    v_exp_f32 v89, v89
    v_exp_f32 v90, v90
    v_exp_f32 v91, v91
    v_cvt_pk_bf16_f32 v108, v88, v89
    v_cvt_pk_bf16_f32 v109, v90, v91
    v_exp_f32 v92, v92
    v_mfma_f32_32x32x16_bf16 v[112:127], v[52:55], v[100:103], v[112:127]
    v_exp_f32 v93, v93
    v_exp_f32 v94, v94
    v_exp_f32 v95, v95
    v_cvt_pk_bf16_f32 v110, v92, v93
    v_cvt_pk_bf16_f32 v111, v94, v95
    s_waitcnt lgkmcnt(0)
    v_readfirstlane_b32 s45, v15
    s_cmp_ge_u32 s45, 16
    s_cbranch_scc0 L_k2_spin0
L_k2_flagok0:
    ds_read_b128 v[32:35], v7 offset:0
    ds_read_b128 v[36:39], v7 offset:1024
    ds_read_b128 v[56:59], v8 offset:18432
    ds_read_b128 v[60:63], v8 offset:19456
    v_exp_f32 v64, v64
    v_mfma_f32_32x32x16_bf16 v[80:95], v[40:43], v[24:27], 0
    v_exp_f32 v65, v65
    v_exp_f32 v66, v66
    v_exp_f32 v67, v67
    v_cvt_pk_bf16_f32 v96, v64, v65
    v_cvt_pk_bf16_f32 v97, v66, v67
    v_exp_f32 v68, v68
    v_mfma_f32_32x32x16_bf16 v[128:143], v[48:51], v[104:107], v[128:143]
    v_exp_f32 v69, v69
    v_exp_f32 v70, v70
    v_exp_f32 v71, v71
    v_cvt_pk_bf16_f32 v98, v68, v69
    v_cvt_pk_bf16_f32 v99, v70, v71
    s_mov_b32 m0, s47
    s_add_u32 s36, s44, s37
    buffer_load_dwordx4 v6, s[4:7], s36 offen lds
    buffer_load_dwordx4 v6, s[4:7], s36 offen offset:1024 lds
    s_add_u32 s37, s37, 16384
    s_and_b32 s37, s37, 0x3ffff
    s_add_u32 s47, s47, 16384
    s_and_b32 s47, s47, 131071
    v_exp_f32 v72, v72
    v_mfma_f32_32x32x16_bf16 v[80:95], v[44:47], v[28:31], v[80:95]
    v_exp_f32 v73, v73
    v_exp_f32 v74, v74
    v_exp_f32 v75, v75
    v_cvt_pk_bf16_f32 v100, v72, v73
    v_cvt_pk_bf16_f32 v101, v74, v75
    v_exp_f32 v76, v76
    v_mfma_f32_32x32x16_bf16 v[128:143], v[52:55], v[108:111], v[128:143]
    v_exp_f32 v77, v77
    v_exp_f32 v78, v78
    v_exp_f32 v79, v79
    v_cvt_pk_bf16_f32 v102, v76, v77
    v_cvt_pk_bf16_f32 v103, v78, v79
    s_waitcnt lgkmcnt(0)
    v_exp_f32 v80, v80
    v_mfma_f32_32x32x16_bf16 v[64:79], v[32:35], v[16:19], 0
    v_exp_f32 v81, v81
    v_exp_f32 v82, v82
    v_exp_f32 v83, v83
    v_cvt_pk_bf16_f32 v104, v80, v81
    v_cvt_pk_bf16_f32 v105, v82, v83
    v_exp_f32 v84, v84
    v_mfma_f32_32x32x16_bf16 v[112:127], v[56:59], v[96:99], v[112:127]
    v_exp_f32 v85, v85
    v_exp_f32 v86, v86
    v_exp_f32 v87, v87
    v_cvt_pk_bf16_f32 v106, v84, v85
    v_cvt_pk_bf16_f32 v107, v86, v87
    s_mov_b32 m0, s47
    s_add_u32 s36, s44, s37
    buffer_load_dwordx4 v6, s[4:7], s36 offen lds
    buffer_load_dwordx4 v6, s[4:7], s36 offen offset:1024 lds
    s_add_u32 s37, s37, 16384
    s_and_b32 s37, s37, 0x3ffff
    s_add_u32 s47, s47, 16384
    s_and_b32 s47, s47, 131071
    v_exp_f32 v88, v88
    v_mfma_f32_32x32x16_bf16 v[64:79], v[36:39], v[20:23], v[64:79]
    v_exp_f32 v89, v89
    v_exp_f32 v90, v90
    v_exp_f32 v91, v91
    v_cvt_pk_bf16_f32 v108, v88, v89
    v_cvt_pk_bf16_f32 v109, v90, v91
    v_mov_b32 v8, v7
    v_add_u32 v7, 32768, v7
    v_and_b32 v7, 131071, v7
    v_add_u32 v9, 4, v9
    s_add_u32 s46, s46, 1
    v_exp_f32 v92, v92
    v_mfma_f32_32x32x16_bf16 v[112:127], v[60:63], v[100:103], v[112:127]
    v_exp_f32 v93, v93
    v_exp_f32 v94, v94
    v_exp_f32 v95, v95
    v_cvt_pk_bf16_f32 v110, v92, v93
    v_cvt_pk_bf16_f32 v111, v94, v95
    s_cmp_lt_u32 s46, 5
    s_cbranch_scc1 L_k2_loop0
    .p2align 6
L_k2_loop1:
    ds_read_b128 v[40:43], v8 offset:16384
    ds_read_b128 v[44:47], v8 offset:17408
    ds_read_b128 v[48:51], v8 offset:2048
    ds_read_b128 v[52:55], v8 offset:3072
    v_exp_f32 v64, v64
    v_mfma_f32_32x32x16_bf16 v[80:95], v[32:35], v[24:27], 0
    v_exp_f32 v65, v65
    v_exp_f32 v66, v66
    v_exp_f32 v67, v67
    v_cvt_pk_bf16_f32 v96, v64, v65
    v_cvt_pk_bf16_f32 v97, v66, v67
    v_exp_f32 v68, v68
    v_mfma_f32_32x32x16_bf16 v[128:143], v[56:59], v[104:107], v[128:143]
    v_exp_f32 v69, v69
    v_exp_f32 v70, v70
    v_exp_f32 v71, v71
    v_cvt_pk_bf16_f32 v98, v68, v69
    v_cvt_pk_bf16_f32 v99, v70, v71
    v_exp_f32 v72, v72
    v_mfma_f32_32x32x16_bf16 v[80:95], v[36:39], v[28:31], v[80:95]
    v_exp_f32 v73, v73
    v_exp_f32 v74, v74
    v_exp_f32 v75, v75
    v_cvt_pk_bf16_f32 v100, v72, v73
    v_cvt_pk_bf16_f32 v101, v74, v75
    v_exp_f32 v76, v76
    v_mfma_f32_32x32x16_bf16 v[128:143], v[60:63], v[108:111], v[128:143]
    v_exp_f32 v77, v77
    v_exp_f32 v78, v78
    v_exp_f32 v79, v79
    v_cvt_pk_bf16_f32 v102, v76, v77
    v_cvt_pk_bf16_f32 v103, v78, v79
    s_waitcnt vmcnt(0)
    s_mov_b64 exec, 1
    ds_add_u32 v9, v14
    s_mov_b64 exec, -1
    s_waitcnt lgkmcnt(1)
    v_exp_f32 v80, v80
    v_mfma_f32_32x32x16_bf16 v[64:79], v[40:43], v[16:19], 0
    v_exp_f32 v81, v81
    v_exp_f32 v82, v82
    v_exp_f32 v83, v83
    v_cvt_pk_bf16_f32 v104, v80, v81
    v_cvt_pk_bf16_f32 v105, v82, v83
    v_exp_f32 v84, v84
    v_mfma_f32_32x32x16_bf16 v[112:127], v[48:51], v[96:99], v[112:127]
    v_exp_f32 v85, v85
    v_exp_f32 v86, v86
    v_exp_f32 v87, v87
    v_cvt_pk_bf16_f32 v106, v84, v85
    v_cvt_pk_bf16_f32 v107, v86, v87
    ds_read_b32 v15, v9
    v_exp_f32 v88, v88
    v_mfma_f32_32x32x16_bf16 v[64:79], v[44:47], v[20:23], v[64:79]
    v_exp_f32 v89, v89
    v_exp_f32 v90, v90
    v_exp_f32 v91, v91
    v_cvt_pk_bf16_f32 v108, v88, v89
    v_cvt_pk_bf16_f32 v109, v90, v91
    v_exp_f32 v92, v92
    v_mfma_f32_32x32x16_bf16 v[112:127], v[52:55], v[100:103], v[112:127]
    v_exp_f32 v93, v93
    v_exp_f32 v94, v94
    v_exp_f32 v95, v95
    v_cvt_pk_bf16_f32 v110, v92, v93
    v_cvt_pk_bf16_f32 v111, v94, v95
    s_waitcnt lgkmcnt(0)
    v_readfirstlane_b32 s45, v15
    s_cmp_ge_u32 s45, 16
    s_cbranch_scc0 L_k2_spin1
L_k2_flagok1:
    ds_read_b128 v[32:35], v7 offset:0
    ds_read_b128 v[36:39], v7 offset:1024
    ds_read_b128 v[56:59], v8 offset:18432
    ds_read_b128 v[60:63], v8 offset:19456
    v_exp_f32 v64, v64
    v_mfma_f32_32x32x16_bf16 v[80:95], v[40:43], v[24:27], 0
    v_exp_f32 v65, v65
    v_exp_f32 v66, v66
    v_exp_f32 v67, v67
    v_cvt_pk_bf16_f32 v96, v64, v65
    v_cvt_pk_bf16_f32 v97, v66, v67
    v_exp_f32 v68, v68
    v_mfma_f32_32x32x16_bf16 v[128:143], v[48:51], v[104:107], v[128:143]
    v_exp_f32 v69, v69
    v_exp_f32 v70, v70
    v_exp_f32 v71, v71
    v_cvt_pk_bf16_f32 v98, v68, v69
    v_cvt_pk_bf16_f32 v99, v70, v71
    v_exp_f32 v72, v72
    v_mfma_f32_32x32x16_bf16 v[80:95], v[44:47], v[28:31], v[80:95]
    v_exp_f32 v73, v73
    v_exp_f32 v74, v74
    v_exp_f32 v75, v75
    v_cvt_pk_bf16_f32 v100, v72, v73
    v_cvt_pk_bf16_f32 v101, v74, v75
    v_exp_f32 v76, v76
    v_mfma_f32_32x32x16_bf16 v[128:143], v[52:55], v[108:111], v[128:143]
    v_exp_f32 v77, v77
    v_exp_f32 v78, v78
    v_exp_f32 v79, v79
    v_cvt_pk_bf16_f32 v102, v76, v77
    v_cvt_pk_bf16_f32 v103, v78, v79
    s_waitcnt lgkmcnt(0)
    v_exp_f32 v80, v80
    v_mfma_f32_32x32x16_bf16 v[64:79], v[32:35], v[16:19], 0
    v_exp_f32 v81, v81
    v_exp_f32 v82, v82
    v_exp_f32 v83, v83
    v_cvt_pk_bf16_f32 v104, v80, v81
    v_cvt_pk_bf16_f32 v105, v82, v83
    v_exp_f32 v84, v84
    v_mfma_f32_32x32x16_bf16 v[112:127], v[56:59], v[96:99], v[112:127]
    v_exp_f32 v85, v85
    v_exp_f32 v86, v86
    v_exp_f32 v87, v87
    v_cvt_pk_bf16_f32 v106, v84, v85
    v_cvt_pk_bf16_f32 v107, v86, v87
    v_exp_f32 v88, v88
    v_mfma_f32_32x32x16_bf16 v[64:79], v[36:39], v[20:23], v[64:79]
    v_exp_f32 v89, v89
    v_exp_f32 v90, v90
    v_exp_f32 v91, v91
    v_cvt_pk_bf16_f32 v108, v88, v89
    v_cvt_pk_bf16_f32 v109, v90, v91
    v_mov_b32 v8, v7
    v_add_u32 v7, 32768, v7
    v_and_b32 v7, 131071, v7
    v_add_u32 v9, 4, v9
    s_add_u32 s46, s46, 1
    v_exp_f32 v92, v92
    v_mfma_f32_32x32x16_bf16 v[112:127], v[60:63], v[100:103], v[112:127]
    v_exp_f32 v93, v93
    v_exp_f32 v94, v94
    v_exp_f32 v95, v95
    v_cvt_pk_bf16_f32 v110, v92, v93
    v_cvt_pk_bf16_f32 v111, v94, v95
    s_cmp_lt_u32 s46, 8
    s_cbranch_scc1 L_k2_loop1
    s_branch L_k2_loopdone
L_k2_spin0:
    s_sleep 1
    ds_read_b32 v15, v9
    s_waitcnt lgkmcnt(0)
    v_readfirstlane_b32 s45, v15
    s_cmp_ge_u32 s45, 16
    s_cbranch_scc0 L_k2_spin0
    s_branch L_k2_flagok0
L_k2_spin1:
    s_sleep 1
    ds_read_b32 v15, v9
    s_waitcnt lgkmcnt(0)
    v_readfirstlane_b32 s45, v15
    s_cmp_ge_u32 s45, 16
    s_cbranch_scc0 L_k2_spin1
    s_branch L_k2_flagok1
L_k2_loopdone:
    v_mfma_f32_32x32x16_bf16 v[128:143], v[56:59], v[104:107], v[128:143]
    v_mfma_f32_32x32x16_bf16 v[128:143], v[60:63], v[108:111], v[128:143]
    s_mul_i32 s33, s48, 24576
    v_lshlrev_b32 v2, 4, v1
    v_add_u32 v2, s33, v2
    s_lshl_b32 s33, s48, 3
    s_add_u32 s33, s33, 157776
    v_mov_b32 v9, s33
    s_cmp_ge_u32 s40, 2
    s_cbranch_scc1 L_k2_send2
    s_cmp_eq_u32 s40, 1
    s_cbranch_scc1 L_k2_own1
L_k2_own0:
    s_nop 7
    ds_write_b128 v2, v[128:131] offset:12288
    ds_write_b128 v2, v[132:135] offset:13312
    ds_write_b128 v2, v[136:139] offset:14336
    ds_write_b128 v2, v[140:143] offset:15360
    s_waitcnt lgkmcnt(0)
    s_mov_b64 exec, 1
    ds_add_u32 v9, v14 offset:4
    s_mov_b64 exec, -1
L_k2_e0w:
    ds_read_b32 v15, v9 offset:32
    s_waitcnt lgkmcnt(0)
    v_readfirstlane_b32 s45, v15
    s_cmp_ge_u32 s45, 2
    s_cbranch_scc1 L_k2_e0k
    s_sleep 1
    s_branch L_k2_e0w
L_k2_e0k:
    ds_read_b128 v[48:51], v2 offset:4096
    ds_read_b128 v[52:55], v2 offset:5120
    ds_read_b128 v[56:59], v2 offset:6144
    ds_read_b128 v[60:63], v2 offset:7168
    ds_read_b128 v[64:67], v2 offset:8192
    ds_read_b128 v[68:71], v2 offset:9216
    ds_read_b128 v[72:75], v2 offset:10240
    ds_read_b128 v[76:79], v2 offset:11264
    v_lshrrev_b32 v3, 5, v1
    s_mul_i32 s34, s31, 7
    v_add_u32 v3, s34, v3
    v_and_b32 v4, 1, v3
    v_lshrrev_b32 v3, 1, v3
    v_lshlrev_b32 v3, 9, v3
    v_lshl_add_u32 v3, v4, 3, v3
    v_and_b32 v4, 31, v1
    v_lshl_add_u32 v10, v4, 4, v3
    v_mov_b32 v4, 0x7fffffff
    v_cmp_gt_u32 vcc, 32, v1
    s_add_u32 s39, s39, 0
    s_mul_i32 s34, s39, 28672
    s_add_u32 s34, s34, 10485760
    v_cndmask_b32 v11, v4, v10, vcc
    s_mov_b32 s40, 0
L_k2_p0w:
    ds_read_b32 v15, v9 offset:0
    s_waitcnt lgkmcnt(0)
    v_readfirstlane_b32 s45, v15
    s_cmp_ge_u32 s45, 1
    s_cbranch_scc1 L_k2_p0k
    s_sleep 1
    s_branch L_k2_p0w
L_k2_p0k:
    ds_read_b128 v[32:35], v2 offset:0
    ds_read_b128 v[36:39], v2 offset:1024
    ds_read_b128 v[40:43], v2 offset:2048
    ds_read_b128 v[44:47], v2 offset:3072
    v_pk_add_f32 v[112:113], v[112:113], v[48:49]
    v_pk_add_f32 v[114:115], v[114:115], v[50:51]
    v_pk_add_f32 v[116:117], v[116:117], v[52:53]
    v_pk_add_f32 v[118:119], v[118:119], v[54:55]
    v_pk_add_f32 v[120:121], v[120:121], v[56:57]
    v_pk_add_f32 v[122:123], v[122:123], v[58:59]
    v_pk_add_f32 v[124:125], v[124:125], v[60:61]
    v_pk_add_f32 v[126:127], v[126:127], v[62:63]
    v_pk_add_f32 v[112:113], v[112:113], v[64:65]
    v_pk_add_f32 v[114:115], v[114:115], v[66:67]
    v_pk_add_f32 v[116:117], v[116:117], v[68:69]
    v_pk_add_f32 v[118:119], v[118:119], v[70:71]
    v_pk_add_f32 v[120:121], v[120:121], v[72:73]
    v_pk_add_f32 v[122:123], v[122:123], v[74:75]
    v_pk_add_f32 v[124:125], v[124:125], v[76:77]
    v_pk_add_f32 v[126:127], v[126:127], v[78:79]
    s_waitcnt lgkmcnt(0)
    v_pk_add_f32 v[112:113], v[112:113], v[32:33]
    v_pk_add_f32 v[114:115], v[114:115], v[34:35]
    v_pk_add_f32 v[116:117], v[116:117], v[36:37]
    v_pk_add_f32 v[118:119], v[118:119], v[38:39]
    v_pk_add_f32 v[120:121], v[120:121], v[40:41]
    v_pk_add_f32 v[122:123], v[122:123], v[42:43]
    v_pk_add_f32 v[124:125], v[124:125], v[44:45]
    v_pk_add_f32 v[126:127], v[126:127], v[46:47]
    s_branch L_k2_final
L_k2_send2:
    s_sub_u32 s33, s40, 1
    s_lshl_b32 s33, s33, 12
    v_add_u32 v2, s33, v2
    s_nop 7
    ds_write_b128 v2, v[112:115] offset:0
    ds_write_b128 v2, v[116:119] offset:1024
    ds_write_b128 v2, v[120:123] offset:2048
    ds_write_b128 v2, v[124:127] offset:3072
    ds_write_b128 v2, v[128:131] offset:12288
    ds_write_b128 v2, v[132:135] offset:13312
    ds_write_b128 v2, v[136:139] offset:14336
    ds_write_b128 v2, v[140:143] offset:15360
    s_waitcnt lgkmcnt(0)
    s_mov_b64 exec, 1
    ds_add_u32 v9, v14 offset:32
    ds_add_u32 v9, v14 offset:36
    s_mov_b64 exec, -1
    s_waitcnt lgkmcnt(0)
    s_endpgm
L_k2_own1:
    s_nop 7
    ds_write_b128 v2, v[112:115] offset:0
    ds_write_b128 v2, v[116:119] offset:1024
    ds_write_b128 v2, v[120:123] offset:2048
    ds_write_b128 v2, v[124:127] offset:3072
    s_waitcnt lgkmcnt(0)
    s_mov_b64 exec, 1
    ds_add_u32 v9, v14 offset:0
    s_mov_b64 exec, -1
L_k2_e1w:
    ds_read_b32 v15, v9 offset:36
    s_waitcnt lgkmcnt(0)
    v_readfirstlane_b32 s45, v15
    s_cmp_ge_u32 s45, 2
    s_cbranch_scc1 L_k2_e1k
    s_sleep 1
    s_branch L_k2_e1w
L_k2_e1k:
    ds_read_b128 v[48:51], v2 offset:16384
    ds_read_b128 v[52:55], v2 offset:17408
    ds_read_b128 v[56:59], v2 offset:18432
    ds_read_b128 v[60:63], v2 offset:19456
    ds_read_b128 v[64:67], v2 offset:20480
    ds_read_b128 v[68:71], v2 offset:21504
    ds_read_b128 v[72:75], v2 offset:22528
    ds_read_b128 v[76:79], v2 offset:23552
    v_lshrrev_b32 v3, 5, v1
    s_mul_i32 s34, s31, 7
    v_add_u32 v3, s34, v3
    v_and_b32 v4, 1, v3
    v_lshrrev_b32 v3, 1, v3
    v_lshlrev_b32 v3, 9, v3
    v_lshl_add_u32 v3, v4, 3, v3
    v_and_b32 v4, 31, v1
    v_lshl_add_u32 v10, v4, 4, v3
    v_mov_b32 v4, 0x7fffffff
    v_cmp_gt_u32 vcc, 32, v1
    s_add_u32 s39, s39, 1
    s_mul_i32 s34, s39, 28672
    s_add_u32 s34, s34, 10485760
    v_cndmask_b32 v11, v4, v10, vcc
    s_mov_b32 s40, 1
L_k2_p1w:
    ds_read_b32 v15, v9 offset:4
    s_waitcnt lgkmcnt(0)
    v_readfirstlane_b32 s45, v15
    s_cmp_ge_u32 s45, 1
    s_cbranch_scc1 L_k2_p1k
    s_sleep 1
    s_branch L_k2_p1w
L_k2_p1k:
    ds_read_b128 v[32:35], v2 offset:12288
    ds_read_b128 v[36:39], v2 offset:13312
    ds_read_b128 v[40:43], v2 offset:14336
    ds_read_b128 v[44:47], v2 offset:15360
    v_pk_add_f32 v[112:113], v[128:129], v[48:49]
    v_pk_add_f32 v[114:115], v[130:131], v[50:51]
    v_pk_add_f32 v[116:117], v[132:133], v[52:53]
    v_pk_add_f32 v[118:119], v[134:135], v[54:55]
    v_pk_add_f32 v[120:121], v[136:137], v[56:57]
    v_pk_add_f32 v[122:123], v[138:139], v[58:59]
    v_pk_add_f32 v[124:125], v[140:141], v[60:61]
    v_pk_add_f32 v[126:127], v[142:143], v[62:63]
    v_pk_add_f32 v[112:113], v[112:113], v[64:65]
    v_pk_add_f32 v[114:115], v[114:115], v[66:67]
    v_pk_add_f32 v[116:117], v[116:117], v[68:69]
    v_pk_add_f32 v[118:119], v[118:119], v[70:71]
    v_pk_add_f32 v[120:121], v[120:121], v[72:73]
    v_pk_add_f32 v[122:123], v[122:123], v[74:75]
    v_pk_add_f32 v[124:125], v[124:125], v[76:77]
    v_pk_add_f32 v[126:127], v[126:127], v[78:79]
    s_waitcnt lgkmcnt(0)
    v_pk_add_f32 v[112:113], v[112:113], v[32:33]
    v_pk_add_f32 v[114:115], v[114:115], v[34:35]
    v_pk_add_f32 v[116:117], v[116:117], v[36:37]
    v_pk_add_f32 v[118:119], v[118:119], v[38:39]
    v_pk_add_f32 v[120:121], v[120:121], v[40:41]
    v_pk_add_f32 v[122:123], v[122:123], v[42:43]
    v_pk_add_f32 v[124:125], v[124:125], v[44:45]
    v_pk_add_f32 v[126:127], v[126:127], v[46:47]
L_k2_final:
    v_mov_b32 v14, v124
    v_mov_b32 v15, v124
    v_pk_mul_f32 v[2:3], v[124:125], 0
    v_pk_mul_f32 v[4:5], v[112:113], 0
    v_permlane32_swap_b32 v14, v15
    v_pk_fma_f32 v[2:3], v[126:127], 0, v[2:3]
    v_pk_fma_f32 v[4:5], v[114:115], 0, v[4:5]
    v_pk_fma_f32 v[4:5], v[116:117], 0, v[4:5]
    v_pk_fma_f32 v[4:5], v[118:119], 0, v[4:5]
    v_pk_fma_f32 v[4:5], v[120:121], 0, v[4:5]
    v_pk_fma_f32 v[4:5], v[122:123], 0, v[4:5]
    v_rcp_f32 v14, v15
    v_add_f32 v2, v2, v3
    v_cmp_gt_u32 vcc, 32, v1
    v_add_f32 v4, v4, v5
    v_add_f32 v4, v4, v15
    v_cndmask_b32 v2, 0, v2, vcc
    v_mov_b32 v15, v14
    v_add_f32 v4, v4, v2
    s_cmp_eq_u32 s40, 2
    s_cbranch_scc1 L_k2_store
    v_mov_b32 v2, 864026624
    v_cmp_ngt_f32 vcc, v4, v2
    v_mov_b32 v2, 1400897536
    v_cmp_nlt_f32 s[42:43], v4, v2
    s_or_b64 vcc, vcc, s[42:43]
    s_cbranch_vccnz L_k2_fallback
L_k2_store:
    v_pk_mul_f32 v[112:113], v[112:113], v[14:15]
    v_pk_mul_f32 v[114:115], v[114:115], v[14:15]
    v_cvt_pk_bf16_f32 v112, v112, v113
    v_cvt_pk_bf16_f32 v113, v114, v115
    buffer_store_dwordx2 v[112:113], v10, s[4:7], s34 offen offset:0
    v_pk_mul_f32 v[116:117], v[116:117], v[14:15]
    v_pk_mul_f32 v[118:119], v[118:119], v[14:15]
    v_cvt_pk_bf16_f32 v116, v116, v117
    v_cvt_pk_bf16_f32 v117, v118, v119
    buffer_store_dwordx2 v[116:117], v10, s[4:7], s34 offen offset:512
    v_pk_mul_f32 v[120:121], v[120:121], v[14:15]
    v_pk_mul_f32 v[122:123], v[122:123], v[14:15]
    v_cvt_pk_bf16_f32 v120, v120, v121
    v_cvt_pk_bf16_f32 v121, v122, v123
    buffer_store_dwordx2 v[120:121], v10, s[4:7], s34 offen offset:1024
    v_pk_mul_f32 v[124:125], v[124:125], v[14:15]
    v_pk_mul_f32 v[126:127], v[126:127], v[14:15]
    v_cvt_pk_bf16_f32 v124, v124, v125
    v_cvt_pk_bf16_f32 v125, v126, v127
    buffer_store_dwordx2 v[124:125], v11, s[4:7], s34 offen offset:1536
    s_endpgm
L_k2_fallback:
    s_cmp_eq_u32 s40, 0
    s_cbranch_scc1 L_k2_fbq
    v_mov_b32 v16, v24
    v_mov_b32 v17, v25
    v_mov_b32 v18, v26
    v_mov_b32 v19, v27
    v_mov_b32 v20, v28
    v_mov_b32 v21, v29
    v_mov_b32 v22, v30
    v_mov_b32 v23, v31
L_k2_fbq:
    s_mov_b32 s40, 2
    s_lshl_b32 s37, s31, 18
    s_add_u32 s37, s37, 2097152
    v_lshlrev_b32 v2, 4, v1
    v_mov_b32 v6, 0xff800000
    s_mov_b32 s41, 0
    v_mov_b32 v112, 0
    v_mov_b32 v113, 0
    v_mov_b32 v114, 0
    v_mov_b32 v115, 0
    v_mov_b32 v116, 0
    v_mov_b32 v117, 0
    v_mov_b32 v118, 0
    v_mov_b32 v119, 0
    v_mov_b32 v120, 0
    v_mov_b32 v121, 0
    v_mov_b32 v122, 0
    v_mov_b32 v123, 0
    v_mov_b32 v124, 0
    v_mov_b32 v125, 0
    v_mov_b32 v126, 0
    v_mov_b32 v127, 0
L_k2_fbloop:
    buffer_load_dwordx4 v[32:35], v2, s[4:7], s37 offen offset:0
    buffer_load_dwordx4 v[36:39], v2, s[4:7], s37 offen offset:1024
    buffer_load_dwordx4 v[48:51], v2, s[4:7], s37 offen offset:2048
    buffer_load_dwordx4 v[52:55], v2, s[4:7], s37 offen offset:3072
    s_waitcnt vmcnt(0)
    v_mfma_f32_32x32x16_bf16 v[64:79], v[32:35], v[16:19], 0
    v_mfma_f32_32x32x16_bf16 v[64:79], v[36:39], v[20:23], v[64:79]
    s_nop 15
    s_nop 3
    v_mov_b32 v7, v6
    v_max3_f32 v7, v64, v65, v7
    v_max3_f32 v7, v66, v67, v7
    v_max3_f32 v7, v68, v69, v7
    v_max3_f32 v7, v70, v71, v7
    v_max3_f32 v7, v72, v73, v7
    v_max3_f32 v7, v74, v75, v7
    v_max3_f32 v7, v76, v77, v7
    v_max3_f32 v7, v78, v79, v7
    v_mov_b32 v3, v7
    v_mov_b32 v4, v7
    s_nop 1
    v_permlane32_swap_b32 v3, v4
    s_nop 1
    v_max3_f32 v7, v7, v3, v4
    v_sub_f32 v8, v6, v7
    v_exp_f32 v8, v8
    v_mov_b32 v6, v7
    v_sub_f32 v64, v64, v7
    v_exp_f32 v64, v64
    v_sub_f32 v65, v65, v7
    v_exp_f32 v65, v65
    v_sub_f32 v66, v66, v7
    v_exp_f32 v66, v66
    v_sub_f32 v67, v67, v7
    v_exp_f32 v67, v67
    v_sub_f32 v68, v68, v7
    v_exp_f32 v68, v68
    v_sub_f32 v69, v69, v7
    v_exp_f32 v69, v69
    v_sub_f32 v70, v70, v7
    v_exp_f32 v70, v70
    v_sub_f32 v71, v71, v7
    v_exp_f32 v71, v71
    v_sub_f32 v72, v72, v7
    v_exp_f32 v72, v72
    v_sub_f32 v73, v73, v7
    v_exp_f32 v73, v73
    v_sub_f32 v74, v74, v7
    v_exp_f32 v74, v74
    v_sub_f32 v75, v75, v7
    v_exp_f32 v75, v75
    v_sub_f32 v76, v76, v7
    v_exp_f32 v76, v76
    v_sub_f32 v77, v77, v7
    v_exp_f32 v77, v77
    v_sub_f32 v78, v78, v7
    v_exp_f32 v78, v78
    v_sub_f32 v79, v79, v7
    v_exp_f32 v79, v79
    v_mul_f32 v112, v112, v8
    v_mul_f32 v113, v113, v8
    v_mul_f32 v114, v114, v8
    v_mul_f32 v115, v115, v8
    v_mul_f32 v116, v116, v8
    v_mul_f32 v117, v117, v8
    v_mul_f32 v118, v118, v8
    v_mul_f32 v119, v119, v8
    v_mul_f32 v120, v120, v8
    v_mul_f32 v121, v121, v8
    v_mul_f32 v122, v122, v8
    v_mul_f32 v123, v123, v8
    v_mul_f32 v124, v124, v8
    v_mul_f32 v125, v125, v8
    v_mul_f32 v126, v126, v8
    v_mul_f32 v127, v127, v8
    v_cvt_pk_bf16_f32 v96, v64, v65
    v_cvt_pk_bf16_f32 v97, v66, v67
    v_cvt_pk_bf16_f32 v98, v68, v69
    v_cvt_pk_bf16_f32 v99, v70, v71
    v_cvt_pk_bf16_f32 v100, v72, v73
    v_cvt_pk_bf16_f32 v101, v74, v75
    v_cvt_pk_bf16_f32 v102, v76, v77
    v_cvt_pk_bf16_f32 v103, v78, v79
    s_nop 1
    v_mfma_f32_32x32x16_bf16 v[112:127], v[48:51], v[96:99], v[112:127]
    v_mfma_f32_32x32x16_bf16 v[112:127], v[52:55], v[100:103], v[112:127]
    s_add_u32 s37, s37, 4096
    s_add_u32 s41, s41, 1
    s_nop 15
    s_nop 3
    s_cmp_lt_u32 s41, 64
    s_cbranch_scc1 L_k2_fbloop
    s_branch L_k2_final
L_k2_fft:
    s_sub_u32 s37, s30, 8
    v_lshlrev_b32 v6, 4, v1
    s_lshl_b32 s33, s31, 18
    s_add_u32 s33, s33, 2097152
    s_lshl_b32 s35, s37, 12
    s_add_u32 s33, s33, s35
    s_and_b32 s34, s2, 0
    s_lshl_b32 s34, s34, 17
    s_add_u32 s33, s33, s34
    s_barrier
    s_add_u32 m0, s35, 32768
    s_add_u32 s34, s33, 32768
    buffer_load_dwordx4 v6, s[4:7], s34 offen offset:0 lds
    buffer_load_dwordx4 v6, s[4:7], s34 offen offset:1024 lds
    buffer_load_dwordx4 v6, s[4:7], s34 offen offset:2048 lds
    buffer_load_dwordx4 v6, s[4:7], s34 offen offset:3072 lds
    s_add_u32 m0, s35, 49152
    s_add_u32 s34, s33, 49152
    buffer_load_dwordx4 v6, s[4:7], s34 offen offset:0 lds
    buffer_load_dwordx4 v6, s[4:7], s34 offen offset:1024 lds
    buffer_load_dwordx4 v6, s[4:7], s34 offen offset:2048 lds
    buffer_load_dwordx4 v6, s[4:7], s34 offen offset:3072 lds
    s_waitcnt vmcnt(0)
    v_mov_b32 v7, 157696
    v_mov_b32 v8, 2
    s_mov_b64 exec, 1
    ds_add_u32 v7, v8 offset:0
    s_mov_b64 exec, -1
    s_add_u32 m0, s35, 65536
    s_add_u32 s34, s33, 65536
    buffer_load_dwordx4 v6, s[4:7], s34 offen offset:0 lds
    buffer_load_dwordx4 v6, s[4:7], s34 offen offset:1024 lds
    buffer_load_dwordx4 v6, s[4:7], s34 offen offset:2048 lds
    buffer_load_dwordx4 v6, s[4:7], s34 offen offset:3072 lds
    s_add_u32 m0, s35, 81920
    s_add_u32 s34, s33, 81920
    buffer_load_dwordx4 v6, s[4:7], s34 offen offset:0 lds
    buffer_load_dwordx4 v6, s[4:7], s34 offen offset:1024 lds
    buffer_load_dwordx4 v6, s[4:7], s34 offen offset:2048 lds
    buffer_load_dwordx4 v6, s[4:7], s34 offen offset:3072 lds
    s_waitcnt vmcnt(0)
    v_mov_b32 v7, 157696
    v_mov_b32 v8, 2
    s_mov_b64 exec, 1
    ds_add_u32 v7, v8 offset:4
    s_mov_b64 exec, -1
    s_waitcnt lgkmcnt(0)
    s_cmp_ge_u32 s2, 225
    s_cbranch_scc1 L_k2_pfonly
    s_lshr_b32 s40, s37, 1
    s_and_b32 s41, s37, 1
    s_cmp_eq_u32 s2, 224
    s_cselect_b32 s39, 0, s2
    s_mul_i32 s33, s39, 8320
    s_lshl_b32 s34, s41, 12
    s_add_u32 s33, s33, s34
    s_add_u32 s33, s33, 6291456
    s_lshl_b32 s34, s40, 12
    s_lshl_b32 s35, s37, 12
    s_add_u32 s36, s35, 40960
    buffer_load_dwordx4 v[16:19], v6, s[4:7], s33 offen offset:0
    buffer_load_dwordx4 v[20:23], v6, s[4:7], s33 offen offset:1024
    buffer_load_dwordx4 v[24:27], v6, s[4:7], s33 offen offset:2048
    buffer_load_dwordx4 v[28:31], v6, s[4:7], s33 offen offset:3072
    buffer_load_dwordx4 v[32:35], v6, s[8:11], s34 offen offset:0
    buffer_load_dwordx4 v[36:39], v6, s[8:11], s34 offen offset:1024
    buffer_load_dwordx4 v[40:43], v6, s[8:11], s34 offen offset:2048
    buffer_load_dwordx4 v[44:47], v6, s[8:11], s34 offen offset:3072
    buffer_load_dwordx4 v[48:51], v6, s[8:11], s36 offen offset:0
    buffer_load_dwordx4 v[52:55], v6, s[8:11], s36 offen offset:1024
    buffer_load_dwordx4 v[56:59], v6, s[8:11], s36 offen offset:2048
    buffer_load_dwordx4 v[60:63], v6, s[8:11], s36 offen offset:3072
    s_lshl_b32 s34, s37, 13
    s_add_u32 s34, s34, 8192
    s_add_u32 s33, s34, 4096
    s_add_u32 s36, s35, 57344
    buffer_load_dwordx4 v[80:83], v6, s[8:11], s34 offen offset:0
    buffer_load_dwordx4 v[84:87], v6, s[8:11], s34 offen offset:1024
    buffer_load_dwordx4 v[88:91], v6, s[8:11], s34 offen offset:2048
    buffer_load_dwordx4 v[92:95], v6, s[8:11], s34 offen offset:3072
    buffer_load_dwordx4 v[96:99], v6, s[8:11], s33 offen offset:0
    buffer_load_dwordx4 v[100:103], v6, s[8:11], s33 offen offset:1024
    buffer_load_dwordx4 v[104:107], v6, s[8:11], s33 offen offset:2048
    buffer_load_dwordx4 v[108:111], v6, s[8:11], s33 offen offset:3072
    v_and_b32 v2, 31, v1
    v_lshrrev_b32 v3, 5, v1
    v_lshrrev_b32 v4, 3, v2
    v_lshl_add_u32 v4, v3, 5, v4
    v_mul_u32_u24 v4, 7296, v4
    v_and_b32 v5, 7, v2
    v_lshl_add_u32 v4, v5, 2, v4
    s_lshl_b32 s33, s2, 5
    s_mul_i32 s34, s37, 466944
    s_add_u32 s33, s33, s34
    s_add_u32 s33, s33, 8388608
    v_mov_b32 v9, v4
    s_mov_b32 s46, s33
    s_mov_b32 s47, s36
    v_mul_u32_u24 v4, 2176, v3
    v_lshl_add_u32 v4, v2, 2, v4
    s_mul_i32 s33, s40, 4352
    s_lshl_b32 s34, s41, 7
    s_add_u32 s33, s33, s34
    s_add_u32 s33, s33, 131072
    v_add_u32 v10, s33, v4
    v_mul_u32_u24 v4, 272, v2
    v_lshl_add_u32 v5, v3, 4, v4
    v_add_u32 v11, 131072, v5
    v_lshl_add_u32 v5, v3, 5, v4
    s_lshl_b32 s33, s37, 6
    s_add_u32 s33, s33, 139776
    v_add_u32 v12, s33, v5
    v_mul_u32_u24 v4, 1152, v3
    v_lshl_add_u32 v4, v2, 2, v4
    s_mul_i32 s33, s37, 2304
    s_add_u32 s33, s33, 148480
    v_add_u32 v13, s33, v4
    v_mul_u32_u24 v4, 144, v2
    v_lshl_add_u32 v4, v3, 4, v4
    s_mul_i32 s33, s41, 4608
    s_add_u32 s33, s33, 148480
    v_add_u32 v14, s33, v4
    v_lshlrev_b32 v4, 4, v2
    v_lshl_add_u32 v15, v3, 10, v4
    s_waitcnt vmcnt(12)
    s_cmp_eq_u32 s2, 0
    s_cbranch_scc1 L_k2_sp0
    s_cmp_eq_u32 s2, 224
    s_cbranch_scc0 L_k2_spdone
    v_lshrrev_b32 v16, 16, v16
    v_lshrrev_b32 v17, 16, v17
    v_lshrrev_b32 v18, 16, v18
    v_lshrrev_b32 v19, 16, v19
    v_lshrrev_b32 v20, 16, v20
    v_lshrrev_b32 v21, 16, v21
    v_lshrrev_b32 v22, 16, v22
    v_lshrrev_b32 v23, 16, v23
    v_lshrrev_b32 v24, 16, v24
    v_lshrrev_b32 v25, 16, v25
    v_lshrrev_b32 v26, 16, v26
    v_lshrrev_b32 v27, 16, v27
    v_lshrrev_b32 v28, 16, v28
    v_lshrrev_b32 v29, 16, v29
    v_lshrrev_b32 v30, 16, v30
    v_lshrrev_b32 v31, 16, v31
    s_branch L_k2_spdone
L_k2_sp0:
    v_and_b32 v16, 0xffff, v16
    v_and_b32 v17, 0xffff, v17
    v_and_b32 v18, 0xffff, v18
    v_and_b32 v19, 0xffff, v19
    v_and_b32 v20, 0xffff, v20
    v_and_b32 v21, 0xffff, v21
    v_and_b32 v22, 0xffff, v22
    v_and_b32 v23, 0xffff, v23
    v_and_b32 v24, 0xffff, v24
    v_and_b32 v25, 0xffff, v25
    v_and_b32 v26, 0xffff, v26
    v_and_b32 v27, 0xffff, v27
    v_and_b32 v28, 0xffff, v28
    v_and_b32 v29, 0xffff, v29
    v_and_b32 v30, 0xffff, v30
    v_and_b32 v31, 0xffff, v31
L_k2_spdone:
    s_nop 1
    v_mfma_f32_32x32x16_bf16 v[120:135], v[32:35], v[16:19], 0
    v_mfma_f32_32x32x16_bf16 v[120:135], v[36:39], v[20:23], v[120:135]
    v_mfma_f32_32x32x16_bf16 v[120:135], v[40:43], v[24:27], v[120:135]
    v_mfma_f32_32x32x16_bf16 v[120:135], v[44:47], v[28:31], v[120:135]
    s_waitcnt vmcnt(8)
    s_nop 15
    v_mul_f32 v4, v120, v48
    v_mul_f32 v5, v120, v49
    v_fma_f32 v4, -v121, v49, v4
    v_fmac_f32 v5, v121, v48
    v_cvt_pk_bf16_f32 v16, v4, v5
    v_mul_f32 v4, v122, v50
    v_mul_f32 v5, v122, v51
    v_fma_f32 v4, -v123, v51, v4
    v_fmac_f32 v5, v123, v50
    v_cvt_pk_bf16_f32 v17, v4, v5
    v_mul_f32 v4, v124, v52
    v_mul_f32 v5, v124, v53
    v_fma_f32 v4, -v125, v53, v4
    v_fmac_f32 v5, v125, v52
    v_cvt_pk_bf16_f32 v18, v4, v5
    v_mul_f32 v4, v126, v54
    v_mul_f32 v5, v126, v55
    v_fma_f32 v4, -v127, v55, v4
    v_fmac_f32 v5, v127, v54
    v_cvt_pk_bf16_f32 v19, v4, v5
    v_mul_f32 v4, v128, v56
    v_mul_f32 v5, v128, v57
    v_fma_f32 v4, -v129, v57, v4
    v_fmac_f32 v5, v129, v56
    v_cvt_pk_bf16_f32 v20, v4, v5
    v_mul_f32 v4, v130, v58
    v_mul_f32 v5, v130, v59
    v_fma_f32 v4, -v131, v59, v4
    v_fmac_f32 v5, v131, v58
    v_cvt_pk_bf16_f32 v21, v4, v5
    v_mul_f32 v4, v132, v60
    v_mul_f32 v5, v132, v61
    v_fma_f32 v4, -v133, v61, v4
    v_fmac_f32 v5, v133, v60
    v_cvt_pk_bf16_f32 v22, v4, v5
    v_mul_f32 v4, v134, v62
    v_mul_f32 v5, v134, v63
    v_fma_f32 v4, -v135, v63, v4
    v_fmac_f32 v5, v135, v62
    v_cvt_pk_bf16_f32 v23, v4, v5
    ds_write_b32 v10, v16 offset:0
    ds_write_b32 v10, v17 offset:272
    ds_write_b32 v10, v18 offset:544
    ds_write_b32 v10, v19 offset:816
    ds_write_b32 v10, v20 offset:1088
    ds_write_b32 v10, v21 offset:1360
    ds_write_b32 v10, v22 offset:1632
    ds_write_b32 v10, v23 offset:1904
    buffer_load_dword v112, v9, s[4:7], s46 offen
    s_add_u32 s46, s46, 29184
    buffer_load_dword v113, v9, s[4:7], s46 offen
    s_add_u32 s46, s46, 29184
    buffer_load_dword v114, v9, s[4:7], s46 offen
    s_add_u32 s46, s46, 29184
    buffer_load_dword v115, v9, s[4:7], s46 offen
    s_add_u32 s46, s46, 29184
    buffer_load_dword v116, v9, s[4:7], s46 offen
    s_add_u32 s46, s46, 29184
    buffer_load_dword v117, v9, s[4:7], s46 offen
    s_add_u32 s46, s46, 29184
    buffer_load_dword v118, v9, s[4:7], s46 offen
    s_add_u32 s46, s46, 29184
    buffer_load_dword v119, v9, s[4:7], s46 offen
    s_add_u32 s46, s46, 29184
    buffer_load_dwordx4 v[64:67], v6, s[8:11], s47 offen offset:0
    buffer_load_dwordx4 v[68:71], v6, s[8:11], s47 offen offset:1024
    buffer_load_dwordx4 v[72:75], v6, s[8:11], s47 offen offset:2048
    buffer_load_dwordx4 v[76:79], v6, s[8:11], s47 offen offset:3072
    s_load_dwordx2 s[50:51], s[0:1], 40
    s_getpc_b64 s[52:53]
    s_add_u32 s52, s52, tbl_gf@rel32@lo+4
    s_addc_u32 s53, s53, tbl_gf@rel32@hi+12
    s_getpc_b64 s[54:55]
    s_add_u32 s54, s54, k3_kernel@rel32@lo+4
    s_addc_u32 s55, s55, k3_kernel@rel32@hi+12
    s_lshr_b32 s33, s2, 3
    s_lshl_b32 s33, s33, 2
    s_add_u32 s33, s33, s37
    s_mul_i32 s33, s33, 3136
    v_lshlrev_b32 v7, 7, v1
    v_min_u32 v8, 3200, v7
    s_waitcnt lgkmcnt(0)
    s_mov_b32 s56, s50
    s_and_b32 s57, s51, 0xffff
    s_mov_b32 s58, 401408
    s_mov_b32 s59, 0x20000
    s_mov_b32 s60, s52
    s_and_b32 s61, s53, 0xffff
    s_mov_b32 s62, 401408
    s_mov_b32 s63, 0x20000
    buffer_load_dword v0, v8, s[56:59], s33 offen
    buffer_load_dword v0, v8, s[60:63], s33 offen
    s_mov_b32 s56, s54
    s_and_b32 s57, s55, 0xffff
    s_mov_b32 s58, L_k3_end-k3_kernel
    s_mov_b32 s59, 0x20000
    buffer_load_dword v0, v7, s[56:59], 0 offen
    s_waitcnt lgkmcnt(0)
    v_mov_b32 v7, 157696
    v_mov_b32 v8, 1
    s_mov_b64 exec, 1
    ds_add_u32 v7, v8 offset:96
    s_mov_b64 exec, -1
L_k2fs_27:
    ds_read_b32 v8, v7 offset:96
    s_waitcnt lgkmcnt(0)
    v_readfirstlane_b32 s45, v8
    s_cmp_ge_u32 s45, 4
    s_cbranch_scc1 L_k2fo_28
    s_sleep 1
    s_branch L_k2fs_27
L_k2fo_28:
    ds_read_b128 v[136:139], v11 offset:0
    ds_read_b128 v[140:143], v11 offset:32
    ds_read_b128 v[144:147], v11 offset:64
    ds_read_b128 v[148:151], v11 offset:96
    ds_read_b128 v[152:155], v11 offset:128
    ds_read_b128 v[156:159], v11 offset:160
    ds_read_b128 v[160:163], v11 offset:192
    ds_read_b128 v[164:167], v11 offset:224
    s_waitcnt vmcnt(15)
    s_waitcnt lgkmcnt(7)
    v_mfma_f32_32x32x16_bf16 v[120:135], v[80:83], v[136:139], 0
    s_waitcnt lgkmcnt(6)
    v_mfma_f32_32x32x16_bf16 v[120:135], v[84:87], v[140:143], v[120:135]
    s_waitcnt lgkmcnt(5)
    v_mfma_f32_32x32x16_bf16 v[120:135], v[88:91], v[144:147], v[120:135]
    s_waitcnt lgkmcnt(4)
    v_mfma_f32_32x32x16_bf16 v[120:135], v[92:95], v[148:151], v[120:135]
    s_waitcnt lgkmcnt(3)
    v_mfma_f32_32x32x16_bf16 v[120:135], v[96:99], v[152:155], v[120:135]
    s_waitcnt lgkmcnt(2)
    v_mfma_f32_32x32x16_bf16 v[120:135], v[100:103], v[156:159], v[120:135]
    s_waitcnt lgkmcnt(1)
    v_mfma_f32_32x32x16_bf16 v[120:135], v[104:107], v[160:163], v[120:135]
    s_waitcnt lgkmcnt(0)
    v_mfma_f32_32x32x16_bf16 v[120:135], v[108:111], v[164:167], v[120:135]
    s_waitcnt vmcnt(7)
    v_lshlrev_b32 v48, 16, v112
    v_and_b32 v49, 0xffff0000, v112
    v_lshlrev_b32 v50, 16, v113
    v_and_b32 v51, 0xffff0000, v113
    v_lshlrev_b32 v52, 16, v114
    v_and_b32 v53, 0xffff0000, v114
    v_lshlrev_b32 v54, 16, v115
    v_and_b32 v55, 0xffff0000, v115
    v_lshlrev_b32 v56, 16, v116
    v_and_b32 v57, 0xffff0000, v116
    v_lshlrev_b32 v58, 16, v117
    v_and_b32 v59, 0xffff0000, v117
    v_lshlrev_b32 v60, 16, v118
    v_and_b32 v61, 0xffff0000, v118
    v_lshlrev_b32 v62, 16, v119
    v_and_b32 v63, 0xffff0000, v119
    v_mul_f32 v4, v120, v48
    v_mul_f32 v5, v120, v49
    v_fma_f32 v4, -v121, v49, v4
    v_fmac_f32 v5, v121, v48
    v_cvt_pk_bf16_f32 v16, v4, -v5
    v_mul_f32 v4, v122, v50
    v_mul_f32 v5, v122, v51
    v_fma_f32 v4, -v123, v51, v4
    v_fmac_f32 v5, v123, v50
    v_cvt_pk_bf16_f32 v17, v4, -v5
    v_mul_f32 v4, v124, v52
    v_mul_f32 v5, v124, v53
    v_fma_f32 v4, -v125, v53, v4
    v_fmac_f32 v5, v125, v52
    v_cvt_pk_bf16_f32 v18, v4, -v5
    v_mul_f32 v4, v126, v54
    v_mul_f32 v5, v126, v55
    v_fma_f32 v4, -v127, v55, v4
    v_fmac_f32 v5, v127, v54
    v_cvt_pk_bf16_f32 v19, v4, -v5
    v_mul_f32 v4, v128, v56
    v_mul_f32 v5, v128, v57
    v_fma_f32 v4, -v129, v57, v4
    v_fmac_f32 v5, v129, v56
    v_cvt_pk_bf16_f32 v20, v4, -v5
    v_mul_f32 v4, v130, v58
    v_mul_f32 v5, v130, v59
    v_fma_f32 v4, -v131, v59, v4
    v_fmac_f32 v5, v131, v58
    v_cvt_pk_bf16_f32 v21, v4, -v5
    v_mul_f32 v4, v132, v60
    v_mul_f32 v5, v132, v61
    v_fma_f32 v4, -v133, v61, v4
    v_fmac_f32 v5, v133, v60
    v_cvt_pk_bf16_f32 v22, v4, -v5
    v_mul_f32 v4, v134, v62
    v_mul_f32 v5, v134, v63
    v_fma_f32 v4, -v135, v63, v4
    v_fmac_f32 v5, v135, v62
    v_cvt_pk_bf16_f32 v23, v4, -v5
    ds_write_b128 v12, v[16:19]
    ds_write_b128 v12, v[20:23] offset:16
    s_waitcnt lgkmcnt(0)
    v_mov_b32 v7, 157696
    v_mov_b32 v8, 1
    s_mov_b64 exec, 1
    ds_add_u32 v7, v8 offset:100
    s_mov_b64 exec, -1
L_k2fs_29:
    ds_read_b32 v8, v7 offset:100
    s_waitcnt lgkmcnt(0)
    v_readfirstlane_b32 s45, v8
    s_cmp_ge_u32 s45, 4
    s_cbranch_scc1 L_k2fo_30
    s_sleep 1
    s_branch L_k2fs_29
L_k2fo_30:
    ds_read_b128 v[136:139], v11 offset:8704
    ds_read_b128 v[140:143], v11 offset:8736
    ds_read_b128 v[144:147], v11 offset:8768
    ds_read_b128 v[148:151], v11 offset:8800
    ds_read_b128 v[152:155], v11 offset:8832
    ds_read_b128 v[156:159], v11 offset:8864
    ds_read_b128 v[160:163], v11 offset:8896
    ds_read_b128 v[164:167], v11 offset:8928
    s_waitcnt lgkmcnt(7)
    v_mfma_f32_32x32x16_bf16 v[120:135], v[80:83], v[136:139], 0
    s_waitcnt lgkmcnt(6)
    v_mfma_f32_32x32x16_bf16 v[120:135], v[84:87], v[140:143], v[120:135]
    s_waitcnt lgkmcnt(5)
    v_mfma_f32_32x32x16_bf16 v[120:135], v[88:91], v[144:147], v[120:135]
    s_waitcnt lgkmcnt(4)
    v_mfma_f32_32x32x16_bf16 v[120:135], v[92:95], v[148:151], v[120:135]
    s_waitcnt lgkmcnt(3)
    v_mfma_f32_32x32x16_bf16 v[120:135], v[96:99], v[152:155], v[120:135]
    s_waitcnt lgkmcnt(2)
    v_mfma_f32_32x32x16_bf16 v[120:135], v[100:103], v[156:159], v[120:135]
    s_waitcnt lgkmcnt(1)
    v_mfma_f32_32x32x16_bf16 v[120:135], v[104:107], v[160:163], v[120:135]
    s_waitcnt lgkmcnt(0)
    v_mfma_f32_32x32x16_bf16 v[120:135], v[108:111], v[164:167], v[120:135]
    s_waitcnt vmcnt(3)
    s_nop 15
    v_mul_f32 v4, v120, v64
    v_mul_f32 v5, v120, v65
    v_fma_f32 v4, -v121, v65, v4
    v_fmac_f32 v5, v121, v64
    v_cvt_pk_bf16_f32 v16, v4, v5
    v_mul_f32 v4, v122, v66
    v_mul_f32 v5, v122, v67
    v_fma_f32 v4, -v123, v67, v4
    v_fmac_f32 v5, v123, v66
    v_cvt_pk_bf16_f32 v17, v4, v5
    v_mul_f32 v4, v124, v68
    v_mul_f32 v5, v124, v69
    v_fma_f32 v4, -v125, v69, v4
    v_fmac_f32 v5, v125, v68
    v_cvt_pk_bf16_f32 v18, v4, v5
    v_mul_f32 v4, v126, v70
    v_mul_f32 v5, v126, v71
    v_fma_f32 v4, -v127, v71, v4
    v_fmac_f32 v5, v127, v70
    v_cvt_pk_bf16_f32 v19, v4, v5
    v_mul_f32 v4, v128, v72
    v_mul_f32 v5, v128, v73
    v_fma_f32 v4, -v129, v73, v4
    v_fmac_f32 v5, v129, v72
    v_cvt_pk_bf16_f32 v20, v4, v5
    v_mul_f32 v4, v130, v74
    v_mul_f32 v5, v130, v75
    v_fma_f32 v4, -v131, v75, v4
    v_fmac_f32 v5, v131, v74
    v_cvt_pk_bf16_f32 v21, v4, v5
    v_mul_f32 v4, v132, v76
    v_mul_f32 v5, v132, v77
    v_fma_f32 v4, -v133, v77, v4
    v_fmac_f32 v5, v133, v76
    v_cvt_pk_bf16_f32 v22, v4, v5
    v_mul_f32 v4, v134, v78
    v_mul_f32 v5, v134, v79
    v_fma_f32 v4, -v135, v79, v4
    v_fmac_f32 v5, v135, v78
    v_cvt_pk_bf16_f32 v23, v4, v5
    ds_write_b32 v13, v16 offset:0
    ds_write_b32 v13, v17 offset:144
    ds_write_b32 v13, v18 offset:288
    ds_write_b32 v13, v19 offset:432
    ds_write_b32 v13, v20 offset:576
    ds_write_b32 v13, v21 offset:720
    ds_write_b32 v13, v22 offset:864
    ds_write_b32 v13, v23 offset:1008
    s_waitcnt lgkmcnt(0)
    v_mov_b32 v7, 157696
    v_mov_b32 v8, 1
    s_mov_b64 exec, 1
    ds_add_u32 v7, v8 offset:104
    s_mov_b64 exec, -1
L_k2fs_31:
    ds_read_b32 v8, v7 offset:104
    s_waitcnt lgkmcnt(0)
    v_readfirstlane_b32 s45, v8
    s_cmp_ge_u32 s45, 4
    s_cbranch_scc1 L_k2fo_32
    s_sleep 1
    s_branch L_k2fs_31
L_k2fo_32:
    ds_read_b128 v[136:139], v14 offset:0
    ds_read_b128 v[140:143], v14 offset:32
    ds_read_b128 v[144:147], v14 offset:64
    ds_read_b128 v[148:151], v14 offset:96
    s_waitcnt lgkmcnt(3)
    v_mfma_f32_32x32x16_bf16 v[120:135], v[32:35], v[136:139], 0
    s_waitcnt lgkmcnt(2)
    v_mfma_f32_32x32x16_bf16 v[120:135], v[36:39], v[140:143], v[120:135]
    s_waitcnt lgkmcnt(1)
    v_mfma_f32_32x32x16_bf16 v[120:135], v[40:43], v[144:147], v[120:135]
    s_waitcnt lgkmcnt(0)
    v_mfma_f32_32x32x16_bf16 v[120:135], v[44:47], v[148:151], v[120:135]
    s_mul_i32 s33, s2, 8448
    s_cmp_eq_u32 s2, 224
    s_cselect_b32 s33, 4224, s33
    s_lshl_b32 s34, s41, 9
    s_add_u32 s33, s33, s34
    s_lshl_b32 s34, s40, 11
    s_add_u32 s33, s33, s34
    s_add_u32 s33, s33, 12582912
    s_add_u32 s34, s33, 4224
    s_nop 7
    v_cvt_pk_bf16_f32 v16, v120, v122
    v_cvt_pk_bf16_f32 v20, -v121, -v123
    v_cvt_pk_bf16_f32 v17, v124, v126
    v_cvt_pk_bf16_f32 v21, -v125, -v127
    v_cvt_pk_bf16_f32 v18, v128, v130
    v_cvt_pk_bf16_f32 v22, -v129, -v131
    v_cvt_pk_bf16_f32 v19, v132, v134
    v_cvt_pk_bf16_f32 v23, -v133, -v135
    buffer_store_dwordx4 v[16:19], v15, s[4:7], s33 offen
    s_cmp_eq_u32 s39, 0
    s_cbranch_scc1 L_k2_gate
    buffer_store_dwordx4 v[20:23], v15, s[4:7], s34 offen
L_k2_gate:
    s_endpgm
L_k2_pfonly:
    s_load_dwordx2 s[50:51], s[0:1], 40
    s_getpc_b64 s[52:53]
    s_add_u32 s52, s52, tbl_gf@rel32@lo+4
    s_addc_u32 s53, s53, tbl_gf@rel32@hi+12
    s_getpc_b64 s[54:55]
    s_add_u32 s54, s54, k3_kernel@rel32@lo+4
    s_addc_u32 s55, s55, k3_kernel@rel32@hi+12
    s_lshr_b32 s33, s2, 3
    s_lshl_b32 s33, s33, 2
    s_add_u32 s33, s33, s37
    s_mul_i32 s33, s33, 3136
    v_lshlrev_b32 v7, 7, v1
    v_min_u32 v8, 3200, v7
    s_waitcnt lgkmcnt(0)
    s_mov_b32 s56, s50
    s_and_b32 s57, s51, 0xffff
    s_mov_b32 s58, 401408
    s_mov_b32 s59, 0x20000
    s_mov_b32 s60, s52
    s_and_b32 s61, s53, 0xffff
    s_mov_b32 s62, 401408
    s_mov_b32 s63, 0x20000
    buffer_load_dword v0, v8, s[56:59], s33 offen
    buffer_load_dword v0, v8, s[60:63], s33 offen
    s_mov_b32 s56, s54
    s_and_b32 s57, s55, 0xffff
    s_mov_b32 s58, L_k3_end-k3_kernel
    s_mov_b32 s59, 0x20000
    buffer_load_dword v0, v7, s[56:59], 0 offen
    s_endpgm
L_k2_end:
    s_endpgm

.globl k3_kernel
.p2align 8
.type k3_kernel,@function
k3_kernel:

    s_cmp_ge_u32 s2, 224
    s_cbranch_scc1 L_k3_end
    s_load_dwordx2 s[24:25], s[0:1], 72
    s_load_dwordx2 s[26:27], s[0:1], 40
    s_load_dwordx2 s[28:29], s[0:1], 56
    s_getpc_b64 s[20:21]
    s_add_u32 s20, s20, tbl_gf@rel32@lo+4
    s_addc_u32 s21, s21, tbl_gf@rel32@hi+12
    v_and_b32 v1, 63, v0
    v_lshrrev_b32 v2, 6, v0
    s_and_b32 s33, s2, 7
    s_lshr_b32 s34, s2, 3
    v_readfirstlane_b32 s30, v2
    s_lshl_b32 s31, s33, 2
    s_and_b32 s35, s34, 3
    s_add_u32 s31, s31, s35
    s_lshr_b32 s32, s34, 2
    s_and_b32 s37, s30, 3
    v_lshlrev_b32 v9, 4, v1
    v_mov_b32 v6, 131072
    v_mov_b32 v8, 1
    s_cmp_ge_u32 s30, 4
    s_cbranch_scc0 L_k3_compute
    v_lshrrev_b32 v2, 3, v1
    v_and_b32 v3, 7, v1
    v_bfe_u32 v4, v1, 4, 1
    v_lshlrev_b32 v4, 2, v4
    v_xor_b32 v3, v3, v4
    v_lshlrev_b32 v3, 4, v3
    v_mul_u32_u24 v4, 896, v2
    v_add_u32 v10, v4, v3
    v_mul_u32_u24 v4, 4224, v2
    v_add_u32 v11, v4, v3
    s_lshl_b32 s41, s37, 11
    s_mul_i32 s43, s37, 14336
    s_lshl_b32 s33, s32, 7
    s_add_u32 s43, s43, s33
    s_mul_i32 s44, s37, 67584
    s_lshl_b32 s33, s31, 7
    s_add_u32 s44, s44, s33
    s_add_u32 s44, s44, 12582912
    s_waitcnt lgkmcnt(0)
    s_mov_b32 s4, s24
    s_and_b32 s5, s25, 0xffff
    s_mov_b32 s6, 15728640
    s_mov_b32 s7, 0x20000
    s_mov_b32 s8, s26
    s_and_b32 s9, s27, 0xffff
    s_mov_b32 s10, 401408
    s_mov_b32 s11, 0x20000
    s_add_u32 m0, s41, 0
    s_add_u32 s33, s43, 0
    buffer_load_dwordx4 v10, s[8:11], s33 offen lds
    s_add_u32 m0, s41, 1024
    s_add_u32 s33, s43, 7168
    buffer_load_dwordx4 v10, s[8:11], s33 offen lds
    s_add_u32 m0, s41, 8192
    s_add_u32 s33, s44, 0
    buffer_load_dwordx4 v11, s[4:7], s33 offen lds
    s_add_u32 m0, s41, 9216
    s_add_u32 s33, s44, 33792
    buffer_load_dwordx4 v11, s[4:7], s33 offen lds
    s_barrier
    s_add_u32 m0, s41, 16384
    s_add_u32 s33, s43, 57344
    buffer_load_dwordx4 v10, s[8:11], s33 offen lds
    s_add_u32 m0, s41, 17408
    s_add_u32 s33, s43, 64512
    buffer_load_dwordx4 v10, s[8:11], s33 offen lds
    s_add_u32 m0, s41, 24576
    s_add_u32 s33, s44, 270336
    buffer_load_dwordx4 v11, s[4:7], s33 offen lds
    s_add_u32 m0, s41, 25600
    s_add_u32 s33, s44, 304128
    buffer_load_dwordx4 v11, s[4:7], s33 offen lds
    s_waitcnt vmcnt(6)
    s_mov_b64 exec, 1
    ds_add_u32 v6, v8 offset:0
    s_mov_b64 exec, -1
    s_add_u32 m0, s41, 32768
    s_add_u32 s33, s43, 114688
    buffer_load_dwordx4 v10, s[8:11], s33 offen lds
    s_add_u32 m0, s41, 33792
    s_add_u32 s33, s43, 121856
    buffer_load_dwordx4 v10, s[8:11], s33 offen lds
    s_waitcnt vmcnt(6)
    s_mov_b64 exec, 1
    ds_add_u32 v6, v8 offset:4
    s_mov_b64 exec, -1
    s_add_u32 m0, s41, 40960
    s_add_u32 s33, s44, 540672
    buffer_load_dwordx4 v11, s[4:7], s33 offen lds
    s_add_u32 m0, s41, 41984
    s_add_u32 s33, s44, 574464
    buffer_load_dwordx4 v11, s[4:7], s33 offen lds
    s_waitcnt vmcnt(6)
    s_mov_b64 exec, 1
    ds_add_u32 v6, v8 offset:8
    s_mov_b64 exec, -1
    s_add_u32 m0, s41, 49152
    s_add_u32 s33, s43, 172032
    buffer_load_dwordx4 v10, s[8:11], s33 offen lds
    s_add_u32 m0, s41, 50176
    s_add_u32 s33, s43, 179200
    buffer_load_dwordx4 v10, s[8:11], s33 offen lds
    s_waitcnt vmcnt(6)
    s_mov_b64 exec, 1
    ds_add_u32 v6, v8 offset:12
    s_mov_b64 exec, -1
    s_add_u32 m0, s41, 57344
    s_add_u32 s33, s44, 811008
    buffer_load_dwordx4 v11, s[4:7], s33 offen lds
    s_add_u32 m0, s41, 58368
    s_add_u32 s33, s44, 844800
    buffer_load_dwordx4 v11, s[4:7], s33 offen lds
    s_waitcnt vmcnt(6)
    s_mov_b64 exec, 1
    ds_add_u32 v6, v8 offset:16
    s_mov_b64 exec, -1
    s_add_u32 m0, s41, 65536
    s_add_u32 s33, s43, 229376
    buffer_load_dwordx4 v10, s[8:11], s33 offen lds
    s_add_u32 m0, s41, 66560
    s_add_u32 s33, s43, 236544
    buffer_load_dwordx4 v10, s[8:11], s33 offen lds
    s_waitcnt vmcnt(6)
    s_mov_b64 exec, 1
    ds_add_u32 v6, v8 offset:20
    s_mov_b64 exec, -1
    s_add_u32 m0, s41, 73728
    s_add_u32 s33, s44, 1081344
    buffer_load_dwordx4 v11, s[4:7], s33 offen lds
    s_add_u32 m0, s41, 74752
    s_add_u32 s33, s44, 1115136
    buffer_load_dwordx4 v11, s[4:7], s33 offen lds
    s_waitcnt vmcnt(6)
    s_mov_b64 exec, 1
    ds_add_u32 v6, v8 offset:24
    s_mov_b64 exec, -1
    s_add_u32 m0, s41, 81920
    s_add_u32 s33, s43, 286720
    buffer_load_dwordx4 v10, s[8:11], s33 offen lds
    s_add_u32 m0, s41, 82944
    s_add_u32 s33, s43, 293888
    buffer_load_dwordx4 v10, s[8:11], s33 offen lds
    s_waitcnt vmcnt(6)
    s_mov_b64 exec, 1
    ds_add_u32 v6, v8 offset:28
    s_mov_b64 exec, -1
    s_add_u32 m0, s41, 90112
    s_add_u32 s33, s44, 1351680
    buffer_load_dwordx4 v11, s[4:7], s33 offen lds
    s_add_u32 m0, s41, 91136
    s_add_u32 s33, s44, 1385472
    buffer_load_dwordx4 v11, s[4:7], s33 offen lds
    s_waitcnt vmcnt(6)
    s_mov_b64 exec, 1
    ds_add_u32 v6, v8 offset:32
    s_mov_b64 exec, -1
    s_add_u32 m0, s41, 98304
    s_add_u32 s33, s43, 344064
    buffer_load_dwordx4 v10, s[8:11], s33 offen lds
    s_add_u32 m0, s41, 99328
    s_add_u32 s33, s43, 351232
    buffer_load_dwordx4 v10, s[8:11], s33 offen lds
    s_waitcnt vmcnt(6)
    s_mov_b64 exec, 1
    ds_add_u32 v6, v8 offset:36
    s_mov_b64 exec, -1
    s_add_u32 m0, s41, 106496
    s_add_u32 s33, s44, 1622016
    buffer_load_dwordx4 v11, s[4:7], s33 offen lds
    s_add_u32 m0, s41, 107520
    s_add_u32 s33, s44, 1655808
    buffer_load_dwordx4 v11, s[4:7], s33 offen lds
    s_waitcnt vmcnt(6)
    s_mov_b64 exec, 1
    ds_add_u32 v6, v8 offset:40
    s_mov_b64 exec, -1
    s_waitcnt vmcnt(4)
    s_mov_b64 exec, 1
    ds_add_u32 v6, v8 offset:44
    s_mov_b64 exec, -1
    s_waitcnt vmcnt(2)
    s_mov_b64 exec, 1
    ds_add_u32 v6, v8 offset:48
    s_mov_b64 exec, -1
    s_waitcnt vmcnt(0)
    s_mov_b64 exec, 1
    ds_add_u32 v6, v8 offset:52
    s_mov_b64 exec, -1
    s_waitcnt lgkmcnt(0)
    s_endpgm
L_k3_compute:
    v_and_b32 v2, 31, v1
    v_lshl_add_u32 v3, v2, 2, v6
    v_mov_b32 v4, 0
    ds_write_b32 v3, v4
    s_lshr_b32 s40, s30, 1
    s_and_b32 s41, s30, 1
    s_cmp_eq_u32 s40, 0
    s_cselect_b32 s33, s31, s32
    s_cselect_b32 s34, 10485760, 0
    s_lshl_b32 s33, s33, 1
    s_add_u32 s33, s33, s41
    s_mul_i32 s42, s33, 28672
    s_add_u32 s42, s42, s34
    s_waitcnt lgkmcnt(0)
    s_mov_b32 s46, 15728640
    s_cmp_eq_u32 s40, 0
    s_cselect_b32 s44, s24, s20
    s_cselect_b32 s45, s25, s21
    s_cselect_b32 s46, s46, 401408
    s_mov_b32 s47, 0x20000
    s_and_b32 s45, s45, 0xffff
    buffer_load_dwordx4 v[120:123], v9, s[44:47], s42 offen offset:0
    buffer_load_dwordx4 v[124:127], v9, s[44:47], s42 offen offset:1024
    buffer_load_dwordx4 v[128:131], v9, s[44:47], s42 offen offset:2048
    buffer_load_dwordx4 v[132:135], v9, s[44:47], s42 offen offset:3072
    s_add_u32 s42, s42, 4096
    s_barrier
    buffer_load_dwordx4 v[136:139], v9, s[44:47], s42 offen offset:0
    buffer_load_dwordx4 v[140:143], v9, s[44:47], s42 offen offset:1024
    buffer_load_dwordx4 v[144:147], v9, s[44:47], s42 offen offset:2048
    buffer_load_dwordx4 v[148:151], v9, s[44:47], s42 offen offset:3072
    s_add_u32 s42, s42, 4096
    s_mov_b32 s4, s24
    s_and_b32 s5, s25, 0xffff
    s_mov_b32 s6, 15728640
    s_mov_b32 s7, 0x20000
    s_mov_b32 s16, s28
    s_and_b32 s17, s29, 0xffff
    s_mov_b32 s18, 1835008
    s_mov_b32 s19, 0x20000
    s_xor_b32 s48, s41, s40
    v_lshlrev_b32 v3, 3, v2
    s_lshl_b32 s33, s31, 9
    s_lshl_b32 s34, s48, 8
    s_add_u32 s33, s33, s34
    s_add_u32 s33, s33, 14680064
    buffer_load_dwordx2 v[14:15], v3, s[4:7], s33 offen
    v_lshrrev_b32 v3, 5, v1
    v_bfe_u32 v4, v1, 2, 2
    v_lshl_add_u32 v5, v3, 3, v4
    v_lshlrev_b32 v5, 7, v5
    v_lshrrev_b32 v4, 1, v4
    v_lshl_add_u32 v5, v4, 6, v5
    v_bfe_u32 v4, v1, 4, 1
    v_lshl_add_u32 v5, v4, 5, v5
    v_and_b32 v4, 3, v1
    v_lshl_add_u32 v5, v4, 3, v5
    s_lshl_b32 s33, s40, 13
    v_add_u32 v10, s33, v5
    v_xor_b32 v11, 64, v10
    v_add_u32 v12, 0x10000, v10
    v_add_u32 v13, 0x10000, v11
    s_lshl_b32 s33, s40, 2
    v_add_u32 v6, s33, v6
    v_and_b32 v4, 7, v2
    v_mul_u32_u24 v16, 57344, v4
    v_lshrrev_b32 v4, 3, v2
    v_mul_u32_u24 v4, 896, v4
    v_add_u32 v16, v16, v4
    v_lshl_add_u32 v16, v3, 4, v16
    s_lshr_b32 s33, s31, 3
    s_lshl_b32 s33, s33, 9
    s_and_b32 s34, s31, 7
    s_lshl_b32 s34, s34, 3
    s_add_u32 s33, s33, s34
    s_lshl_b32 s34, s48, 2
    s_add_u32 s33, s33, s34
    s_mul_i32 s33, s33, 896
    s_lshl_b32 s34, s32, 7
    s_add_u32 s33, s33, s34
    s_lshl_b32 s34, s41, 6
    s_add_u32 s36, s33, s34
    v_add_u32 v18, 114688, v9
    v_mul_u32_u24 v17, 80, v2
    v_lshl_add_u32 v17, v3, 3, v17
    v_add_u32 v17, 114688, v17
    v_lshrrev_b32 v4, 2, v1
    v_and_b32 v5, 3, v1
    v_mul_u32_u24 v19, 80, v4
    v_lshl_add_u32 v19, v5, 4, v19
    v_add_u32 v19, 114688, v19
    v_and_b32 v20, 7, v4
    v_mul_u32_u24 v20, 57344, v20
    v_lshrrev_b32 v4, 3, v4
    v_mul_u32_u24 v4, 896, v4
    v_add_u32 v20, v20, v4
    v_lshl_add_u32 v20, v5, 4, v20
    s_cmp_eq_u32 s40, 1
    s_cbranch_scc1 L_k3_F
    s_mov_b32 vcc_lo, 0
L_sp_33:
    ds_read_b32 v7, v6 offset:0
    s_waitcnt lgkmcnt(0)
    v_readfirstlane_b32 s38, v7
    s_cmp_ge_u32 s38, 4
    s_cbranch_scc1 L_ok_34
    s_sleep 1
    s_add_u32 vcc_lo, vcc_lo, 1
    s_cmp_lt_u32 vcc_lo, 0x400000
    s_cbranch_scc1 L_sp_33
L_ok_34:
    ds_read_b32 v7, v6 offset:8
    ds_read_b64_tr_b16 v[24:25], v10 offset:0
    ds_read_b64_tr_b16 v[26:27], v10 offset:512
    ds_read_b64_tr_b16 v[28:29], v11 offset:0
    ds_read_b64_tr_b16 v[30:31], v11 offset:512
    ds_read_b64_tr_b16 v[32:33], v10 offset:2048
    ds_read_b64_tr_b16 v[34:35], v10 offset:2560
    ds_read_b64_tr_b16 v[36:37], v11 offset:2048
    ds_read_b64_tr_b16 v[38:39], v11 offset:2560
    ds_read_b64_tr_b16 v[40:41], v10 offset:4096
    ds_read_b64_tr_b16 v[42:43], v10 offset:4608
    ds_read_b64_tr_b16 v[44:45], v11 offset:4096
    ds_read_b64_tr_b16 v[46:47], v11 offset:4608
    ds_read_b64_tr_b16 v[48:49], v10 offset:6144
    ds_read_b64_tr_b16 v[50:51], v10 offset:6656
    ds_read_b64_tr_b16 v[52:53], v11 offset:6144
    ds_read_b64_tr_b16 v[54:55], v11 offset:6656
    buffer_load_dwordx4 v[152:155], v9, s[44:47], s42 offen offset:0
    buffer_load_dwordx4 v[156:159], v9, s[44:47], s42 offen offset:1024
    buffer_load_dwordx4 v[160:163], v9, s[44:47], s42 offen offset:2048
    buffer_load_dwordx4 v[164:167], v9, s[44:47], s42 offen offset:3072
    s_add_u32 s42, s42, 4096
    s_waitcnt lgkmcnt(15)
    v_readfirstlane_b32 s38, v7
    s_waitcnt vmcnt(9)
    s_cmp_ge_u32 s38, 4
    s_cbranch_scc0 L_k3slow_35
    s_waitcnt lgkmcnt(14)
    v_mfma_f32_32x32x16_bf16 v[88:103], v[24:27], v[120:123], 0
    ds_read_b32 v7, v6 offset:16
    ds_read_b64_tr_b16 v[56:57], v10 offset:16384
    ds_read_b64_tr_b16 v[58:59], v10 offset:16896
    s_waitcnt lgkmcnt(15)
    v_mfma_f32_32x32x16_bf16 v[104:119], v[28:31], v[120:123], 0
    ds_read_b64_tr_b16 v[60:61], v11 offset:16384
    ds_read_b64_tr_b16 v[62:63], v11 offset:16896
    ds_read_b64_tr_b16 v[64:65], v10 offset:18432
    s_waitcnt lgkmcnt(15)
    v_mfma_f32_32x32x16_bf16 v[88:103], v[32:35], v[124:127], v[88:103]
    ds_read_b64_tr_b16 v[66:67], v10 offset:18944
    ds_read_b64_tr_b16 v[68:69], v11 offset:18432
    ds_read_b64_tr_b16 v[70:71], v11 offset:18944
    s_waitcnt lgkmcnt(15)
    v_mfma_f32_32x32x16_bf16 v[104:119], v[36:39], v[124:127], v[104:119]
    ds_read_b64_tr_b16 v[72:73], v10 offset:20480
    ds_read_b64_tr_b16 v[74:75], v10 offset:20992
    ds_read_b64_tr_b16 v[76:77], v11 offset:20480
    s_waitcnt lgkmcnt(15)
    v_mfma_f32_32x32x16_bf16 v[88:103], v[40:43], v[128:131], v[88:103]
    ds_read_b64_tr_b16 v[78:79], v11 offset:20992
    ds_read_b64_tr_b16 v[80:81], v10 offset:22528
    ds_read_b64_tr_b16 v[82:83], v10 offset:23040
    s_waitcnt lgkmcnt(15)
    v_mfma_f32_32x32x16_bf16 v[104:119], v[44:47], v[128:131], v[104:119]
    ds_read_b64_tr_b16 v[84:85], v11 offset:22528
    ds_read_b64_tr_b16 v[86:87], v11 offset:23040
    s_waitcnt lgkmcnt(15)
    v_mfma_f32_32x32x16_bf16 v[88:103], v[48:51], v[132:135], v[88:103]
    s_waitcnt lgkmcnt(15)
    v_mfma_f32_32x32x16_bf16 v[104:119], v[52:55], v[132:135], v[104:119]
    s_branch L_k3join_36
L_k3slow_35:
    s_waitcnt lgkmcnt(14)
    v_mfma_f32_32x32x16_bf16 v[88:103], v[24:27], v[120:123], 0
    s_waitcnt lgkmcnt(12)
    v_mfma_f32_32x32x16_bf16 v[104:119], v[28:31], v[120:123], 0
    s_waitcnt lgkmcnt(10)
    v_mfma_f32_32x32x16_bf16 v[88:103], v[32:35], v[124:127], v[88:103]
    s_waitcnt lgkmcnt(8)
    v_mfma_f32_32x32x16_bf16 v[104:119], v[36:39], v[124:127], v[104:119]
    s_waitcnt lgkmcnt(6)
    v_mfma_f32_32x32x16_bf16 v[88:103], v[40:43], v[128:131], v[88:103]
    s_waitcnt lgkmcnt(4)
    v_mfma_f32_32x32x16_bf16 v[104:119], v[44:47], v[128:131], v[104:119]
    s_waitcnt lgkmcnt(2)
    v_mfma_f32_32x32x16_bf16 v[88:103], v[48:51], v[132:135], v[88:103]
    s_waitcnt lgkmcnt(0)
    v_mfma_f32_32x32x16_bf16 v[104:119], v[52:55], v[132:135], v[104:119]
    s_mov_b32 vcc_lo, 0
L_sp_37:
    ds_read_b32 v7, v6 offset:8
    s_waitcnt lgkmcnt(0)
    v_readfirstlane_b32 s38, v7
    s_cmp_ge_u32 s38, 4
    s_cbranch_scc1 L_ok_38
    s_sleep 1
    s_add_u32 vcc_lo, vcc_lo, 1
    s_cmp_lt_u32 vcc_lo, 0x400000
    s_cbranch_scc1 L_sp_37
L_ok_38:
    ds_read_b32 v7, v6 offset:16
    ds_read_b64_tr_b16 v[56:57], v10 offset:16384
    ds_read_b64_tr_b16 v[58:59], v10 offset:16896
    ds_read_b64_tr_b16 v[60:61], v11 offset:16384
    ds_read_b64_tr_b16 v[62:63], v11 offset:16896
    ds_read_b64_tr_b16 v[64:65], v10 offset:18432
    ds_read_b64_tr_b16 v[66:67], v10 offset:18944
    ds_read_b64_tr_b16 v[68:69], v11 offset:18432
    ds_read_b64_tr_b16 v[70:71], v11 offset:18944
    ds_read_b64_tr_b16 v[72:73], v10 offset:20480
    ds_read_b64_tr_b16 v[74:75], v10 offset:20992
    ds_read_b64_tr_b16 v[76:77], v11 offset:20480
    ds_read_b64_tr_b16 v[78:79], v11 offset:20992
    ds_read_b64_tr_b16 v[80:81], v10 offset:22528
    ds_read_b64_tr_b16 v[82:83], v10 offset:23040
    ds_read_b64_tr_b16 v[84:85], v11 offset:22528
    ds_read_b64_tr_b16 v[86:87], v11 offset:23040
L_k3join_36:
    buffer_load_dwordx4 v[168:171], v9, s[44:47], s42 offen offset:0
    buffer_load_dwordx4 v[172:175], v9, s[44:47], s42 offen offset:1024
    buffer_load_dwordx4 v[176:179], v9, s[44:47], s42 offen offset:2048
    buffer_load_dwordx4 v[180:183], v9, s[44:47], s42 offen offset:3072
    s_add_u32 s42, s42, 4096
    s_waitcnt lgkmcnt(15)
    v_readfirstlane_b32 s38, v7
    s_waitcnt vmcnt(9)
    s_cmp_ge_u32 s38, 4
    s_cbranch_scc0 L_k3slow_39
    s_waitcnt lgkmcnt(14)
    v_mfma_f32_32x32x16_bf16 v[88:103], v[56:59], v[136:139], v[88:103]
    ds_read_b32 v7, v6 offset:24
    ds_read_b64_tr_b16 v[24:25], v10 offset:32768
    ds_read_b64_tr_b16 v[26:27], v10 offset:33280
    s_waitcnt lgkmcnt(15)
    v_mfma_f32_32x32x16_bf16 v[104:119], v[60:63], v[136:139], v[104:119]
    ds_read_b64_tr_b16 v[28:29], v11 offset:32768
    ds_read_b64_tr_b16 v[30:31], v11 offset:33280
    ds_read_b64_tr_b16 v[32:33], v10 offset:34816
    s_waitcnt lgkmcnt(15)
    v_mfma_f32_32x32x16_bf16 v[88:103], v[64:67], v[140:143], v[88:103]
    ds_read_b64_tr_b16 v[34:35], v10 offset:35328
    ds_read_b64_tr_b16 v[36:37], v11 offset:34816
    ds_read_b64_tr_b16 v[38:39], v11 offset:35328
    s_waitcnt lgkmcnt(15)
    v_mfma_f32_32x32x16_bf16 v[104:119], v[68:71], v[140:143], v[104:119]
    ds_read_b64_tr_b16 v[40:41], v10 offset:36864
    ds_read_b64_tr_b16 v[42:43], v10 offset:37376
    ds_read_b64_tr_b16 v[44:45], v11 offset:36864
    s_waitcnt lgkmcnt(15)
    v_mfma_f32_32x32x16_bf16 v[88:103], v[72:75], v[144:147], v[88:103]
    ds_read_b64_tr_b16 v[46:47], v11 offset:37376
    ds_read_b64_tr_b16 v[48:49], v10 offset:38912
    ds_read_b64_tr_b16 v[50:51], v10 offset:39424
    s_waitcnt lgkmcnt(15)
    v_mfma_f32_32x32x16_bf16 v[104:119], v[76:79], v[144:147], v[104:119]
    ds_read_b64_tr_b16 v[52:53], v11 offset:38912
    ds_read_b64_tr_b16 v[54:55], v11 offset:39424
    s_waitcnt lgkmcnt(15)
    v_mfma_f32_32x32x16_bf16 v[88:103], v[80:83], v[148:151], v[88:103]
    s_waitcnt lgkmcnt(15)
    v_mfma_f32_32x32x16_bf16 v[104:119], v[84:87], v[148:151], v[104:119]
    s_branch L_k3join_40
L_k3slow_39:
    s_waitcnt lgkmcnt(14)
    v_mfma_f32_32x32x16_bf16 v[88:103], v[56:59], v[136:139], v[88:103]
    s_waitcnt lgkmcnt(12)
    v_mfma_f32_32x32x16_bf16 v[104:119], v[60:63], v[136:139], v[104:119]
    s_waitcnt lgkmcnt(10)
    v_mfma_f32_32x32x16_bf16 v[88:103], v[64:67], v[140:143], v[88:103]
    s_waitcnt lgkmcnt(8)
    v_mfma_f32_32x32x16_bf16 v[104:119], v[68:71], v[140:143], v[104:119]
    s_waitcnt lgkmcnt(6)
    v_mfma_f32_32x32x16_bf16 v[88:103], v[72:75], v[144:147], v[88:103]
    s_waitcnt lgkmcnt(4)
    v_mfma_f32_32x32x16_bf16 v[104:119], v[76:79], v[144:147], v[104:119]
    s_waitcnt lgkmcnt(2)
    v_mfma_f32_32x32x16_bf16 v[88:103], v[80:83], v[148:151], v[88:103]
    s_waitcnt lgkmcnt(0)
    v_mfma_f32_32x32x16_bf16 v[104:119], v[84:87], v[148:151], v[104:119]
    s_mov_b32 vcc_lo, 0
L_sp_41:
    ds_read_b32 v7, v6 offset:16
    s_waitcnt lgkmcnt(0)
    v_readfirstlane_b32 s38, v7
    s_cmp_ge_u32 s38, 4
    s_cbranch_scc1 L_ok_42
    s_sleep 1
    s_add_u32 vcc_lo, vcc_lo, 1
    s_cmp_lt_u32 vcc_lo, 0x400000
    s_cbranch_scc1 L_sp_41
L_ok_42:
    ds_read_b32 v7, v6 offset:24
    ds_read_b64_tr_b16 v[24:25], v10 offset:32768
    ds_read_b64_tr_b16 v[26:27], v10 offset:33280
    ds_read_b64_tr_b16 v[28:29], v11 offset:32768
    ds_read_b64_tr_b16 v[30:31], v11 offset:33280
    ds_read_b64_tr_b16 v[32:33], v10 offset:34816
    ds_read_b64_tr_b16 v[34:35], v10 offset:35328
    ds_read_b64_tr_b16 v[36:37], v11 offset:34816
    ds_read_b64_tr_b16 v[38:39], v11 offset:35328
    ds_read_b64_tr_b16 v[40:41], v10 offset:36864
    ds_read_b64_tr_b16 v[42:43], v10 offset:37376
    ds_read_b64_tr_b16 v[44:45], v11 offset:36864
    ds_read_b64_tr_b16 v[46:47], v11 offset:37376
    ds_read_b64_tr_b16 v[48:49], v10 offset:38912
    ds_read_b64_tr_b16 v[50:51], v10 offset:39424
    ds_read_b64_tr_b16 v[52:53], v11 offset:38912
    ds_read_b64_tr_b16 v[54:55], v11 offset:39424
L_k3join_40:
    buffer_load_dwordx4 v[184:187], v9, s[44:47], s42 offen offset:0
    buffer_load_dwordx4 v[188:191], v9, s[44:47], s42 offen offset:1024
    buffer_load_dwordx4 v[192:195], v9, s[44:47], s42 offen offset:2048
    buffer_load_dwordx4 v[196:199], v9, s[44:47], s42 offen offset:3072
    s_add_u32 s42, s42, 4096
    s_waitcnt lgkmcnt(15)
    v_readfirstlane_b32 s38, v7
    s_waitcnt vmcnt(8)
    s_cmp_ge_u32 s38, 4
    s_cbranch_scc0 L_k3slow_43
    s_waitcnt lgkmcnt(14)
    v_mfma_f32_32x32x16_bf16 v[88:103], v[24:27], v[152:155], v[88:103]
    ds_read_b32 v7, v6 offset:32
    ds_read_b64_tr_b16 v[56:57], v10 offset:49152
    ds_read_b64_tr_b16 v[58:59], v10 offset:49664
    s_waitcnt lgkmcnt(15)
    v_mfma_f32_32x32x16_bf16 v[104:119], v[28:31], v[152:155], v[104:119]
    ds_read_b64_tr_b16 v[60:61], v11 offset:49152
    ds_read_b64_tr_b16 v[62:63], v11 offset:49664
    ds_read_b64_tr_b16 v[64:65], v10 offset:51200
    s_waitcnt lgkmcnt(15)
    v_mfma_f32_32x32x16_bf16 v[88:103], v[32:35], v[156:159], v[88:103]
    ds_read_b64_tr_b16 v[66:67], v10 offset:51712
    ds_read_b64_tr_b16 v[68:69], v11 offset:51200
    ds_read_b64_tr_b16 v[70:71], v11 offset:51712
    s_waitcnt lgkmcnt(15)
    v_mfma_f32_32x32x16_bf16 v[104:119], v[36:39], v[156:159], v[104:119]
    ds_read_b64_tr_b16 v[72:73], v10 offset:53248
    ds_read_b64_tr_b16 v[74:75], v10 offset:53760
    ds_read_b64_tr_b16 v[76:77], v11 offset:53248
    s_waitcnt lgkmcnt(15)
    v_mfma_f32_32x32x16_bf16 v[88:103], v[40:43], v[160:163], v[88:103]
    ds_read_b64_tr_b16 v[78:79], v11 offset:53760
    ds_read_b64_tr_b16 v[80:81], v10 offset:55296
    ds_read_b64_tr_b16 v[82:83], v10 offset:55808
    s_waitcnt lgkmcnt(15)
    v_mfma_f32_32x32x16_bf16 v[104:119], v[44:47], v[160:163], v[104:119]
    ds_read_b64_tr_b16 v[84:85], v11 offset:55296
    ds_read_b64_tr_b16 v[86:87], v11 offset:55808
    s_waitcnt lgkmcnt(15)
    v_mfma_f32_32x32x16_bf16 v[88:103], v[48:51], v[164:167], v[88:103]
    s_waitcnt lgkmcnt(15)
    v_mfma_f32_32x32x16_bf16 v[104:119], v[52:55], v[164:167], v[104:119]
    s_branch L_k3join_44
L_k3slow_43:
    s_waitcnt lgkmcnt(14)
    v_mfma_f32_32x32x16_bf16 v[88:103], v[24:27], v[152:155], v[88:103]
    s_waitcnt lgkmcnt(12)
    v_mfma_f32_32x32x16_bf16 v[104:119], v[28:31], v[152:155], v[104:119]
    s_waitcnt lgkmcnt(10)
    v_mfma_f32_32x32x16_bf16 v[88:103], v[32:35], v[156:159], v[88:103]
    s_waitcnt lgkmcnt(8)
    v_mfma_f32_32x32x16_bf16 v[104:119], v[36:39], v[156:159], v[104:119]
    s_waitcnt lgkmcnt(6)
    v_mfma_f32_32x32x16_bf16 v[88:103], v[40:43], v[160:163], v[88:103]
    s_waitcnt lgkmcnt(4)
    v_mfma_f32_32x32x16_bf16 v[104:119], v[44:47], v[160:163], v[104:119]
    s_waitcnt lgkmcnt(2)
    v_mfma_f32_32x32x16_bf16 v[88:103], v[48:51], v[164:167], v[88:103]
    s_waitcnt lgkmcnt(0)
    v_mfma_f32_32x32x16_bf16 v[104:119], v[52:55], v[164:167], v[104:119]
    s_mov_b32 vcc_lo, 0
L_sp_45:
    ds_read_b32 v7, v6 offset:24
    s_waitcnt lgkmcnt(0)
    v_readfirstlane_b32 s38, v7
    s_cmp_ge_u32 s38, 4
    s_cbranch_scc1 L_ok_46
    s_sleep 1
    s_add_u32 vcc_lo, vcc_lo, 1
    s_cmp_lt_u32 vcc_lo, 0x400000
    s_cbranch_scc1 L_sp_45
L_ok_46:
    ds_read_b32 v7, v6 offset:32
    ds_read_b64_tr_b16 v[56:57], v10 offset:49152
    ds_read_b64_tr_b16 v[58:59], v10 offset:49664
    ds_read_b64_tr_b16 v[60:61], v11 offset:49152
    ds_read_b64_tr_b16 v[62:63], v11 offset:49664
    ds_read_b64_tr_b16 v[64:65], v10 offset:51200
    ds_read_b64_tr_b16 v[66:67], v10 offset:51712
    ds_read_b64_tr_b16 v[68:69], v11 offset:51200
    ds_read_b64_tr_b16 v[70:71], v11 offset:51712
    ds_read_b64_tr_b16 v[72:73], v10 offset:53248
    ds_read_b64_tr_b16 v[74:75], v10 offset:53760
    ds_read_b64_tr_b16 v[76:77], v11 offset:53248
    ds_read_b64_tr_b16 v[78:79], v11 offset:53760
    ds_read_b64_tr_b16 v[80:81], v10 offset:55296
    ds_read_b64_tr_b16 v[82:83], v10 offset:55808
    ds_read_b64_tr_b16 v[84:85], v11 offset:55296
    ds_read_b64_tr_b16 v[86:87], v11 offset:55808
L_k3join_44:
    buffer_load_dwordx4 v[200:203], v9, s[44:47], s42 offen offset:0
    buffer_load_dwordx4 v[204:207], v9, s[44:47], s42 offen offset:1024
    buffer_load_dwordx4 v[208:211], v9, s[44:47], s42 offen offset:2048
    buffer_load_dwordx4 v[212:215], v9, s[44:47], s42 offen offset:3072
    s_add_u32 s42, s42, 4096
    s_waitcnt lgkmcnt(15)
    v_readfirstlane_b32 s38, v7
    s_waitcnt vmcnt(8)
    s_cmp_ge_u32 s38, 4
    s_cbranch_scc0 L_k3slow_47
    s_waitcnt lgkmcnt(14)
    v_mfma_f32_32x32x16_bf16 v[88:103], v[56:59], v[168:171], v[88:103]
    ds_read_b32 v7, v6 offset:40
    ds_read_b64_tr_b16 v[24:25], v12 offset:0
    ds_read_b64_tr_b16 v[26:27], v12 offset:512
    s_waitcnt lgkmcnt(15)
    v_mfma_f32_32x32x16_bf16 v[104:119], v[60:63], v[168:171], v[104:119]
    ds_read_b64_tr_b16 v[28:29], v13 offset:0
    ds_read_b64_tr_b16 v[30:31], v13 offset:512
    ds_read_b64_tr_b16 v[32:33], v12 offset:2048
    s_waitcnt lgkmcnt(15)
    v_mfma_f32_32x32x16_bf16 v[88:103], v[64:67], v[172:175], v[88:103]
    ds_read_b64_tr_b16 v[34:35], v12 offset:2560
    ds_read_b64_tr_b16 v[36:37], v13 offset:2048
    ds_read_b64_tr_b16 v[38:39], v13 offset:2560
    s_waitcnt lgkmcnt(15)
    v_mfma_f32_32x32x16_bf16 v[104:119], v[68:71], v[172:175], v[104:119]
    ds_read_b64_tr_b16 v[40:41], v12 offset:4096
    ds_read_b64_tr_b16 v[42:43], v12 offset:4608
    ds_read_b64_tr_b16 v[44:45], v13 offset:4096
    s_waitcnt lgkmcnt(15)
    v_mfma_f32_32x32x16_bf16 v[88:103], v[72:75], v[176:179], v[88:103]
    ds_read_b64_tr_b16 v[46:47], v13 offset:4608
    ds_read_b64_tr_b16 v[48:49], v12 offset:6144
    ds_read_b64_tr_b16 v[50:51], v12 offset:6656
    s_waitcnt lgkmcnt(15)
    v_mfma_f32_32x32x16_bf16 v[104:119], v[76:79], v[176:179], v[104:119]
    ds_read_b64_tr_b16 v[52:53], v13 offset:6144
    ds_read_b64_tr_b16 v[54:55], v13 offset:6656
    s_waitcnt lgkmcnt(15)
    v_mfma_f32_32x32x16_bf16 v[88:103], v[80:83], v[180:183], v[88:103]
    s_waitcnt lgkmcnt(15)
    v_mfma_f32_32x32x16_bf16 v[104:119], v[84:87], v[180:183], v[104:119]
    s_branch L_k3join_48
L_k3slow_47:
    s_waitcnt lgkmcnt(14)
    v_mfma_f32_32x32x16_bf16 v[88:103], v[56:59], v[168:171], v[88:103]
    s_waitcnt lgkmcnt(12)
    v_mfma_f32_32x32x16_bf16 v[104:119], v[60:63], v[168:171], v[104:119]
    s_waitcnt lgkmcnt(10)
    v_mfma_f32_32x32x16_bf16 v[88:103], v[64:67], v[172:175], v[88:103]
    s_waitcnt lgkmcnt(8)
    v_mfma_f32_32x32x16_bf16 v[104:119], v[68:71], v[172:175], v[104:119]
    s_waitcnt lgkmcnt(6)
    v_mfma_f32_32x32x16_bf16 v[88:103], v[72:75], v[176:179], v[88:103]
    s_waitcnt lgkmcnt(4)
    v_mfma_f32_32x32x16_bf16 v[104:119], v[76:79], v[176:179], v[104:119]
    s_waitcnt lgkmcnt(2)
    v_mfma_f32_32x32x16_bf16 v[88:103], v[80:83], v[180:183], v[88:103]
    s_waitcnt lgkmcnt(0)
    v_mfma_f32_32x32x16_bf16 v[104:119], v[84:87], v[180:183], v[104:119]
    s_mov_b32 vcc_lo, 0
L_sp_49:
    ds_read_b32 v7, v6 offset:32
    s_waitcnt lgkmcnt(0)
    v_readfirstlane_b32 s38, v7
    s_cmp_ge_u32 s38, 4
    s_cbranch_scc1 L_ok_50
    s_sleep 1
    s_add_u32 vcc_lo, vcc_lo, 1
    s_cmp_lt_u32 vcc_lo, 0x400000
    s_cbranch_scc1 L_sp_49
L_ok_50:
    ds_read_b32 v7, v6 offset:40
    ds_read_b64_tr_b16 v[24:25], v12 offset:0
    ds_read_b64_tr_b16 v[26:27], v12 offset:512
    ds_read_b64_tr_b16 v[28:29], v13 offset:0
    ds_read_b64_tr_b16 v[30:31], v13 offset:512
    ds_read_b64_tr_b16 v[32:33], v12 offset:2048
    ds_read_b64_tr_b16 v[34:35], v12 offset:2560
    ds_read_b64_tr_b16 v[36:37], v13 offset:2048
    ds_read_b64_tr_b16 v[38:39], v13 offset:2560
    ds_read_b64_tr_b16 v[40:41], v12 offset:4096
    ds_read_b64_tr_b16 v[42:43], v12 offset:4608
    ds_read_b64_tr_b16 v[44:45], v13 offset:4096
    ds_read_b64_tr_b16 v[46:47], v13 offset:4608
    ds_read_b64_tr_b16 v[48:49], v12 offset:6144
    ds_read_b64_tr_b16 v[50:51], v12 offset:6656
    ds_read_b64_tr_b16 v[52:53], v13 offset:6144
    ds_read_b64_tr_b16 v[54:55], v13 offset:6656
L_k3join_48:
    buffer_load_dwordx4 v[216:219], v9, s[44:47], s42 offen offset:0
    buffer_load_dwordx4 v[220:223], v9, s[44:47], s42 offen offset:1024
    buffer_load_dwordx4 v[224:227], v9, s[44:47], s42 offen offset:2048
    buffer_load_dwordx4 v[228:231], v9, s[44:47], s42 offen offset:3072
    s_add_u32 s42, s42, 4096
    s_waitcnt lgkmcnt(15)
    v_readfirstlane_b32 s38, v7
    s_waitcnt vmcnt(8)
    s_cmp_ge_u32 s38, 4
    s_cbranch_scc0 L_k3slow_51
    s_waitcnt lgkmcnt(14)
    v_mfma_f32_32x32x16_bf16 v[88:103], v[24:27], v[184:187], v[88:103]
    ds_read_b32 v7, v6 offset:48
    ds_read_b64_tr_b16 v[56:57], v12 offset:16384
    ds_read_b64_tr_b16 v[58:59], v12 offset:16896
    s_waitcnt lgkmcnt(15)
    v_mfma_f32_32x32x16_bf16 v[104:119], v[28:31], v[184:187], v[104:119]
    ds_read_b64_tr_b16 v[60:61], v13 offset:16384
    ds_read_b64_tr_b16 v[62:63], v13 offset:16896
    ds_read_b64_tr_b16 v[64:65], v12 offset:18432
    s_waitcnt lgkmcnt(15)
    v_mfma_f32_32x32x16_bf16 v[88:103], v[32:35], v[188:191], v[88:103]
    ds_read_b64_tr_b16 v[66:67], v12 offset:18944
    ds_read_b64_tr_b16 v[68:69], v13 offset:18432
    ds_read_b64_tr_b16 v[70:71], v13 offset:18944
    s_waitcnt lgkmcnt(15)
    v_mfma_f32_32x32x16_bf16 v[104:119], v[36:39], v[188:191], v[104:119]
    ds_read_b64_tr_b16 v[72:73], v12 offset:20480
    ds_read_b64_tr_b16 v[74:75], v12 offset:20992
    ds_read_b64_tr_b16 v[76:77], v13 offset:20480
    s_waitcnt lgkmcnt(15)
    v_mfma_f32_32x32x16_bf16 v[88:103], v[40:43], v[192:195], v[88:103]
    ds_read_b64_tr_b16 v[78:79], v13 offset:20992
    ds_read_b64_tr_b16 v[80:81], v12 offset:22528
    ds_read_b64_tr_b16 v[82:83], v12 offset:23040
    s_waitcnt lgkmcnt(15)
    v_mfma_f32_32x32x16_bf16 v[104:119], v[44:47], v[192:195], v[104:119]
    ds_read_b64_tr_b16 v[84:85], v13 offset:22528
    ds_read_b64_tr_b16 v[86:87], v13 offset:23040
    s_waitcnt lgkmcnt(15)
    v_mfma_f32_32x32x16_bf16 v[88:103], v[48:51], v[196:199], v[88:103]
    s_waitcnt lgkmcnt(15)
    v_mfma_f32_32x32x16_bf16 v[104:119], v[52:55], v[196:199], v[104:119]
    s_branch L_k3join_52
L_k3slow_51:
    s_waitcnt lgkmcnt(14)
    v_mfma_f32_32x32x16_bf16 v[88:103], v[24:27], v[184:187], v[88:103]
    s_waitcnt lgkmcnt(12)
    v_mfma_f32_32x32x16_bf16 v[104:119], v[28:31], v[184:187], v[104:119]
    s_waitcnt lgkmcnt(10)
    v_mfma_f32_32x32x16_bf16 v[88:103], v[32:35], v[188:191], v[88:103]
    s_waitcnt lgkmcnt(8)
    v_mfma_f32_32x32x16_bf16 v[104:119], v[36:39], v[188:191], v[104:119]
    s_waitcnt lgkmcnt(6)
    v_mfma_f32_32x32x16_bf16 v[88:103], v[40:43], v[192:195], v[88:103]
    s_waitcnt lgkmcnt(4)
    v_mfma_f32_32x32x16_bf16 v[104:119], v[44:47], v[192:195], v[104:119]
    s_waitcnt lgkmcnt(2)
    v_mfma_f32_32x32x16_bf16 v[88:103], v[48:51], v[196:199], v[88:103]
    s_waitcnt lgkmcnt(0)
    v_mfma_f32_32x32x16_bf16 v[104:119], v[52:55], v[196:199], v[104:119]
    s_mov_b32 vcc_lo, 0
L_sp_53:
    ds_read_b32 v7, v6 offset:40
    s_waitcnt lgkmcnt(0)
    v_readfirstlane_b32 s38, v7
    s_cmp_ge_u32 s38, 4
    s_cbranch_scc1 L_ok_54
    s_sleep 1
    s_add_u32 vcc_lo, vcc_lo, 1
    s_cmp_lt_u32 vcc_lo, 0x400000
    s_cbranch_scc1 L_sp_53
L_ok_54:
    ds_read_b32 v7, v6 offset:48
    ds_read_b64_tr_b16 v[56:57], v12 offset:16384
    ds_read_b64_tr_b16 v[58:59], v12 offset:16896
    ds_read_b64_tr_b16 v[60:61], v13 offset:16384
    ds_read_b64_tr_b16 v[62:63], v13 offset:16896
    ds_read_b64_tr_b16 v[64:65], v12 offset:18432
    ds_read_b64_tr_b16 v[66:67], v12 offset:18944
    ds_read_b64_tr_b16 v[68:69], v13 offset:18432
    ds_read_b64_tr_b16 v[70:71], v13 offset:18944
    ds_read_b64_tr_b16 v[72:73], v12 offset:20480
    ds_read_b64_tr_b16 v[74:75], v12 offset:20992
    ds_read_b64_tr_b16 v[76:77], v13 offset:20480
    ds_read_b64_tr_b16 v[78:79], v13 offset:20992
    ds_read_b64_tr_b16 v[80:81], v12 offset:22528
    ds_read_b64_tr_b16 v[82:83], v12 offset:23040
    ds_read_b64_tr_b16 v[84:85], v13 offset:22528
    ds_read_b64_tr_b16 v[86:87], v13 offset:23040
L_k3join_52:
    s_waitcnt lgkmcnt(15)
    v_readfirstlane_b32 s38, v7
    s_waitcnt vmcnt(4)
    s_cmp_ge_u32 s38, 4
    s_cbranch_scc0 L_k3slow_55
    s_waitcnt lgkmcnt(14)
    v_mfma_f32_32x32x16_bf16 v[88:103], v[56:59], v[200:203], v[88:103]
    ds_read_b32 v7, v6
    ds_read_b64_tr_b16 v[24:25], v12 offset:32768
    ds_read_b64_tr_b16 v[26:27], v12 offset:33280
    s_waitcnt lgkmcnt(15)
    v_mfma_f32_32x32x16_bf16 v[104:119], v[60:63], v[200:203], v[104:119]
    ds_read_b64_tr_b16 v[28:29], v13 offset:32768
    ds_read_b64_tr_b16 v[30:31], v13 offset:33280
    ds_read_b64_tr_b16 v[32:33], v12 offset:34816
    s_waitcnt lgkmcnt(15)
    v_mfma_f32_32x32x16_bf16 v[88:103], v[64:67], v[204:207], v[88:103]
    ds_read_b64_tr_b16 v[34:35], v12 offset:35328
    ds_read_b64_tr_b16 v[36:37], v13 offset:34816
    ds_read_b64_tr_b16 v[38:39], v13 offset:35328
    s_waitcnt lgkmcnt(15)
    v_mfma_f32_32x32x16_bf16 v[104:119], v[68:71], v[204:207], v[104:119]
    ds_read_b64_tr_b16 v[40:41], v12 offset:36864
    ds_read_b64_tr_b16 v[42:43], v12 offset:37376
    ds_read_b64_tr_b16 v[44:45], v13 offset:36864
    s_waitcnt lgkmcnt(15)
    v_mfma_f32_32x32x16_bf16 v[88:103], v[72:75], v[208:211], v[88:103]
    ds_read_b64_tr_b16 v[46:47], v13 offset:37376
    ds_read_b64_tr_b16 v[48:49], v12 offset:38912
    ds_read_b64_tr_b16 v[50:51], v12 offset:39424
    s_waitcnt lgkmcnt(15)
    v_mfma_f32_32x32x16_bf16 v[104:119], v[76:79], v[208:211], v[104:119]
    ds_read_b64_tr_b16 v[52:53], v13 offset:38912
    ds_read_b64_tr_b16 v[54:55], v13 offset:39424
    s_waitcnt lgkmcnt(15)
    v_mfma_f32_32x32x16_bf16 v[88:103], v[80:83], v[212:215], v[88:103]
    s_waitcnt lgkmcnt(15)
    v_mfma_f32_32x32x16_bf16 v[104:119], v[84:87], v[212:215], v[104:119]
    s_branch L_k3join_56
L_k3slow_55:
    s_waitcnt lgkmcnt(14)
    v_mfma_f32_32x32x16_bf16 v[88:103], v[56:59], v[200:203], v[88:103]
    s_waitcnt lgkmcnt(12)
    v_mfma_f32_32x32x16_bf16 v[104:119], v[60:63], v[200:203], v[104:119]
    s_waitcnt lgkmcnt(10)
    v_mfma_f32_32x32x16_bf16 v[88:103], v[64:67], v[204:207], v[88:103]
    s_waitcnt lgkmcnt(8)
    v_mfma_f32_32x32x16_bf16 v[104:119], v[68:71], v[204:207], v[104:119]
    s_waitcnt lgkmcnt(6)
    v_mfma_f32_32x32x16_bf16 v[88:103], v[72:75], v[208:211], v[88:103]
    s_waitcnt lgkmcnt(4)
    v_mfma_f32_32x32x16_bf16 v[104:119], v[76:79], v[208:211], v[104:119]
    s_waitcnt lgkmcnt(2)
    v_mfma_f32_32x32x16_bf16 v[88:103], v[80:83], v[212:215], v[88:103]
    s_waitcnt lgkmcnt(0)
    v_mfma_f32_32x32x16_bf16 v[104:119], v[84:87], v[212:215], v[104:119]
    s_mov_b32 vcc_lo, 0
L_sp_57:
    ds_read_b32 v7, v6 offset:48
    s_waitcnt lgkmcnt(0)
    v_readfirstlane_b32 s38, v7
    s_cmp_ge_u32 s38, 4
    s_cbranch_scc1 L_ok_58
    s_sleep 1
    s_add_u32 vcc_lo, vcc_lo, 1
    s_cmp_lt_u32 vcc_lo, 0x400000
    s_cbranch_scc1 L_sp_57
L_ok_58:
    ds_read_b32 v7, v6
    ds_read_b64_tr_b16 v[24:25], v12 offset:32768
    ds_read_b64_tr_b16 v[26:27], v12 offset:33280
    ds_read_b64_tr_b16 v[28:29], v13 offset:32768
    ds_read_b64_tr_b16 v[30:31], v13 offset:33280
    ds_read_b64_tr_b16 v[32:33], v12 offset:34816
    ds_read_b64_tr_b16 v[34:35], v12 offset:35328
    ds_read_b64_tr_b16 v[36:37], v13 offset:34816
    ds_read_b64_tr_b16 v[38:39], v13 offset:35328
    ds_read_b64_tr_b16 v[40:41], v12 offset:36864
    ds_read_b64_tr_b16 v[42:43], v12 offset:37376
    ds_read_b64_tr_b16 v[44:45], v13 offset:36864
    ds_read_b64_tr_b16 v[46:47], v13 offset:37376
    ds_read_b64_tr_b16 v[48:49], v12 offset:38912
    ds_read_b64_tr_b16 v[50:51], v12 offset:39424
    ds_read_b64_tr_b16 v[52:53], v13 offset:38912
    ds_read_b64_tr_b16 v[54:55], v13 offset:39424
L_k3join_56:
    s_waitcnt vmcnt(0)
    s_waitcnt lgkmcnt(14)
    v_mfma_f32_32x32x16_bf16 v[88:103], v[24:27], v[216:219], v[88:103]
    s_waitcnt lgkmcnt(12)
    v_mfma_f32_32x32x16_bf16 v[104:119], v[28:31], v[216:219], v[104:119]
    s_waitcnt lgkmcnt(10)
    v_mfma_f32_32x32x16_bf16 v[88:103], v[32:35], v[220:223], v[88:103]
    s_waitcnt lgkmcnt(8)
    v_mfma_f32_32x32x16_bf16 v[104:119], v[36:39], v[220:223], v[104:119]
    s_waitcnt lgkmcnt(6)
    v_mfma_f32_32x32x16_bf16 v[88:103], v[40:43], v[224:227], v[88:103]
    s_waitcnt lgkmcnt(4)
    v_mfma_f32_32x32x16_bf16 v[104:119], v[44:47], v[224:227], v[104:119]
    s_waitcnt lgkmcnt(2)
    v_mfma_f32_32x32x16_bf16 v[88:103], v[48:51], v[228:231], v[88:103]
    s_waitcnt lgkmcnt(0)
    v_mfma_f32_32x32x16_bf16 v[104:119], v[52:55], v[228:231], v[104:119]
    s_cmp_eq_u32 s41, 1
    s_cbranch_scc1 L_k3_t1
    s_nop 15
    ds_write_b128 v18, v[104:107] offset:12288
    ds_write_b128 v18, v[108:111] offset:13312
    ds_write_b128 v18, v[112:115] offset:14336
    ds_write_b128 v18, v[116:119] offset:15360
    s_waitcnt vmcnt(0) lgkmcnt(0)
    ds_write_b32 v6, v8 offset:76
    v_mul_f32 v24, v88, v15
    v_mul_f32 v25, v89, v15
    v_mul_f32 v26, v90, v15
    v_mul_f32 v27, v91, v15
    v_mul_f32 v28, v92, v15
    v_mul_f32 v29, v93, v15
    v_mul_f32 v30, v94, v15
    v_mul_f32 v31, v95, v15
    v_mul_f32 v32, v96, v15
    v_mul_f32 v33, v97, v15
    v_mul_f32 v34, v98, v15
    v_mul_f32 v35, v99, v15
    v_mul_f32 v36, v100, v15
    v_mul_f32 v37, v101, v15
    v_mul_f32 v38, v102, v15
    v_mul_f32 v39, v103, v15
    s_mov_b32 vcc_lo, 0
L_sp_59:
    ds_read_b32 v7, v6 offset:64
    s_waitcnt lgkmcnt(0)
    v_readfirstlane_b32 s38, v7
    s_cmp_ge_u32 s38, 1
    s_cbranch_scc1 L_ok_60
    s_sleep 1
    s_add_u32 vcc_lo, vcc_lo, 1
    s_cmp_lt_u32 vcc_lo, 0x400000
    s_cbranch_scc1 L_sp_59
L_ok_60:
    ds_read_b128 v[56:59], v18 offset:0
    ds_read_b128 v[60:63], v18 offset:1024
    ds_read_b128 v[64:67], v18 offset:2048
    ds_read_b128 v[68:71], v18 offset:3072
    s_waitcnt lgkmcnt(3)
    v_fmac_f32 v24, v56, v14
    v_fmac_f32 v25, v57, v14
    v_fmac_f32 v26, v58, v14
    v_fmac_f32 v27, v59, v14
    v_cvt_pk_bf16_f32 v40, v24, v25
    v_cvt_pk_bf16_f32 v41, v26, v27
    s_waitcnt lgkmcnt(2)
    v_fmac_f32 v28, v60, v14
    v_fmac_f32 v29, v61, v14
    v_fmac_f32 v30, v62, v14
    v_fmac_f32 v31, v63, v14
    v_cvt_pk_bf16_f32 v42, v28, v29
    v_cvt_pk_bf16_f32 v43, v30, v31
    s_waitcnt lgkmcnt(1)
    v_fmac_f32 v32, v64, v14
    v_fmac_f32 v33, v65, v14
    v_fmac_f32 v34, v66, v14
    v_fmac_f32 v35, v67, v14
    v_cvt_pk_bf16_f32 v44, v32, v33
    v_cvt_pk_bf16_f32 v45, v34, v35
    s_waitcnt lgkmcnt(0)
    v_fmac_f32 v36, v68, v14
    v_fmac_f32 v37, v69, v14
    v_fmac_f32 v38, v70, v14
    v_fmac_f32 v39, v71, v14
    v_cvt_pk_bf16_f32 v46, v36, v37
    v_cvt_pk_bf16_f32 v47, v38, v39
    ds_write_b64 v17, v[40:41] offset:0
    ds_write_b64 v17, v[42:43] offset:16
    ds_write_b64 v17, v[44:45] offset:32
    ds_write_b64 v17, v[46:47] offset:48
    s_waitcnt lgkmcnt(0)
    ds_read_b128 v[24:27], v19 offset:0
    ds_read_b128 v[28:31], v19 offset:1280
    s_waitcnt lgkmcnt(1)
    buffer_store_dwordx4 v[24:27], v20, s[16:19], s36 offen offset:0
    s_waitcnt lgkmcnt(0)
    buffer_store_dwordx4 v[28:31], v20, s[16:19], s36 offen offset:1792
    s_endpgm
L_k3_t1:
    s_nop 15
    ds_write_b128 v18, v[88:91] offset:8192
    ds_write_b128 v18, v[92:95] offset:9216
    ds_write_b128 v18, v[96:99] offset:10240
    ds_write_b128 v18, v[100:103] offset:11264
    s_waitcnt vmcnt(0) lgkmcnt(0)
    ds_write_b32 v6, v8 offset:72
    v_mul_f32 v24, v104, v15
    v_mul_f32 v25, v105, v15
    v_mul_f32 v26, v106, v15
    v_mul_f32 v27, v107, v15
    v_mul_f32 v28, v108, v15
    v_mul_f32 v29, v109, v15
    v_mul_f32 v30, v110, v15
    v_mul_f32 v31, v111, v15
    v_mul_f32 v32, v112, v15
    v_mul_f32 v33, v113, v15
    v_mul_f32 v34, v114, v15
    v_mul_f32 v35, v115, v15
    v_mul_f32 v36, v116, v15
    v_mul_f32 v37, v117, v15
    v_mul_f32 v38, v118, v15
    v_mul_f32 v39, v119, v15
    s_mov_b32 vcc_lo, 0
L_sp_61:
    ds_read_b32 v7, v6 offset:68
    s_waitcnt lgkmcnt(0)
    v_readfirstlane_b32 s38, v7
    s_cmp_ge_u32 s38, 1
    s_cbranch_scc1 L_ok_62
    s_sleep 1
    s_add_u32 vcc_lo, vcc_lo, 1
    s_cmp_lt_u32 vcc_lo, 0x400000
    s_cbranch_scc1 L_sp_61
L_ok_62:
    ds_read_b128 v[56:59], v18 offset:4096
    ds_read_b128 v[60:63], v18 offset:5120
    ds_read_b128 v[64:67], v18 offset:6144
    ds_read_b128 v[68:71], v18 offset:7168
    s_waitcnt lgkmcnt(3)
    v_fmac_f32 v24, v56, v14
    v_fmac_f32 v25, v57, v14
    v_fmac_f32 v26, v58, v14
    v_fmac_f32 v27, v59, v14
    v_cvt_pk_bf16_f32 v40, v24, v25
    v_cvt_pk_bf16_f32 v41, v26, v27
    s_waitcnt lgkmcnt(2)
    v_fmac_f32 v28, v60, v14
    v_fmac_f32 v29, v61, v14
    v_fmac_f32 v30, v62, v14
    v_fmac_f32 v31, v63, v14
    v_cvt_pk_bf16_f32 v42, v28, v29
    v_cvt_pk_bf16_f32 v43, v30, v31
    s_waitcnt lgkmcnt(1)
    v_fmac_f32 v32, v64, v14
    v_fmac_f32 v33, v65, v14
    v_fmac_f32 v34, v66, v14
    v_fmac_f32 v35, v67, v14
    v_cvt_pk_bf16_f32 v44, v32, v33
    v_cvt_pk_bf16_f32 v45, v34, v35
    s_waitcnt lgkmcnt(0)
    v_fmac_f32 v36, v68, v14
    v_fmac_f32 v37, v69, v14
    v_fmac_f32 v38, v70, v14
    v_fmac_f32 v39, v71, v14
    v_cvt_pk_bf16_f32 v46, v36, v37
    v_cvt_pk_bf16_f32 v47, v38, v39
    ds_write_b64 v17, v[40:41] offset:4096
    ds_write_b64 v17, v[42:43] offset:4112
    ds_write_b64 v17, v[44:45] offset:4128
    ds_write_b64 v17, v[46:47] offset:4144
    s_waitcnt lgkmcnt(0)
    ds_read_b128 v[24:27], v19 offset:4096
    ds_read_b128 v[28:31], v19 offset:5376
    s_waitcnt lgkmcnt(1)
    buffer_store_dwordx4 v[24:27], v20, s[16:19], s36 offen offset:0
    s_waitcnt lgkmcnt(0)
    buffer_store_dwordx4 v[28:31], v20, s[16:19], s36 offen offset:1792
    s_endpgm
L_k3_F:
    s_mov_b32 vcc_lo, 0
L_sp_63:
    ds_read_b32 v7, v6 offset:0
    s_waitcnt lgkmcnt(0)
    v_readfirstlane_b32 s38, v7
    s_cmp_ge_u32 s38, 4
    s_cbranch_scc1 L_ok_64
    s_sleep 1
    s_add_u32 vcc_lo, vcc_lo, 1
    s_cmp_lt_u32 vcc_lo, 0x400000
    s_cbranch_scc1 L_sp_63
L_ok_64:
    ds_read_b32 v7, v6 offset:8
    ds_read_b64_tr_b16 v[24:25], v10 offset:0
    ds_read_b64_tr_b16 v[26:27], v10 offset:512
    ds_read_b64_tr_b16 v[28:29], v11 offset:0
    ds_read_b64_tr_b16 v[30:31], v11 offset:512
    ds_read_b64_tr_b16 v[32:33], v10 offset:2048
    ds_read_b64_tr_b16 v[34:35], v10 offset:2560
    ds_read_b64_tr_b16 v[36:37], v11 offset:2048
    ds_read_b64_tr_b16 v[38:39], v11 offset:2560
    ds_read_b64_tr_b16 v[40:41], v10 offset:4096
    ds_read_b64_tr_b16 v[42:43], v10 offset:4608
    ds_read_b64_tr_b16 v[44:45], v11 offset:4096
    ds_read_b64_tr_b16 v[46:47], v11 offset:4608
    ds_read_b64_tr_b16 v[48:49], v10 offset:6144
    ds_read_b64_tr_b16 v[50:51], v10 offset:6656
    ds_read_b64_tr_b16 v[52:53], v11 offset:6144
    ds_read_b64_tr_b16 v[54:55], v11 offset:6656
    buffer_load_dwordx4 v[152:155], v9, s[44:47], s42 offen offset:0
    buffer_load_dwordx4 v[156:159], v9, s[44:47], s42 offen offset:1024
    buffer_load_dwordx4 v[160:163], v9, s[44:47], s42 offen offset:2048
    buffer_load_dwordx4 v[164:167], v9, s[44:47], s42 offen offset:3072
    s_add_u32 s42, s42, 4096
    s_waitcnt lgkmcnt(15)
    v_readfirstlane_b32 s38, v7
    s_waitcnt vmcnt(9)
    s_cmp_ge_u32 s38, 4
    s_cbranch_scc0 L_k3slow_65
    s_waitcnt lgkmcnt(14)
    v_mfma_f32_32x32x16_bf16 v[88:103], v[120:123], v[24:27], 0
    ds_read_b32 v7, v6 offset:16
    ds_read_b64_tr_b16 v[56:57], v10 offset:16384
    ds_read_b64_tr_b16 v[58:59], v10 offset:16896
    s_waitcnt lgkmcnt(15)
    v_mfma_f32_32x32x16_bf16 v[104:119], v[120:123], v[28:31], 0
    ds_read_b64_tr_b16 v[60:61], v11 offset:16384
    ds_read_b64_tr_b16 v[62:63], v11 offset:16896
    ds_read_b64_tr_b16 v[64:65], v10 offset:18432
    s_waitcnt lgkmcnt(15)
    v_mfma_f32_32x32x16_bf16 v[88:103], v[124:127], v[32:35], v[88:103]
    ds_read_b64_tr_b16 v[66:67], v10 offset:18944
    ds_read_b64_tr_b16 v[68:69], v11 offset:18432
    ds_read_b64_tr_b16 v[70:71], v11 offset:18944
    s_waitcnt lgkmcnt(15)
    v_mfma_f32_32x32x16_bf16 v[104:119], v[124:127], v[36:39], v[104:119]
    ds_read_b64_tr_b16 v[72:73], v10 offset:20480
    ds_read_b64_tr_b16 v[74:75], v10 offset:20992
    ds_read_b64_tr_b16 v[76:77], v11 offset:20480
    s_waitcnt lgkmcnt(15)
    v_mfma_f32_32x32x16_bf16 v[88:103], v[128:131], v[40:43], v[88:103]
    ds_read_b64_tr_b16 v[78:79], v11 offset:20992
    ds_read_b64_tr_b16 v[80:81], v10 offset:22528
    ds_read_b64_tr_b16 v[82:83], v10 offset:23040
    s_waitcnt lgkmcnt(15)
    v_mfma_f32_32x32x16_bf16 v[104:119], v[128:131], v[44:47], v[104:119]
    ds_read_b64_tr_b16 v[84:85], v11 offset:22528
    ds_read_b64_tr_b16 v[86:87], v11 offset:23040
    s_waitcnt lgkmcnt(15)
    v_mfma_f32_32x32x16_bf16 v[88:103], v[132:135], v[48:51], v[88:103]
    s_waitcnt lgkmcnt(15)
    v_mfma_f32_32x32x16_bf16 v[104:119], v[132:135], v[52:55], v[104:119]
    s_branch L_k3join_66
L_k3slow_65:
    s_waitcnt lgkmcnt(14)
    v_mfma_f32_32x32x16_bf16 v[88:103], v[120:123], v[24:27], 0
    s_waitcnt lgkmcnt(12)
    v_mfma_f32_32x32x16_bf16 v[104:119], v[120:123], v[28:31], 0
    s_waitcnt lgkmcnt(10)
    v_mfma_f32_32x32x16_bf16 v[88:103], v[124:127], v[32:35], v[88:103]
    s_waitcnt lgkmcnt(8)
    v_mfma_f32_32x32x16_bf16 v[104:119], v[124:127], v[36:39], v[104:119]
    s_waitcnt lgkmcnt(6)
    v_mfma_f32_32x32x16_bf16 v[88:103], v[128:131], v[40:43], v[88:103]
    s_waitcnt lgkmcnt(4)
    v_mfma_f32_32x32x16_bf16 v[104:119], v[128:131], v[44:47], v[104:119]
    s_waitcnt lgkmcnt(2)
    v_mfma_f32_32x32x16_bf16 v[88:103], v[132:135], v[48:51], v[88:103]
    s_waitcnt lgkmcnt(0)
    v_mfma_f32_32x32x16_bf16 v[104:119], v[132:135], v[52:55], v[104:119]
    s_mov_b32 vcc_lo, 0
L_sp_67:
    ds_read_b32 v7, v6 offset:8
    s_waitcnt lgkmcnt(0)
    v_readfirstlane_b32 s38, v7
    s_cmp_ge_u32 s38, 4
    s_cbranch_scc1 L_ok_68
    s_sleep 1
    s_add_u32 vcc_lo, vcc_lo, 1
    s_cmp_lt_u32 vcc_lo, 0x400000
    s_cbranch_scc1 L_sp_67
L_ok_68:
    ds_read_b32 v7, v6 offset:16
    ds_read_b64_tr_b16 v[56:57], v10 offset:16384
    ds_read_b64_tr_b16 v[58:59], v10 offset:16896
    ds_read_b64_tr_b16 v[60:61], v11 offset:16384
    ds_read_b64_tr_b16 v[62:63], v11 offset:16896
    ds_read_b64_tr_b16 v[64:65], v10 offset:18432
    ds_read_b64_tr_b16 v[66:67], v10 offset:18944
    ds_read_b64_tr_b16 v[68:69], v11 offset:18432
    ds_read_b64_tr_b16 v[70:71], v11 offset:18944
    ds_read_b64_tr_b16 v[72:73], v10 offset:20480
    ds_read_b64_tr_b16 v[74:75], v10 offset:20992
    ds_read_b64_tr_b16 v[76:77], v11 offset:20480
    ds_read_b64_tr_b16 v[78:79], v11 offset:20992
    ds_read_b64_tr_b16 v[80:81], v10 offset:22528
    ds_read_b64_tr_b16 v[82:83], v10 offset:23040
    ds_read_b64_tr_b16 v[84:85], v11 offset:22528
    ds_read_b64_tr_b16 v[86:87], v11 offset:23040
L_k3join_66:
    buffer_load_dwordx4 v[168:171], v9, s[44:47], s42 offen offset:0
    buffer_load_dwordx4 v[172:175], v9, s[44:47], s42 offen offset:1024
    buffer_load_dwordx4 v[176:179], v9, s[44:47], s42 offen offset:2048
    buffer_load_dwordx4 v[180:183], v9, s[44:47], s42 offen offset:3072
    s_add_u32 s42, s42, 4096
    s_waitcnt lgkmcnt(15)
    v_readfirstlane_b32 s38, v7
    s_waitcnt vmcnt(9)
    s_cmp_ge_u32 s38, 4
    s_cbranch_scc0 L_k3slow_69
    s_waitcnt lgkmcnt(14)
    v_mfma_f32_32x32x16_bf16 v[88:103], v[136:139], v[56:59], v[88:103]
    ds_read_b32 v7, v6 offset:24
    ds_read_b64_tr_b16 v[24:25], v10 offset:32768
    ds_read_b64_tr_b16 v[26:27], v10 offset:33280
    s_waitcnt lgkmcnt(15)
    v_mfma_f32_32x32x16_bf16 v[104:119], v[136:139], v[60:63], v[104:119]
    ds_read_b64_tr_b16 v[28:29], v11 offset:32768
    ds_read_b64_tr_b16 v[30:31], v11 offset:33280
    ds_read_b64_tr_b16 v[32:33], v10 offset:34816
    s_waitcnt lgkmcnt(15)
    v_mfma_f32_32x32x16_bf16 v[88:103], v[140:143], v[64:67], v[88:103]
    ds_read_b64_tr_b16 v[34:35], v10 offset:35328
    ds_read_b64_tr_b16 v[36:37], v11 offset:34816
    ds_read_b64_tr_b16 v[38:39], v11 offset:35328
    s_waitcnt lgkmcnt(15)
    v_mfma_f32_32x32x16_bf16 v[104:119], v[140:143], v[68:71], v[104:119]
    ds_read_b64_tr_b16 v[40:41], v10 offset:36864
    ds_read_b64_tr_b16 v[42:43], v10 offset:37376
    ds_read_b64_tr_b16 v[44:45], v11 offset:36864
    s_waitcnt lgkmcnt(15)
    v_mfma_f32_32x32x16_bf16 v[88:103], v[144:147], v[72:75], v[88:103]
    ds_read_b64_tr_b16 v[46:47], v11 offset:37376
    ds_read_b64_tr_b16 v[48:49], v10 offset:38912
    ds_read_b64_tr_b16 v[50:51], v10 offset:39424
    s_waitcnt lgkmcnt(15)
    v_mfma_f32_32x32x16_bf16 v[104:119], v[144:147], v[76:79], v[104:119]
    ds_read_b64_tr_b16 v[52:53], v11 offset:38912
    ds_read_b64_tr_b16 v[54:55], v11 offset:39424
    s_waitcnt lgkmcnt(15)
    v_mfma_f32_32x32x16_bf16 v[88:103], v[148:151], v[80:83], v[88:103]
    s_waitcnt lgkmcnt(15)
    v_mfma_f32_32x32x16_bf16 v[104:119], v[148:151], v[84:87], v[104:119]
    s_branch L_k3join_70
L_k3slow_69:
    s_waitcnt lgkmcnt(14)
    v_mfma_f32_32x32x16_bf16 v[88:103], v[136:139], v[56:59], v[88:103]
    s_waitcnt lgkmcnt(12)
    v_mfma_f32_32x32x16_bf16 v[104:119], v[136:139], v[60:63], v[104:119]
    s_waitcnt lgkmcnt(10)
    v_mfma_f32_32x32x16_bf16 v[88:103], v[140:143], v[64:67], v[88:103]
    s_waitcnt lgkmcnt(8)
    v_mfma_f32_32x32x16_bf16 v[104:119], v[140:143], v[68:71], v[104:119]
    s_waitcnt lgkmcnt(6)
    v_mfma_f32_32x32x16_bf16 v[88:103], v[144:147], v[72:75], v[88:103]
    s_waitcnt lgkmcnt(4)
    v_mfma_f32_32x32x16_bf16 v[104:119], v[144:147], v[76:79], v[104:119]
    s_waitcnt lgkmcnt(2)
    v_mfma_f32_32x32x16_bf16 v[88:103], v[148:151], v[80:83], v[88:103]
    s_waitcnt lgkmcnt(0)
    v_mfma_f32_32x32x16_bf16 v[104:119], v[148:151], v[84:87], v[104:119]
    s_mov_b32 vcc_lo, 0
L_sp_71:
    ds_read_b32 v7, v6 offset:16
    s_waitcnt lgkmcnt(0)
    v_readfirstlane_b32 s38, v7
    s_cmp_ge_u32 s38, 4
    s_cbranch_scc1 L_ok_72
    s_sleep 1
    s_add_u32 vcc_lo, vcc_lo, 1
    s_cmp_lt_u32 vcc_lo, 0x400000
    s_cbranch_scc1 L_sp_71
L_ok_72:
    ds_read_b32 v7, v6 offset:24
    ds_read_b64_tr_b16 v[24:25], v10 offset:32768
    ds_read_b64_tr_b16 v[26:27], v10 offset:33280
    ds_read_b64_tr_b16 v[28:29], v11 offset:32768
    ds_read_b64_tr_b16 v[30:31], v11 offset:33280
    ds_read_b64_tr_b16 v[32:33], v10 offset:34816
    ds_read_b64_tr_b16 v[34:35], v10 offset:35328
    ds_read_b64_tr_b16 v[36:37], v11 offset:34816
    ds_read_b64_tr_b16 v[38:39], v11 offset:35328
    ds_read_b64_tr_b16 v[40:41], v10 offset:36864
    ds_read_b64_tr_b16 v[42:43], v10 offset:37376
    ds_read_b64_tr_b16 v[44:45], v11 offset:36864
    ds_read_b64_tr_b16 v[46:47], v11 offset:37376
    ds_read_b64_tr_b16 v[48:49], v10 offset:38912
    ds_read_b64_tr_b16 v[50:51], v10 offset:39424
    ds_read_b64_tr_b16 v[52:53], v11 offset:38912
    ds_read_b64_tr_b16 v[54:55], v11 offset:39424
L_k3join_70:
    buffer_load_dwordx4 v[184:187], v9, s[44:47], s42 offen offset:0
    buffer_load_dwordx4 v[188:191], v9, s[44:47], s42 offen offset:1024
    buffer_load_dwordx4 v[192:195], v9, s[44:47], s42 offen offset:2048
    buffer_load_dwordx4 v[196:199], v9, s[44:47], s42 offen offset:3072
    s_add_u32 s42, s42, 4096
    s_waitcnt lgkmcnt(15)
    v_readfirstlane_b32 s38, v7
    s_waitcnt vmcnt(8)
    s_cmp_ge_u32 s38, 4
    s_cbranch_scc0 L_k3slow_73
    s_waitcnt lgkmcnt(14)
    v_mfma_f32_32x32x16_bf16 v[88:103], v[152:155], v[24:27], v[88:103]
    ds_read_b32 v7, v6 offset:32
    ds_read_b64_tr_b16 v[56:57], v10 offset:49152
    ds_read_b64_tr_b16 v[58:59], v10 offset:49664
    s_waitcnt lgkmcnt(15)
    v_mfma_f32_32x32x16_bf16 v[104:119], v[152:155], v[28:31], v[104:119]
    ds_read_b64_tr_b16 v[60:61], v11 offset:49152
    ds_read_b64_tr_b16 v[62:63], v11 offset:49664
    ds_read_b64_tr_b16 v[64:65], v10 offset:51200
    s_waitcnt lgkmcnt(15)
    v_mfma_f32_32x32x16_bf16 v[88:103], v[156:159], v[32:35], v[88:103]
    ds_read_b64_tr_b16 v[66:67], v10 offset:51712
    ds_read_b64_tr_b16 v[68:69], v11 offset:51200
    ds_read_b64_tr_b16 v[70:71], v11 offset:51712
    s_waitcnt lgkmcnt(15)
    v_mfma_f32_32x32x16_bf16 v[104:119], v[156:159], v[36:39], v[104:119]
    ds_read_b64_tr_b16 v[72:73], v10 offset:53248
    ds_read_b64_tr_b16 v[74:75], v10 offset:53760
    ds_read_b64_tr_b16 v[76:77], v11 offset:53248
    s_waitcnt lgkmcnt(15)
    v_mfma_f32_32x32x16_bf16 v[88:103], v[160:163], v[40:43], v[88:103]
    ds_read_b64_tr_b16 v[78:79], v11 offset:53760
    ds_read_b64_tr_b16 v[80:81], v10 offset:55296
    ds_read_b64_tr_b16 v[82:83], v10 offset:55808
    s_waitcnt lgkmcnt(15)
    v_mfma_f32_32x32x16_bf16 v[104:119], v[160:163], v[44:47], v[104:119]
    ds_read_b64_tr_b16 v[84:85], v11 offset:55296
    ds_read_b64_tr_b16 v[86:87], v11 offset:55808
    s_waitcnt lgkmcnt(15)
    v_mfma_f32_32x32x16_bf16 v[88:103], v[164:167], v[48:51], v[88:103]
    s_waitcnt lgkmcnt(15)
    v_mfma_f32_32x32x16_bf16 v[104:119], v[164:167], v[52:55], v[104:119]
    s_branch L_k3join_74
L_k3slow_73:
    s_waitcnt lgkmcnt(14)
    v_mfma_f32_32x32x16_bf16 v[88:103], v[152:155], v[24:27], v[88:103]
    s_waitcnt lgkmcnt(12)
    v_mfma_f32_32x32x16_bf16 v[104:119], v[152:155], v[28:31], v[104:119]
    s_waitcnt lgkmcnt(10)
    v_mfma_f32_32x32x16_bf16 v[88:103], v[156:159], v[32:35], v[88:103]
    s_waitcnt lgkmcnt(8)
    v_mfma_f32_32x32x16_bf16 v[104:119], v[156:159], v[36:39], v[104:119]
    s_waitcnt lgkmcnt(6)
    v_mfma_f32_32x32x16_bf16 v[88:103], v[160:163], v[40:43], v[88:103]
    s_waitcnt lgkmcnt(4)
    v_mfma_f32_32x32x16_bf16 v[104:119], v[160:163], v[44:47], v[104:119]
    s_waitcnt lgkmcnt(2)
    v_mfma_f32_32x32x16_bf16 v[88:103], v[164:167], v[48:51], v[88:103]
    s_waitcnt lgkmcnt(0)
    v_mfma_f32_32x32x16_bf16 v[104:119], v[164:167], v[52:55], v[104:119]
    s_mov_b32 vcc_lo, 0
L_sp_75:
    ds_read_b32 v7, v6 offset:24
    s_waitcnt lgkmcnt(0)
    v_readfirstlane_b32 s38, v7
    s_cmp_ge_u32 s38, 4
    s_cbranch_scc1 L_ok_76
    s_sleep 1
    s_add_u32 vcc_lo, vcc_lo, 1
    s_cmp_lt_u32 vcc_lo, 0x400000
    s_cbranch_scc1 L_sp_75
L_ok_76:
    ds_read_b32 v7, v6 offset:32
    ds_read_b64_tr_b16 v[56:57], v10 offset:49152
    ds_read_b64_tr_b16 v[58:59], v10 offset:49664
    ds_read_b64_tr_b16 v[60:61], v11 offset:49152
    ds_read_b64_tr_b16 v[62:63], v11 offset:49664
    ds_read_b64_tr_b16 v[64:65], v10 offset:51200
    ds_read_b64_tr_b16 v[66:67], v10 offset:51712
    ds_read_b64_tr_b16 v[68:69], v11 offset:51200
    ds_read_b64_tr_b16 v[70:71], v11 offset:51712
    ds_read_b64_tr_b16 v[72:73], v10 offset:53248
    ds_read_b64_tr_b16 v[74:75], v10 offset:53760
    ds_read_b64_tr_b16 v[76:77], v11 offset:53248
    ds_read_b64_tr_b16 v[78:79], v11 offset:53760
    ds_read_b64_tr_b16 v[80:81], v10 offset:55296
    ds_read_b64_tr_b16 v[82:83], v10 offset:55808
    ds_read_b64_tr_b16 v[84:85], v11 offset:55296
    ds_read_b64_tr_b16 v[86:87], v11 offset:55808
L_k3join_74:
    buffer_load_dwordx4 v[200:203], v9, s[44:47], s42 offen offset:0
    buffer_load_dwordx4 v[204:207], v9, s[44:47], s42 offen offset:1024
    buffer_load_dwordx4 v[208:211], v9, s[44:47], s42 offen offset:2048
    buffer_load_dwordx4 v[212:215], v9, s[44:47], s42 offen offset:3072
    s_add_u32 s42, s42, 4096
    s_waitcnt lgkmcnt(15)
    v_readfirstlane_b32 s38, v7
    s_waitcnt vmcnt(8)
    s_cmp_ge_u32 s38, 4
    s_cbranch_scc0 L_k3slow_77
    s_waitcnt lgkmcnt(14)
    v_mfma_f32_32x32x16_bf16 v[88:103], v[168:171], v[56:59], v[88:103]
    ds_read_b32 v7, v6 offset:40
    ds_read_b64_tr_b16 v[24:25], v12 offset:0
    ds_read_b64_tr_b16 v[26:27], v12 offset:512
    s_waitcnt lgkmcnt(15)
    v_mfma_f32_32x32x16_bf16 v[104:119], v[168:171], v[60:63], v[104:119]
    ds_read_b64_tr_b16 v[28:29], v13 offset:0
    ds_read_b64_tr_b16 v[30:31], v13 offset:512
    ds_read_b64_tr_b16 v[32:33], v12 offset:2048
    s_waitcnt lgkmcnt(15)
    v_mfma_f32_32x32x16_bf16 v[88:103], v[172:175], v[64:67], v[88:103]
    ds_read_b64_tr_b16 v[34:35], v12 offset:2560
    ds_read_b64_tr_b16 v[36:37], v13 offset:2048
    ds_read_b64_tr_b16 v[38:39], v13 offset:2560
    s_waitcnt lgkmcnt(15)
    v_mfma_f32_32x32x16_bf16 v[104:119], v[172:175], v[68:71], v[104:119]
    ds_read_b64_tr_b16 v[40:41], v12 offset:4096
    ds_read_b64_tr_b16 v[42:43], v12 offset:4608
    ds_read_b64_tr_b16 v[44:45], v13 offset:4096
    s_waitcnt lgkmcnt(15)
    v_mfma_f32_32x32x16_bf16 v[88:103], v[176:179], v[72:75], v[88:103]
    ds_read_b64_tr_b16 v[46:47], v13 offset:4608
    ds_read_b64_tr_b16 v[48:49], v12 offset:6144
    ds_read_b64_tr_b16 v[50:51], v12 offset:6656
    s_waitcnt lgkmcnt(15)
    v_mfma_f32_32x32x16_bf16 v[104:119], v[176:179], v[76:79], v[104:119]
    ds_read_b64_tr_b16 v[52:53], v13 offset:6144
    ds_read_b64_tr_b16 v[54:55], v13 offset:6656
    s_waitcnt lgkmcnt(15)
    v_mfma_f32_32x32x16_bf16 v[88:103], v[180:183], v[80:83], v[88:103]
    s_waitcnt lgkmcnt(15)
    v_mfma_f32_32x32x16_bf16 v[104:119], v[180:183], v[84:87], v[104:119]
    s_branch L_k3join_78
L_k3slow_77:
    s_waitcnt lgkmcnt(14)
    v_mfma_f32_32x32x16_bf16 v[88:103], v[168:171], v[56:59], v[88:103]
    s_waitcnt lgkmcnt(12)
    v_mfma_f32_32x32x16_bf16 v[104:119], v[168:171], v[60:63], v[104:119]
    s_waitcnt lgkmcnt(10)
    v_mfma_f32_32x32x16_bf16 v[88:103], v[172:175], v[64:67], v[88:103]
    s_waitcnt lgkmcnt(8)
    v_mfma_f32_32x32x16_bf16 v[104:119], v[172:175], v[68:71], v[104:119]
    s_waitcnt lgkmcnt(6)
    v_mfma_f32_32x32x16_bf16 v[88:103], v[176:179], v[72:75], v[88:103]
    s_waitcnt lgkmcnt(4)
    v_mfma_f32_32x32x16_bf16 v[104:119], v[176:179], v[76:79], v[104:119]
    s_waitcnt lgkmcnt(2)
    v_mfma_f32_32x32x16_bf16 v[88:103], v[180:183], v[80:83], v[88:103]
    s_waitcnt lgkmcnt(0)
    v_mfma_f32_32x32x16_bf16 v[104:119], v[180:183], v[84:87], v[104:119]
    s_mov_b32 vcc_lo, 0
L_sp_79:
    ds_read_b32 v7, v6 offset:32
    s_waitcnt lgkmcnt(0)
    v_readfirstlane_b32 s38, v7
    s_cmp_ge_u32 s38, 4
    s_cbranch_scc1 L_ok_80
    s_sleep 1
    s_add_u32 vcc_lo, vcc_lo, 1
    s_cmp_lt_u32 vcc_lo, 0x400000
    s_cbranch_scc1 L_sp_79
L_ok_80:
    ds_read_b32 v7, v6 offset:40
    ds_read_b64_tr_b16 v[24:25], v12 offset:0
    ds_read_b64_tr_b16 v[26:27], v12 offset:512
    ds_read_b64_tr_b16 v[28:29], v13 offset:0
    ds_read_b64_tr_b16 v[30:31], v13 offset:512
    ds_read_b64_tr_b16 v[32:33], v12 offset:2048
    ds_read_b64_tr_b16 v[34:35], v12 offset:2560
    ds_read_b64_tr_b16 v[36:37], v13 offset:2048
    ds_read_b64_tr_b16 v[38:39], v13 offset:2560
    ds_read_b64_tr_b16 v[40:41], v12 offset:4096
    ds_read_b64_tr_b16 v[42:43], v12 offset:4608
    ds_read_b64_tr_b16 v[44:45], v13 offset:4096
    ds_read_b64_tr_b16 v[46:47], v13 offset:4608
    ds_read_b64_tr_b16 v[48:49], v12 offset:6144
    ds_read_b64_tr_b16 v[50:51], v12 offset:6656
    ds_read_b64_tr_b16 v[52:53], v13 offset:6144
    ds_read_b64_tr_b16 v[54:55], v13 offset:6656
L_k3join_78:
    buffer_load_dwordx4 v[216:219], v9, s[44:47], s42 offen offset:0
    buffer_load_dwordx4 v[220:223], v9, s[44:47], s42 offen offset:1024
    buffer_load_dwordx4 v[224:227], v9, s[44:47], s42 offen offset:2048
    buffer_load_dwordx4 v[228:231], v9, s[44:47], s42 offen offset:3072
    s_add_u32 s42, s42, 4096
    s_waitcnt lgkmcnt(15)
    v_readfirstlane_b32 s38, v7
    s_waitcnt vmcnt(8)
    s_cmp_ge_u32 s38, 4
    s_cbranch_scc0 L_k3slow_81
    s_waitcnt lgkmcnt(14)
    v_mfma_f32_32x32x16_bf16 v[88:103], v[184:187], v[24:27], v[88:103]
    ds_read_b32 v7, v6 offset:48
    ds_read_b64_tr_b16 v[56:57], v12 offset:16384
    ds_read_b64_tr_b16 v[58:59], v12 offset:16896
    s_waitcnt lgkmcnt(15)
    v_mfma_f32_32x32x16_bf16 v[104:119], v[184:187], v[28:31], v[104:119]
    ds_read_b64_tr_b16 v[60:61], v13 offset:16384
    ds_read_b64_tr_b16 v[62:63], v13 offset:16896
    ds_read_b64_tr_b16 v[64:65], v12 offset:18432
    s_waitcnt lgkmcnt(15)
    v_mfma_f32_32x32x16_bf16 v[88:103], v[188:191], v[32:35], v[88:103]
    ds_read_b64_tr_b16 v[66:67], v12 offset:18944
    ds_read_b64_tr_b16 v[68:69], v13 offset:18432
    ds_read_b64_tr_b16 v[70:71], v13 offset:18944
    s_waitcnt lgkmcnt(15)
    v_mfma_f32_32x32x16_bf16 v[104:119], v[188:191], v[36:39], v[104:119]
    ds_read_b64_tr_b16 v[72:73], v12 offset:20480
    ds_read_b64_tr_b16 v[74:75], v12 offset:20992
    ds_read_b64_tr_b16 v[76:77], v13 offset:20480
    s_waitcnt lgkmcnt(15)
    v_mfma_f32_32x32x16_bf16 v[88:103], v[192:195], v[40:43], v[88:103]
    ds_read_b64_tr_b16 v[78:79], v13 offset:20992
    ds_read_b64_tr_b16 v[80:81], v12 offset:22528
    ds_read_b64_tr_b16 v[82:83], v12 offset:23040
    s_waitcnt lgkmcnt(15)
    v_mfma_f32_32x32x16_bf16 v[104:119], v[192:195], v[44:47], v[104:119]
    ds_read_b64_tr_b16 v[84:85], v13 offset:22528
    ds_read_b64_tr_b16 v[86:87], v13 offset:23040
    s_waitcnt lgkmcnt(15)
    v_mfma_f32_32x32x16_bf16 v[88:103], v[196:199], v[48:51], v[88:103]
    s_waitcnt lgkmcnt(15)
    v_mfma_f32_32x32x16_bf16 v[104:119], v[196:199], v[52:55], v[104:119]
    s_branch L_k3join_82
L_k3slow_81:
    s_waitcnt lgkmcnt(14)
    v_mfma_f32_32x32x16_bf16 v[88:103], v[184:187], v[24:27], v[88:103]
    s_waitcnt lgkmcnt(12)
    v_mfma_f32_32x32x16_bf16 v[104:119], v[184:187], v[28:31], v[104:119]
    s_waitcnt lgkmcnt(10)
    v_mfma_f32_32x32x16_bf16 v[88:103], v[188:191], v[32:35], v[88:103]
    s_waitcnt lgkmcnt(8)
    v_mfma_f32_32x32x16_bf16 v[104:119], v[188:191], v[36:39], v[104:119]
    s_waitcnt lgkmcnt(6)
    v_mfma_f32_32x32x16_bf16 v[88:103], v[192:195], v[40:43], v[88:103]
    s_waitcnt lgkmcnt(4)
    v_mfma_f32_32x32x16_bf16 v[104:119], v[192:195], v[44:47], v[104:119]
    s_waitcnt lgkmcnt(2)
    v_mfma_f32_32x32x16_bf16 v[88:103], v[196:199], v[48:51], v[88:103]
    s_waitcnt lgkmcnt(0)
    v_mfma_f32_32x32x16_bf16 v[104:119], v[196:199], v[52:55], v[104:119]
    s_mov_b32 vcc_lo, 0
L_sp_83:
    ds_read_b32 v7, v6 offset:40
    s_waitcnt lgkmcnt(0)
    v_readfirstlane_b32 s38, v7
    s_cmp_ge_u32 s38, 4
    s_cbranch_scc1 L_ok_84
    s_sleep 1
    s_add_u32 vcc_lo, vcc_lo, 1
    s_cmp_lt_u32 vcc_lo, 0x400000
    s_cbranch_scc1 L_sp_83
L_ok_84:
    ds_read_b32 v7, v6 offset:48
    ds_read_b64_tr_b16 v[56:57], v12 offset:16384
    ds_read_b64_tr_b16 v[58:59], v12 offset:16896
    ds_read_b64_tr_b16 v[60:61], v13 offset:16384
    ds_read_b64_tr_b16 v[62:63], v13 offset:16896
    ds_read_b64_tr_b16 v[64:65], v12 offset:18432
    ds_read_b64_tr_b16 v[66:67], v12 offset:18944
    ds_read_b64_tr_b16 v[68:69], v13 offset:18432
    ds_read_b64_tr_b16 v[70:71], v13 offset:18944
    ds_read_b64_tr_b16 v[72:73], v12 offset:20480
    ds_read_b64_tr_b16 v[74:75], v12 offset:20992
    ds_read_b64_tr_b16 v[76:77], v13 offset:20480
    ds_read_b64_tr_b16 v[78:79], v13 offset:20992
    ds_read_b64_tr_b16 v[80:81], v12 offset:22528
    ds_read_b64_tr_b16 v[82:83], v12 offset:23040
    ds_read_b64_tr_b16 v[84:85], v13 offset:22528
    ds_read_b64_tr_b16 v[86:87], v13 offset:23040
L_k3join_82:
    s_waitcnt lgkmcnt(15)
    v_readfirstlane_b32 s38, v7
    s_waitcnt vmcnt(4)
    s_cmp_ge_u32 s38, 4
    s_cbranch_scc0 L_k3slow_85
    s_waitcnt lgkmcnt(14)
    v_mfma_f32_32x32x16_bf16 v[88:103], v[200:203], v[56:59], v[88:103]
    ds_read_b32 v7, v6
    ds_read_b64_tr_b16 v[24:25], v12 offset:32768
    ds_read_b64_tr_b16 v[26:27], v12 offset:33280
    s_waitcnt lgkmcnt(15)
    v_mfma_f32_32x32x16_bf16 v[104:119], v[200:203], v[60:63], v[104:119]
    ds_read_b64_tr_b16 v[28:29], v13 offset:32768
    ds_read_b64_tr_b16 v[30:31], v13 offset:33280
    ds_read_b64_tr_b16 v[32:33], v12 offset:34816
    s_waitcnt lgkmcnt(15)
    v_mfma_f32_32x32x16_bf16 v[88:103], v[204:207], v[64:67], v[88:103]
    ds_read_b64_tr_b16 v[34:35], v12 offset:35328
    ds_read_b64_tr_b16 v[36:37], v13 offset:34816
    ds_read_b64_tr_b16 v[38:39], v13 offset:35328
    s_waitcnt lgkmcnt(15)
    v_mfma_f32_32x32x16_bf16 v[104:119], v[204:207], v[68:71], v[104:119]
    ds_read_b64_tr_b16 v[40:41], v12 offset:36864
    ds_read_b64_tr_b16 v[42:43], v12 offset:37376
    ds_read_b64_tr_b16 v[44:45], v13 offset:36864
    s_waitcnt lgkmcnt(15)
    v_mfma_f32_32x32x16_bf16 v[88:103], v[208:211], v[72:75], v[88:103]
    ds_read_b64_tr_b16 v[46:47], v13 offset:37376
    ds_read_b64_tr_b16 v[48:49], v12 offset:38912
    ds_read_b64_tr_b16 v[50:51], v12 offset:39424
    s_waitcnt lgkmcnt(15)
    v_mfma_f32_32x32x16_bf16 v[104:119], v[208:211], v[76:79], v[104:119]
    ds_read_b64_tr_b16 v[52:53], v13 offset:38912
    ds_read_b64_tr_b16 v[54:55], v13 offset:39424
    s_waitcnt lgkmcnt(15)
    v_mfma_f32_32x32x16_bf16 v[88:103], v[212:215], v[80:83], v[88:103]
    s_waitcnt lgkmcnt(15)
    v_mfma_f32_32x32x16_bf16 v[104:119], v[212:215], v[84:87], v[104:119]
    s_branch L_k3join_86
L_k3slow_85:
    s_waitcnt lgkmcnt(14)
    v_mfma_f32_32x32x16_bf16 v[88:103], v[200:203], v[56:59], v[88:103]
    s_waitcnt lgkmcnt(12)
    v_mfma_f32_32x32x16_bf16 v[104:119], v[200:203], v[60:63], v[104:119]
    s_waitcnt lgkmcnt(10)
    v_mfma_f32_32x32x16_bf16 v[88:103], v[204:207], v[64:67], v[88:103]
    s_waitcnt lgkmcnt(8)
    v_mfma_f32_32x32x16_bf16 v[104:119], v[204:207], v[68:71], v[104:119]
    s_waitcnt lgkmcnt(6)
    v_mfma_f32_32x32x16_bf16 v[88:103], v[208:211], v[72:75], v[88:103]
    s_waitcnt lgkmcnt(4)
    v_mfma_f32_32x32x16_bf16 v[104:119], v[208:211], v[76:79], v[104:119]
    s_waitcnt lgkmcnt(2)
    v_mfma_f32_32x32x16_bf16 v[88:103], v[212:215], v[80:83], v[88:103]
    s_waitcnt lgkmcnt(0)
    v_mfma_f32_32x32x16_bf16 v[104:119], v[212:215], v[84:87], v[104:119]
    s_mov_b32 vcc_lo, 0
L_sp_87:
    ds_read_b32 v7, v6 offset:48
    s_waitcnt lgkmcnt(0)
    v_readfirstlane_b32 s38, v7
    s_cmp_ge_u32 s38, 4
    s_cbranch_scc1 L_ok_88
    s_sleep 1
    s_add_u32 vcc_lo, vcc_lo, 1
    s_cmp_lt_u32 vcc_lo, 0x400000
    s_cbranch_scc1 L_sp_87
L_ok_88:
    ds_read_b32 v7, v6
    ds_read_b64_tr_b16 v[24:25], v12 offset:32768
    ds_read_b64_tr_b16 v[26:27], v12 offset:33280
    ds_read_b64_tr_b16 v[28:29], v13 offset:32768
    ds_read_b64_tr_b16 v[30:31], v13 offset:33280
    ds_read_b64_tr_b16 v[32:33], v12 offset:34816
    ds_read_b64_tr_b16 v[34:35], v12 offset:35328
    ds_read_b64_tr_b16 v[36:37], v13 offset:34816
    ds_read_b64_tr_b16 v[38:39], v13 offset:35328
    ds_read_b64_tr_b16 v[40:41], v12 offset:36864
    ds_read_b64_tr_b16 v[42:43], v12 offset:37376
    ds_read_b64_tr_b16 v[44:45], v13 offset:36864
    ds_read_b64_tr_b16 v[46:47], v13 offset:37376
    ds_read_b64_tr_b16 v[48:49], v12 offset:38912
    ds_read_b64_tr_b16 v[50:51], v12 offset:39424
    ds_read_b64_tr_b16 v[52:53], v13 offset:38912
    ds_read_b64_tr_b16 v[54:55], v13 offset:39424
L_k3join_86:
    s_waitcnt vmcnt(0)
    s_waitcnt lgkmcnt(14)
    v_mfma_f32_32x32x16_bf16 v[88:103], v[216:219], v[24:27], v[88:103]
    s_waitcnt lgkmcnt(12)
    v_mfma_f32_32x32x16_bf16 v[104:119], v[216:219], v[28:31], v[104:119]
    s_waitcnt lgkmcnt(10)
    v_mfma_f32_32x32x16_bf16 v[88:103], v[220:223], v[32:35], v[88:103]
    s_waitcnt lgkmcnt(8)
    v_mfma_f32_32x32x16_bf16 v[104:119], v[220:223], v[36:39], v[104:119]
    s_waitcnt lgkmcnt(6)
    v_mfma_f32_32x32x16_bf16 v[88:103], v[224:227], v[40:43], v[88:103]
    s_waitcnt lgkmcnt(4)
    v_mfma_f32_32x32x16_bf16 v[104:119], v[224:227], v[44:47], v[104:119]
    s_waitcnt lgkmcnt(2)
    v_mfma_f32_32x32x16_bf16 v[88:103], v[228:231], v[48:51], v[88:103]
    s_waitcnt lgkmcnt(0)
    v_mfma_f32_32x32x16_bf16 v[104:119], v[228:231], v[52:55], v[104:119]
    s_cmp_eq_u32 s41, 1
    s_cbranch_scc1 L_k3_t3
    s_nop 15
    ds_write_b128 v18, v[88:91] offset:0
    ds_write_b128 v18, v[92:95] offset:1024
    ds_write_b128 v18, v[96:99] offset:2048
    ds_write_b128 v18, v[100:103] offset:3072
    s_waitcnt vmcnt(0) lgkmcnt(0)
    ds_write_b32 v6, v8 offset:60
    v_mul_f32 v24, v104, v14
    v_mul_f32 v25, v105, v14
    v_mul_f32 v26, v106, v14
    v_mul_f32 v27, v107, v14
    v_mul_f32 v28, v108, v14
    v_mul_f32 v29, v109, v14
    v_mul_f32 v30, v110, v14
    v_mul_f32 v31, v111, v14
    v_mul_f32 v32, v112, v14
    v_mul_f32 v33, v113, v14
    v_mul_f32 v34, v114, v14
    v_mul_f32 v35, v115, v14
    v_mul_f32 v36, v116, v14
    v_mul_f32 v37, v117, v14
    v_mul_f32 v38, v118, v14
    v_mul_f32 v39, v119, v14
    s_mov_b32 vcc_lo, 0
L_sp_89:
    ds_read_b32 v7, v6 offset:68
    s_waitcnt lgkmcnt(0)
    v_readfirstlane_b32 s38, v7
    s_cmp_ge_u32 s38, 1
    s_cbranch_scc1 L_ok_90
    s_sleep 1
    s_add_u32 vcc_lo, vcc_lo, 1
    s_cmp_lt_u32 vcc_lo, 0x400000
    s_cbranch_scc1 L_sp_89
L_ok_90:
    ds_read_b128 v[56:59], v18 offset:8192
    ds_read_b128 v[60:63], v18 offset:9216
    ds_read_b128 v[64:67], v18 offset:10240
    ds_read_b128 v[68:71], v18 offset:11264
    s_waitcnt lgkmcnt(3)
    v_fmac_f32 v24, v56, v15
    v_fmac_f32 v25, v57, v15
    v_fmac_f32 v26, v58, v15
    v_fmac_f32 v27, v59, v15
    v_cvt_pk_bf16_f32 v40, v24, v25
    v_cvt_pk_bf16_f32 v41, v26, v27
    s_waitcnt lgkmcnt(2)
    v_fmac_f32 v28, v60, v15
    v_fmac_f32 v29, v61, v15
    v_fmac_f32 v30, v62, v15
    v_fmac_f32 v31, v63, v15
    v_cvt_pk_bf16_f32 v42, v28, v29
    v_cvt_pk_bf16_f32 v43, v30, v31
    s_waitcnt lgkmcnt(1)
    v_fmac_f32 v32, v64, v15
    v_fmac_f32 v33, v65, v15
    v_fmac_f32 v34, v66, v15
    v_fmac_f32 v35, v67, v15
    v_cvt_pk_bf16_f32 v44, v32, v33
    v_cvt_pk_bf16_f32 v45, v34, v35
    s_waitcnt lgkmcnt(0)
    v_fmac_f32 v36, v68, v15
    v_fmac_f32 v37, v69, v15
    v_fmac_f32 v38, v70, v15
    v_fmac_f32 v39, v71, v15
    v_cvt_pk_bf16_f32 v46, v36, v37
    v_cvt_pk_bf16_f32 v47, v38, v39
    ds_write_b64 v17, v[40:41] offset:8192
    ds_write_b64 v17, v[42:43] offset:8208
    ds_write_b64 v17, v[44:45] offset:8224
    ds_write_b64 v17, v[46:47] offset:8240
    s_waitcnt lgkmcnt(0)
    ds_read_b128 v[24:27], v19 offset:8192
    ds_read_b128 v[28:31], v19 offset:9472
    s_waitcnt lgkmcnt(1)
    buffer_store_dwordx4 v[24:27], v20, s[16:19], s36 offen offset:0
    s_waitcnt lgkmcnt(0)
    buffer_store_dwordx4 v[28:31], v20, s[16:19], s36 offen offset:1792
    s_endpgm
L_k3_t3:
    s_nop 15
    ds_write_b128 v18, v[104:107] offset:4096
    ds_write_b128 v18, v[108:111] offset:5120
    ds_write_b128 v18, v[112:115] offset:6144
    ds_write_b128 v18, v[116:119] offset:7168
    s_waitcnt vmcnt(0) lgkmcnt(0)
    ds_write_b32 v6, v8 offset:64
    v_mul_f32 v24, v88, v14
    v_mul_f32 v25, v89, v14
    v_mul_f32 v26, v90, v14
    v_mul_f32 v27, v91, v14
    v_mul_f32 v28, v92, v14
    v_mul_f32 v29, v93, v14
    v_mul_f32 v30, v94, v14
    v_mul_f32 v31, v95, v14
    v_mul_f32 v32, v96, v14
    v_mul_f32 v33, v97, v14
    v_mul_f32 v34, v98, v14
    v_mul_f32 v35, v99, v14
    v_mul_f32 v36, v100, v14
    v_mul_f32 v37, v101, v14
    v_mul_f32 v38, v102, v14
    v_mul_f32 v39, v103, v14
    s_mov_b32 vcc_lo, 0
L_sp_91:
    ds_read_b32 v7, v6 offset:72
    s_waitcnt lgkmcnt(0)
    v_readfirstlane_b32 s38, v7
    s_cmp_ge_u32 s38, 1
    s_cbranch_scc1 L_ok_92
    s_sleep 1
    s_add_u32 vcc_lo, vcc_lo, 1
    s_cmp_lt_u32 vcc_lo, 0x400000
    s_cbranch_scc1 L_sp_91
L_ok_92:
    ds_read_b128 v[56:59], v18 offset:12288
    ds_read_b128 v[60:63], v18 offset:13312
    ds_read_b128 v[64:67], v18 offset:14336
    ds_read_b128 v[68:71], v18 offset:15360
    s_waitcnt lgkmcnt(3)
    v_fmac_f32 v24, v56, v15
    v_fmac_f32 v25, v57, v15
    v_fmac_f32 v26, v58, v15
    v_fmac_f32 v27, v59, v15
    v_cvt_pk_bf16_f32 v40, v24, v25
    v_cvt_pk_bf16_f32 v41, v26, v27
    s_waitcnt lgkmcnt(2)
    v_fmac_f32 v28, v60, v15
    v_fmac_f32 v29, v61, v15
    v_fmac_f32 v30, v62, v15
    v_fmac_f32 v31, v63, v15
    v_cvt_pk_bf16_f32 v42, v28, v29
    v_cvt_pk_bf16_f32 v43, v30, v31
    s_waitcnt lgkmcnt(1)
    v_fmac_f32 v32, v64, v15
    v_fmac_f32 v33, v65, v15
    v_fmac_f32 v34, v66, v15
    v_fmac_f32 v35, v67, v15
    v_cvt_pk_bf16_f32 v44, v32, v33
    v_cvt_pk_bf16_f32 v45, v34, v35
    s_waitcnt lgkmcnt(0)
    v_fmac_f32 v36, v68, v15
    v_fmac_f32 v37, v69, v15
    v_fmac_f32 v38, v70, v15
    v_fmac_f32 v39, v71, v15
    v_cvt_pk_bf16_f32 v46, v36, v37
    v_cvt_pk_bf16_f32 v47, v38, v39
    ds_write_b64 v17, v[40:41] offset:12288
    ds_write_b64 v17, v[42:43] offset:12304
    ds_write_b64 v17, v[44:45] offset:12320
    ds_write_b64 v17, v[46:47] offset:12336
    s_waitcnt lgkmcnt(0)
    ds_read_b128 v[24:27], v19 offset:12288
    ds_read_b128 v[28:31], v19 offset:13568
    s_waitcnt lgkmcnt(1)
    buffer_store_dwordx4 v[24:27], v20, s[16:19], s36 offen offset:0
    s_waitcnt lgkmcnt(0)
    buffer_store_dwordx4 v[28:31], v20, s[16:19], s36 offen offset:1792
    s_endpgm
L_k3_end:
    s_endpgm
.section .rodata,"a"

.p2align 6
.amdhsa_kernel k1_kernel
  .amdhsa_next_free_vgpr 112
  .amdhsa_next_free_sgpr 64
  .amdhsa_accum_offset 112
  .amdhsa_group_segment_fixed_size 0
  .amdhsa_kernarg_size 80
  .amdhsa_user_sgpr_count 2
  .amdhsa_user_sgpr_kernarg_segment_ptr 1
  .amdhsa_system_sgpr_workgroup_id_x 1
.end_amdhsa_kernel

.p2align 6
.amdhsa_kernel k2_kernel
  .amdhsa_next_free_vgpr 168
  .amdhsa_next_free_sgpr 64
  .amdhsa_accum_offset 168
  .amdhsa_group_segment_fixed_size 0
  .amdhsa_kernarg_size 80
  .amdhsa_user_sgpr_count 2
  .amdhsa_user_sgpr_kernarg_segment_ptr 1
  .amdhsa_system_sgpr_workgroup_id_x 1
.end_amdhsa_kernel

.p2align 6
.amdhsa_kernel k3_kernel
  .amdhsa_next_free_vgpr 232
  .amdhsa_next_free_sgpr 64
  .amdhsa_accum_offset 232
  .amdhsa_group_segment_fixed_size 0
  .amdhsa_kernarg_size 80
  .amdhsa_user_sgpr_count 2
  .amdhsa_user_sgpr_kernarg_segment_ptr 1
  .amdhsa_system_sgpr_workgroup_id_x 1
.end_amdhsa_kernel
.set cs_0, 0x3f80
.set cs_1, 0x3f80
.set cs_2, 0x3f80
.set cs_3, 0x3f80
.set cs_4, 0x3f80
.set cs_5, 0x3f7f
.set cs_6, 0x3f7f
.set cs_7, 0x3f7f
.set cs_8, 0x3f7e
.set cs_9, 0x3f7e
.set cs_10, 0x3f7d
.set cs_11, 0x3f7d
.set cs_12, 0x3f7c
.set cs_13, 0x3f7c
.set cs_14, 0x3f7b
.set cs_15, 0x3f7a
.set cs_16, 0x3f7a
.set cs_17, 0x3f79
.set cs_18, 0x3f78
.set cs_19, 0x3f77
.set cs_20, 0x3f76
.set cs_21, 0x3f75
.set cs_22, 0x3f74
.set cs_23, 0x3f73
.set cs_24, 0x3f72
.set cs_25, 0x3f70
.set cs_26, 0x3f6f
.set cs_27, 0x3f6e
.set cs_28, 0x3f6d
.set cs_29, 0x3f6b
.set cs_30, 0x3f6a
.set cs_31, 0x3f68
.set cs_32, 0x3f67
.set cs_33, 0x3f65
.set cs_34, 0x3f63
.set cs_35, 0x3f62
.set cs_36, 0x3f60
.set cs_37, 0x3f5e
.set cs_38, 0x3f5c
.set cs_39, 0x3f5b
.set cs_40, 0x3f59
.set cs_41, 0x3f57
.set cs_42, 0x3f55
.set cs_43, 0x3f53
.set cs_44, 0x3f51
.set cs_45, 0x3f4f
.set cs_46, 0x3f4d
.set cs_47, 0x3f4a
.set cs_48, 0x3f48
.set cs_49, 0x3f46
.set cs_50, 0x3f44
.set cs_51, 0x3f41
.set cs_52, 0x3f3f
.set cs_53, 0x3f3c
.set cs_54, 0x3f3a
.set cs_55, 0x3f38
.set cs_56, 0x3f35
.set cs_57, 0x3f32
.set cs_58, 0x3f30
.set cs_59, 0x3f2d
.set cs_60, 0x3f2b
.set cs_61, 0x3f28
.set cs_62, 0x3f25
.set cs_63, 0x3f22
.set cs_64, 0x3f20
.set cs_65, 0x3f1d
.set cs_66, 0x3f1a
.set cs_67, 0x3f17
.set cs_68, 0x3f14
.set cs_69, 0x3f11
.set cs_70, 0x3f0e
.set cs_71, 0x3f0b
.set cs_72, 0x3f08
.set cs_73, 0x3f05
.set cs_74, 0x3f02
.set cs_75, 0x3efe
.set cs_76, 0x3ef8
.set cs_77, 0x3ef1
.set cs_78, 0x3eeb
.set cs_79, 0x3ee5
.set cs_80, 0x3ede
.set cs_81, 0x3ed8
.set cs_82, 0x3ed1
.set cs_83, 0x3ecb
.set cs_84, 0x3ec4
.set cs_85, 0x3ebd
.set cs_86, 0x3eb7
.set cs_87, 0x3eb0
.set cs_88, 0x3ea9
.set cs_89, 0x3ea2
.set cs_90, 0x3e9b
.set cs_91, 0x3e95
.set cs_92, 0x3e8e
.set cs_93, 0x3e87
.set cs_94, 0x3e80
.set cs_95, 0x3e72
.set cs_96, 0x3e64
.set cs_97, 0x3e56
.set cs_98, 0x3e48
.set cs_99, 0x3e3a
.set cs_100, 0x3e2c
.set cs_101, 0x3e1d
.set cs_102, 0x3e0f
.set cs_103, 0x3e01
.set cs_104, 0x3de5
.set cs_105, 0x3dc9
.set cs_106, 0x3dac
.set cs_107, 0x3d8f
.set cs_108, 0x3d66
.set cs_109, 0x3d2c
.set cs_110, 0x3ce6
.set cs_111, 0x3c66
.set cs_112, 0x0
.set cs_113, 0xbc66
.set cs_114, 0xbce6
.set cs_115, 0xbd2c
.set cs_116, 0xbd66
.set cs_117, 0xbd8f
.set cs_118, 0xbdac
.set cs_119, 0xbdc9
.set cs_120, 0xbde5
.set cs_121, 0xbe01
.set cs_122, 0xbe0f
.set cs_123, 0xbe1d
.set cs_124, 0xbe2c
.set cs_125, 0xbe3a
.set cs_126, 0xbe48
.set cs_127, 0xbe56
.set cs_128, 0xbe64
.set cs_129, 0xbe72
.set cs_130, 0xbe80
.set cs_131, 0xbe87
.set cs_132, 0xbe8e
.set cs_133, 0xbe95
.set cs_134, 0xbe9b
.set cs_135, 0xbea2
.set cs_136, 0xbea9
.set cs_137, 0xbeb0
.set cs_138, 0xbeb7
.set cs_139, 0xbebd
.set cs_140, 0xbec4
.set cs_141, 0xbecb
.set cs_142, 0xbed1
.set cs_143, 0xbed8
.set cs_144, 0xbede
.set cs_145, 0xbee5
.set cs_146, 0xbeeb
.set cs_147, 0xbef1
.set cs_148, 0xbef8
.set cs_149, 0xbefe
.set cs_150, 0xbf02
.set cs_151, 0xbf05
.set cs_152, 0xbf08
.set cs_153, 0xbf0b
.set cs_154, 0xbf0e
.set cs_155, 0xbf11
.set cs_156, 0xbf14
.set cs_157, 0xbf17
.set cs_158, 0xbf1a
.set cs_159, 0xbf1d
.set cs_160, 0xbf20
.set cs_161, 0xbf22
.set cs_162, 0xbf25
.set cs_163, 0xbf28
.set cs_164, 0xbf2b
.set cs_165, 0xbf2d
.set cs_166, 0xbf30
.set cs_167, 0xbf32
.set cs_168, 0xbf35
.set cs_169, 0xbf38
.set cs_170, 0xbf3a
.set cs_171, 0xbf3c
.set cs_172, 0xbf3f
.set cs_173, 0xbf41
.set cs_174, 0xbf44
.set cs_175, 0xbf46
.set cs_176, 0xbf48
.set cs_177, 0xbf4a
.set cs_178, 0xbf4d
.set cs_179, 0xbf4f
.set cs_180, 0xbf51
.set cs_181, 0xbf53
.set cs_182, 0xbf55
.set cs_183, 0xbf57
.set cs_184, 0xbf59
.set cs_185, 0xbf5b
.set cs_186, 0xbf5c
.set cs_187, 0xbf5e
.set cs_188, 0xbf60
.set cs_189, 0xbf62
.set cs_190, 0xbf63
.set cs_191, 0xbf65
.set cs_192, 0xbf67
.set cs_193, 0xbf68
.set cs_194, 0xbf6a
.set cs_195, 0xbf6b
.set cs_196, 0xbf6d
.set cs_197, 0xbf6e
.set cs_198, 0xbf6f
.set cs_199, 0xbf70
.set cs_200, 0xbf72
.set cs_201, 0xbf73
.set cs_202, 0xbf74
.set cs_203, 0xbf75
.set cs_204, 0xbf76
.set cs_205, 0xbf77
.set cs_206, 0xbf78
.set cs_207, 0xbf79
.set cs_208, 0xbf7a
.set cs_209, 0xbf7a
.set cs_210, 0xbf7b
.set cs_211, 0xbf7c
.set cs_212, 0xbf7c
.set cs_213, 0xbf7d
.set cs_214, 0xbf7d
.set cs_215, 0xbf7e
.set cs_216, 0xbf7e
.set cs_217, 0xbf7f
.set cs_218, 0xbf7f
.set cs_219, 0xbf7f
.set cs_220, 0xbf80
.set cs_221, 0xbf80
.set cs_222, 0xbf80
.set cs_223, 0xbf80
.set cs_224, 0xbf80
.set cs_225, 0xbf80
.set cs_226, 0xbf80
.set cs_227, 0xbf80
.set cs_228, 0xbf80
.set cs_229, 0xbf7f
.set cs_230, 0xbf7f
.set cs_231, 0xbf7f
.set cs_232, 0xbf7e
.set cs_233, 0xbf7e
.set cs_234, 0xbf7d
.set cs_235, 0xbf7d
.set cs_236, 0xbf7c
.set cs_237, 0xbf7c
.set cs_238, 0xbf7b
.set cs_239, 0xbf7a
.set cs_240, 0xbf7a
.set cs_241, 0xbf79
.set cs_242, 0xbf78
.set cs_243, 0xbf77
.set cs_244, 0xbf76
.set cs_245, 0xbf75
.set cs_246, 0xbf74
.set cs_247, 0xbf73
.set cs_248, 0xbf72
.set cs_249, 0xbf70
.set cs_250, 0xbf6f
.set cs_251, 0xbf6e
.set cs_252, 0xbf6d
.set cs_253, 0xbf6b
.set cs_254, 0xbf6a
.set cs_255, 0xbf68
.set cs_256, 0xbf67
.set cs_257, 0xbf65
.set cs_258, 0xbf63
.set cs_259, 0xbf62
.set cs_260, 0xbf60
.set cs_261, 0xbf5e
.set cs_262, 0xbf5c
.set cs_263, 0xbf5b
.set cs_264, 0xbf59
.set cs_265, 0xbf57
.set cs_266, 0xbf55
.set cs_267, 0xbf53
.set cs_268, 0xbf51
.set cs_269, 0xbf4f
.set cs_270, 0xbf4d
.set cs_271, 0xbf4a
.set cs_272, 0xbf48
.set cs_273, 0xbf46
.set cs_274, 0xbf44
.set cs_275, 0xbf41
.set cs_276, 0xbf3f
.set cs_277, 0xbf3c
.set cs_278, 0xbf3a
.set cs_279, 0xbf38
.set cs_280, 0xbf35
.set cs_281, 0xbf32
.set cs_282, 0xbf30
.set cs_283, 0xbf2d
.set cs_284, 0xbf2b
.set cs_285, 0xbf28
.set cs_286, 0xbf25
.set cs_287, 0xbf22
.set cs_288, 0xbf20
.set cs_289, 0xbf1d
.set cs_290, 0xbf1a
.set cs_291, 0xbf17
.set cs_292, 0xbf14
.set cs_293, 0xbf11
.set cs_294, 0xbf0e
.set cs_295, 0xbf0b
.set cs_296, 0xbf08
.set cs_297, 0xbf05
.set cs_298, 0xbf02
.set cs_299, 0xbefe
.set cs_300, 0xbef8
.set cs_301, 0xbef1
.set cs_302, 0xbeeb
.set cs_303, 0xbee5
.set cs_304, 0xbede
.set cs_305, 0xbed8
.set cs_306, 0xbed1
.set cs_307, 0xbecb
.set cs_308, 0xbec4
.set cs_309, 0xbebd
.set cs_310, 0xbeb7
.set cs_311, 0xbeb0
.set cs_312, 0xbea9
.set cs_313, 0xbea2
.set cs_314, 0xbe9b
.set cs_315, 0xbe95
.set cs_316, 0xbe8e
.set cs_317, 0xbe87
.set cs_318, 0xbe80
.set cs_319, 0xbe72
.set cs_320, 0xbe64
.set cs_321, 0xbe56
.set cs_322, 0xbe48
.set cs_323, 0xbe3a
.set cs_324, 0xbe2c
.set cs_325, 0xbe1d
.set cs_326, 0xbe0f
.set cs_327, 0xbe01
.set cs_328, 0xbde5
.set cs_329, 0xbdc9
.set cs_330, 0xbdac
.set cs_331, 0xbd8f
.set cs_332, 0xbd66
.set cs_333, 0xbd2c
.set cs_334, 0xbce6
.set cs_335, 0xbc66
.set cs_336, 0x0
.set cs_337, 0x3c66
.set cs_338, 0x3ce6
.set cs_339, 0x3d2c
.set cs_340, 0x3d66
.set cs_341, 0x3d8f
.set cs_342, 0x3dac
.set cs_343, 0x3dc9
.set cs_344, 0x3de5
.set cs_345, 0x3e01
.set cs_346, 0x3e0f
.set cs_347, 0x3e1d
.set cs_348, 0x3e2c
.set cs_349, 0x3e3a
.set cs_350, 0x3e48
.set cs_351, 0x3e56
.set cs_352, 0x3e64
.set cs_353, 0x3e72
.set cs_354, 0x3e80
.set cs_355, 0x3e87
.set cs_356, 0x3e8e
.set cs_357, 0x3e95
.set cs_358, 0x3e9b
.set cs_359, 0x3ea2
.set cs_360, 0x3ea9
.set cs_361, 0x3eb0
.set cs_362, 0x3eb7
.set cs_363, 0x3ebd
.set cs_364, 0x3ec4
.set cs_365, 0x3ecb
.set cs_366, 0x3ed1
.set cs_367, 0x3ed8
.set cs_368, 0x3ede
.set cs_369, 0x3ee5
.set cs_370, 0x3eeb
.set cs_371, 0x3ef1
.set cs_372, 0x3ef8
.set cs_373, 0x3efe
.set cs_374, 0x3f02
.set cs_375, 0x3f05
.set cs_376, 0x3f08
.set cs_377, 0x3f0b
.set cs_378, 0x3f0e
.set cs_379, 0x3f11
.set cs_380, 0x3f14
.set cs_381, 0x3f17
.set cs_382, 0x3f1a
.set cs_383, 0x3f1d
.set cs_384, 0x3f20
.set cs_385, 0x3f22
.set cs_386, 0x3f25
.set cs_387, 0x3f28
.set cs_388, 0x3f2b
.set cs_389, 0x3f2d
.set cs_390, 0x3f30
.set cs_391, 0x3f32
.set cs_392, 0x3f35
.set cs_393, 0x3f38
.set cs_394, 0x3f3a
.set cs_395, 0x3f3c
.set cs_396, 0x3f3f
.set cs_397, 0x3f41
.set cs_398, 0x3f44
.set cs_399, 0x3f46
.set cs_400, 0x3f48
.set cs_401, 0x3f4a
.set cs_402, 0x3f4d
.set cs_403, 0x3f4f
.set cs_404, 0x3f51
.set cs_405, 0x3f53
.set cs_406, 0x3f55
.set cs_407, 0x3f57
.set cs_408, 0x3f59
.set cs_409, 0x3f5b
.set cs_410, 0x3f5c
.set cs_411, 0x3f5e
.set cs_412, 0x3f60
.set cs_413, 0x3f62
.set cs_414, 0x3f63
.set cs_415, 0x3f65
.set cs_416, 0x3f67
.set cs_417, 0x3f68
.set cs_418, 0x3f6a
.set cs_419, 0x3f6b
.set cs_420, 0x3f6d
.set cs_421, 0x3f6e
.set cs_422, 0x3f6f
.set cs_423, 0x3f70
.set cs_424, 0x3f72
.set cs_425, 0x3f73
.set cs_426, 0x3f74
.set cs_427, 0x3f75
.set cs_428, 0x3f76
.set cs_429, 0x3f77
.set cs_430, 0x3f78
.set cs_431, 0x3f79
.set cs_432, 0x3f7a
.set cs_433, 0x3f7a
.set cs_434, 0x3f7b
.set cs_435, 0x3f7c
.set cs_436, 0x3f7c
.set cs_437, 0x3f7d
.set cs_438, 0x3f7d
.set cs_439, 0x3f7e
.set cs_440, 0x3f7e
.set cs_441, 0x3f7f
.set cs_442, 0x3f7f
.set cs_443, 0x3f7f
.set cs_444, 0x3f80
.set cs_445, 0x3f80
.set cs_446, 0x3f80
.set cs_447, 0x3f80
.set cs_1000, 0x3f00
.set cs_1224, 0xbf00
.altmacro
.macro em8 a,b,c,d,e,f,g,h
.short cs_\a, cs_\b, cs_\c, cs_\d, cs_\e, cs_\f, cs_\g, cs_\h
.endm
.macro quad4 dd, kk, hf
.if \kk == 0
em8 %(\hf), %(\hf+(224*\dd)%448), %((\dd)%448), %((\dd+112)%448), %((2*\dd)%448), %((2*\dd+112)%448), %((3*\dd)%448), %((3*\dd+112)%448)
.else
em8 %((\dd*\kk)%448), %((\dd*\kk+112)%448), %((\dd*(\kk+1))%448), %((\dd*(\kk+1)+112)%448), %((\dd*(\kk+2))%448), %((\dd*(\kk+2)+112)%448), %((\dd*(\kk+3))%448), %((\dd*(\kk+3)+112)%448)
.endif
.endm
.p2align 8
tbl_fd:
.set t_d, 0
.rept 448
.set t_k, 0
.rept 56
quad4 %t_d, %t_k, 0
.set t_k, t_k+4
.endr
.set t_d, t_d+1
.endr
.p2align 8
tbl_gf:
.set t_ct, 0
.rept 14
.set t_q, 0
.rept 56
.set t_n, 0
.rept 32
quad4 %(32*t_ct+t_n), %(4*t_q), 1000
.set t_n, t_n+1
.endr
.set t_q, t_q+1
.endr
.set t_ct, t_ct+1
.endr
.noaltmacro
.p2align 8
tbl_fft:
.long 0x3f80,0x3f80,0x3f80,0x3f80,0x3f808000,0x3f808000,0x3f808000,0x3f808000
.long 0x3f80,0x3e483f7b,0x3ec43f6d,0x3f0e3f55,0x3f808000,0x3f7bbe48,0x3f6dbec4,0x3f55bf0e
.long 0x3f80,0x3f800000,0xbf80,0xbf800000,0x3f808000,0xbf80,0xbf808000,0x3f80
.long 0x3f80,0x3f7bbe48,0xbec4bf6d,0xbf553f0e,0x3f808000,0xbe48bf7b,0xbf6d3ec4,0x3f0e3f55
.long 0x3f80,0x3ec43f6d,0x3f353f35,0x3f6d3ec4,0x3f808000,0x3f6dbec4,0x3f35bf35,0x3ec4bf6d
.long 0x3f80,0x3f0e3f55,0x3f6d3ec4,0x3f7bbe48,0x3f808000,0x3f55bf0e,0x3ec4bf6d,0xbe48bf7b
.long 0x3f80,0x3f6dbec4,0xbf35bf35,0xbec43f6d,0x3f808000,0xbec4bf6d,0xbf353f35,0x3f6d3ec4
.long 0x3f80,0x3f55bf0e,0xbf6dbec4,0x3e483f7b,0x3f808000,0xbf0ebf55,0xbec43f6d,0x3f7bbe48
.long 0x3f80,0x3f353f35,0x3f800000,0x3f35bf35,0x3f808000,0x3f35bf35,0xbf80,0xbf35bf35
.long 0x3f80,0x3f553f0e,0x3f6dbec4,0x3e48bf7b,0x3f808000,0x3f0ebf55,0xbec4bf6d,0xbf7bbe48
.long 0x3f80,0x3f35bf35,0xbf800000,0x3f353f35,0x3f808000,0xbf35bf35,0x3f80,0x3f35bf35
.long 0x3f80,0x3f0ebf55,0xbf6d3ec4,0x3f7b3e48,0x3f808000,0xbf55bf0e,0x3ec43f6d,0x3e48bf7b
.long 0x3f80,0x3f6d3ec4,0x3f35bf35,0xbec4bf6d,0x3f808000,0x3ec4bf6d,0xbf35bf35,0xbf6d3ec4
.long 0x3f80,0x3f7b3e48,0x3ec4bf6d,0xbf55bf0e,0x3f808000,0x3e48bf7b,0xbf6dbec4,0xbf0e3f55
.long 0x3f80,0x3ec4bf6d,0xbf353f35,0x3f6dbec4,0x3f808000,0xbf6dbec4,0x3f353f35,0xbec4bf6d
.long 0x3f80,0x3e48bf7b,0xbec43f6d,0x3f0ebf55,0x3f808000,0xbf7bbe48,0x3f6d3ec4,0xbf55bf0e
.long 0x3f80,0x3f80,0x3f80,0x3f80,0x3f808000,0x3f808000,0x3f808000,0x3f808000
.long 0x3f353f35,0x3f553f0e,0x3f6d3ec4,0x3f7b3e48,0x3f35bf35,0x3f0ebf55,0x3ec4bf6d,0x3e48bf7b
.long 0x3f80,0x3f800000,0xbf80,0xbf800000,0x3f808000,0xbf80,0xbf808000,0x3f80
.long 0x3f353f35,0x3f0ebf55,0xbf6dbec4,0xbe483f7b,0x3f35bf35,0xbf55bf0e,0xbec43f6d,0x3f7b3e48
.long 0x3f800000,0x3f6dbec4,0x3f35bf35,0x3ec4bf6d,0xbf80,0xbec4bf6d,0xbf35bf35,0xbf6dbec4
.long 0x3f35bf35,0x3e48bf7b,0xbec4bf6d,0xbf55bf0e,0xbf35bf35,0xbf7bbe48,0xbf6d3ec4,0xbf0e3f55
.long 0x3f800000,0xbec4bf6d,0xbf353f35,0x3f6d3ec4,0xbf80,0xbf6d3ec4,0x3f353f35,0x3ec4bf6d
.long 0x3f35bf35,0xbf7bbe48,0x3ec43f6d,0x3f0ebf55,0xbf35bf35,0xbe483f7b,0x3f6dbec4,0xbf55bf0e
.long 0xbf80,0xbf35bf35,0xbf800000,0xbf353f35,0xbf808000,0xbf353f35,0x3f80,0x3f353f35
.long 0xbf35bf35,0xbf7b3e48,0xbec43f6d,0x3f0e3f55,0xbf353f35,0x3e483f7b,0x3f6d3ec4,0x3f55bf0e
.long 0xbf80,0xbf353f35,0x3f800000,0xbf35bf35,0xbf808000,0x3f353f35,0xbf80,0xbf353f35
.long 0xbf35bf35,0x3e483f7b,0x3ec4bf6d,0xbf553f0e,0xbf353f35,0x3f7bbe48,0xbf6dbec4,0x3f0e3f55
.long 0xbf800000,0xbec43f6d,0x3f353f35,0x3f6dbec4,0x3f80,0x3f6d3ec4,0x3f35bf35,0xbec4bf6d
.long 0xbf353f35,0x3f0e3f55,0x3f6dbec4,0xbe48bf7b,0x3f353f35,0x3f55bf0e,0xbec4bf6d,0xbf7b3e48
.long 0xbf800000,0x3f6d3ec4,0xbf35bf35,0x3ec43f6d,0x3f80,0x3ec4bf6d,0xbf353f35,0x3f6dbec4
.long 0xbf353f35,0x3f55bf0e,0xbf6d3ec4,0x3f7bbe48,0x3f353f35,0xbf0ebf55,0x3ec43f6d,0xbe48bf7b
.long 0x3f80,0x3f80,0x3f80,0x3f80,0x3f808000,0x3f808000,0x3f808000,0x3f808000
.long 0x3f800000,0x3f7bbe48,0x3f6dbec4,0x3f55bf0e,0xbf80,0xbe48bf7b,0xbec4bf6d,0xbf0ebf55
.long 0x3f80,0x3f800000,0xbf80,0xbf800000,0x3f808000,0xbf80,0xbf808000,0x3f80
.long 0x3f800000,0xbe48bf7b,0xbf6d3ec4,0x3f0e3f55,0xbf80,0xbf7b3e48,0x3ec43f6d,0x3f55bf0e
.long 0xbf80,0xbec4bf6d,0xbf35bf35,0xbf6dbec4,0xbf808000,0xbf6d3ec4,0xbf353f35,0xbec43f6d
.long 0xbf800000,0xbf553f0e,0xbec43f6d,0x3e483f7b,0x3f80,0x3f0e3f55,0x3f6d3ec4,0x3f7bbe48
.long 0xbf80,0xbf6d3ec4,0x3f353f35,0x3ec4bf6d,0xbf808000,0x3ec43f6d,0x3f35bf35,0xbf6dbec4
.long 0xbf800000,0x3f0e3f55,0x3ec4bf6d,0xbf7b3e48,0x3f80,0x3f55bf0e,0xbf6dbec4,0x3e483f7b
.long 0x3f80,0x3f353f35,0x3f800000,0x3f35bf35,0x3f808000,0x3f35bf35,0xbf80,0xbf35bf35
.long 0x3f800000,0x3f0ebf55,0xbec4bf6d,0xbf7bbe48,0xbf80,0xbf55bf0e,0xbf6d3ec4,0xbe483f7b
.long 0x3f80,0x3f35bf35,0xbf800000,0x3f353f35,0x3f808000,0xbf35bf35,0x3f80,0x3f35bf35
.long 0x3f800000,0xbf55bf0e,0x3ec43f6d,0x3e48bf7b,0xbf80,0xbf0e3f55,0x3f6dbec4,0xbf7bbe48
.long 0xbf80,0xbf6dbec4,0xbf353f35,0x3ec43f6d,0xbf808000,0xbec43f6d,0x3f353f35,0x3f6dbec4
.long 0xbf800000,0xbe483f7b,0x3f6d3ec4,0x3f0ebf55,0x3f80,0x3f7b3e48,0x3ec4bf6d,0xbf55bf0e
.long 0xbf80,0xbec43f6d,0x3f35bf35,0xbf6d3ec4,0xbf808000,0x3f6d3ec4,0xbf35bf35,0x3ec43f6d
.long 0xbf800000,0x3f7b3e48,0xbf6dbec4,0x3f553f0e,0x3f80,0x3e48bf7b,0xbec43f6d,0x3f0ebf55
.long 0x3f80,0x3f80,0x3f80,0x3f80,0x3f808000,0x3f808000,0x3f808000,0x3f808000
.long 0x3f35bf35,0x3f0ebf55,0x3ec4bf6d,0x3e48bf7b,0xbf35bf35,0xbf55bf0e,0xbf6dbec4,0xbf7bbe48
.long 0x3f80,0x3f800000,0xbf80,0xbf800000,0x3f808000,0xbf80,0xbf808000,0x3f80
.long 0x3f35bf35,0xbf55bf0e,0xbec43f6d,0x3f7b3e48,0xbf35bf35,0xbf0e3f55,0x3f6d3ec4,0x3e48bf7b
.long 0xbf800000,0xbf6d3ec4,0xbf353f35,0xbec43f6d,0x3f80,0x3ec43f6d,0x3f353f35,0x3f6d3ec4
.long 0x3f353f35,0x3f7b3e48,0x3f6dbec4,0x3f0ebf55,0x3f35bf35,0x3e48bf7b,0xbec4bf6d,0xbf55bf0e
.long 0xbf800000,0x3ec43f6d,0x3f35bf35,0xbf6dbec4,0x3f80,0x3f6dbec4,0xbf35bf35,0xbec43f6d
.long 0x3f353f35,0x3e48bf7b,0xbf6d3ec4,0x3f553f0e,0x3f35bf35,0xbf7bbe48,0x3ec43f6d,0x3f0ebf55
.long 0xbf80,0xbf35bf35,0xbf800000,0xbf353f35,0xbf808000,0xbf353f35,0x3f80,0x3f353f35
.long 0xbf353f35,0x3e483f7b,0x3f6d3ec4,0x3f55bf0e,0x3f353f35,0x3f7bbe48,0x3ec4bf6d,0xbf0ebf55
.long 0xbf80,0xbf353f35,0x3f800000,0xbf35bf35,0xbf808000,0x3f353f35,0xbf80,0xbf353f35
.long 0xbf353f35,0x3f7bbe48,0xbf6dbec4,0x3f0e3f55,0x3f353f35,0xbe48bf7b,0xbec43f6d,0x3f55bf0e
.long 0x3f800000,0x3ec4bf6d,0xbf35bf35,0xbf6d3ec4,0xbf80,0xbf6dbec4,0xbf353f35,0x3ec43f6d
.long 0xbf35bf35,0xbf553f0e,0x3ec43f6d,0x3f7bbe48,0xbf353f35,0x3f0e3f55,0x3f6dbec4,0xbe48bf7b
.long 0x3f800000,0xbf6dbec4,0x3f353f35,0xbec4bf6d,0xbf80,0xbec43f6d,0x3f35bf35,0xbf6d3ec4
.long 0xbf35bf35,0x3f0e3f55,0xbec4bf6d,0x3e483f7b,0xbf353f35,0x3f55bf0e,0xbf6d3ec4,0x3f7bbe48
.long 0x3f80,0x3f80,0x3f80,0x3f80,0x3f808000,0x3f808000,0x3f808000,0x3f808000
.long 0xbf80,0xbe48bf7b,0xbec4bf6d,0xbf0ebf55,0xbf808000,0xbf7b3e48,0xbf6d3ec4,0xbf553f0e
.long 0x3f80,0x3f800000,0xbf80,0xbf800000,0x3f808000,0xbf80,0xbf808000,0x3f80
.long 0xbf80,0xbf7b3e48,0x3ec43f6d,0x3f55bf0e,0xbf808000,0x3e483f7b,0x3f6dbec4,0xbf0ebf55
.long 0x3f80,0x3ec43f6d,0x3f353f35,0x3f6d3ec4,0x3f808000,0x3f6dbec4,0x3f35bf35,0x3ec4bf6d
.long 0xbf80,0xbf0ebf55,0xbf6dbec4,0xbf7b3e48,0xbf808000,0xbf553f0e,0xbec43f6d,0x3e483f7b
.long 0x3f80,0x3f6dbec4,0xbf35bf35,0xbec43f6d,0x3f808000,0xbec4bf6d,0xbf353f35,0x3f6d3ec4
.long 0xbf80,0xbf553f0e,0x3f6d3ec4,0xbe48bf7b,0xbf808000,0x3f0e3f55,0x3ec4bf6d,0xbf7b3e48
.long 0x3f80,0x3f353f35,0x3f800000,0x3f35bf35,0x3f808000,0x3f35bf35,0xbf80,0xbf35bf35
.long 0xbf80,0xbf55bf0e,0xbf6d3ec4,0xbe483f7b,0xbf808000,0xbf0e3f55,0x3ec43f6d,0x3f7b3e48
.long 0x3f80,0x3f35bf35,0xbf800000,0x3f353f35,0x3f808000,0xbf35bf35,0x3f80,0x3f35bf35
.long 0xbf80,0xbf0e3f55,0x3f6dbec4,0xbf7bbe48,0xbf808000,0x3f553f0e,0xbec4bf6d,0xbe483f7b
.long 0x3f80,0x3f6d3ec4,0x3f35bf35,0xbec4bf6d,0x3f808000,0x3ec4bf6d,0xbf35bf35,0xbf6d3ec4
.long 0xbf80,0xbf7bbe48,0xbec43f6d,0x3f553f0e,0xbf808000,0xbe483f7b,0x3f6d3ec4,0x3f0ebf55
.long 0x3f80,0x3ec4bf6d,0xbf353f35,0x3f6dbec4,0x3f808000,0xbf6dbec4,0x3f353f35,0xbec4bf6d
.long 0xbf80,0xbe483f7b,0x3ec4bf6d,0xbf0e3f55,0xbf808000,0x3f7b3e48,0xbf6dbec4,0x3f553f0e
.long 0x3f80,0x3f80,0x3f80,0x3f80,0x3f808000,0x3f808000,0x3f808000,0x3f808000
.long 0xbf35bf35,0xbf55bf0e,0xbf6dbec4,0xbf7bbe48,0xbf353f35,0xbf0e3f55,0xbec43f6d,0xbe483f7b
.long 0x3f80,0x3f800000,0xbf80,0xbf800000,0x3f808000,0xbf80,0xbf808000,0x3f80
.long 0xbf35bf35,0xbf0e3f55,0x3f6d3ec4,0x3e48bf7b,0xbf353f35,0x3f553f0e,0x3ec4bf6d,0xbf7bbe48
.long 0x3f800000,0x3f6dbec4,0x3f35bf35,0x3ec4bf6d,0xbf80,0xbec4bf6d,0xbf35bf35,0xbf6dbec4
.long 0xbf353f35,0xbe483f7b,0x3ec43f6d,0x3f553f0e,0x3f353f35,0x3f7b3e48,0x3f6dbec4,0x3f0ebf55
.long 0x3f800000,0xbec4bf6d,0xbf353f35,0x3f6d3ec4,0xbf80,0xbf6d3ec4,0x3f353f35,0x3ec4bf6d
.long 0xbf353f35,0x3f7b3e48,0xbec4bf6d,0xbf0e3f55,0x3f353f35,0x3e48bf7b,0xbf6d3ec4,0x3f553f0e
.long 0xbf80,0xbf35bf35,0xbf800000,0xbf353f35,0xbf808000,0xbf353f35,0x3f80,0x3f353f35
.long 0x3f353f35,0x3f7bbe48,0x3ec4bf6d,0xbf0ebf55,0x3f35bf35,0xbe48bf7b,0xbf6dbec4,0xbf553f0e
.long 0xbf80,0xbf353f35,0x3f800000,0xbf35bf35,0xbf808000,0x3f353f35,0xbf80,0xbf353f35
.long 0x3f353f35,0xbe48bf7b,0xbec43f6d,0x3f55bf0e,0x3f35bf35,0xbf7b3e48,0x3f6d3ec4,0xbf0ebf55
.long 0xbf800000,0xbec43f6d,0x3f353f35,0x3f6dbec4,0x3f80,0x3f6d3ec4,0x3f35bf35,0xbec4bf6d
.long 0x3f35bf35,0xbf0ebf55,0xbf6d3ec4,0x3e483f7b,0xbf35bf35,0xbf553f0e,0x3ec43f6d,0x3f7bbe48
.long 0xbf800000,0x3f6d3ec4,0xbf35bf35,0x3ec43f6d,0x3f80,0x3ec4bf6d,0xbf353f35,0x3f6dbec4
.long 0x3f35bf35,0xbf553f0e,0x3f6dbec4,0xbf7b3e48,0xbf35bf35,0x3f0e3f55,0xbec4bf6d,0x3e483f7b
.long 0x3f80,0x3f80,0x3f80,0x3f80,0x3f808000,0x3f808000,0x3f808000,0x3f808000
.long 0xbf800000,0xbf7b3e48,0xbf6d3ec4,0xbf553f0e,0x3f80,0x3e483f7b,0x3ec43f6d,0x3f0e3f55
.long 0x3f80,0x3f800000,0xbf80,0xbf800000,0x3f808000,0xbf80,0xbf808000,0x3f80
.long 0xbf800000,0x3e483f7b,0x3f6dbec4,0xbf0ebf55,0x3f80,0x3f7bbe48,0xbec4bf6d,0xbf553f0e
.long 0xbf80,0xbec4bf6d,0xbf35bf35,0xbf6dbec4,0xbf808000,0xbf6d3ec4,0xbf353f35,0xbec43f6d
.long 0x3f800000,0x3f55bf0e,0x3ec4bf6d,0xbe48bf7b,0xbf80,0xbf0ebf55,0xbf6dbec4,0xbf7b3e48
.long 0xbf80,0xbf6d3ec4,0x3f353f35,0x3ec4bf6d,0xbf808000,0x3ec43f6d,0x3f35bf35,0xbf6dbec4
.long 0x3f800000,0xbf0ebf55,0xbec43f6d,0x3f7bbe48,0xbf80,0xbf553f0e,0x3f6d3ec4,0xbe48bf7b
.long 0x3f80,0x3f353f35,0x3f800000,0x3f35bf35,0x3f808000,0x3f35bf35,0xbf80,0xbf35bf35
.long 0xbf800000,0xbf0e3f55,0x3ec43f6d,0x3f7b3e48,0x3f80,0x3f553f0e,0x3f6dbec4,0x3e48bf7b
.long 0x3f80,0x3f35bf35,0xbf800000,0x3f353f35,0x3f808000,0xbf35bf35,0x3f80,0x3f35bf35
.long 0xbf800000,0x3f553f0e,0xbec4bf6d,0xbe483f7b,0x3f80,0x3f0ebf55,0xbf6d3ec4,0x3f7b3e48
.long 0xbf80,0xbf6dbec4,0xbf353f35,0x3ec43f6d,0xbf808000,0xbec43f6d,0x3f353f35,0x3f6dbec4
.long 0x3f800000,0x3e48bf7b,0xbf6dbec4,0xbf0e3f55,0xbf80,0xbf7bbe48,0xbec43f6d,0x3f553f0e
.long 0xbf80,0xbec43f6d,0x3f35bf35,0xbf6d3ec4,0xbf808000,0x3f6d3ec4,0xbf35bf35,0x3ec43f6d
.long 0x3f800000,0xbf7bbe48,0x3f6d3ec4,0xbf55bf0e,0xbf80,0xbe483f7b,0x3ec4bf6d,0xbf0e3f55
.long 0x3f80,0x3f80,0x3f80,0x3f80,0x3f808000,0x3f808000,0x3f808000,0x3f808000
.long 0xbf353f35,0xbf0e3f55,0xbec43f6d,0xbe483f7b,0x3f353f35,0x3f553f0e,0x3f6d3ec4,0x3f7b3e48
.long 0x3f80,0x3f800000,0xbf80,0xbf800000,0x3f808000,0xbf80,0xbf808000,0x3f80
.long 0xbf353f35,0x3f553f0e,0x3ec4bf6d,0xbf7bbe48,0x3f353f35,0x3f0ebf55,0xbf6dbec4,0xbe483f7b
.long 0xbf800000,0xbf6d3ec4,0xbf353f35,0xbec43f6d,0x3f80,0x3ec43f6d,0x3f353f35,0x3f6d3ec4
.long 0xbf35bf35,0xbf7bbe48,0xbf6d3ec4,0xbf0e3f55,0xbf353f35,0xbe483f7b,0x3ec43f6d,0x3f553f0e
.long 0xbf800000,0x3ec43f6d,0x3f35bf35,0xbf6dbec4,0x3f80,0x3f6dbec4,0xbf35bf35,0xbec43f6d
.long 0xbf35bf35,0xbe483f7b,0x3f6dbec4,0xbf55bf0e,0xbf353f35,0x3f7b3e48,0xbec4bf6d,0xbf0e3f55
.long 0xbf80,0xbf35bf35,0xbf800000,0xbf353f35,0xbf808000,0xbf353f35,0x3f80,0x3f353f35
.long 0x3f35bf35,0xbe48bf7b,0xbf6dbec4,0xbf553f0e,0xbf35bf35,0xbf7b3e48,0xbec43f6d,0x3f0e3f55
.long 0xbf80,0xbf353f35,0x3f800000,0xbf35bf35,0xbf808000,0x3f353f35,0xbf80,0xbf353f35
.long 0x3f35bf35,0xbf7b3e48,0x3f6d3ec4,0xbf0ebf55,0xbf35bf35,0x3e483f7b,0x3ec4bf6d,0xbf553f0e
.long 0x3f800000,0x3ec4bf6d,0xbf35bf35,0xbf6d3ec4,0xbf80,0xbf6dbec4,0xbf353f35,0x3ec43f6d
.long 0x3f353f35,0x3f55bf0e,0xbec4bf6d,0xbf7b3e48,0x3f35bf35,0xbf0ebf55,0xbf6d3ec4,0x3e483f7b
.long 0x3f800000,0xbf6dbec4,0x3f353f35,0xbec4bf6d,0xbf80,0xbec43f6d,0x3f35bf35,0xbf6d3ec4
.long 0x3f353f35,0xbf0ebf55,0x3ec43f6d,0xbe48bf7b,0x3f35bf35,0xbf553f0e,0x3f6dbec4,0xbf7b3e48
.long 0x3f80,0xbf80,0x3f80,0xbf80,0x3f808000,0xbf808000,0x3f808000,0xbf808000
.long 0x3f80,0xbe48bf7b,0x3ec43f6d,0xbf0ebf55,0x3f808000,0xbf7b3e48,0x3f6dbec4,0xbf553f0e
.long 0x3f80,0xbf800000,0xbf80,0x3f800000,0x3f808000,0x3f80,0xbf808000,0xbf80
.long 0x3f80,0xbf7b3e48,0xbec4bf6d,0x3f55bf0e,0x3f808000,0x3e483f7b,0xbf6d3ec4,0xbf0ebf55
.long 0x3f80,0xbec4bf6d,0x3f353f35,0xbf6dbec4,0x3f808000,0xbf6d3ec4,0x3f35bf35,0xbec43f6d
.long 0x3f80,0xbf0ebf55,0x3f6d3ec4,0xbf7b3e48,0x3f808000,0xbf553f0e,0x3ec4bf6d,0x3e483f7b
.long 0x3f80,0xbf6d3ec4,0xbf35bf35,0x3ec4bf6d,0x3f808000,0x3ec43f6d,0xbf353f35,0xbf6dbec4
.long 0x3f80,0xbf553f0e,0xbf6dbec4,0xbe48bf7b,0x3f808000,0x3f0e3f55,0xbec43f6d,0xbf7b3e48
.long 0x3f80,0xbf35bf35,0x3f800000,0xbf353f35,0x3f808000,0xbf353f35,0xbf80,0x3f353f35
.long 0x3f80,0xbf55bf0e,0x3f6dbec4,0xbe483f7b,0x3f808000,0xbf0e3f55,0xbec4bf6d,0x3f7b3e48
.long 0x3f80,0xbf353f35,0xbf800000,0xbf35bf35,0x3f808000,0x3f353f35,0x3f80,0xbf353f35
.long 0x3f80,0xbf0e3f55,0xbf6d3ec4,0xbf7bbe48,0x3f808000,0x3f553f0e,0x3ec43f6d,0xbe483f7b
.long 0x3f80,0xbf6dbec4,0x3f35bf35,0x3ec43f6d,0x3f808000,0xbec43f6d,0xbf35bf35,0x3f6dbec4
.long 0x3f80,0xbf7bbe48,0x3ec4bf6d,0x3f553f0e,0x3f808000,0xbe483f7b,0xbf6dbec4,0x3f0ebf55
.long 0x3f80,0xbec43f6d,0xbf353f35,0xbf6d3ec4,0x3f808000,0x3f6d3ec4,0x3f353f35,0x3ec43f6d
.long 0x3f80,0xbe483f7b,0xbec43f6d,0xbf0e3f55,0x3f808000,0x3f7b3e48,0x3f6d3ec4,0x3f553f0e
.long 0x3f80,0xbf80,0x3f80,0xbf80,0x3f808000,0xbf808000,0x3f808000,0xbf808000
.long 0x3f353f35,0xbf55bf0e,0x3f6d3ec4,0xbf7bbe48,0x3f35bf35,0xbf0e3f55,0x3ec4bf6d,0xbe483f7b
.long 0x3f80,0xbf800000,0xbf80,0x3f800000,0x3f808000,0x3f80,0xbf808000,0xbf80
.long 0x3f353f35,0xbf0e3f55,0xbf6dbec4,0x3e48bf7b,0x3f35bf35,0x3f553f0e,0xbec43f6d,0xbf7bbe48
.long 0x3f800000,0xbf6d3ec4,0x3f35bf35,0xbec43f6d,0xbf80,0x3ec43f6d,0xbf35bf35,0x3f6d3ec4
.long 0x3f35bf35,0xbe483f7b,0xbec4bf6d,0x3f553f0e,0xbf35bf35,0x3f7b3e48,0xbf6d3ec4,0x3f0ebf55
.long 0x3f800000,0x3ec43f6d,0xbf353f35,0xbf6dbec4,0xbf80,0x3f6dbec4,0x3f353f35,0xbec43f6d
.long 0x3f35bf35,0x3f7b3e48,0x3ec43f6d,0xbf0e3f55,0xbf35bf35,0x3e48bf7b,0x3f6dbec4,0x3f553f0e
.long 0xbf80,0x3f353f35,0xbf800000,0x3f35bf35,0xbf808000,0x3f35bf35,0x3f80,0xbf35bf35
.long 0xbf35bf35,0x3f7bbe48,0xbec43f6d,0xbf0ebf55,0xbf353f35,0xbe48bf7b,0x3f6d3ec4,0xbf553f0e
.long 0xbf80,0x3f35bf35,0x3f800000,0x3f353f35,0xbf808000,0xbf35bf35,0xbf80,0x3f35bf35
.long 0xbf35bf35,0xbe48bf7b,0x3ec4bf6d,0x3f55bf0e,0xbf353f35,0xbf7b3e48,0xbf6dbec4,0xbf0ebf55
.long 0xbf800000,0x3ec4bf6d,0x3f353f35,0xbf6d3ec4,0x3f80,0xbf6dbec4,0x3f35bf35,0x3ec43f6d
.long 0xbf353f35,0xbf0ebf55,0x3f6dbec4,0x3e483f7b,0x3f353f35,0xbf553f0e,0xbec4bf6d,0x3f7bbe48
.long 0xbf800000,0xbf6dbec4,0xbf35bf35,0xbec4bf6d,0x3f80,0xbec43f6d,0xbf353f35,0xbf6d3ec4
.long 0xbf353f35,0xbf553f0e,0xbf6d3ec4,0xbf7b3e48,0x3f353f35,0x3f0e3f55,0x3ec43f6d,0x3e483f7b
.long 0x3f80,0xbf80,0x3f80,0xbf80,0x3f808000,0xbf808000,0x3f808000,0xbf808000
.long 0x3f800000,0xbf7b3e48,0x3f6dbec4,0xbf553f0e,0xbf80,0x3e483f7b,0xbec4bf6d,0x3f0e3f55
.long 0x3f80,0xbf800000,0xbf80,0x3f800000,0x3f808000,0x3f80,0xbf808000,0xbf80
.long 0x3f800000,0x3e483f7b,0xbf6d3ec4,0xbf0ebf55,0xbf80,0x3f7bbe48,0x3ec43f6d,0xbf553f0e
.long 0xbf80,0x3ec43f6d,0xbf35bf35,0x3f6d3ec4,0xbf808000,0x3f6dbec4,0xbf353f35,0x3ec4bf6d
.long 0xbf800000,0x3f55bf0e,0xbec43f6d,0xbe48bf7b,0x3f80,0xbf0ebf55,0x3f6d3ec4,0xbf7b3e48
.long 0xbf80,0x3f6dbec4,0x3f353f35,0xbec43f6d,0xbf808000,0xbec4bf6d,0x3f35bf35,0x3f6d3ec4
.long 0xbf800000,0xbf0ebf55,0x3ec4bf6d,0x3f7bbe48,0x3f80,0xbf553f0e,0xbf6dbec4,0xbe48bf7b
.long 0x3f80,0xbf35bf35,0x3f800000,0xbf353f35,0x3f808000,0xbf353f35,0xbf80,0x3f353f35
.long 0x3f800000,0xbf0e3f55,0xbec4bf6d,0x3f7b3e48,0xbf80,0x3f553f0e,0xbf6d3ec4,0x3e48bf7b
.long 0x3f80,0xbf353f35,0xbf800000,0xbf35bf35,0x3f808000,0x3f353f35,0x3f80,0xbf353f35
.long 0x3f800000,0x3f553f0e,0x3ec43f6d,0xbe483f7b,0xbf80,0x3f0ebf55,0x3f6dbec4,0x3f7b3e48
.long 0xbf80,0x3f6d3ec4,0xbf353f35,0xbec4bf6d,0xbf808000,0x3ec4bf6d,0x3f353f35,0xbf6d3ec4
.long 0xbf800000,0x3e48bf7b,0x3f6d3ec4,0xbf0e3f55,0x3f80,0xbf7bbe48,0x3ec4bf6d,0x3f553f0e
.long 0xbf80,0x3ec4bf6d,0x3f35bf35,0x3f6dbec4,0xbf808000,0xbf6dbec4,0xbf35bf35,0xbec4bf6d
.long 0xbf800000,0xbf7bbe48,0xbf6dbec4,0xbf55bf0e,0x3f80,0xbe483f7b,0xbec43f6d,0xbf0e3f55
.long 0x3f80,0xbf80,0x3f80,0xbf80,0x3f808000,0xbf808000,0x3f808000,0xbf808000
.long 0x3f35bf35,0xbf0e3f55,0x3ec4bf6d,0xbe483f7b,0xbf35bf35,0x3f553f0e,0xbf6dbec4,0x3f7b3e48
.long 0x3f80,0xbf800000,0xbf80,0x3f800000,0x3f808000,0x3f80,0xbf808000,0xbf80
.long 0x3f35bf35,0x3f553f0e,0xbec43f6d,0xbf7bbe48,0xbf35bf35,0x3f0ebf55,0x3f6d3ec4,0xbe483f7b
.long 0xbf800000,0x3f6dbec4,0xbf353f35,0x3ec4bf6d,0x3f80,0xbec4bf6d,0x3f353f35,0xbf6dbec4
.long 0x3f353f35,0xbf7bbe48,0x3f6dbec4,0xbf0e3f55,0x3f35bf35,0xbe483f7b,0xbec4bf6d,0x3f553f0e
.long 0xbf800000,0xbec4bf6d,0x3f35bf35,0x3f6d3ec4,0x3f80,0xbf6d3ec4,0xbf35bf35,0x3ec4bf6d
.long 0x3f353f35,0xbe483f7b,0xbf6d3ec4,0xbf55bf0e,0x3f35bf35,0x3f7b3e48,0x3ec43f6d,0xbf0e3f55
.long 0xbf80,0x3f353f35,0xbf800000,0x3f35bf35,0xbf808000,0x3f35bf35,0x3f80,0xbf35bf35
.long 0xbf353f35,0xbe48bf7b,0x3f6d3ec4,0xbf553f0e,0x3f353f35,0xbf7b3e48,0x3ec4bf6d,0x3f0e3f55
.long 0xbf80,0x3f35bf35,0x3f800000,0x3f353f35,0xbf808000,0xbf35bf35,0xbf80,0x3f35bf35
.long 0xbf353f35,0xbf7b3e48,0xbf6dbec4,0xbf0ebf55,0x3f353f35,0x3e483f7b,0xbec43f6d,0xbf553f0e
.long 0x3f800000,0xbec43f6d,0xbf35bf35,0x3f6dbec4,0xbf80,0x3f6d3ec4,0xbf353f35,0xbec4bf6d
.long 0xbf35bf35,0x3f55bf0e,0x3ec43f6d,0xbf7b3e48,0xbf353f35,0xbf0ebf55,0x3f6dbec4,0x3e483f7b
.long 0x3f800000,0x3f6d3ec4,0x3f353f35,0x3ec43f6d,0xbf80,0x3ec4bf6d,0x3f35bf35,0x3f6dbec4
.long 0xbf35bf35,0xbf0ebf55,0xbec4bf6d,0xbe48bf7b,0xbf353f35,0xbf553f0e,0xbf6d3ec4,0xbf7b3e48
.long 0x3f80,0xbf80,0x3f80,0xbf80,0x3f808000,0xbf808000,0x3f808000,0xbf808000
.long 0xbf80,0x3e483f7b,0xbec4bf6d,0x3f0e3f55,0xbf808000,0x3f7bbe48,0xbf6d3ec4,0x3f55bf0e
.long 0x3f80,0xbf800000,0xbf80,0x3f800000,0x3f808000,0x3f80,0xbf808000,0xbf80
.long 0xbf80,0x3f7bbe48,0x3ec43f6d,0xbf553f0e,0xbf808000,0xbe48bf7b,0x3f6dbec4,0x3f0e3f55
.long 0x3f80,0xbec4bf6d,0x3f353f35,0xbf6dbec4,0x3f808000,0xbf6d3ec4,0x3f35bf35,0xbec43f6d
.long 0xbf80,0x3f0e3f55,0xbf6dbec4,0x3f7bbe48,0xbf808000,0x3f55bf0e,0xbec43f6d,0xbe48bf7b
.long 0x3f80,0xbf6d3ec4,0xbf35bf35,0x3ec4bf6d,0x3f808000,0x3ec43f6d,0xbf353f35,0xbf6dbec4
.long 0xbf80,0x3f55bf0e,0x3f6d3ec4,0x3e483f7b,0xbf808000,0xbf0ebf55,0x3ec4bf6d,0x3f7bbe48
.long 0x3f80,0xbf35bf35,0x3f800000,0xbf353f35,0x3f808000,0xbf353f35,0xbf80,0x3f353f35
.long 0xbf80,0x3f553f0e,0xbf6d3ec4,0x3e48bf7b,0xbf808000,0x3f0ebf55,0x3ec43f6d,0xbf7bbe48
.long 0x3f80,0xbf353f35,0xbf800000,0xbf35bf35,0x3f808000,0x3f353f35,0x3f80,0xbf353f35
.long 0xbf80,0x3f0ebf55,0x3f6dbec4,0x3f7b3e48,0xbf808000,0xbf55bf0e,0xbec4bf6d,0x3e48bf7b
.long 0x3f80,0xbf6dbec4,0x3f35bf35,0x3ec43f6d,0x3f808000,0xbec43f6d,0xbf35bf35,0x3f6dbec4
.long 0xbf80,0x3f7b3e48,0xbec43f6d,0xbf55bf0e,0xbf808000,0x3e48bf7b,0x3f6d3ec4,0xbf0e3f55
.long 0x3f80,0xbec43f6d,0xbf353f35,0xbf6d3ec4,0x3f808000,0x3f6d3ec4,0x3f353f35,0x3ec43f6d
.long 0xbf80,0x3e48bf7b,0x3ec4bf6d,0x3f0ebf55,0xbf808000,0xbf7bbe48,0xbf6dbec4,0xbf55bf0e
.long 0x3f80,0xbf80,0x3f80,0xbf80,0x3f808000,0xbf808000,0x3f808000,0xbf808000
.long 0xbf35bf35,0x3f553f0e,0xbf6dbec4,0x3f7b3e48,0xbf353f35,0x3f0ebf55,0xbec43f6d,0x3e48bf7b
.long 0x3f80,0xbf800000,0xbf80,0x3f800000,0x3f808000,0x3f80,0xbf808000,0xbf80
.long 0xbf35bf35,0x3f0ebf55,0x3f6d3ec4,0xbe483f7b,0xbf353f35,0xbf55bf0e,0x3ec4bf6d,0x3f7b3e48
.long 0x3f800000,0xbf6d3ec4,0x3f35bf35,0xbec43f6d,0xbf80,0x3ec43f6d,0xbf35bf35,0x3f6d3ec4
.long 0xbf353f35,0x3e48bf7b,0x3ec43f6d,0xbf55bf0e,0x3f353f35,0xbf7bbe48,0x3f6dbec4,0xbf0e3f55
.long 0x3f800000,0x3ec43f6d,0xbf353f35,0xbf6dbec4,0xbf80,0x3f6dbec4,0x3f353f35,0xbec43f6d
.long 0xbf353f35,0xbf7bbe48,0xbec4bf6d,0x3f0ebf55,0x3f353f35,0xbe483f7b,0xbf6d3ec4,0xbf55bf0e
.long 0xbf80,0x3f353f35,0xbf800000,0x3f35bf35,0xbf808000,0x3f35bf35,0x3f80,0xbf35bf35
.long 0x3f353f35,0xbf7b3e48,0x3ec4bf6d,0x3f0e3f55,0x3f35bf35,0x3e483f7b,0xbf6dbec4,0x3f55bf0e
.long 0xbf80,0x3f35bf35,0x3f800000,0x3f353f35,0xbf808000,0xbf35bf35,0xbf80,0x3f35bf35
.long 0x3f353f35,0x3e483f7b,0xbec43f6d,0xbf553f0e,0x3f35bf35,0x3f7bbe48,0x3f6d3ec4,0x3f0e3f55
.long 0xbf800000,0x3ec4bf6d,0x3f353f35,0xbf6d3ec4,0x3f80,0xbf6dbec4,0x3f35bf35,0x3ec43f6d
.long 0x3f35bf35,0x3f0e3f55,0xbf6d3ec4,0xbe48bf7b,0xbf35bf35,0x3f55bf0e,0x3ec43f6d,0xbf7b3e48
.long 0xbf800000,0xbf6dbec4,0xbf35bf35,0xbec4bf6d,0x3f80,0xbec43f6d,0xbf353f35,0xbf6d3ec4
.long 0x3f35bf35,0x3f55bf0e,0x3f6dbec4,0x3f7bbe48,0xbf35bf35,0xbf0ebf55,0xbec4bf6d,0xbe48bf7b
.long 0x3f80,0xbf80,0x3f80,0xbf80,0x3f808000,0xbf808000,0x3f808000,0xbf808000
.long 0xbf800000,0x3f7bbe48,0xbf6d3ec4,0x3f55bf0e,0x3f80,0xbe48bf7b,0x3ec43f6d,0xbf0ebf55
.long 0x3f80,0xbf800000,0xbf80,0x3f800000,0x3f808000,0x3f80,0xbf808000,0xbf80
.long 0xbf800000,0xbe48bf7b,0x3f6dbec4,0x3f0e3f55,0x3f80,0xbf7b3e48,0xbec4bf6d,0x3f55bf0e
.long 0xbf80,0x3ec43f6d,0xbf35bf35,0x3f6d3ec4,0xbf808000,0x3f6dbec4,0xbf353f35,0x3ec4bf6d
.long 0x3f800000,0xbf553f0e,0x3ec4bf6d,0x3e483f7b,0xbf80,0x3f0e3f55,0xbf6dbec4,0x3f7bbe48
.long 0xbf80,0x3f6dbec4,0x3f353f35,0xbec43f6d,0xbf808000,0xbec4bf6d,0x3f35bf35,0x3f6d3ec4
.long 0x3f800000,0x3f0e3f55,0xbec43f6d,0xbf7b3e48,0xbf80,0x3f55bf0e,0x3f6d3ec4,0x3e483f7b
.long 0x3f80,0xbf35bf35,0x3f800000,0xbf353f35,0x3f808000,0xbf353f35,0xbf80,0x3f353f35
.long 0xbf800000,0x3f0ebf55,0x3ec43f6d,0xbf7bbe48,0x3f80,0xbf55bf0e,0x3f6dbec4,0xbe483f7b
.long 0x3f80,0xbf353f35,0xbf800000,0xbf35bf35,0x3f808000,0x3f353f35,0x3f80,0xbf353f35
.long 0xbf800000,0xbf55bf0e,0xbec4bf6d,0x3e48bf7b,0x3f80,0xbf0e3f55,0xbf6d3ec4,0xbf7bbe48
.long 0xbf80,0x3f6d3ec4,0xbf353f35,0xbec4bf6d,0xbf808000,0x3ec4bf6d,0x3f353f35,0xbf6d3ec4
.long 0x3f800000,0xbe483f7b,0xbf6dbec4,0x3f0ebf55,0xbf80,0x3f7b3e48,0xbec43f6d,0xbf55bf0e
.long 0xbf80,0x3ec4bf6d,0x3f35bf35,0x3f6dbec4,0xbf808000,0xbf6dbec4,0xbf35bf35,0xbec4bf6d
.long 0x3f800000,0x3f7b3e48,0x3f6d3ec4,0x3f553f0e,0xbf80,0x3e48bf7b,0x3ec4bf6d,0x3f0ebf55
.long 0x3f80,0xbf80,0x3f80,0xbf80,0x3f808000,0xbf808000,0x3f808000,0xbf808000
.long 0xbf353f35,0x3f0ebf55,0xbec43f6d,0x3e48bf7b,0x3f353f35,0xbf55bf0e,0x3f6d3ec4,0xbf7bbe48
.long 0x3f80,0xbf800000,0xbf80,0x3f800000,0x3f808000,0x3f80,0xbf808000,0xbf80
.long 0xbf353f35,0xbf55bf0e,0x3ec4bf6d,0x3f7b3e48,0x3f353f35,0xbf0e3f55,0xbf6dbec4,0x3e48bf7b
.long 0xbf800000,0x3f6dbec4,0xbf353f35,0x3ec4bf6d,0x3f80,0xbec4bf6d,0x3f353f35,0xbf6dbec4
.long 0xbf35bf35,0x3f7b3e48,0xbf6d3ec4,0x3f0ebf55,0xbf353f35,0x3e48bf7b,0x3ec43f6d,0xbf55bf0e
.long 0xbf800000,0xbec4bf6d,0x3f35bf35,0x3f6d3ec4,0x3f80,0xbf6d3ec4,0xbf35bf35,0x3ec4bf6d
.long 0xbf35bf35,0x3e48bf7b,0x3f6dbec4,0x3f553f0e,0xbf353f35,0xbf7bbe48,0xbec4bf6d,0x3f0ebf55
.long 0xbf80,0x3f353f35,0xbf800000,0x3f35bf35,0xbf808000,0x3f35bf35,0x3f80,0xbf35bf35
.long 0x3f35bf35,0x3e483f7b,0xbf6dbec4,0x3f55bf0e,0xbf35bf35,0x3f7bbe48,0xbec43f6d,0xbf0ebf55
.long 0xbf80,0x3f35bf35,0x3f800000,0x3f353f35,0xbf808000,0xbf35bf35,0xbf80,0x3f35bf35
.long 0x3f35bf35,0x3f7bbe48,0x3f6d3ec4,0x3f0e3f55,0xbf35bf35,0xbe48bf7b,0x3ec4bf6d,0x3f55bf0e
.long 0x3f800000,0xbec43f6d,0xbf35bf35,0x3f6dbec4,0xbf80,0x3f6d3ec4,0xbf353f35,0xbec4bf6d
.long 0x3f353f35,0xbf553f0e,0xbec4bf6d,0x3f7bbe48,0x3f35bf35,0x3f0e3f55,0xbf6d3ec4,0xbe48bf7b
.long 0x3f800000,0x3f6d3ec4,0x3f353f35,0x3ec43f6d,0xbf80,0x3ec4bf6d,0x3f35bf35,0x3f6dbec4
.long 0x3f353f35,0x3f0e3f55,0x3ec43f6d,0x3e483f7b,0x3f35bf35,0x3f55bf0e,0x3f6dbec4,0x3f7bbe48
.long 0x3f80,0x3f80,0x3f80,0x3f80,0x3f808000,0x3f808000,0x3f808000,0x3f808000
.long 0x3f80,0x3dc93f7f,0x3e483f7b,0x3e953f75,0x3f808000,0x3f7fbdc9,0x3f7bbe48,0x3f75be95
.long 0x3f80,0x3f353f35,0x3f800000,0x3f35bf35,0x3f808000,0x3f35bf35,0xbf80,0xbf35bf35
.long 0x3f80,0x3f463f22,0x3f7bbe48,0x3ef1bf62,0x3f808000,0x3f22bf46,0xbe48bf7b,0xbf62bef1
.long 0x3f80,0x3e483f7b,0x3ec43f6d,0x3f0e3f55,0x3f808000,0x3f7bbe48,0x3f6dbec4,0x3f55bf0e
.long 0x3f80,0x3e953f75,0x3f0e3f55,0x3f463f22,0x3f808000,0x3f75be95,0x3f55bf0e,0x3f22bf46
.long 0x3f80,0x3f553f0e,0x3f6dbec4,0x3e48bf7b,0x3f808000,0x3f0ebf55,0xbec4bf6d,0xbf7bbe48
.long 0x3f80,0x3f623ef1,0x3f55bf0e,0xbdc9bf7f,0x3f808000,0x3ef1bf62,0xbf0ebf55,0xbf7f3dc9
.long 0x3f80,0x3ec43f6d,0x3f353f35,0x3f6d3ec4,0x3f808000,0x3f6dbec4,0x3f35bf35,0x3ec4bf6d
.long 0x3f80,0x3ef13f62,0x3f553f0e,0x3f7f3dc9,0x3f808000,0x3f62bef1,0x3f0ebf55,0x3dc9bf7f
.long 0x3f80,0x3f6d3ec4,0x3f35bf35,0xbec4bf6d,0x3f808000,0x3ec4bf6d,0xbf35bf35,0xbf6d3ec4
.long 0x3f80,0x3f753e95,0x3f0ebf55,0xbf22bf46,0x3f808000,0x3e95bf75,0xbf55bf0e,0xbf463f22
.long 0x3f80,0x3f0e3f55,0x3f6d3ec4,0x3f7bbe48,0x3f808000,0x3f55bf0e,0x3ec4bf6d,0xbe48bf7b
.long 0x3f80,0x3f223f46,0x3f7b3e48,0x3f62bef1,0x3f808000,0x3f46bf22,0x3e48bf7b,0xbef1bf62
.long 0x3f80,0x3f7b3e48,0x3ec4bf6d,0xbf55bf0e,0x3f808000,0x3e48bf7b,0xbf6dbec4,0xbf0e3f55
.long 0x3f80,0x3f7f3dc9,0x3e48bf7b,0xbf75be95,0x3f808000,0x3dc9bf7f,0xbf7bbe48,0xbe953f75
.long 0x3f80,0x3f80,0x3f80,0x3f80,0x3f808000,0x3f808000,0x3f808000,0x3f808000
.long 0x3ec43f6d,0x3ef13f62,0x3f0e3f55,0x3f223f46,0x3f6dbec4,0x3f62bef1,0x3f55bf0e,0x3f46bf22
.long 0xbf80,0xbf35bf35,0xbf800000,0xbf353f35,0xbf808000,0xbf353f35,0x3f80,0x3f353f35
.long 0xbec4bf6d,0xbf75be95,0xbf553f0e,0xbdc93f7f,0xbf6d3ec4,0xbe953f75,0x3f0e3f55,0x3f7f3dc9
.long 0x3f353f35,0x3f553f0e,0x3f6d3ec4,0x3f7b3e48,0x3f35bf35,0x3f0ebf55,0x3ec4bf6d,0x3e48bf7b
.long 0x3f6d3ec4,0x3f7f3dc9,0x3f7bbe48,0x3f62bef1,0x3ec4bf6d,0x3dc9bf7f,0xbe48bf7b,0xbef1bf62
.long 0xbf35bf35,0xbf7b3e48,0xbec43f6d,0x3f0e3f55,0xbf353f35,0x3e483f7b,0x3f6d3ec4,0x3f55bf0e
.long 0xbf6dbec4,0xbf463f22,0x3e483f7b,0x3f753e95,0xbec43f6d,0x3f223f46,0x3f7bbe48,0x3e95bf75
.long 0x3f800000,0x3f6dbec4,0x3f35bf35,0x3ec4bf6d,0xbf80,0xbec4bf6d,0xbf35bf35,0xbf6dbec4
.long 0x3f6dbec4,0x3f22bf46,0x3e48bf7b,0xbe95bf75,0xbec4bf6d,0xbf46bf22,0xbf7bbe48,0xbf753e95
.long 0xbf800000,0xbec43f6d,0x3f353f35,0x3f6dbec4,0x3f80,0x3f6d3ec4,0x3f35bf35,0xbec4bf6d
.long 0xbf6d3ec4,0x3dc93f7f,0x3f7b3e48,0x3ef1bf62,0x3ec43f6d,0x3f7fbdc9,0x3e48bf7b,0xbf62bef1
.long 0x3f35bf35,0x3e48bf7b,0xbec4bf6d,0xbf55bf0e,0xbf35bf35,0xbf7bbe48,0xbf6d3ec4,0xbf0e3f55
.long 0x3ec4bf6d,0xbe95bf75,0xbf55bf0e,0xbf7f3dc9,0xbf6dbec4,0xbf753e95,0xbf0e3f55,0x3dc93f7f
.long 0xbf353f35,0x3f0e3f55,0x3f6dbec4,0xbe48bf7b,0x3f353f35,0x3f55bf0e,0xbec4bf6d,0xbf7b3e48
.long 0xbec43f6d,0x3f623ef1,0x3f0ebf55,0xbf46bf22,0x3f6d3ec4,0x3ef1bf62,0xbf55bf0e,0xbf223f46
.long 0x3f80,0x3f80,0x3f80,0x3f80,0x3f808000,0x3f808000,0x3f808000,0x3f808000
.long 0x3f353f35,0x3f463f22,0x3f553f0e,0x3f623ef1,0x3f35bf35,0x3f22bf46,0x3f0ebf55,0x3ef1bf62
.long 0x3f80,0x3f353f35,0x3f800000,0x3f35bf35,0x3f808000,0x3f35bf35,0xbf80,0xbf35bf35
.long 0x3f353f35,0x3f7fbdc9,0x3f0ebf55,0xbe95bf75,0x3f35bf35,0xbdc9bf7f,0xbf55bf0e,0xbf753e95
.long 0x3f800000,0x3f7bbe48,0x3f6dbec4,0x3f55bf0e,0xbf80,0xbe48bf7b,0xbec4bf6d,0xbf0ebf55
.long 0x3f35bf35,0x3ef1bf62,0x3e48bf7b,0xbdc9bf7f,0xbf35bf35,0xbf62bef1,0xbf7bbe48,0xbf7f3dc9
.long 0x3f800000,0x3f0ebf55,0xbec4bf6d,0xbf7bbe48,0xbf80,0xbf55bf0e,0xbf6d3ec4,0xbe483f7b
.long 0x3f35bf35,0xbe95bf75,0xbf7bbe48,0xbf223f46,0xbf35bf35,0xbf753e95,0xbe483f7b,0x3f463f22
.long 0xbf80,0xbec4bf6d,0xbf35bf35,0xbf6dbec4,0xbf808000,0xbf6d3ec4,0xbf353f35,0xbec43f6d
.long 0xbf35bf35,0xbf75be95,0xbf7b3e48,0xbf463f22,0xbf353f35,0xbe953f75,0x3e483f7b,0x3f223f46
.long 0xbf80,0xbf6dbec4,0xbf353f35,0x3ec43f6d,0xbf808000,0xbec43f6d,0x3f353f35,0x3f6dbec4
.long 0xbf35bf35,0xbf623ef1,0x3e483f7b,0x3f7f3dc9,0xbf353f35,0x3ef13f62,0x3f7bbe48,0x3dc9bf7f
.long 0xbf800000,0xbf553f0e,0xbec43f6d,0x3e483f7b,0x3f80,0x3f0e3f55,0x3f6d3ec4,0x3f7bbe48
.long 0xbf353f35,0xbdc93f7f,0x3f0e3f55,0x3f753e95,0x3f353f35,0x3f7f3dc9,0x3f55bf0e,0x3e95bf75
.long 0xbf800000,0xbe483f7b,0x3f6d3ec4,0x3f0ebf55,0x3f80,0x3f7b3e48,0x3ec4bf6d,0xbf55bf0e
.long 0xbf353f35,0x3f223f46,0x3f55bf0e,0xbef1bf62,0x3f353f35,0x3f46bf22,0xbf0ebf55,0xbf623ef1
.long 0x3f80,0x3f80,0x3f80,0x3f80,0x3f808000,0x3f808000,0x3f808000,0x3f808000
.long 0x3f6d3ec4,0x3f753e95,0x3f7b3e48,0x3f7f3dc9,0x3ec4bf6d,0x3e95bf75,0x3e48bf7b,0x3dc9bf7f
.long 0xbf80,0xbf35bf35,0xbf800000,0xbf353f35,0xbf808000,0xbf353f35,0x3f80,0x3f353f35
.long 0xbf6dbec4,0xbf623ef1,0xbe483f7b,0x3f223f46,0xbec43f6d,0x3ef13f62,0x3f7b3e48,0x3f46bf22
.long 0x3f35bf35,0x3f0ebf55,0x3ec4bf6d,0x3e48bf7b,0xbf35bf35,0xbf55bf0e,0xbf6dbec4,0xbf7bbe48
.long 0xbec4bf6d,0xbf22bf46,0xbf55bf0e,0xbf75be95,0xbf6d3ec4,0xbf463f22,0xbf0e3f55,0xbe953f75
.long 0xbf353f35,0x3e483f7b,0x3f6d3ec4,0x3f55bf0e,0x3f353f35,0x3f7bbe48,0x3ec4bf6d,0xbf0ebf55
.long 0x3ec43f6d,0x3f7f3dc9,0x3f0ebf55,0xbef1bf62,0x3f6dbec4,0x3dc9bf7f,0xbf55bf0e,0xbf623ef1
.long 0xbf800000,0xbf6d3ec4,0xbf353f35,0xbec43f6d,0x3f80,0x3ec43f6d,0x3f353f35,0x3f6d3ec4
.long 0xbec43f6d,0x3dc93f7f,0x3f0e3f55,0x3f623ef1,0x3f6d3ec4,0x3f7fbdc9,0x3f55bf0e,0x3ef1bf62
.long 0x3f800000,0x3ec4bf6d,0xbf35bf35,0xbf6d3ec4,0xbf80,0xbf6dbec4,0xbf353f35,0x3ec43f6d
.long 0x3ec4bf6d,0xbf46bf22,0xbf553f0e,0x3e953f75,0xbf6dbec4,0xbf223f46,0x3f0e3f55,0x3f75be95
.long 0x3f353f35,0x3f7b3e48,0x3f6dbec4,0x3f0ebf55,0x3f35bf35,0x3e48bf7b,0xbec4bf6d,0xbf55bf0e
.long 0x3f6dbec4,0x3ef1bf62,0xbe48bf7b,0xbf46bf22,0xbec4bf6d,0xbf62bef1,0xbf7b3e48,0xbf223f46
.long 0xbf35bf35,0xbf553f0e,0x3ec43f6d,0x3f7bbe48,0xbf353f35,0x3f0e3f55,0x3f6dbec4,0xbe48bf7b
.long 0xbf6d3ec4,0x3e953f75,0x3f7bbe48,0xbdc9bf7f,0x3ec43f6d,0x3f75be95,0xbe48bf7b,0xbf7f3dc9
.long 0x3f80,0x3f80,0x3f80,0x3f80,0x3f808000,0x3f808000,0x3f808000,0x3f808000
.long 0x3f800000,0x3f7fbdc9,0x3f7bbe48,0x3f75be95,0xbf80,0xbdc9bf7f,0xbe48bf7b,0xbe95bf75
.long 0x3f80,0x3f353f35,0x3f800000,0x3f35bf35,0x3f808000,0x3f35bf35,0xbf80,0xbf35bf35
.long 0x3f800000,0x3f22bf46,0xbe48bf7b,0xbf62bef1,0xbf80,0xbf46bf22,0xbf7b3e48,0xbef13f62
.long 0xbf80,0xbe48bf7b,0xbec4bf6d,0xbf0ebf55,0xbf808000,0xbf7b3e48,0xbf6d3ec4,0xbf553f0e
.long 0xbf800000,0xbf753e95,0xbf553f0e,0xbf223f46,0x3f80,0x3e953f75,0x3f0e3f55,0x3f463f22
.long 0xbf80,0xbf55bf0e,0xbf6d3ec4,0xbe483f7b,0xbf808000,0xbf0e3f55,0x3ec43f6d,0x3f7b3e48
.long 0xbf800000,0xbef13f62,0x3f0e3f55,0x3f7fbdc9,0x3f80,0x3f623ef1,0x3f55bf0e,0xbdc9bf7f
.long 0x3f80,0x3ec43f6d,0x3f353f35,0x3f6d3ec4,0x3f808000,0x3f6dbec4,0x3f35bf35,0x3ec4bf6d
.long 0x3f800000,0x3f62bef1,0x3f0ebf55,0x3dc9bf7f,0xbf80,0xbef1bf62,0xbf55bf0e,0xbf7fbdc9
.long 0x3f80,0x3f6d3ec4,0x3f35bf35,0xbec4bf6d,0x3f808000,0x3ec4bf6d,0xbf35bf35,0xbf6d3ec4
.long 0x3f800000,0x3e95bf75,0xbf55bf0e,0xbf463f22,0xbf80,0xbf75be95,0xbf0e3f55,0x3f223f46
.long 0xbf80,0xbf0ebf55,0xbf6dbec4,0xbf7b3e48,0xbf808000,0xbf553f0e,0xbec43f6d,0x3e483f7b
.long 0xbf800000,0xbf463f22,0xbe483f7b,0x3ef13f62,0x3f80,0x3f223f46,0x3f7b3e48,0x3f62bef1
.long 0xbf80,0xbf7bbe48,0xbec43f6d,0x3f553f0e,0xbf808000,0xbe483f7b,0x3f6d3ec4,0x3f0ebf55
.long 0xbf800000,0xbdc93f7f,0x3f7b3e48,0x3e95bf75,0x3f80,0x3f7f3dc9,0x3e48bf7b,0xbf75be95
.long 0x3f80,0x3f80,0x3f80,0x3f80,0x3f808000,0x3f808000,0x3f808000,0x3f808000
.long 0x3f6dbec4,0x3f62bef1,0x3f55bf0e,0x3f46bf22,0xbec4bf6d,0xbef1bf62,0xbf0ebf55,0xbf22bf46
.long 0xbf80,0xbf35bf35,0xbf800000,0xbf353f35,0xbf808000,0xbf353f35,0x3f80,0x3f353f35
.long 0xbf6d3ec4,0xbe953f75,0x3f0e3f55,0x3f7f3dc9,0x3ec43f6d,0x3f753e95,0x3f55bf0e,0x3dc9bf7f
.long 0xbf35bf35,0xbf55bf0e,0xbf6dbec4,0xbf7bbe48,0xbf353f35,0xbf0e3f55,0xbec43f6d,0xbe483f7b
.long 0xbec43f6d,0xbdc93f7f,0x3e483f7b,0x3ef13f62,0x3f6d3ec4,0x3f7f3dc9,0x3f7bbe48,0x3f62bef1
.long 0x3f353f35,0x3f7bbe48,0x3ec4bf6d,0xbf0ebf55,0x3f35bf35,0xbe48bf7b,0xbf6dbec4,0xbf553f0e
.long 0x3ec4bf6d,0xbf22bf46,0xbf7b3e48,0xbe953f75,0xbf6dbec4,0xbf463f22,0x3e483f7b,0x3f753e95
.long 0x3f800000,0x3f6dbec4,0x3f35bf35,0x3ec4bf6d,0xbf80,0xbec4bf6d,0xbf35bf35,0xbf6dbec4
.long 0xbec4bf6d,0xbf46bf22,0xbf7bbe48,0xbf753e95,0xbf6d3ec4,0xbf223f46,0xbe483f7b,0x3e953f75
.long 0xbf800000,0xbec43f6d,0x3f353f35,0x3f6dbec4,0x3f80,0x3f6d3ec4,0x3f35bf35,0xbec4bf6d
.long 0x3ec43f6d,0x3f7fbdc9,0x3e48bf7b,0xbf62bef1,0x3f6dbec4,0xbdc9bf7f,0xbf7bbe48,0xbef13f62
.long 0xbf353f35,0xbe483f7b,0x3ec43f6d,0x3f553f0e,0x3f353f35,0x3f7b3e48,0x3f6dbec4,0x3f0ebf55
.long 0x3f6d3ec4,0x3f75be95,0x3f0ebf55,0xbdc9bf7f,0x3ec4bf6d,0xbe95bf75,0xbf55bf0e,0xbf7f3dc9
.long 0x3f35bf35,0xbf0ebf55,0xbf6d3ec4,0x3e483f7b,0xbf35bf35,0xbf553f0e,0x3ec43f6d,0x3f7bbe48
.long 0xbf6dbec4,0xbef13f62,0x3f553f0e,0x3f22bf46,0xbec43f6d,0x3f623ef1,0x3f0ebf55,0xbf46bf22
.long 0x3f80,0x3f80,0x3f80,0x3f80,0x3f808000,0x3f808000,0x3f808000,0x3f808000
.long 0x3f35bf35,0x3f22bf46,0x3f0ebf55,0x3ef1bf62,0xbf35bf35,0xbf46bf22,0xbf55bf0e,0xbf62bef1
.long 0x3f80,0x3f353f35,0x3f800000,0x3f35bf35,0x3f808000,0x3f35bf35,0xbf80,0xbf35bf35
.long 0x3f35bf35,0xbdc9bf7f,0xbf55bf0e,0xbf753e95,0xbf35bf35,0xbf7f3dc9,0xbf0e3f55,0x3e953f75
.long 0xbf800000,0xbf7b3e48,0xbf6d3ec4,0xbf553f0e,0x3f80,0x3e483f7b,0x3ec43f6d,0x3f0e3f55
.long 0x3f353f35,0x3f623ef1,0x3f7b3e48,0x3f7fbdc9,0x3f35bf35,0x3ef1bf62,0x3e48bf7b,0xbdc9bf7f
.long 0xbf800000,0xbf0e3f55,0x3ec43f6d,0x3f7b3e48,0x3f80,0x3f553f0e,0x3f6dbec4,0x3e48bf7b
.long 0x3f353f35,0x3f75be95,0x3e48bf7b,0xbf46bf22,0x3f35bf35,0xbe95bf75,0xbf7bbe48,0xbf223f46
.long 0xbf80,0xbec4bf6d,0xbf35bf35,0xbf6dbec4,0xbf808000,0xbf6d3ec4,0xbf353f35,0xbec43f6d
.long 0xbf353f35,0xbe953f75,0x3e483f7b,0x3f223f46,0x3f353f35,0x3f753e95,0x3f7bbe48,0x3f46bf22
.long 0xbf80,0xbf6dbec4,0xbf353f35,0x3ec43f6d,0xbf808000,0xbec43f6d,0x3f353f35,0x3f6dbec4
.long 0xbf353f35,0x3ef13f62,0x3f7bbe48,0x3dc9bf7f,0x3f353f35,0x3f62bef1,0xbe48bf7b,0xbf7fbdc9
.long 0x3f800000,0x3f55bf0e,0x3ec4bf6d,0xbe48bf7b,0xbf80,0xbf0ebf55,0xbf6dbec4,0xbf7b3e48
.long 0xbf35bf35,0xbf7fbdc9,0xbf553f0e,0xbe953f75,0xbf353f35,0xbdc93f7f,0x3f0e3f55,0x3f753e95
.long 0x3f800000,0x3e48bf7b,0xbf6dbec4,0xbf0e3f55,0xbf80,0xbf7bbe48,0xbec43f6d,0x3f553f0e
.long 0xbf35bf35,0xbf463f22,0x3f0e3f55,0x3f62bef1,0xbf353f35,0x3f223f46,0x3f55bf0e,0xbef1bf62
.long 0x3f80,0x3f80,0x3f80,0x3f80,0x3f808000,0x3f808000,0x3f808000,0x3f808000
.long 0x3ec4bf6d,0x3e95bf75,0x3e48bf7b,0x3dc9bf7f,0xbf6dbec4,0xbf75be95,0xbf7bbe48,0xbf7fbdc9
.long 0xbf80,0xbf35bf35,0xbf800000,0xbf353f35,0xbf808000,0xbf353f35,0x3f80,0x3f353f35
.long 0xbec43f6d,0x3ef13f62,0x3f7b3e48,0x3f46bf22,0x3f6d3ec4,0x3f62bef1,0x3e48bf7b,0xbf22bf46
.long 0xbf353f35,0xbf0e3f55,0xbec43f6d,0xbe483f7b,0x3f353f35,0x3f553f0e,0x3f6d3ec4,0x3f7b3e48
.long 0x3f6dbec4,0x3f46bf22,0x3f0ebf55,0x3e95bf75,0xbec4bf6d,0xbf22bf46,0xbf55bf0e,0xbf75be95
.long 0x3f35bf35,0xbe48bf7b,0xbf6dbec4,0xbf553f0e,0xbf35bf35,0xbf7b3e48,0xbec43f6d,0x3f0e3f55
.long 0xbf6d3ec4,0xbdc93f7f,0x3f553f0e,0x3f62bef1,0x3ec43f6d,0x3f7f3dc9,0x3f0ebf55,0xbef1bf62
.long 0xbf800000,0xbf6d3ec4,0xbf353f35,0xbec43f6d,0x3f80,0x3ec43f6d,0x3f353f35,0x3f6d3ec4
.long 0x3f6d3ec4,0x3f7fbdc9,0x3f55bf0e,0x3ef1bf62,0x3ec4bf6d,0xbdc9bf7f,0xbf0ebf55,0xbf62bef1
.long 0x3f800000,0x3ec4bf6d,0xbf35bf35,0xbf6d3ec4,0xbf80,0xbf6dbec4,0xbf353f35,0x3ec43f6d
.long 0xbf6dbec4,0xbf223f46,0x3f0e3f55,0x3f75be95,0xbec43f6d,0x3f463f22,0x3f55bf0e,0xbe95bf75
.long 0xbf35bf35,0xbf7bbe48,0xbf6d3ec4,0xbf0e3f55,0xbf353f35,0xbe483f7b,0x3ec43f6d,0x3f553f0e
.long 0x3ec43f6d,0x3f623ef1,0x3f7bbe48,0x3f22bf46,0x3f6dbec4,0x3ef1bf62,0xbe48bf7b,0xbf46bf22
.long 0x3f353f35,0x3f55bf0e,0xbec4bf6d,0xbf7b3e48,0x3f35bf35,0xbf0ebf55,0xbf6d3ec4,0x3e483f7b
.long 0xbec4bf6d,0xbf753e95,0x3e483f7b,0x3f7fbdc9,0xbf6d3ec4,0x3e953f75,0x3f7bbe48,0xbdc9bf7f
.long 0x3f80,0x3f80,0x3f80,0x3f80,0x3f808000,0x3f808000,0x3f808000,0x3f808000
.long 0xbf80,0xbdc9bf7f,0xbe48bf7b,0xbe95bf75,0xbf808000,0xbf7f3dc9,0xbf7b3e48,0xbf753e95
.long 0x3f80,0x3f353f35,0x3f800000,0x3f35bf35,0x3f808000,0x3f35bf35,0xbf80,0xbf35bf35
.long 0xbf80,0xbf46bf22,0xbf7b3e48,0xbef13f62,0xbf808000,0xbf223f46,0x3e483f7b,0x3f623ef1
.long 0x3f80,0x3e483f7b,0x3ec43f6d,0x3f0e3f55,0x3f808000,0x3f7bbe48,0x3f6dbec4,0x3f55bf0e
.long 0xbf80,0xbe95bf75,0xbf0ebf55,0xbf46bf22,0xbf808000,0xbf753e95,0xbf553f0e,0xbf223f46
.long 0x3f80,0x3f553f0e,0x3f6dbec4,0x3e48bf7b,0x3f808000,0x3f0ebf55,0xbec4bf6d,0xbf7bbe48
.long 0xbf80,0xbf62bef1,0xbf553f0e,0x3dc93f7f,0xbf808000,0xbef13f62,0x3f0e3f55,0x3f7fbdc9
.long 0x3f80,0x3ec43f6d,0x3f353f35,0x3f6d3ec4,0x3f808000,0x3f6dbec4,0x3f35bf35,0x3ec4bf6d
.long 0xbf80,0xbef1bf62,0xbf55bf0e,0xbf7fbdc9,0xbf808000,0xbf623ef1,0xbf0e3f55,0xbdc93f7f
.long 0x3f80,0x3f6d3ec4,0x3f35bf35,0xbec4bf6d,0x3f808000,0x3ec4bf6d,0xbf35bf35,0xbf6d3ec4
.long 0xbf80,0xbf75be95,0xbf0e3f55,0x3f223f46,0xbf808000,0xbe953f75,0x3f553f0e,0x3f46bf22
.long 0x3f80,0x3f0e3f55,0x3f6d3ec4,0x3f7bbe48,0x3f808000,0x3f55bf0e,0x3ec4bf6d,0xbe48bf7b
.long 0xbf80,0xbf22bf46,0xbf7bbe48,0xbf623ef1,0xbf808000,0xbf463f22,0xbe483f7b,0x3ef13f62
.long 0x3f80,0x3f7b3e48,0x3ec4bf6d,0xbf55bf0e,0x3f808000,0x3e48bf7b,0xbf6dbec4,0xbf0e3f55
.long 0xbf80,0xbf7fbdc9,0xbe483f7b,0x3f753e95,0xbf808000,0xbdc93f7f,0x3f7b3e48,0x3e95bf75
.long 0x3f80,0x3f80,0x3f80,0x3f80,0x3f808000,0x3f808000,0x3f808000,0x3f808000
.long 0xbec4bf6d,0xbef1bf62,0xbf0ebf55,0xbf22bf46,0xbf6d3ec4,0xbf623ef1,0xbf553f0e,0xbf463f22
.long 0xbf80,0xbf35bf35,0xbf800000,0xbf353f35,0xbf808000,0xbf353f35,0x3f80,0x3f353f35
.long 0x3ec43f6d,0x3f753e95,0x3f55bf0e,0x3dc9bf7f,0x3f6dbec4,0x3e95bf75,0xbf0ebf55,0xbf7fbdc9
.long 0x3f353f35,0x3f553f0e,0x3f6d3ec4,0x3f7b3e48,0x3f35bf35,0x3f0ebf55,0x3ec4bf6d,0x3e48bf7b
.long 0xbf6dbec4,0xbf7fbdc9,0xbf7b3e48,0xbf623ef1,0xbec43f6d,0xbdc93f7f,0x3e483f7b,0x3ef13f62
.long 0xbf35bf35,0xbf7b3e48,0xbec43f6d,0x3f0e3f55,0xbf353f35,0x3e483f7b,0x3f6d3ec4,0x3f55bf0e
.long 0x3f6d3ec4,0x3f46bf22,0xbe48bf7b,0xbf75be95,0x3ec4bf6d,0xbf22bf46,0xbf7b3e48,0xbe953f75
.long 0x3f800000,0x3f6dbec4,0x3f35bf35,0x3ec4bf6d,0xbf80,0xbec4bf6d,0xbf35bf35,0xbf6dbec4
.long 0xbf6d3ec4,0xbf223f46,0xbe483f7b,0x3e953f75,0x3ec43f6d,0x3f463f22,0x3f7b3e48,0x3f75be95
.long 0xbf800000,0xbec43f6d,0x3f353f35,0x3f6dbec4,0x3f80,0x3f6d3ec4,0x3f35bf35,0xbec4bf6d
.long 0x3f6dbec4,0xbdc9bf7f,0xbf7bbe48,0xbef13f62,0xbec4bf6d,0xbf7f3dc9,0xbe483f7b,0x3f623ef1
.long 0x3f35bf35,0x3e48bf7b,0xbec4bf6d,0xbf55bf0e,0xbf35bf35,0xbf7bbe48,0xbf6d3ec4,0xbf0e3f55
.long 0xbec43f6d,0x3e953f75,0x3f553f0e,0x3f7fbdc9,0x3f6d3ec4,0x3f75be95,0x3f0ebf55,0xbdc9bf7f
.long 0xbf353f35,0x3f0e3f55,0x3f6dbec4,0xbe48bf7b,0x3f353f35,0x3f55bf0e,0xbec4bf6d,0xbf7b3e48
.long 0x3ec4bf6d,0xbf62bef1,0xbf0e3f55,0x3f463f22,0xbf6dbec4,0xbef13f62,0x3f553f0e,0x3f22bf46
.long 0x3f80,0x3f80,0x3f80,0x3f80,0x3f808000,0x3f808000,0x3f808000,0x3f808000
.long 0xbf35bf35,0xbf46bf22,0xbf55bf0e,0xbf62bef1,0xbf353f35,0xbf223f46,0xbf0e3f55,0xbef13f62
.long 0x3f80,0x3f353f35,0x3f800000,0x3f35bf35,0x3f808000,0x3f35bf35,0xbf80,0xbf35bf35
.long 0xbf35bf35,0xbf7f3dc9,0xbf0e3f55,0x3e953f75,0xbf353f35,0x3dc93f7f,0x3f553f0e,0x3f75be95
.long 0x3f800000,0x3f7bbe48,0x3f6dbec4,0x3f55bf0e,0xbf80,0xbe48bf7b,0xbec4bf6d,0xbf0ebf55
.long 0xbf353f35,0xbef13f62,0xbe483f7b,0x3dc93f7f,0x3f353f35,0x3f623ef1,0x3f7b3e48,0x3f7fbdc9
.long 0x3f800000,0x3f0ebf55,0xbec4bf6d,0xbf7bbe48,0xbf80,0xbf55bf0e,0xbf6d3ec4,0xbe483f7b
.long 0xbf353f35,0x3e953f75,0x3f7b3e48,0x3f22bf46,0x3f353f35,0x3f75be95,0x3e48bf7b,0xbf46bf22
.long 0xbf80,0xbec4bf6d,0xbf35bf35,0xbf6dbec4,0xbf808000,0xbf6d3ec4,0xbf353f35,0xbec43f6d
.long 0x3f353f35,0x3f753e95,0x3f7bbe48,0x3f46bf22,0x3f35bf35,0x3e95bf75,0xbe48bf7b,0xbf22bf46
.long 0xbf80,0xbf6dbec4,0xbf353f35,0x3ec43f6d,0xbf808000,0xbec43f6d,0x3f353f35,0x3f6dbec4
.long 0x3f353f35,0x3f62bef1,0xbe48bf7b,0xbf7fbdc9,0x3f35bf35,0xbef1bf62,0xbf7b3e48,0xbdc93f7f
.long 0xbf800000,0xbf553f0e,0xbec43f6d,0x3e483f7b,0x3f80,0x3f0e3f55,0x3f6d3ec4,0x3f7bbe48
.long 0x3f35bf35,0x3dc9bf7f,0xbf0ebf55,0xbf75be95,0xbf35bf35,0xbf7fbdc9,0xbf553f0e,0xbe953f75
.long 0xbf800000,0xbe483f7b,0x3f6d3ec4,0x3f0ebf55,0x3f80,0x3f7b3e48,0x3ec4bf6d,0xbf55bf0e
.long 0x3f35bf35,0xbf22bf46,0xbf553f0e,0x3ef13f62,0xbf35bf35,0xbf463f22,0x3f0e3f55,0x3f62bef1
.long 0x3f80,0x3f80,0x3f80,0x3f80,0x3f808000,0x3f808000,0x3f808000,0x3f808000
.long 0xbf6dbec4,0xbf75be95,0xbf7bbe48,0xbf7fbdc9,0xbec43f6d,0xbe953f75,0xbe483f7b,0xbdc93f7f
.long 0xbf80,0xbf35bf35,0xbf800000,0xbf353f35,0xbf808000,0xbf353f35,0x3f80,0x3f353f35
.long 0x3f6d3ec4,0x3f62bef1,0x3e48bf7b,0xbf22bf46,0x3ec4bf6d,0xbef1bf62,0xbf7bbe48,0xbf463f22
.long 0x3f35bf35,0x3f0ebf55,0x3ec4bf6d,0x3e48bf7b,0xbf35bf35,0xbf55bf0e,0xbf6dbec4,0xbf7bbe48
.long 0x3ec43f6d,0x3f223f46,0x3f553f0e,0x3f753e95,0x3f6dbec4,0x3f46bf22,0x3f0ebf55,0x3e95bf75
.long 0xbf353f35,0x3e483f7b,0x3f6d3ec4,0x3f55bf0e,0x3f353f35,0x3f7bbe48,0x3ec4bf6d,0xbf0ebf55
.long 0xbec4bf6d,0xbf7fbdc9,0xbf0e3f55,0x3ef13f62,0xbf6d3ec4,0xbdc93f7f,0x3f553f0e,0x3f62bef1
.long 0xbf800000,0xbf6d3ec4,0xbf353f35,0xbec43f6d,0x3f80,0x3ec43f6d,0x3f353f35,0x3f6d3ec4
.long 0x3ec4bf6d,0xbdc9bf7f,0xbf0ebf55,0xbf62bef1,0xbf6dbec4,0xbf7f3dc9,0xbf553f0e,0xbef13f62
.long 0x3f800000,0x3ec4bf6d,0xbf35bf35,0xbf6d3ec4,0xbf80,0xbf6dbec4,0xbf353f35,0x3ec43f6d
.long 0xbec43f6d,0x3f463f22,0x3f55bf0e,0xbe95bf75,0x3f6d3ec4,0x3f22bf46,0xbf0ebf55,0xbf753e95
.long 0x3f353f35,0x3f7b3e48,0x3f6dbec4,0x3f0ebf55,0x3f35bf35,0x3e48bf7b,0xbec4bf6d,0xbf55bf0e
.long 0xbf6d3ec4,0xbef13f62,0x3e483f7b,0x3f463f22,0x3ec43f6d,0x3f623ef1,0x3f7bbe48,0x3f22bf46
.long 0xbf35bf35,0xbf553f0e,0x3ec43f6d,0x3f7bbe48,0xbf353f35,0x3f0e3f55,0x3f6dbec4,0xbe48bf7b
.long 0x3f6dbec4,0xbe95bf75,0xbf7b3e48,0x3dc93f7f,0xbec4bf6d,0xbf753e95,0x3e483f7b,0x3f7fbdc9
.long 0x3f80,0x3f80,0x3f80,0x3f80,0x3f808000,0x3f808000,0x3f808000,0x3f808000
.long 0xbf800000,0xbf7f3dc9,0xbf7b3e48,0xbf753e95,0x3f80,0x3dc93f7f,0x3e483f7b,0x3e953f75
.long 0x3f80,0x3f353f35,0x3f800000,0x3f35bf35,0x3f808000,0x3f35bf35,0xbf80,0xbf35bf35
.long 0xbf800000,0xbf223f46,0x3e483f7b,0x3f623ef1,0x3f80,0x3f463f22,0x3f7bbe48,0x3ef1bf62
.long 0xbf80,0xbe48bf7b,0xbec4bf6d,0xbf0ebf55,0xbf808000,0xbf7b3e48,0xbf6d3ec4,0xbf553f0e
.long 0x3f800000,0x3f75be95,0x3f55bf0e,0x3f22bf46,0xbf80,0xbe95bf75,0xbf0ebf55,0xbf46bf22
.long 0xbf80,0xbf55bf0e,0xbf6d3ec4,0xbe483f7b,0xbf808000,0xbf0e3f55,0x3ec43f6d,0x3f7b3e48
.long 0x3f800000,0x3ef1bf62,0xbf0ebf55,0xbf7f3dc9,0xbf80,0xbf62bef1,0xbf553f0e,0x3dc93f7f
.long 0x3f80,0x3ec43f6d,0x3f353f35,0x3f6d3ec4,0x3f808000,0x3f6dbec4,0x3f35bf35,0x3ec4bf6d
.long 0xbf800000,0xbf623ef1,0xbf0e3f55,0xbdc93f7f,0x3f80,0x3ef13f62,0x3f553f0e,0x3f7f3dc9
.long 0x3f80,0x3f6d3ec4,0x3f35bf35,0xbec4bf6d,0x3f808000,0x3ec4bf6d,0xbf35bf35,0xbf6d3ec4
.long 0xbf800000,0xbe953f75,0x3f553f0e,0x3f46bf22,0x3f80,0x3f753e95,0x3f0ebf55,0xbf22bf46
.long 0xbf80,0xbf0ebf55,0xbf6dbec4,0xbf7b3e48,0xbf808000,0xbf553f0e,0xbec43f6d,0x3e483f7b
.long 0x3f800000,0x3f46bf22,0x3e48bf7b,0xbef1bf62,0xbf80,0xbf22bf46,0xbf7bbe48,0xbf623ef1
.long 0xbf80,0xbf7bbe48,0xbec43f6d,0x3f553f0e,0xbf808000,0xbe483f7b,0x3f6d3ec4,0x3f0ebf55
.long 0x3f800000,0x3dc9bf7f,0xbf7bbe48,0xbe953f75,0xbf80,0xbf7fbdc9,0xbe483f7b,0x3f753e95
.long 0x3f80,0x3f80,0x3f80,0x3f80,0x3f808000,0x3f808000,0x3f808000,0x3f808000
.long 0xbf6d3ec4,0xbf623ef1,0xbf553f0e,0xbf463f22,0x3ec43f6d,0x3ef13f62,0x3f0e3f55,0x3f223f46
.long 0xbf80,0xbf35bf35,0xbf800000,0xbf353f35,0xbf808000,0xbf353f35,0x3f80,0x3f353f35
.long 0x3f6dbec4,0x3e95bf75,0xbf0ebf55,0xbf7fbdc9,0xbec4bf6d,0xbf75be95,0xbf553f0e,0xbdc93f7f
.long 0xbf35bf35,0xbf55bf0e,0xbf6dbec4,0xbf7bbe48,0xbf353f35,0xbf0e3f55,0xbec43f6d,0xbe483f7b
.long 0x3ec4bf6d,0x3dc9bf7f,0xbe48bf7b,0xbef1bf62,0xbf6dbec4,0xbf7fbdc9,0xbf7b3e48,0xbf623ef1
.long 0x3f353f35,0x3f7bbe48,0x3ec4bf6d,0xbf0ebf55,0x3f35bf35,0xbe48bf7b,0xbf6dbec4,0xbf553f0e
.long 0xbec43f6d,0x3f223f46,0x3f7bbe48,0x3e95bf75,0x3f6d3ec4,0x3f46bf22,0xbe48bf7b,0xbf75be95
.long 0x3f800000,0x3f6dbec4,0x3f35bf35,0x3ec4bf6d,0xbf80,0xbec4bf6d,0xbf35bf35,0xbf6dbec4
.long 0x3ec43f6d,0x3f463f22,0x3f7b3e48,0x3f75be95,0x3f6dbec4,0x3f22bf46,0x3e48bf7b,0xbe95bf75
.long 0xbf800000,0xbec43f6d,0x3f353f35,0x3f6dbec4,0x3f80,0x3f6d3ec4,0x3f35bf35,0xbec4bf6d
.long 0xbec4bf6d,0xbf7f3dc9,0xbe483f7b,0x3f623ef1,0xbf6d3ec4,0x3dc93f7f,0x3f7b3e48,0x3ef1bf62
.long 0xbf353f35,0xbe483f7b,0x3ec43f6d,0x3f553f0e,0x3f353f35,0x3f7b3e48,0x3f6dbec4,0x3f0ebf55
.long 0xbf6dbec4,0xbf753e95,0xbf0e3f55,0x3dc93f7f,0xbec43f6d,0x3e953f75,0x3f553f0e,0x3f7fbdc9
.long 0x3f35bf35,0xbf0ebf55,0xbf6d3ec4,0x3e483f7b,0xbf35bf35,0xbf553f0e,0x3ec43f6d,0x3f7bbe48
.long 0x3f6d3ec4,0x3ef1bf62,0xbf55bf0e,0xbf223f46,0x3ec4bf6d,0xbf62bef1,0xbf0e3f55,0x3f463f22
.long 0x3f80,0x3f80,0x3f80,0x3f80,0x3f808000,0x3f808000,0x3f808000,0x3f808000
.long 0xbf353f35,0xbf223f46,0xbf0e3f55,0xbef13f62,0x3f353f35,0x3f463f22,0x3f553f0e,0x3f623ef1
.long 0x3f80,0x3f353f35,0x3f800000,0x3f35bf35,0x3f808000,0x3f35bf35,0xbf80,0xbf35bf35
.long 0xbf353f35,0x3dc93f7f,0x3f553f0e,0x3f75be95,0x3f353f35,0x3f7fbdc9,0x3f0ebf55,0xbe95bf75
.long 0xbf800000,0xbf7b3e48,0xbf6d3ec4,0xbf553f0e,0x3f80,0x3e483f7b,0x3ec43f6d,0x3f0e3f55
.long 0xbf35bf35,0xbf62bef1,0xbf7bbe48,0xbf7f3dc9,0xbf353f35,0xbef13f62,0xbe483f7b,0x3dc93f7f
.long 0xbf800000,0xbf0e3f55,0x3ec43f6d,0x3f7b3e48,0x3f80,0x3f553f0e,0x3f6dbec4,0x3e48bf7b
.long 0xbf35bf35,0xbf753e95,0xbe483f7b,0x3f463f22,0xbf353f35,0x3e953f75,0x3f7b3e48,0x3f22bf46
.long 0xbf80,0xbec4bf6d,0xbf35bf35,0xbf6dbec4,0xbf808000,0xbf6d3ec4,0xbf353f35,0xbec43f6d
.long 0x3f35bf35,0x3e95bf75,0xbe48bf7b,0xbf22bf46,0xbf35bf35,0xbf75be95,0xbf7b3e48,0xbf463f22
.long 0xbf80,0xbf6dbec4,0xbf353f35,0x3ec43f6d,0xbf808000,0xbec43f6d,0x3f353f35,0x3f6dbec4
.long 0x3f35bf35,0xbef1bf62,0xbf7b3e48,0xbdc93f7f,0xbf35bf35,0xbf623ef1,0x3e483f7b,0x3f7f3dc9
.long 0x3f800000,0x3f55bf0e,0x3ec4bf6d,0xbe48bf7b,0xbf80,0xbf0ebf55,0xbf6dbec4,0xbf7b3e48
.long 0x3f353f35,0x3f7f3dc9,0x3f55bf0e,0x3e95bf75,0x3f35bf35,0x3dc9bf7f,0xbf0ebf55,0xbf75be95
.long 0x3f800000,0x3e48bf7b,0xbf6dbec4,0xbf0e3f55,0xbf80,0xbf7bbe48,0xbec43f6d,0x3f553f0e
.long 0x3f353f35,0x3f46bf22,0xbf0ebf55,0xbf623ef1,0x3f35bf35,0xbf22bf46,0xbf553f0e,0x3ef13f62
.long 0x3f80,0x3f80,0x3f80,0x3f80,0x3f808000,0x3f808000,0x3f808000,0x3f808000
.long 0xbec43f6d,0xbe953f75,0xbe483f7b,0xbdc93f7f,0x3f6d3ec4,0x3f753e95,0x3f7b3e48,0x3f7f3dc9
.long 0xbf80,0xbf35bf35,0xbf800000,0xbf353f35,0xbf808000,0xbf353f35,0x3f80,0x3f353f35
.long 0x3ec4bf6d,0xbef1bf62,0xbf7bbe48,0xbf463f22,0xbf6dbec4,0xbf623ef1,0xbe483f7b,0x3f223f46
.long 0xbf353f35,0xbf0e3f55,0xbec43f6d,0xbe483f7b,0x3f353f35,0x3f553f0e,0x3f6d3ec4,0x3f7b3e48
.long 0xbf6d3ec4,0xbf463f22,0xbf0e3f55,0xbe953f75,0x3ec43f6d,0x3f223f46,0x3f553f0e,0x3f753e95
.long 0x3f35bf35,0xbe48bf7b,0xbf6dbec4,0xbf553f0e,0xbf35bf35,0xbf7b3e48,0xbec43f6d,0x3f0e3f55
.long 0x3f6dbec4,0x3dc9bf7f,0xbf55bf0e,0xbf623ef1,0xbec4bf6d,0xbf7fbdc9,0xbf0e3f55,0x3ef13f62
.long 0xbf800000,0xbf6d3ec4,0xbf353f35,0xbec43f6d,0x3f80,0x3ec43f6d,0x3f353f35,0x3f6d3ec4
.long 0xbf6dbec4,0xbf7f3dc9,0xbf553f0e,0xbef13f62,0xbec43f6d,0x3dc93f7f,0x3f0e3f55,0x3f623ef1
.long 0x3f800000,0x3ec4bf6d,0xbf35bf35,0xbf6d3ec4,0xbf80,0xbf6dbec4,0xbf353f35,0x3ec43f6d
.long 0x3f6d3ec4,0x3f22bf46,0xbf0ebf55,0xbf753e95,0x3ec4bf6d,0xbf46bf22,0xbf553f0e,0x3e953f75
.long 0xbf35bf35,0xbf7bbe48,0xbf6d3ec4,0xbf0e3f55,0xbf353f35,0xbe483f7b,0x3ec43f6d,0x3f553f0e
.long 0xbec4bf6d,0xbf62bef1,0xbf7b3e48,0xbf223f46,0xbf6d3ec4,0xbef13f62,0x3e483f7b,0x3f463f22
.long 0x3f353f35,0x3f55bf0e,0xbec4bf6d,0xbf7b3e48,0x3f35bf35,0xbf0ebf55,0xbf6d3ec4,0x3e483f7b
.long 0x3ec43f6d,0x3f75be95,0xbe48bf7b,0xbf7f3dc9,0x3f6dbec4,0xbe95bf75,0xbf7b3e48,0x3dc93f7f
.long 0x3f80,0x3f800000,0xbf80,0xbf800000,0x3f808000,0xbf80,0xbf808000,0x3f80
.long 0x3f80,0x3f7fbdc9,0xbe48bf7b,0xbf753e95,0x3f808000,0xbdc9bf7f,0xbf7b3e48,0x3e953f75
.long 0x3f80,0x3f35bf35,0xbf800000,0x3f353f35,0x3f808000,0xbf35bf35,0x3f80,0x3f35bf35
.long 0x3f80,0x3f22bf46,0xbf7b3e48,0x3f623ef1,0x3f808000,0xbf46bf22,0x3e483f7b,0x3ef1bf62
.long 0x3f80,0x3f7bbe48,0xbec4bf6d,0xbf553f0e,0x3f808000,0xbe48bf7b,0xbf6d3ec4,0x3f0e3f55
.long 0x3f80,0x3f75be95,0xbf0ebf55,0xbf223f46,0x3f808000,0xbe95bf75,0xbf553f0e,0x3f463f22
.long 0x3f80,0x3f0ebf55,0xbf6d3ec4,0x3f7b3e48,0x3f808000,0xbf55bf0e,0x3ec43f6d,0x3e48bf7b
.long 0x3f80,0x3ef1bf62,0xbf553f0e,0x3f7fbdc9,0x3f808000,0xbf62bef1,0x3f0e3f55,0xbdc9bf7f
.long 0x3f80,0x3f6dbec4,0xbf35bf35,0xbec43f6d,0x3f808000,0xbec4bf6d,0xbf353f35,0x3f6d3ec4
.long 0x3f80,0x3f62bef1,0xbf55bf0e,0xbdc93f7f,0x3f808000,0xbef1bf62,0xbf0e3f55,0x3f7f3dc9
.long 0x3f80,0x3ec4bf6d,0xbf353f35,0x3f6dbec4,0x3f808000,0xbf6dbec4,0x3f353f35,0xbec4bf6d
.long 0x3f80,0x3e95bf75,0xbf0e3f55,0x3f46bf22,0x3f808000,0xbf75be95,0x3f553f0e,0xbf22bf46
.long 0x3f80,0x3f55bf0e,0xbf6dbec4,0x3e483f7b,0x3f808000,0xbf0ebf55,0xbec43f6d,0x3f7bbe48
.long 0x3f80,0x3f46bf22,0xbf7bbe48,0x3ef13f62,0x3f808000,0xbf22bf46,0xbe483f7b,0x3f62bef1
.long 0x3f80,0x3e48bf7b,0xbec43f6d,0x3f0ebf55,0x3f808000,0xbf7bbe48,0x3f6d3ec4,0xbf55bf0e
.long 0x3f80,0x3dc9bf7f,0xbe483f7b,0x3e95bf75,0x3f808000,0xbf7fbdc9,0x3f7b3e48,0xbf75be95
.long 0x3f80,0x3f800000,0xbf80,0xbf800000,0x3f808000,0xbf80,0xbf808000,0x3f80
.long 0x3ec43f6d,0x3f62bef1,0xbf0ebf55,0xbf463f22,0x3f6dbec4,0xbef1bf62,0xbf553f0e,0x3f223f46
.long 0xbf80,0xbf353f35,0x3f800000,0xbf35bf35,0xbf808000,0x3f353f35,0xbf80,0xbf353f35
.long 0xbec4bf6d,0xbe953f75,0x3f55bf0e,0xbf7fbdc9,0xbf6d3ec4,0x3f753e95,0xbf0ebf55,0xbdc93f7f
.long 0x3f353f35,0x3f0ebf55,0xbf6dbec4,0xbe483f7b,0x3f35bf35,0xbf55bf0e,0xbec43f6d,0x3f7b3e48
.long 0x3f6d3ec4,0x3dc9bf7f,0xbf7b3e48,0x3ef13f62,0x3ec4bf6d,0xbf7fbdc9,0x3e483f7b,0x3f62bef1
.long 0xbf35bf35,0x3e483f7b,0x3ec4bf6d,0xbf553f0e,0xbf353f35,0x3f7bbe48,0xbf6dbec4,0x3f0e3f55
.long 0xbf6dbec4,0x3f223f46,0xbe48bf7b,0xbe953f75,0xbec43f6d,0x3f46bf22,0xbf7b3e48,0x3f753e95
.long 0x3f800000,0xbec4bf6d,0xbf353f35,0x3f6d3ec4,0xbf80,0xbf6d3ec4,0x3f353f35,0x3ec4bf6d
.long 0x3f6dbec4,0xbf46bf22,0xbe483f7b,0x3f75be95,0xbec4bf6d,0xbf223f46,0x3f7b3e48,0xbe95bf75
.long 0xbf800000,0x3f6d3ec4,0xbf35bf35,0x3ec43f6d,0x3f80,0x3ec4bf6d,0xbf353f35,0x3f6dbec4
.long 0xbf6d3ec4,0x3f7fbdc9,0xbf7bbe48,0x3f623ef1,0x3ec43f6d,0xbdc9bf7f,0xbe483f7b,0x3ef1bf62
.long 0x3f35bf35,0xbf7bbe48,0x3ec43f6d,0x3f0ebf55,0xbf35bf35,0xbe483f7b,0x3f6dbec4,0xbf55bf0e
.long 0x3ec4bf6d,0xbf753e95,0x3f553f0e,0xbdc9bf7f,0xbf6dbec4,0x3e953f75,0x3f0ebf55,0xbf7f3dc9
.long 0xbf353f35,0x3f55bf0e,0xbf6d3ec4,0x3f7bbe48,0x3f353f35,0xbf0ebf55,0x3ec43f6d,0xbe48bf7b
.long 0xbec43f6d,0x3ef1bf62,0xbf0e3f55,0x3f22bf46,0x3f6d3ec4,0xbf62bef1,0x3f553f0e,0xbf46bf22
.long 0x3f80,0x3f800000,0xbf80,0xbf800000,0x3f808000,0xbf80,0xbf808000,0x3f80
.long 0x3f353f35,0x3f22bf46,0xbf55bf0e,0xbef13f62,0x3f35bf35,0xbf46bf22,0xbf0e3f55,0x3f623ef1
.long 0x3f80,0x3f35bf35,0xbf800000,0x3f353f35,0x3f808000,0xbf35bf35,0x3f80,0x3f35bf35
.long 0x3f353f35,0xbdc9bf7f,0xbf0e3f55,0x3f75be95,0x3f35bf35,0xbf7f3dc9,0x3f553f0e,0xbe95bf75
.long 0x3f800000,0xbe48bf7b,0xbf6d3ec4,0x3f0e3f55,0xbf80,0xbf7b3e48,0x3ec43f6d,0x3f55bf0e
.long 0x3f35bf35,0xbf62bef1,0xbe483f7b,0x3f7fbdc9,0xbf35bf35,0xbef13f62,0x3f7b3e48,0xbdc9bf7f
.long 0x3f800000,0xbf55bf0e,0x3ec43f6d,0x3e48bf7b,0xbf80,0xbf0e3f55,0x3f6dbec4,0xbf7bbe48
.long 0x3f35bf35,0xbf753e95,0x3f7b3e48,0xbf46bf22,0xbf35bf35,0x3e953f75,0x3e48bf7b,0xbf223f46
.long 0xbf80,0xbf6d3ec4,0x3f353f35,0x3ec4bf6d,0xbf808000,0x3ec43f6d,0x3f35bf35,0xbf6dbec4
.long 0xbf35bf35,0xbe953f75,0x3f7bbe48,0xbf22bf46,0xbf353f35,0x3f753e95,0xbe48bf7b,0xbf463f22
.long 0xbf80,0xbec43f6d,0x3f35bf35,0xbf6d3ec4,0xbf808000,0x3f6d3ec4,0xbf35bf35,0x3ec43f6d
.long 0xbf35bf35,0x3ef13f62,0xbe48bf7b,0xbdc93f7f,0xbf353f35,0x3f62bef1,0xbf7b3e48,0x3f7f3dc9
.long 0xbf800000,0x3f0e3f55,0x3ec4bf6d,0xbf7b3e48,0x3f80,0x3f55bf0e,0xbf6dbec4,0x3e483f7b
.long 0xbf353f35,0x3f7f3dc9,0xbf0ebf55,0xbe953f75,0x3f353f35,0x3dc9bf7f,0xbf553f0e,0x3f753e95
.long 0xbf800000,0x3f7b3e48,0xbf6dbec4,0x3f553f0e,0x3f80,0x3e48bf7b,0xbec43f6d,0x3f0ebf55
.long 0xbf353f35,0x3f46bf22,0xbf553f0e,0x3f62bef1,0x3f353f35,0xbf22bf46,0x3f0e3f55,0xbef1bf62
.long 0x3f80,0x3f800000,0xbf80,0xbf800000,0x3f808000,0xbf80,0xbf808000,0x3f80
.long 0x3f6d3ec4,0x3e95bf75,0xbf7bbe48,0xbdc93f7f,0x3ec4bf6d,0xbf75be95,0xbe483f7b,0x3f7f3dc9
.long 0xbf80,0xbf353f35,0x3f800000,0xbf35bf35,0xbf808000,0x3f353f35,0xbf80,0xbf353f35
.long 0xbf6dbec4,0x3ef13f62,0x3e48bf7b,0xbf463f22,0xbec43f6d,0x3f62bef1,0xbf7bbe48,0x3f223f46
.long 0x3f35bf35,0xbf55bf0e,0xbec43f6d,0x3f7b3e48,0xbf35bf35,0xbf0e3f55,0x3f6d3ec4,0x3e48bf7b
.long 0xbec4bf6d,0xbf463f22,0x3f553f0e,0x3e95bf75,0xbf6d3ec4,0x3f223f46,0x3f0ebf55,0xbf75be95
.long 0xbf353f35,0x3f7bbe48,0xbf6dbec4,0x3f0e3f55,0x3f353f35,0xbe48bf7b,0xbec43f6d,0x3f55bf0e
.long 0x3ec43f6d,0x3dc9bf7f,0xbf0e3f55,0x3f62bef1,0x3f6dbec4,0xbf7fbdc9,0x3f553f0e,0xbef1bf62
.long 0xbf800000,0x3ec43f6d,0x3f35bf35,0xbf6dbec4,0x3f80,0x3f6dbec4,0xbf35bf35,0xbec43f6d
.long 0xbec43f6d,0x3f7fbdc9,0xbf0ebf55,0xbef13f62,0x3f6d3ec4,0xbdc9bf7f,0xbf553f0e,0x3f623ef1
.long 0x3f800000,0xbf6dbec4,0x3f353f35,0xbec4bf6d,0xbf80,0xbec43f6d,0x3f35bf35,0xbf6d3ec4
.long 0x3ec4bf6d,0xbf223f46,0x3f55bf0e,0xbf753e95,0xbf6dbec4,0x3f463f22,0xbf0ebf55,0x3e953f75
.long 0x3f353f35,0x3e48bf7b,0xbf6d3ec4,0x3f553f0e,0x3f35bf35,0xbf7bbe48,0x3ec43f6d,0x3f0ebf55
.long 0x3f6dbec4,0xbf62bef1,0x3e483f7b,0x3f22bf46,0xbec4bf6d,0xbef13f62,0x3f7bbe48,0xbf46bf22
.long 0xbf35bf35,0x3f0e3f55,0xbec4bf6d,0x3e483f7b,0xbf353f35,0x3f55bf0e,0xbf6d3ec4,0x3f7bbe48
.long 0xbf6d3ec4,0x3f75be95,0xbf7b3e48,0x3f7fbdc9,0x3ec43f6d,0xbe95bf75,0x3e483f7b,0xbdc9bf7f
.long 0x3f80,0x3f800000,0xbf80,0xbf800000,0x3f808000,0xbf80,0xbf808000,0x3f80
.long 0x3f800000,0xbdc9bf7f,0xbf7b3e48,0x3e953f75,0xbf80,0xbf7f3dc9,0x3e483f7b,0x3f75be95
.long 0x3f80,0x3f35bf35,0xbf800000,0x3f353f35,0x3f808000,0xbf35bf35,0x3f80,0x3f35bf35
.long 0x3f800000,0xbf46bf22,0x3e483f7b,0x3ef1bf62,0xbf80,0xbf223f46,0x3f7bbe48,0xbf62bef1
.long 0xbf80,0xbf7b3e48,0x3ec43f6d,0x3f55bf0e,0xbf808000,0x3e483f7b,0x3f6dbec4,0xbf0ebf55
.long 0xbf800000,0x3e953f75,0x3f55bf0e,0xbf46bf22,0x3f80,0x3f75be95,0xbf0ebf55,0xbf223f46
.long 0xbf80,0xbf0e3f55,0x3f6dbec4,0xbf7bbe48,0xbf808000,0x3f553f0e,0xbec4bf6d,0xbe483f7b
.long 0xbf800000,0x3f623ef1,0xbf0ebf55,0x3dc93f7f,0x3f80,0x3ef1bf62,0xbf553f0e,0x3f7fbdc9
.long 0x3f80,0x3f6dbec4,0xbf35bf35,0xbec43f6d,0x3f808000,0xbec4bf6d,0xbf353f35,0x3f6d3ec4
.long 0x3f800000,0xbef1bf62,0xbf0e3f55,0x3f7f3dc9,0xbf80,0xbf623ef1,0x3f553f0e,0x3dc9bf7f
.long 0x3f80,0x3ec4bf6d,0xbf353f35,0x3f6dbec4,0x3f808000,0xbf6dbec4,0x3f353f35,0xbec4bf6d
.long 0x3f800000,0xbf75be95,0x3f553f0e,0xbf22bf46,0xbf80,0xbe953f75,0x3f0ebf55,0xbf463f22
.long 0xbf80,0xbf553f0e,0x3f6d3ec4,0xbe48bf7b,0xbf808000,0x3f0e3f55,0x3ec4bf6d,0xbf7b3e48
.long 0xbf800000,0x3f223f46,0x3e48bf7b,0xbf623ef1,0x3f80,0x3f46bf22,0xbf7bbe48,0x3ef13f62
.long 0xbf80,0xbe483f7b,0x3ec4bf6d,0xbf0e3f55,0xbf808000,0x3f7b3e48,0xbf6dbec4,0x3f553f0e
.long 0xbf800000,0x3f7f3dc9,0xbf7bbe48,0x3f753e95,0x3f80,0x3dc9bf7f,0xbe483f7b,0x3e95bf75
.long 0x3f80,0x3f800000,0xbf80,0xbf800000,0x3f808000,0xbf80,0xbf808000,0x3f80
.long 0x3f6dbec4,0xbef1bf62,0xbf553f0e,0x3f223f46,0xbec4bf6d,0xbf623ef1,0x3f0e3f55,0x3f46bf22
.long 0xbf80,0xbf353f35,0x3f800000,0xbf35bf35,0xbf808000,0x3f353f35,0xbf80,0xbf353f35
.long 0xbf6d3ec4,0x3f753e95,0xbf0ebf55,0xbdc93f7f,0x3ec43f6d,0x3e95bf75,0xbf553f0e,0x3f7f3dc9
.long 0xbf35bf35,0xbf0e3f55,0x3f6d3ec4,0x3e48bf7b,0xbf353f35,0x3f553f0e,0x3ec4bf6d,0xbf7bbe48
.long 0xbec43f6d,0x3f7f3dc9,0xbe48bf7b,0xbf623ef1,0x3f6d3ec4,0x3dc9bf7f,0xbf7b3e48,0x3ef13f62
.long 0x3f353f35,0xbe48bf7b,0xbec43f6d,0x3f55bf0e,0x3f35bf35,0xbf7b3e48,0x3f6d3ec4,0xbf0ebf55
.long 0x3ec4bf6d,0xbf463f22,0x3f7bbe48,0xbf75be95,0xbf6dbec4,0x3f223f46,0xbe48bf7b,0xbe953f75
.long 0x3f800000,0xbec4bf6d,0xbf353f35,0x3f6d3ec4,0xbf80,0xbf6d3ec4,0x3f353f35,0x3ec4bf6d
.long 0xbec4bf6d,0xbf223f46,0x3f7b3e48,0xbe95bf75,0xbf6d3ec4,0x3f463f22,0x3e48bf7b,0xbf753e95
.long 0xbf800000,0x3f6d3ec4,0xbf35bf35,0x3ec43f6d,0x3f80,0x3ec4bf6d,0xbf353f35,0x3f6dbec4
.long 0x3ec43f6d,0xbdc9bf7f,0xbe483f7b,0x3ef1bf62,0x3f6dbec4,0xbf7f3dc9,0x3f7b3e48,0xbf62bef1
.long 0xbf353f35,0x3f7b3e48,0xbec4bf6d,0xbf0e3f55,0x3f353f35,0x3e48bf7b,0xbf6d3ec4,0x3f553f0e
.long 0x3f6d3ec4,0xbe95bf75,0xbf0e3f55,0x3f7fbdc9,0x3ec4bf6d,0xbf753e95,0x3f553f0e,0xbdc9bf7f
.long 0x3f35bf35,0xbf553f0e,0x3f6dbec4,0xbf7b3e48,0xbf35bf35,0x3f0e3f55,0xbec4bf6d,0x3e483f7b
.long 0xbf6dbec4,0x3f623ef1,0xbf55bf0e,0x3f463f22,0xbec43f6d,0x3ef1bf62,0xbf0e3f55,0x3f22bf46
.long 0x3f80,0x3f800000,0xbf80,0xbf800000,0x3f808000,0xbf80,0xbf808000,0x3f80
.long 0x3f35bf35,0xbf46bf22,0xbf0e3f55,0x3f623ef1,0xbf35bf35,0xbf223f46,0x3f553f0e,0x3ef1bf62
.long 0x3f80,0x3f35bf35,0xbf800000,0x3f353f35,0x3f808000,0xbf35bf35,0x3f80,0x3f35bf35
.long 0x3f35bf35,0xbf7f3dc9,0x3f553f0e,0xbe95bf75,0xbf35bf35,0x3dc93f7f,0x3f0ebf55,0xbf753e95
.long 0xbf800000,0x3e483f7b,0x3f6dbec4,0xbf0ebf55,0x3f80,0x3f7bbe48,0xbec4bf6d,0xbf553f0e
.long 0x3f353f35,0x3ef1bf62,0xbf7bbe48,0x3dc93f7f,0x3f35bf35,0xbf62bef1,0xbe483f7b,0x3f7fbdc9
.long 0xbf800000,0x3f553f0e,0xbec4bf6d,0xbe483f7b,0x3f80,0x3f0ebf55,0xbf6d3ec4,0x3f7b3e48
.long 0x3f353f35,0xbe95bf75,0xbe483f7b,0x3f22bf46,0x3f35bf35,0xbf753e95,0x3f7b3e48,0xbf46bf22
.long 0xbf80,0xbf6d3ec4,0x3f353f35,0x3ec4bf6d,0xbf808000,0x3ec43f6d,0x3f35bf35,0xbf6dbec4
.long 0xbf353f35,0x3f753e95,0xbe48bf7b,0xbf463f22,0x3f353f35,0x3e95bf75,0xbf7b3e48,0x3f223f46
.long 0xbf80,0xbec43f6d,0x3f35bf35,0xbf6d3ec4,0xbf808000,0x3f6d3ec4,0xbf35bf35,0x3ec43f6d
.long 0xbf353f35,0x3f62bef1,0xbf7b3e48,0x3f7f3dc9,0x3f353f35,0xbef1bf62,0x3e483f7b,0x3dc9bf7f
.long 0x3f800000,0xbf0ebf55,0xbec43f6d,0x3f7bbe48,0xbf80,0xbf553f0e,0x3f6d3ec4,0xbe48bf7b
.long 0xbf35bf35,0xbdc93f7f,0x3f55bf0e,0xbf75be95,0xbf353f35,0x3f7f3dc9,0xbf0ebf55,0xbe953f75
.long 0x3f800000,0xbf7bbe48,0x3f6d3ec4,0xbf55bf0e,0xbf80,0xbe483f7b,0x3ec4bf6d,0xbf0e3f55
.long 0xbf35bf35,0x3f223f46,0xbf0ebf55,0x3ef13f62,0xbf353f35,0x3f46bf22,0xbf553f0e,0x3f62bef1
.long 0x3f80,0x3f800000,0xbf80,0xbf800000,0x3f808000,0xbf80,0xbf808000,0x3f80
.long 0x3ec4bf6d,0xbf75be95,0xbe483f7b,0x3f7f3dc9,0xbf6dbec4,0xbe953f75,0x3f7b3e48,0x3dc9bf7f
.long 0xbf80,0xbf353f35,0x3f800000,0xbf35bf35,0xbf808000,0x3f353f35,0xbf80,0xbf353f35
.long 0xbec43f6d,0x3f62bef1,0xbf7bbe48,0x3f223f46,0x3f6d3ec4,0xbef1bf62,0xbe483f7b,0x3f46bf22
.long 0xbf353f35,0x3f553f0e,0x3ec4bf6d,0xbf7bbe48,0x3f353f35,0x3f0ebf55,0xbf6dbec4,0xbe483f7b
.long 0x3f6dbec4,0xbf22bf46,0xbf0e3f55,0x3f753e95,0xbec4bf6d,0xbf463f22,0x3f553f0e,0x3e95bf75
.long 0x3f35bf35,0xbf7b3e48,0x3f6d3ec4,0xbf0ebf55,0xbf35bf35,0x3e483f7b,0x3ec4bf6d,0xbf553f0e
.long 0xbf6d3ec4,0x3f7f3dc9,0xbf55bf0e,0x3ef13f62,0x3ec43f6d,0x3dc9bf7f,0xbf0e3f55,0x3f62bef1
.long 0xbf800000,0x3ec43f6d,0x3f35bf35,0xbf6dbec4,0x3f80,0x3f6dbec4,0xbf35bf35,0xbec43f6d
.long 0x3f6d3ec4,0xbdc9bf7f,0xbf553f0e,0x3f623ef1,0x3ec4bf6d,0xbf7f3dc9,0x3f0e3f55,0x3ef1bf62
.long 0x3f800000,0xbf6dbec4,0x3f353f35,0xbec4bf6d,0xbf80,0xbec43f6d,0x3f35bf35,0xbf6d3ec4
.long 0xbf6dbec4,0x3f463f22,0xbf0ebf55,0x3e953f75,0xbec43f6d,0x3f22bf46,0xbf553f0e,0x3f75be95
.long 0xbf35bf35,0xbe483f7b,0x3f6dbec4,0xbf55bf0e,0xbf353f35,0x3f7b3e48,0xbec4bf6d,0xbf0e3f55
.long 0x3ec43f6d,0x3ef1bf62,0xbf7b3e48,0x3f463f22,0x3f6dbec4,0xbf62bef1,0x3e483f7b,0x3f22bf46
.long 0x3f353f35,0xbf0ebf55,0x3ec43f6d,0xbe48bf7b,0x3f35bf35,0xbf553f0e,0x3f6dbec4,0xbf7b3e48
.long 0xbec4bf6d,0x3e953f75,0xbe48bf7b,0x3dc93f7f,0xbf6d3ec4,0x3f75be95,0xbf7b3e48,0x3f7fbdc9
.long 0x3f80,0x3f800000,0xbf80,0xbf800000,0x3f808000,0xbf80,0xbf808000,0x3f80
.long 0xbf80,0xbf7f3dc9,0x3e483f7b,0x3f75be95,0xbf808000,0x3dc93f7f,0x3f7bbe48,0xbe95bf75
.long 0x3f80,0x3f35bf35,0xbf800000,0x3f353f35,0x3f808000,0xbf35bf35,0x3f80,0x3f35bf35
.long 0xbf80,0xbf223f46,0x3f7bbe48,0xbf62bef1,0xbf808000,0x3f463f22,0xbe48bf7b,0xbef13f62
.long 0x3f80,0x3f7bbe48,0xbec4bf6d,0xbf553f0e,0x3f808000,0xbe48bf7b,0xbf6d3ec4,0x3f0e3f55
.long 0xbf80,0xbf753e95,0x3f0e3f55,0x3f22bf46,0xbf808000,0x3e953f75,0x3f55bf0e,0xbf46bf22
.long 0x3f80,0x3f0ebf55,0xbf6d3ec4,0x3f7b3e48,0x3f808000,0xbf55bf0e,0x3ec43f6d,0x3e48bf7b
.long 0xbf80,0xbef13f62,0x3f55bf0e,0xbf7f3dc9,0xbf808000,0x3f623ef1,0xbf0ebf55,0x3dc93f7f
.long 0x3f80,0x3f6dbec4,0xbf35bf35,0xbec43f6d,0x3f808000,0xbec4bf6d,0xbf353f35,0x3f6d3ec4
.long 0xbf80,0xbf623ef1,0x3f553f0e,0x3dc9bf7f,0xbf808000,0x3ef13f62,0x3f0ebf55,0xbf7fbdc9
.long 0x3f80,0x3ec4bf6d,0xbf353f35,0x3f6dbec4,0x3f808000,0xbf6dbec4,0x3f353f35,0xbec4bf6d
.long 0xbf80,0xbe953f75,0x3f0ebf55,0xbf463f22,0xbf808000,0x3f753e95,0xbf55bf0e,0x3f223f46
.long 0x3f80,0x3f55bf0e,0xbf6dbec4,0x3e483f7b,0x3f808000,0xbf0ebf55,0xbec43f6d,0x3f7bbe48
.long 0xbf80,0xbf463f22,0x3f7b3e48,0xbef1bf62,0xbf808000,0x3f223f46,0x3e48bf7b,0xbf623ef1
.long 0x3f80,0x3e48bf7b,0xbec43f6d,0x3f0ebf55,0x3f808000,0xbf7bbe48,0x3f6d3ec4,0xbf55bf0e
.long 0xbf80,0xbdc93f7f,0x3e48bf7b,0xbe953f75,0xbf808000,0x3f7f3dc9,0xbf7bbe48,0x3f753e95
.long 0x3f80,0x3f800000,0xbf80,0xbf800000,0x3f808000,0xbf80,0xbf808000,0x3f80
.long 0xbec4bf6d,0xbf623ef1,0x3f0e3f55,0x3f46bf22,0xbf6d3ec4,0x3ef13f62,0x3f55bf0e,0xbf22bf46
.long 0xbf80,0xbf353f35,0x3f800000,0xbf35bf35,0xbf808000,0x3f353f35,0xbf80,0xbf353f35
.long 0x3ec43f6d,0x3e95bf75,0xbf553f0e,0x3f7f3dc9,0x3f6dbec4,0xbf75be95,0x3f0e3f55,0x3dc9bf7f
.long 0x3f353f35,0x3f0ebf55,0xbf6dbec4,0xbe483f7b,0x3f35bf35,0xbf55bf0e,0xbec43f6d,0x3f7b3e48
.long 0xbf6dbec4,0xbdc93f7f,0x3f7bbe48,0xbef1bf62,0xbec43f6d,0x3f7f3dc9,0xbe48bf7b,0xbf623ef1
.long 0xbf35bf35,0x3e483f7b,0x3ec4bf6d,0xbf553f0e,0xbf353f35,0x3f7bbe48,0xbf6dbec4,0x3f0e3f55
.long 0x3f6d3ec4,0xbf22bf46,0x3e483f7b,0x3e95bf75,0x3ec4bf6d,0xbf463f22,0x3f7bbe48,0xbf75be95
.long 0x3f800000,0xbec4bf6d,0xbf353f35,0x3f6d3ec4,0xbf80,0xbf6d3ec4,0x3f353f35,0x3ec4bf6d
.long 0xbf6d3ec4,0x3f463f22,0x3e48bf7b,0xbf753e95,0x3ec43f6d,0x3f22bf46,0xbf7bbe48,0x3e953f75
.long 0xbf800000,0x3f6d3ec4,0xbf35bf35,0x3ec43f6d,0x3f80,0x3ec4bf6d,0xbf353f35,0x3f6dbec4
.long 0x3f6dbec4,0xbf7f3dc9,0x3f7b3e48,0xbf62bef1,0xbec4bf6d,0x3dc93f7f,0x3e48bf7b,0xbef13f62
.long 0x3f35bf35,0xbf7bbe48,0x3ec43f6d,0x3f0ebf55,0xbf35bf35,0xbe483f7b,0x3f6dbec4,0xbf55bf0e
.long 0xbec43f6d,0x3f75be95,0xbf55bf0e,0x3dc93f7f,0x3f6d3ec4,0xbe95bf75,0xbf0e3f55,0x3f7fbdc9
.long 0xbf353f35,0x3f55bf0e,0xbf6d3ec4,0x3f7bbe48,0x3f353f35,0xbf0ebf55,0x3ec43f6d,0xbe48bf7b
.long 0x3ec4bf6d,0xbef13f62,0x3f0ebf55,0xbf223f46,0xbf6dbec4,0x3f623ef1,0xbf55bf0e,0x3f463f22
.long 0x3f80,0x3f800000,0xbf80,0xbf800000,0x3f808000,0xbf80,0xbf808000,0x3f80
.long 0xbf35bf35,0xbf223f46,0x3f553f0e,0x3ef1bf62,0xbf353f35,0x3f463f22,0x3f0ebf55,0xbf62bef1
.long 0x3f80,0x3f35bf35,0xbf800000,0x3f353f35,0x3f808000,0xbf35bf35,0x3f80,0x3f35bf35
.long 0xbf35bf35,0x3dc93f7f,0x3f0ebf55,0xbf753e95,0xbf353f35,0x3f7fbdc9,0xbf55bf0e,0x3e953f75
.long 0x3f800000,0xbe48bf7b,0xbf6d3ec4,0x3f0e3f55,0xbf80,0xbf7b3e48,0x3ec43f6d,0x3f55bf0e
.long 0xbf353f35,0x3f623ef1,0x3e48bf7b,0xbf7f3dc9,0x3f353f35,0x3ef1bf62,0xbf7bbe48,0x3dc93f7f
.long 0x3f800000,0xbf55bf0e,0x3ec43f6d,0x3e48bf7b,0xbf80,0xbf0e3f55,0x3f6dbec4,0xbf7bbe48
.long 0xbf353f35,0x3f75be95,0xbf7bbe48,0x3f463f22,0x3f353f35,0xbe95bf75,0xbe483f7b,0x3f22bf46
.long 0xbf80,0xbf6d3ec4,0x3f353f35,0x3ec4bf6d,0xbf808000,0x3ec43f6d,0x3f35bf35,0xbf6dbec4
.long 0x3f353f35,0x3e95bf75,0xbf7b3e48,0x3f223f46,0x3f35bf35,0xbf75be95,0x3e483f7b,0x3f46bf22
.long 0xbf80,0xbec43f6d,0x3f35bf35,0xbf6d3ec4,0xbf808000,0x3f6d3ec4,0xbf35bf35,0x3ec43f6d
.long 0x3f353f35,0xbef1bf62,0x3e483f7b,0x3dc9bf7f,0x3f35bf35,0xbf623ef1,0x3f7bbe48,0xbf7fbdc9
.long 0xbf800000,0x3f0e3f55,0x3ec4bf6d,0xbf7b3e48,0x3f80,0x3f55bf0e,0xbf6dbec4,0x3e483f7b
.long 0x3f35bf35,0xbf7fbdc9,0x3f0e3f55,0x3e95bf75,0xbf35bf35,0xbdc93f7f,0x3f55bf0e,0xbf75be95
.long 0xbf800000,0x3f7b3e48,0xbf6dbec4,0x3f553f0e,0x3f80,0x3e48bf7b,0xbec43f6d,0x3f0ebf55
.long 0x3f35bf35,0xbf463f22,0x3f55bf0e,0xbf623ef1,0xbf35bf35,0x3f223f46,0xbf0ebf55,0x3ef13f62
.long 0x3f80,0x3f800000,0xbf80,0xbf800000,0x3f808000,0xbf80,0xbf808000,0x3f80
.long 0xbf6dbec4,0xbe953f75,0x3f7b3e48,0x3dc9bf7f,0xbec43f6d,0x3f753e95,0x3e48bf7b,0xbf7fbdc9
.long 0xbf80,0xbf353f35,0x3f800000,0xbf35bf35,0xbf808000,0x3f353f35,0xbf80,0xbf353f35
.long 0x3f6d3ec4,0xbef1bf62,0xbe483f7b,0x3f46bf22,0x3ec4bf6d,0xbf623ef1,0x3f7b3e48,0xbf22bf46
.long 0x3f35bf35,0xbf55bf0e,0xbec43f6d,0x3f7b3e48,0xbf35bf35,0xbf0e3f55,0x3f6d3ec4,0x3e48bf7b
.long 0x3ec43f6d,0x3f46bf22,0xbf55bf0e,0xbe953f75,0x3f6dbec4,0xbf22bf46,0xbf0e3f55,0x3f753e95
.long 0xbf353f35,0x3f7bbe48,0xbf6dbec4,0x3f0e3f55,0x3f353f35,0xbe48bf7b,0xbec43f6d,0x3f55bf0e
.long 0xbec4bf6d,0xbdc93f7f,0x3f0ebf55,0xbf623ef1,0xbf6d3ec4,0x3f7f3dc9,0xbf55bf0e,0x3ef13f62
.long 0xbf800000,0x3ec43f6d,0x3f35bf35,0xbf6dbec4,0x3f80,0x3f6dbec4,0xbf35bf35,0xbec43f6d
.long 0x3ec4bf6d,0xbf7f3dc9,0x3f0e3f55,0x3ef1bf62,0xbf6dbec4,0x3dc93f7f,0x3f55bf0e,0xbf62bef1
.long 0x3f800000,0xbf6dbec4,0x3f353f35,0xbec4bf6d,0xbf80,0xbec43f6d,0x3f35bf35,0xbf6d3ec4
.long 0xbec43f6d,0x3f22bf46,0xbf553f0e,0x3f75be95,0x3f6d3ec4,0xbf46bf22,0x3f0e3f55,0xbe95bf75
.long 0x3f353f35,0x3e48bf7b,0xbf6d3ec4,0x3f553f0e,0x3f35bf35,0xbf7bbe48,0x3ec43f6d,0x3f0ebf55
.long 0xbf6d3ec4,0x3f623ef1,0xbe48bf7b,0xbf223f46,0x3ec43f6d,0x3ef1bf62,0xbf7b3e48,0x3f463f22
.long 0xbf35bf35,0x3f0e3f55,0xbec4bf6d,0x3e483f7b,0xbf353f35,0x3f55bf0e,0xbf6d3ec4,0x3f7bbe48
.long 0x3f6dbec4,0xbf753e95,0x3f7bbe48,0xbf7f3dc9,0xbec4bf6d,0x3e953f75,0xbe48bf7b,0x3dc93f7f
.long 0x3f80,0x3f800000,0xbf80,0xbf800000,0x3f808000,0xbf80,0xbf808000,0x3f80
.long 0xbf800000,0x3dc93f7f,0x3f7bbe48,0xbe95bf75,0x3f80,0x3f7fbdc9,0xbe48bf7b,0xbf753e95
.long 0x3f80,0x3f35bf35,0xbf800000,0x3f353f35,0x3f808000,0xbf35bf35,0x3f80,0x3f35bf35
.long 0xbf800000,0x3f463f22,0xbe48bf7b,0xbef13f62,0x3f80,0x3f22bf46,0xbf7b3e48,0x3f623ef1
.long 0xbf80,0xbf7b3e48,0x3ec43f6d,0x3f55bf0e,0xbf808000,0x3e483f7b,0x3f6dbec4,0xbf0ebf55
.long 0x3f800000,0xbe95bf75,0xbf553f0e,0x3f463f22,0xbf80,0xbf753e95,0x3f0e3f55,0x3f22bf46
.long 0xbf80,0xbf0e3f55,0x3f6dbec4,0xbf7bbe48,0xbf808000,0x3f553f0e,0xbec4bf6d,0xbe483f7b
.long 0x3f800000,0xbf62bef1,0x3f0e3f55,0xbdc9bf7f,0xbf80,0xbef13f62,0x3f55bf0e,0xbf7f3dc9
.long 0x3f80,0x3f6dbec4,0xbf35bf35,0xbec43f6d,0x3f808000,0xbec4bf6d,0xbf353f35,0x3f6d3ec4
.long 0xbf800000,0x3ef13f62,0x3f0ebf55,0xbf7fbdc9,0x3f80,0x3f62bef1,0xbf55bf0e,0xbdc93f7f
.long 0x3f80,0x3ec4bf6d,0xbf353f35,0x3f6dbec4,0x3f808000,0xbf6dbec4,0x3f353f35,0xbec4bf6d
.long 0xbf800000,0x3f753e95,0xbf55bf0e,0x3f223f46,0x3f80,0x3e95bf75,0xbf0e3f55,0x3f46bf22
.long 0xbf80,0xbf553f0e,0x3f6d3ec4,0xbe48bf7b,0xbf808000,0x3f0e3f55,0x3ec4bf6d,0xbf7b3e48
.long 0x3f800000,0xbf22bf46,0xbe483f7b,0x3f62bef1,0xbf80,0xbf463f22,0x3f7b3e48,0xbef1bf62
.long 0xbf80,0xbe483f7b,0x3ec4bf6d,0xbf0e3f55,0xbf808000,0x3f7b3e48,0xbf6dbec4,0x3f553f0e
.long 0x3f800000,0xbf7fbdc9,0x3f7b3e48,0xbf75be95,0xbf80,0xbdc93f7f,0x3e48bf7b,0xbe953f75
.long 0x3f80,0x3f800000,0xbf80,0xbf800000,0x3f808000,0xbf80,0xbf808000,0x3f80
.long 0xbf6d3ec4,0x3ef13f62,0x3f55bf0e,0xbf22bf46,0x3ec43f6d,0x3f62bef1,0xbf0ebf55,0xbf463f22
.long 0xbf80,0xbf353f35,0x3f800000,0xbf35bf35,0xbf808000,0x3f353f35,0xbf80,0xbf353f35
.long 0x3f6dbec4,0xbf75be95,0x3f0e3f55,0x3dc9bf7f,0xbec4bf6d,0xbe953f75,0x3f55bf0e,0xbf7fbdc9
.long 0xbf35bf35,0xbf0e3f55,0x3f6d3ec4,0x3e48bf7b,0xbf353f35,0x3f553f0e,0x3ec4bf6d,0xbf7bbe48
.long 0x3ec4bf6d,0xbf7fbdc9,0x3e483f7b,0x3f62bef1,0xbf6dbec4,0xbdc93f7f,0x3f7bbe48,0xbef1bf62
.long 0x3f353f35,0xbe48bf7b,0xbec43f6d,0x3f55bf0e,0x3f35bf35,0xbf7b3e48,0x3f6d3ec4,0xbf0ebf55
.long 0xbec43f6d,0x3f46bf22,0xbf7b3e48,0x3f753e95,0x3f6d3ec4,0xbf22bf46,0x3e483f7b,0x3e95bf75
.long 0x3f800000,0xbec4bf6d,0xbf353f35,0x3f6d3ec4,0xbf80,0xbf6d3ec4,0x3f353f35,0x3ec4bf6d
.long 0x3ec43f6d,0x3f22bf46,0xbf7bbe48,0x3e953f75,0x3f6dbec4,0xbf46bf22,0xbe483f7b,0x3f75be95
.long 0xbf800000,0x3f6d3ec4,0xbf35bf35,0x3ec43f6d,0x3f80,0x3ec4bf6d,0xbf353f35,0x3f6dbec4
.long 0xbec4bf6d,0x3dc93f7f,0x3e48bf7b,0xbef13f62,0xbf6d3ec4,0x3f7fbdc9,0xbf7bbe48,0x3f623ef1
.long 0xbf353f35,0x3f7b3e48,0xbec4bf6d,0xbf0e3f55,0x3f353f35,0x3e48bf7b,0xbf6d3ec4,0x3f553f0e
.long 0xbf6dbec4,0x3e953f75,0x3f0ebf55,0xbf7f3dc9,0xbec43f6d,0x3f75be95,0xbf55bf0e,0x3dc93f7f
.long 0x3f35bf35,0xbf553f0e,0x3f6dbec4,0xbf7b3e48,0xbf35bf35,0x3f0e3f55,0xbec4bf6d,0x3e483f7b
.long 0x3f6d3ec4,0xbf62bef1,0x3f553f0e,0xbf46bf22,0x3ec4bf6d,0xbef13f62,0x3f0ebf55,0xbf223f46
.long 0x3f80,0x3f800000,0xbf80,0xbf800000,0x3f808000,0xbf80,0xbf808000,0x3f80
.long 0xbf353f35,0x3f463f22,0x3f0ebf55,0xbf62bef1,0x3f353f35,0x3f22bf46,0xbf55bf0e,0xbef13f62
.long 0x3f80,0x3f35bf35,0xbf800000,0x3f353f35,0x3f808000,0xbf35bf35,0x3f80,0x3f35bf35
.long 0xbf353f35,0x3f7fbdc9,0xbf55bf0e,0x3e953f75,0x3f353f35,0xbdc9bf7f,0xbf0e3f55,0x3f75be95
.long 0xbf800000,0x3e483f7b,0x3f6dbec4,0xbf0ebf55,0x3f80,0x3f7bbe48,0xbec4bf6d,0xbf553f0e
.long 0xbf35bf35,0xbef13f62,0x3f7b3e48,0xbdc9bf7f,0xbf353f35,0x3f623ef1,0x3e48bf7b,0xbf7f3dc9
.long 0xbf800000,0x3f553f0e,0xbec4bf6d,0xbe483f7b,0x3f80,0x3f0ebf55,0xbf6d3ec4,0x3f7b3e48
.long 0xbf35bf35,0x3e953f75,0x3e48bf7b,0xbf223f46,0xbf353f35,0x3f75be95,0xbf7bbe48,0x3f463f22
.long 0xbf80,0xbf6d3ec4,0x3f353f35,0x3ec4bf6d,0xbf808000,0x3ec43f6d,0x3f35bf35,0xbf6dbec4
.long 0x3f35bf35,0xbf75be95,0x3e483f7b,0x3f46bf22,0xbf35bf35,0xbe953f75,0x3f7bbe48,0xbf22bf46
.long 0xbf80,0xbec43f6d,0x3f35bf35,0xbf6d3ec4,0xbf808000,0x3f6d3ec4,0xbf35bf35,0x3ec43f6d
.long 0x3f35bf35,0xbf623ef1,0x3f7bbe48,0xbf7fbdc9,0xbf35bf35,0x3ef13f62,0xbe48bf7b,0xbdc93f7f
.long 0x3f800000,0xbf0ebf55,0xbec43f6d,0x3f7bbe48,0xbf80,0xbf553f0e,0x3f6d3ec4,0xbe48bf7b
.long 0x3f353f35,0x3dc9bf7f,0xbf553f0e,0x3f753e95,0x3f35bf35,0xbf7fbdc9,0x3f0e3f55,0x3e95bf75
.long 0x3f800000,0xbf7bbe48,0x3f6d3ec4,0xbf55bf0e,0xbf80,0xbe483f7b,0x3ec4bf6d,0xbf0e3f55
.long 0x3f353f35,0xbf22bf46,0x3f0e3f55,0xbef1bf62,0x3f35bf35,0xbf463f22,0x3f55bf0e,0xbf623ef1
.long 0x3f80,0x3f800000,0xbf80,0xbf800000,0x3f808000,0xbf80,0xbf808000,0x3f80
.long 0xbec43f6d,0x3f753e95,0x3e48bf7b,0xbf7fbdc9,0x3f6d3ec4,0x3e95bf75,0xbf7bbe48,0xbdc93f7f
.long 0xbf80,0xbf353f35,0x3f800000,0xbf35bf35,0xbf808000,0x3f353f35,0xbf80,0xbf353f35
.long 0x3ec4bf6d,0xbf623ef1,0x3f7b3e48,0xbf22bf46,0xbf6dbec4,0x3ef13f62,0x3e48bf7b,0xbf463f22
.long 0xbf353f35,0x3f553f0e,0x3ec4bf6d,0xbf7bbe48,0x3f353f35,0x3f0ebf55,0xbf6dbec4,0xbe483f7b
.long 0xbf6d3ec4,0x3f223f46,0x3f0ebf55,0xbf75be95,0x3ec43f6d,0x3f46bf22,0xbf55bf0e,0xbe953f75
.long 0x3f35bf35,0xbf7b3e48,0x3f6d3ec4,0xbf0ebf55,0xbf35bf35,0x3e483f7b,0x3ec4bf6d,0xbf553f0e
.long 0x3f6dbec4,0xbf7fbdc9,0x3f553f0e,0xbef1bf62,0xbec4bf6d,0xbdc93f7f,0x3f0ebf55,0xbf623ef1
.long 0xbf800000,0x3ec43f6d,0x3f35bf35,0xbf6dbec4,0x3f80,0x3f6dbec4,0xbf35bf35,0xbec43f6d
.long 0xbf6dbec4,0x3dc93f7f,0x3f55bf0e,0xbf62bef1,0xbec43f6d,0x3f7fbdc9,0xbf0ebf55,0xbef13f62
.long 0x3f800000,0xbf6dbec4,0x3f353f35,0xbec4bf6d,0xbf80,0xbec43f6d,0x3f35bf35,0xbf6d3ec4
.long 0x3f6d3ec4,0xbf46bf22,0x3f0e3f55,0xbe95bf75,0x3ec4bf6d,0xbf223f46,0x3f55bf0e,0xbf753e95
.long 0xbf35bf35,0xbe483f7b,0x3f6dbec4,0xbf55bf0e,0xbf353f35,0x3f7b3e48,0xbec4bf6d,0xbf0e3f55
.long 0xbec4bf6d,0xbef13f62,0x3f7bbe48,0xbf46bf22,0xbf6d3ec4,0x3f623ef1,0xbe48bf7b,0xbf223f46
.long 0x3f353f35,0xbf0ebf55,0x3ec43f6d,0xbe48bf7b,0x3f35bf35,0xbf553f0e,0x3f6dbec4,0xbf7b3e48
.long 0x3ec43f6d,0xbe95bf75,0x3e483f7b,0xbdc9bf7f,0x3f6dbec4,0xbf753e95,0x3f7bbe48,0xbf7f3dc9
.long 0x3f80,0xbf80,0x3f80,0xbf80,0x3f808000,0xbf808000,0x3f808000,0xbf808000
.long 0x3f80,0xbdc9bf7f,0x3e483f7b,0xbe95bf75,0x3f808000,0xbf7f3dc9,0x3f7bbe48,0xbf753e95
.long 0x3f80,0xbf35bf35,0x3f800000,0xbf353f35,0x3f808000,0xbf353f35,0xbf80,0x3f353f35
.long 0x3f80,0xbf46bf22,0x3f7bbe48,0xbef13f62,0x3f808000,0xbf223f46,0xbe48bf7b,0x3f623ef1
.long 0x3f80,0xbe48bf7b,0x3ec43f6d,0xbf0ebf55,0x3f808000,0xbf7b3e48,0x3f6dbec4,0xbf553f0e
.long 0x3f80,0xbe95bf75,0x3f0e3f55,0xbf46bf22,0x3f808000,0xbf753e95,0x3f55bf0e,0xbf223f46
.long 0x3f80,0xbf55bf0e,0x3f6dbec4,0xbe483f7b,0x3f808000,0xbf0e3f55,0xbec4bf6d,0x3f7b3e48
.long 0x3f80,0xbf62bef1,0x3f55bf0e,0x3dc93f7f,0x3f808000,0xbef13f62,0xbf0ebf55,0x3f7fbdc9
.long 0x3f80,0xbec4bf6d,0x3f353f35,0xbf6dbec4,0x3f808000,0xbf6d3ec4,0x3f35bf35,0xbec43f6d
.long 0x3f80,0xbef1bf62,0x3f553f0e,0xbf7fbdc9,0x3f808000,0xbf623ef1,0x3f0ebf55,0xbdc93f7f
.long 0x3f80,0xbf6dbec4,0x3f35bf35,0x3ec43f6d,0x3f808000,0xbec43f6d,0xbf35bf35,0x3f6dbec4
.long 0x3f80,0xbf75be95,0x3f0ebf55,0x3f223f46,0x3f808000,0xbe953f75,0xbf55bf0e,0x3f46bf22
.long 0x3f80,0xbf0ebf55,0x3f6d3ec4,0xbf7b3e48,0x3f808000,0xbf553f0e,0x3ec4bf6d,0x3e483f7b
.long 0x3f80,0xbf22bf46,0x3f7b3e48,0xbf623ef1,0x3f808000,0xbf463f22,0x3e48bf7b,0x3ef13f62
.long 0x3f80,0xbf7bbe48,0x3ec4bf6d,0x3f553f0e,0x3f808000,0xbe483f7b,0xbf6dbec4,0x3f0ebf55
.long 0x3f80,0xbf7fbdc9,0x3e48bf7b,0x3f753e95,0x3f808000,0xbdc93f7f,0xbf7bbe48,0x3e95bf75
.long 0x3f80,0xbf80,0x3f80,0xbf80,0x3f808000,0xbf808000,0x3f808000,0xbf808000
.long 0x3ec43f6d,0xbef1bf62,0x3f0e3f55,0xbf22bf46,0x3f6dbec4,0xbf623ef1,0x3f55bf0e,0xbf463f22
.long 0xbf80,0x3f353f35,0xbf800000,0x3f35bf35,0xbf808000,0x3f35bf35,0x3f80,0xbf35bf35
.long 0xbec4bf6d,0x3f753e95,0xbf553f0e,0x3dc9bf7f,0xbf6d3ec4,0x3e95bf75,0x3f0e3f55,0xbf7fbdc9
.long 0x3f353f35,0xbf55bf0e,0x3f6d3ec4,0xbf7bbe48,0x3f35bf35,0xbf0e3f55,0x3ec4bf6d,0xbe483f7b
.long 0x3f6d3ec4,0xbf7fbdc9,0x3f7bbe48,0xbf623ef1,0x3ec4bf6d,0xbdc93f7f,0xbe48bf7b,0x3ef13f62
.long 0xbf35bf35,0x3f7bbe48,0xbec43f6d,0xbf0ebf55,0xbf353f35,0xbe48bf7b,0x3f6d3ec4,0xbf553f0e
.long 0xbf6dbec4,0x3f46bf22,0x3e483f7b,0xbf75be95,0xbec43f6d,0xbf22bf46,0x3f7bbe48,0xbe953f75
.long 0x3f800000,0xbf6d3ec4,0x3f35bf35,0xbec43f6d,0xbf80,0x3ec43f6d,0xbf35bf35,0x3f6d3ec4
.long 0x3f6dbec4,0xbf223f46,0x3e48bf7b,0x3e953f75,0xbec4bf6d,0x3f463f22,0xbf7bbe48,0x3f75be95
.long 0xbf800000,0x3ec4bf6d,0x3f353f35,0xbf6d3ec4,0x3f80,0xbf6dbec4,0x3f35bf35,0x3ec43f6d
.long 0xbf6d3ec4,0xbdc9bf7f,0x3f7b3e48,0xbef13f62,0x3ec43f6d,0xbf7f3dc9,0x3e48bf7b,0x3f623ef1
.long 0x3f35bf35,0xbe483f7b,0xbec4bf6d,0x3f553f0e,0xbf35bf35,0x3f7b3e48,0xbf6d3ec4,0x3f0ebf55
.long 0x3ec4bf6d,0x3e953f75,0xbf55bf0e,0x3f7fbdc9,0xbf6dbec4,0x3f75be95,0xbf0e3f55,0xbdc9bf7f
.long 0xbf353f35,0xbf0ebf55,0x3f6dbec4,0x3e483f7b,0x3f353f35,0xbf553f0e,0xbec4bf6d,0x3f7bbe48
.long 0xbec43f6d,0xbf62bef1,0x3f0ebf55,0x3f463f22,0x3f6d3ec4,0xbef13f62,0xbf55bf0e,0x3f22bf46
.long 0x3f80,0xbf80,0x3f80,0xbf80,0x3f808000,0xbf808000,0x3f808000,0xbf808000
.long 0x3f353f35,0xbf46bf22,0x3f553f0e,0xbf62bef1,0x3f35bf35,0xbf223f46,0x3f0ebf55,0xbef13f62
.long 0x3f80,0xbf35bf35,0x3f800000,0xbf353f35,0x3f808000,0xbf353f35,0xbf80,0x3f353f35
.long 0x3f353f35,0xbf7f3dc9,0x3f0ebf55,0x3e953f75,0x3f35bf35,0x3dc93f7f,0xbf55bf0e,0x3f75be95
.long 0x3f800000,0xbf7b3e48,0x3f6dbec4,0xbf553f0e,0xbf80,0x3e483f7b,0xbec4bf6d,0x3f0e3f55
.long 0x3f35bf35,0xbef13f62,0x3e48bf7b,0x3dc93f7f,0xbf35bf35,0x3f623ef1,0xbf7bbe48,0x3f7fbdc9
.long 0x3f800000,0xbf0e3f55,0xbec4bf6d,0x3f7b3e48,0xbf80,0x3f553f0e,0xbf6d3ec4,0x3e48bf7b
.long 0x3f35bf35,0x3e953f75,0xbf7bbe48,0x3f22bf46,0xbf35bf35,0x3f75be95,0xbe483f7b,0xbf46bf22
.long 0xbf80,0x3ec43f6d,0xbf35bf35,0x3f6d3ec4,0xbf808000,0x3f6dbec4,0xbf353f35,0x3ec4bf6d
.long 0xbf35bf35,0x3f753e95,0xbf7b3e48,0x3f46bf22,0xbf353f35,0x3e95bf75,0x3e483f7b,0xbf22bf46
.long 0xbf80,0x3f6d3ec4,0xbf353f35,0xbec4bf6d,0xbf808000,0x3ec4bf6d,0x3f353f35,0xbf6d3ec4
.long 0xbf35bf35,0x3f62bef1,0x3e483f7b,0xbf7fbdc9,0xbf353f35,0xbef1bf62,0x3f7bbe48,0xbdc93f7f
.long 0xbf800000,0x3f55bf0e,0xbec43f6d,0xbe48bf7b,0x3f80,0xbf0ebf55,0x3f6d3ec4,0xbf7b3e48
.long 0xbf353f35,0x3dc9bf7f,0x3f0e3f55,0xbf75be95,0x3f353f35,0xbf7fbdc9,0x3f55bf0e,0xbe953f75
.long 0xbf800000,0x3e48bf7b,0x3f6d3ec4,0xbf0e3f55,0x3f80,0xbf7bbe48,0x3ec4bf6d,0x3f553f0e
.long 0xbf353f35,0xbf22bf46,0x3f55bf0e,0x3ef13f62,0x3f353f35,0xbf463f22,0xbf0ebf55,0x3f62bef1
.long 0x3f80,0xbf80,0x3f80,0xbf80,0x3f808000,0xbf808000,0x3f808000,0xbf808000
.long 0x3f6d3ec4,0xbf75be95,0x3f7b3e48,0xbf7fbdc9,0x3ec4bf6d,0xbe953f75,0x3e48bf7b,0xbdc93f7f
.long 0xbf80,0x3f353f35,0xbf800000,0x3f35bf35,0xbf808000,0x3f35bf35,0x3f80,0xbf35bf35
.long 0xbf6dbec4,0x3f62bef1,0xbe483f7b,0xbf22bf46,0xbec43f6d,0xbef1bf62,0x3f7b3e48,0xbf463f22
.long 0x3f35bf35,0xbf0e3f55,0x3ec4bf6d,0xbe483f7b,0xbf35bf35,0x3f553f0e,0xbf6dbec4,0x3f7b3e48
.long 0xbec4bf6d,0x3f223f46,0xbf55bf0e,0x3f753e95,0xbf6d3ec4,0x3f46bf22,0xbf0e3f55,0x3e95bf75
.long 0xbf353f35,0xbe48bf7b,0x3f6d3ec4,0xbf553f0e,0x3f353f35,0xbf7b3e48,0x3ec4bf6d,0x3f0e3f55
.long 0x3ec43f6d,0xbf7fbdc9,0x3f0ebf55,0x3ef13f62,0x3f6dbec4,0xbdc93f7f,0xbf55bf0e,0x3f62bef1
.long 0xbf800000,0x3f6dbec4,0xbf353f35,0x3ec4bf6d,0x3f80,0xbec4bf6d,0x3f353f35,0xbf6dbec4
.long 0xbec43f6d,0xbdc9bf7f,0x3f0e3f55,0xbf62bef1,0x3f6d3ec4,0xbf7f3dc9,0x3f55bf0e,0xbef13f62
.long 0x3f800000,0xbec43f6d,0xbf35bf35,0x3f6dbec4,0xbf80,0x3f6d3ec4,0xbf353f35,0xbec4bf6d
.long 0x3ec4bf6d,0x3f463f22,0xbf553f0e,0xbe95bf75,0xbf6dbec4,0x3f22bf46,0x3f0e3f55,0xbf753e95
.long 0x3f353f35,0xbf7bbe48,0x3f6dbec4,0xbf0e3f55,0x3f35bf35,0xbe483f7b,0xbec4bf6d,0x3f553f0e
.long 0x3f6dbec4,0xbef13f62,0xbe48bf7b,0x3f463f22,0xbec4bf6d,0x3f623ef1,0xbf7b3e48,0x3f22bf46
.long 0xbf35bf35,0x3f55bf0e,0x3ec43f6d,0xbf7b3e48,0xbf353f35,0xbf0ebf55,0x3f6dbec4,0x3e483f7b
.long 0xbf6d3ec4,0xbe95bf75,0x3f7bbe48,0x3dc93f7f,0x3ec43f6d,0xbf753e95,0xbe48bf7b,0x3f7fbdc9
.long 0x3f80,0xbf80,0x3f80,0xbf80,0x3f808000,0xbf808000,0x3f808000,0xbf808000
.long 0x3f800000,0xbf7f3dc9,0x3f7bbe48,0xbf753e95,0xbf80,0x3dc93f7f,0xbe48bf7b,0x3e953f75
.long 0x3f80,0xbf35bf35,0x3f800000,0xbf353f35,0x3f808000,0xbf353f35,0xbf80,0x3f353f35
.long 0x3f800000,0xbf223f46,0xbe48bf7b,0x3f623ef1,0xbf80,0x3f463f22,0xbf7b3e48,0x3ef1bf62
.long 0xbf80,0x3e483f7b,0xbec4bf6d,0x3f0e3f55,0xbf808000,0x3f7bbe48,0xbf6d3ec4,0x3f55bf0e
.long 0xbf800000,0x3f75be95,0xbf553f0e,0x3f22bf46,0x3f80,0xbe95bf75,0x3f0e3f55,0xbf46bf22
.long 0xbf80,0x3f553f0e,0xbf6d3ec4,0x3e48bf7b,0xbf808000,0x3f0ebf55,0x3ec43f6d,0xbf7bbe48
.long 0xbf800000,0x3ef1bf62,0x3f0e3f55,0xbf7f3dc9,0x3f80,0xbf62bef1,0x3f55bf0e,0x3dc93f7f
.long 0x3f80,0xbec4bf6d,0x3f353f35,0xbf6dbec4,0x3f808000,0xbf6d3ec4,0x3f35bf35,0xbec43f6d
.long 0x3f800000,0xbf623ef1,0x3f0ebf55,0xbdc93f7f,0xbf80,0x3ef13f62,0xbf55bf0e,0x3f7f3dc9
.long 0x3f80,0xbf6dbec4,0x3f35bf35,0x3ec43f6d,0x3f808000,0xbec43f6d,0xbf35bf35,0x3f6dbec4
.long 0x3f800000,0xbe953f75,0xbf55bf0e,0x3f46bf22,0xbf80,0x3f753e95,0xbf0e3f55,0xbf22bf46
.long 0xbf80,0x3f0e3f55,0xbf6dbec4,0x3f7bbe48,0xbf808000,0x3f55bf0e,0xbec43f6d,0xbe48bf7b
.long 0xbf800000,0x3f46bf22,0xbe483f7b,0xbef1bf62,0x3f80,0xbf22bf46,0x3f7b3e48,0xbf623ef1
.long 0xbf80,0x3f7b3e48,0xbec43f6d,0xbf55bf0e,0xbf808000,0x3e48bf7b,0x3f6d3ec4,0xbf0e3f55
.long 0xbf800000,0x3dc9bf7f,0x3f7b3e48,0xbe953f75,0x3f80,0xbf7fbdc9,0x3e48bf7b,0x3f753e95
.long 0x3f80,0xbf80,0x3f80,0xbf80,0x3f808000,0xbf808000,0x3f808000,0xbf808000
.long 0x3f6dbec4,0xbf623ef1,0x3f55bf0e,0xbf463f22,0xbec4bf6d,0x3ef13f62,0xbf0ebf55,0x3f223f46
.long 0xbf80,0x3f353f35,0xbf800000,0x3f35bf35,0xbf808000,0x3f35bf35,0x3f80,0xbf35bf35
.long 0xbf6d3ec4,0x3e95bf75,0x3f0e3f55,0xbf7fbdc9,0x3ec43f6d,0xbf75be95,0x3f55bf0e,0xbdc93f7f
.long 0xbf35bf35,0x3f553f0e,0xbf6dbec4,0x3f7b3e48,0xbf353f35,0x3f0ebf55,0xbec43f6d,0x3e48bf7b
.long 0xbec43f6d,0x3dc9bf7f,0x3e483f7b,0xbef1bf62,0x3f6d3ec4,0xbf7fbdc9,0x3f7bbe48,0xbf623ef1
.long 0x3f353f35,0xbf7b3e48,0x3ec4bf6d,0x3f0e3f55,0x3f35bf35,0x3e483f7b,0xbf6dbec4,0x3f55bf0e
.long 0x3ec4bf6d,0x3f223f46,0xbf7b3e48,0x3e95bf75,0xbf6dbec4,0x3f46bf22,0x3e483f7b,0xbf75be95
.long 0x3f800000,0xbf6d3ec4,0x3f35bf35,0xbec43f6d,0xbf80,0x3ec43f6d,0xbf35bf35,0x3f6d3ec4
.long 0xbec4bf6d,0x3f463f22,0xbf7bbe48,0x3f75be95,0xbf6d3ec4,0x3f22bf46,0xbe483f7b,0xbe95bf75
.long 0xbf800000,0x3ec4bf6d,0x3f353f35,0xbf6d3ec4,0x3f80,0xbf6dbec4,0x3f35bf35,0x3ec43f6d
.long 0x3ec43f6d,0xbf7f3dc9,0x3e48bf7b,0x3f623ef1,0x3f6dbec4,0x3dc93f7f,0xbf7bbe48,0x3ef1bf62
.long 0xbf353f35,0x3e48bf7b,0x3ec43f6d,0xbf55bf0e,0x3f353f35,0xbf7bbe48,0x3f6dbec4,0xbf0e3f55
.long 0x3f6d3ec4,0xbf753e95,0x3f0ebf55,0x3dc93f7f,0x3ec4bf6d,0x3e953f75,0xbf55bf0e,0x3f7fbdc9
.long 0x3f35bf35,0x3f0e3f55,0xbf6d3ec4,0xbe48bf7b,0xbf35bf35,0x3f55bf0e,0x3ec43f6d,0xbf7b3e48
.long 0xbf6dbec4,0x3ef1bf62,0x3f553f0e,0xbf223f46,0xbec43f6d,0xbf62bef1,0x3f0ebf55,0x3f463f22
.long 0x3f80,0xbf80,0x3f80,0xbf80,0x3f808000,0xbf808000,0x3f808000,0xbf808000
.long 0x3f35bf35,0xbf223f46,0x3f0ebf55,0xbef13f62,0xbf35bf35,0x3f463f22,0xbf55bf0e,0x3f623ef1
.long 0x3f80,0xbf35bf35,0x3f800000,0xbf353f35,0x3f808000,0xbf353f35,0xbf80,0x3f353f35
.long 0x3f35bf35,0x3dc93f7f,0xbf55bf0e,0x3f75be95,0xbf35bf35,0x3f7fbdc9,0xbf0e3f55,0xbe95bf75
.long 0xbf800000,0x3f7bbe48,0xbf6d3ec4,0x3f55bf0e,0x3f80,0xbe48bf7b,0x3ec43f6d,0xbf0ebf55
.long 0x3f353f35,0xbf62bef1,0x3f7b3e48,0xbf7f3dc9,0x3f35bf35,0xbef13f62,0x3e48bf7b,0x3dc93f7f
.long 0xbf800000,0x3f0ebf55,0x3ec43f6d,0xbf7bbe48,0x3f80,0xbf55bf0e,0x3f6dbec4,0xbe483f7b
.long 0x3f353f35,0xbf753e95,0x3e48bf7b,0x3f463f22,0x3f35bf35,0x3e953f75,0xbf7bbe48,0x3f22bf46
.long 0xbf80,0x3ec43f6d,0xbf35bf35,0x3f6d3ec4,0xbf808000,0x3f6dbec4,0xbf353f35,0x3ec4bf6d
.long 0xbf353f35,0x3e95bf75,0x3e483f7b,0xbf22bf46,0x3f353f35,0xbf75be95,0x3f7bbe48,0xbf463f22
.long 0xbf80,0x3f6d3ec4,0xbf353f35,0xbec4bf6d,0xbf808000,0x3ec4bf6d,0x3f353f35,0xbf6d3ec4
.long 0xbf353f35,0xbef1bf62,0x3f7bbe48,0xbdc93f7f,0x3f353f35,0xbf623ef1,0xbe48bf7b,0x3f7f3dc9
.long 0x3f800000,0xbf553f0e,0x3ec4bf6d,0x3e483f7b,0xbf80,0x3f0e3f55,0xbf6dbec4,0x3f7bbe48
.long 0xbf35bf35,0x3f7f3dc9,0xbf553f0e,0x3e95bf75,0xbf353f35,0x3dc9bf7f,0x3f0e3f55,0xbf75be95
.long 0x3f800000,0xbe483f7b,0xbf6dbec4,0x3f0ebf55,0xbf80,0x3f7b3e48,0xbec43f6d,0xbf55bf0e
.long 0xbf35bf35,0x3f46bf22,0x3f0e3f55,0xbf623ef1,0xbf353f35,0xbf22bf46,0x3f55bf0e,0x3ef13f62
.long 0x3f80,0xbf80,0x3f80,0xbf80,0x3f808000,0xbf808000,0x3f808000,0xbf808000
.long 0x3ec4bf6d,0xbe953f75,0x3e48bf7b,0xbdc93f7f,0xbf6dbec4,0x3f753e95,0xbf7bbe48,0x3f7f3dc9
.long 0xbf80,0x3f353f35,0xbf800000,0x3f35bf35,0xbf808000,0x3f35bf35,0x3f80,0xbf35bf35
.long 0xbec43f6d,0xbef1bf62,0x3f7b3e48,0xbf463f22,0x3f6d3ec4,0xbf623ef1,0x3e48bf7b,0x3f223f46
.long 0xbf353f35,0x3f0ebf55,0xbec43f6d,0x3e48bf7b,0x3f353f35,0xbf55bf0e,0x3f6d3ec4,0xbf7bbe48
.long 0x3f6dbec4,0xbf463f22,0x3f0ebf55,0xbe953f75,0xbec4bf6d,0x3f223f46,0xbf55bf0e,0x3f753e95
.long 0x3f35bf35,0x3e483f7b,0xbf6dbec4,0x3f55bf0e,0xbf35bf35,0x3f7bbe48,0xbec43f6d,0xbf0ebf55
.long 0xbf6d3ec4,0x3dc9bf7f,0x3f553f0e,0xbf623ef1,0x3ec43f6d,0xbf7fbdc9,0x3f0ebf55,0x3ef13f62
.long 0xbf800000,0x3f6dbec4,0xbf353f35,0x3ec4bf6d,0x3f80,0xbec4bf6d,0x3f353f35,0xbf6dbec4
.long 0x3f6d3ec4,0xbf7f3dc9,0x3f55bf0e,0xbef13f62,0x3ec4bf6d,0x3dc93f7f,0xbf0ebf55,0x3f623ef1
.long 0x3f800000,0xbec43f6d,0xbf35bf35,0x3f6dbec4,0xbf80,0x3f6d3ec4,0xbf353f35,0xbec4bf6d
.long 0xbf6dbec4,0x3f22bf46,0x3f0e3f55,0xbf753e95,0xbec43f6d,0xbf46bf22,0x3f55bf0e,0x3e953f75
.long 0xbf35bf35,0x3f7b3e48,0xbf6d3ec4,0x3f0ebf55,0xbf353f35,0x3e48bf7b,0x3ec43f6d,0xbf55bf0e
.long 0x3ec43f6d,0xbf62bef1,0x3f7bbe48,0xbf223f46,0x3f6dbec4,0xbef13f62,0xbe48bf7b,0x3f463f22
.long 0x3f353f35,0xbf553f0e,0xbec4bf6d,0x3f7bbe48,0x3f35bf35,0x3f0e3f55,0xbf6d3ec4,0xbe48bf7b
.long 0xbec4bf6d,0x3f75be95,0x3e483f7b,0xbf7f3dc9,0xbf6d3ec4,0xbe95bf75,0x3f7bbe48,0x3dc93f7f
.long 0x3f80,0xbf80,0x3f80,0xbf80,0x3f808000,0xbf808000,0x3f808000,0xbf808000
.long 0xbf80,0x3dc93f7f,0xbe48bf7b,0x3e953f75,0xbf808000,0x3f7fbdc9,0xbf7b3e48,0x3f75be95
.long 0x3f80,0xbf35bf35,0x3f800000,0xbf353f35,0x3f808000,0xbf353f35,0xbf80,0x3f353f35
.long 0xbf80,0x3f463f22,0xbf7b3e48,0x3ef1bf62,0xbf808000,0x3f22bf46,0x3e483f7b,0xbf62bef1
.long 0x3f80,0xbe48bf7b,0x3ec43f6d,0xbf0ebf55,0x3f808000,0xbf7b3e48,0x3f6dbec4,0xbf553f0e
.long 0xbf80,0x3e953f75,0xbf0ebf55,0x3f463f22,0xbf808000,0x3f75be95,0xbf553f0e,0x3f22bf46
.long 0x3f80,0xbf55bf0e,0x3f6dbec4,0xbe483f7b,0x3f808000,0xbf0e3f55,0xbec4bf6d,0x3f7b3e48
.long 0xbf80,0x3f623ef1,0xbf553f0e,0xbdc9bf7f,0xbf808000,0x3ef1bf62,0x3f0e3f55,0xbf7f3dc9
.long 0x3f80,0xbec4bf6d,0x3f353f35,0xbf6dbec4,0x3f808000,0xbf6d3ec4,0x3f35bf35,0xbec43f6d
.long 0xbf80,0x3ef13f62,0xbf55bf0e,0x3f7f3dc9,0xbf808000,0x3f62bef1,0xbf0e3f55,0x3dc9bf7f
.long 0x3f80,0xbf6dbec4,0x3f35bf35,0x3ec43f6d,0x3f808000,0xbec43f6d,0xbf35bf35,0x3f6dbec4
.long 0xbf80,0x3f753e95,0xbf0e3f55,0xbf22bf46,0xbf808000,0x3e95bf75,0x3f553f0e,0xbf463f22
.long 0x3f80,0xbf0ebf55,0x3f6d3ec4,0xbf7b3e48,0x3f808000,0xbf553f0e,0x3ec4bf6d,0x3e483f7b
.long 0xbf80,0x3f223f46,0xbf7bbe48,0x3f62bef1,0xbf808000,0x3f46bf22,0xbe483f7b,0xbef1bf62
.long 0x3f80,0xbf7bbe48,0x3ec4bf6d,0x3f553f0e,0x3f808000,0xbe483f7b,0xbf6dbec4,0x3f0ebf55
.long 0xbf80,0x3f7f3dc9,0xbe483f7b,0xbf75be95,0xbf808000,0x3dc9bf7f,0x3f7b3e48,0xbe953f75
.long 0x3f80,0xbf80,0x3f80,0xbf80,0x3f808000,0xbf808000,0x3f808000,0xbf808000
.long 0xbec4bf6d,0x3ef13f62,0xbf0ebf55,0x3f223f46,0xbf6d3ec4,0x3f62bef1,0xbf553f0e,0x3f46bf22
.long 0xbf80,0x3f353f35,0xbf800000,0x3f35bf35,0xbf808000,0x3f35bf35,0x3f80,0xbf35bf35
.long 0x3ec43f6d,0xbf75be95,0x3f55bf0e,0xbdc93f7f,0x3f6dbec4,0xbe953f75,0xbf0ebf55,0x3f7f3dc9
.long 0x3f353f35,0xbf55bf0e,0x3f6d3ec4,0xbf7bbe48,0x3f35bf35,0xbf0e3f55,0x3ec4bf6d,0xbe483f7b
.long 0xbf6dbec4,0x3f7f3dc9,0xbf7b3e48,0x3f62bef1,0xbec43f6d,0x3dc9bf7f,0x3e483f7b,0xbef1bf62
.long 0xbf35bf35,0x3f7bbe48,0xbec43f6d,0xbf0ebf55,0xbf353f35,0xbe48bf7b,0x3f6d3ec4,0xbf553f0e
.long 0x3f6d3ec4,0xbf463f22,0xbe48bf7b,0x3f753e95,0x3ec4bf6d,0x3f223f46,0xbf7b3e48,0x3e95bf75
.long 0x3f800000,0xbf6d3ec4,0x3f35bf35,0xbec43f6d,0xbf80,0x3ec43f6d,0xbf35bf35,0x3f6d3ec4
.long 0xbf6d3ec4,0x3f22bf46,0xbe483f7b,0xbe95bf75,0x3ec43f6d,0xbf46bf22,0x3f7b3e48,0xbf753e95
.long 0xbf800000,0x3ec4bf6d,0x3f353f35,0xbf6d3ec4,0x3f80,0xbf6dbec4,0x3f35bf35,0x3ec43f6d
.long 0x3f6dbec4,0x3dc93f7f,0xbf7bbe48,0x3ef1bf62,0xbec4bf6d,0x3f7fbdc9,0xbe483f7b,0xbf62bef1
.long 0x3f35bf35,0xbe483f7b,0xbec4bf6d,0x3f553f0e,0xbf35bf35,0x3f7b3e48,0xbf6d3ec4,0x3f0ebf55
.long 0xbec43f6d,0xbe95bf75,0x3f553f0e,0xbf7f3dc9,0x3f6d3ec4,0xbf753e95,0x3f0ebf55,0x3dc93f7f
.long 0xbf353f35,0xbf0ebf55,0x3f6dbec4,0x3e483f7b,0x3f353f35,0xbf553f0e,0xbec4bf6d,0x3f7bbe48
.long 0x3ec4bf6d,0x3f623ef1,0xbf0e3f55,0xbf46bf22,0xbf6dbec4,0x3ef1bf62,0x3f553f0e,0xbf223f46
.long 0x3f80,0xbf80,0x3f80,0xbf80,0x3f808000,0xbf808000,0x3f808000,0xbf808000
.long 0xbf35bf35,0x3f463f22,0xbf55bf0e,0x3f623ef1,0xbf353f35,0x3f22bf46,0xbf0e3f55,0x3ef1bf62
.long 0x3f80,0xbf35bf35,0x3f800000,0xbf353f35,0x3f808000,0xbf353f35,0xbf80,0x3f353f35
.long 0xbf35bf35,0x3f7fbdc9,0xbf0e3f55,0xbe95bf75,0xbf353f35,0xbdc9bf7f,0x3f553f0e,0xbf753e95
.long 0x3f800000,0xbf7b3e48,0x3f6dbec4,0xbf553f0e,0xbf80,0x3e483f7b,0xbec4bf6d,0x3f0e3f55
.long 0xbf353f35,0x3ef1bf62,0xbe483f7b,0xbdc9bf7f,0x3f353f35,0xbf62bef1,0x3f7b3e48,0xbf7f3dc9
.long 0x3f800000,0xbf0e3f55,0xbec4bf6d,0x3f7b3e48,0xbf80,0x3f553f0e,0xbf6d3ec4,0x3e48bf7b
.long 0xbf353f35,0xbe95bf75,0x3f7b3e48,0xbf223f46,0x3f353f35,0xbf753e95,0x3e48bf7b,0x3f463f22
.long 0xbf80,0x3ec43f6d,0xbf35bf35,0x3f6d3ec4,0xbf808000,0x3f6dbec4,0xbf353f35,0x3ec4bf6d
.long 0x3f353f35,0xbf75be95,0x3f7bbe48,0xbf463f22,0x3f35bf35,0xbe953f75,0xbe48bf7b,0x3f223f46
.long 0xbf80,0x3f6d3ec4,0xbf353f35,0xbec4bf6d,0xbf808000,0x3ec4bf6d,0x3f353f35,0xbf6d3ec4
.long 0x3f353f35,0xbf623ef1,0xbe48bf7b,0x3f7f3dc9,0x3f35bf35,0x3ef13f62,0xbf7b3e48,0x3dc9bf7f
.long 0xbf800000,0x3f55bf0e,0xbec43f6d,0xbe48bf7b,0x3f80,0xbf0ebf55,0x3f6d3ec4,0xbf7b3e48
.long 0x3f35bf35,0xbdc93f7f,0xbf0ebf55,0x3f753e95,0xbf35bf35,0x3f7f3dc9,0xbf553f0e,0x3e95bf75
.long 0xbf800000,0x3e48bf7b,0x3f6d3ec4,0xbf0e3f55,0x3f80,0xbf7bbe48,0x3ec4bf6d,0x3f553f0e
.long 0x3f35bf35,0x3f223f46,0xbf553f0e,0xbef1bf62,0xbf35bf35,0x3f46bf22,0x3f0e3f55,0xbf623ef1
.long 0x3f80,0xbf80,0x3f80,0xbf80,0x3f808000,0xbf808000,0x3f808000,0xbf808000
.long 0xbf6dbec4,0x3f753e95,0xbf7bbe48,0x3f7f3dc9,0xbec43f6d,0x3e95bf75,0xbe483f7b,0x3dc9bf7f
.long 0xbf80,0x3f353f35,0xbf800000,0x3f35bf35,0xbf808000,0x3f35bf35,0x3f80,0xbf35bf35
.long 0x3f6d3ec4,0xbf623ef1,0x3e48bf7b,0x3f223f46,0x3ec4bf6d,0x3ef13f62,0xbf7bbe48,0x3f46bf22
.long 0x3f35bf35,0xbf0e3f55,0x3ec4bf6d,0xbe483f7b,0xbf35bf35,0x3f553f0e,0xbf6dbec4,0x3f7b3e48
.long 0x3ec43f6d,0xbf22bf46,0x3f553f0e,0xbf75be95,0x3f6dbec4,0xbf463f22,0x3f0ebf55,0xbe953f75
.long 0xbf353f35,0xbe48bf7b,0x3f6d3ec4,0xbf553f0e,0x3f353f35,0xbf7b3e48,0x3ec4bf6d,0x3f0e3f55
.long 0xbec4bf6d,0x3f7f3dc9,0xbf0e3f55,0xbef1bf62,0xbf6d3ec4,0x3dc9bf7f,0x3f553f0e,0xbf623ef1
.long 0xbf800000,0x3f6dbec4,0xbf353f35,0x3ec4bf6d,0x3f80,0xbec4bf6d,0x3f353f35,0xbf6dbec4
.long 0x3ec4bf6d,0x3dc93f7f,0xbf0ebf55,0x3f623ef1,0xbf6dbec4,0x3f7fbdc9,0xbf553f0e,0x3ef1bf62
.long 0x3f800000,0xbec43f6d,0xbf35bf35,0x3f6dbec4,0xbf80,0x3f6d3ec4,0xbf353f35,0xbec4bf6d
.long 0xbec43f6d,0xbf46bf22,0x3f55bf0e,0x3e953f75,0x3f6d3ec4,0xbf223f46,0xbf0ebf55,0x3f75be95
.long 0x3f353f35,0xbf7bbe48,0x3f6dbec4,0xbf0e3f55,0x3f35bf35,0xbe483f7b,0xbec4bf6d,0x3f553f0e
.long 0xbf6d3ec4,0x3ef1bf62,0x3e483f7b,0xbf46bf22,0x3ec43f6d,0xbf62bef1,0x3f7bbe48,0xbf223f46
.long 0xbf35bf35,0x3f55bf0e,0x3ec43f6d,0xbf7b3e48,0xbf353f35,0xbf0ebf55,0x3f6dbec4,0x3e483f7b
.long 0x3f6dbec4,0x3e953f75,0xbf7b3e48,0xbdc9bf7f,0xbec4bf6d,0x3f75be95,0x3e483f7b,0xbf7f3dc9
.long 0x3f80,0xbf80,0x3f80,0xbf80,0x3f808000,0xbf808000,0x3f808000,0xbf808000
.long 0xbf800000,0x3f7fbdc9,0xbf7b3e48,0x3f75be95,0x3f80,0xbdc9bf7f,0x3e483f7b,0xbe95bf75
.long 0x3f80,0xbf35bf35,0x3f800000,0xbf353f35,0x3f808000,0xbf353f35,0xbf80,0x3f353f35
.long 0xbf800000,0x3f22bf46,0x3e483f7b,0xbf62bef1,0x3f80,0xbf46bf22,0x3f7bbe48,0xbef13f62
.long 0xbf80,0x3e483f7b,0xbec4bf6d,0x3f0e3f55,0xbf808000,0x3f7bbe48,0xbf6d3ec4,0x3f55bf0e
.long 0x3f800000,0xbf753e95,0x3f55bf0e,0xbf223f46,0xbf80,0x3e953f75,0xbf0ebf55,0x3f463f22
.long 0xbf80,0x3f553f0e,0xbf6d3ec4,0x3e48bf7b,0xbf808000,0x3f0ebf55,0x3ec43f6d,0xbf7bbe48
.long 0x3f800000,0xbef13f62,0xbf0ebf55,0x3f7fbdc9,0xbf80,0x3f623ef1,0xbf553f0e,0xbdc9bf7f
.long 0x3f80,0xbec4bf6d,0x3f353f35,0xbf6dbec4,0x3f808000,0xbf6d3ec4,0x3f35bf35,0xbec43f6d
.long 0xbf800000,0x3f62bef1,0xbf0e3f55,0x3dc9bf7f,0x3f80,0xbef1bf62,0x3f553f0e,0xbf7fbdc9
.long 0x3f80,0xbf6dbec4,0x3f35bf35,0x3ec43f6d,0x3f808000,0xbec43f6d,0xbf35bf35,0x3f6dbec4
.long 0xbf800000,0x3e95bf75,0x3f553f0e,0xbf463f22,0x3f80,0xbf75be95,0x3f0ebf55,0x3f223f46
.long 0xbf80,0x3f0e3f55,0xbf6dbec4,0x3f7bbe48,0xbf808000,0x3f55bf0e,0xbec43f6d,0xbe48bf7b
.long 0x3f800000,0xbf463f22,0x3e48bf7b,0x3ef13f62,0xbf80,0x3f223f46,0xbf7bbe48,0x3f62bef1
.long 0xbf80,0x3f7b3e48,0xbec43f6d,0xbf55bf0e,0xbf808000,0x3e48bf7b,0x3f6d3ec4,0xbf0e3f55
.long 0x3f800000,0xbdc93f7f,0xbf7bbe48,0x3e95bf75,0xbf80,0x3f7f3dc9,0xbe483f7b,0xbf75be95
.long 0x3f80,0xbf80,0x3f80,0xbf80,0x3f808000,0xbf808000,0x3f808000,0xbf808000
.long 0xbf6d3ec4,0x3f62bef1,0xbf553f0e,0x3f46bf22,0x3ec43f6d,0xbef1bf62,0x3f0e3f55,0xbf22bf46
.long 0xbf80,0x3f353f35,0xbf800000,0x3f35bf35,0xbf808000,0x3f35bf35,0x3f80,0xbf35bf35
.long 0x3f6dbec4,0xbe953f75,0xbf0ebf55,0x3f7f3dc9,0xbec4bf6d,0x3f753e95,0xbf553f0e,0x3dc9bf7f
.long 0xbf35bf35,0x3f553f0e,0xbf6dbec4,0x3f7b3e48,0xbf353f35,0x3f0ebf55,0xbec43f6d,0x3e48bf7b
.long 0x3ec4bf6d,0xbdc93f7f,0xbe48bf7b,0x3ef13f62,0xbf6dbec4,0x3f7f3dc9,0xbf7b3e48,0x3f62bef1
.long 0x3f353f35,0xbf7b3e48,0x3ec4bf6d,0x3f0e3f55,0x3f35bf35,0x3e483f7b,0xbf6dbec4,0x3f55bf0e
.long 0xbec43f6d,0xbf22bf46,0x3f7bbe48,0xbe953f75,0x3f6d3ec4,0xbf463f22,0xbe48bf7b,0x3f753e95
.long 0x3f800000,0xbf6d3ec4,0x3f35bf35,0xbec43f6d,0xbf80,0x3ec43f6d,0xbf35bf35,0x3f6d3ec4
.long 0x3ec43f6d,0xbf46bf22,0x3f7b3e48,0xbf753e95,0x3f6dbec4,0xbf223f46,0x3e48bf7b,0x3e953f75
.long 0xbf800000,0x3ec4bf6d,0x3f353f35,0xbf6d3ec4,0x3f80,0xbf6dbec4,0x3f35bf35,0x3ec43f6d
.long 0xbec4bf6d,0x3f7fbdc9,0xbe483f7b,0xbf62bef1,0xbf6d3ec4,0xbdc9bf7f,0x3f7b3e48,0xbef13f62
.long 0xbf353f35,0x3e48bf7b,0x3ec43f6d,0xbf55bf0e,0x3f353f35,0xbf7bbe48,0x3f6dbec4,0xbf0e3f55
.long 0xbf6dbec4,0x3f75be95,0xbf0e3f55,0xbdc9bf7f,0xbec43f6d,0xbe95bf75,0x3f553f0e,0xbf7f3dc9
.long 0x3f35bf35,0x3f0e3f55,0xbf6d3ec4,0xbe48bf7b,0xbf35bf35,0x3f55bf0e,0x3ec43f6d,0xbf7b3e48
.long 0x3f6d3ec4,0xbef13f62,0xbf55bf0e,0x3f22bf46,0x3ec4bf6d,0x3f623ef1,0xbf0e3f55,0xbf46bf22
.long 0x3f80,0xbf80,0x3f80,0xbf80,0x3f808000,0xbf808000,0x3f808000,0xbf808000
.long 0xbf353f35,0x3f22bf46,0xbf0e3f55,0x3ef1bf62,0x3f353f35,0xbf46bf22,0x3f553f0e,0xbf62bef1
.long 0x3f80,0xbf35bf35,0x3f800000,0xbf353f35,0x3f808000,0xbf353f35,0xbf80,0x3f353f35
.long 0xbf353f35,0xbdc9bf7f,0x3f553f0e,0xbf753e95,0x3f353f35,0xbf7f3dc9,0x3f0ebf55,0x3e953f75
.long 0xbf800000,0x3f7bbe48,0xbf6d3ec4,0x3f55bf0e,0x3f80,0xbe48bf7b,0x3ec43f6d,0xbf0ebf55
.long 0xbf35bf35,0x3f623ef1,0xbf7bbe48,0x3f7fbdc9,0xbf353f35,0x3ef1bf62,0xbe483f7b,0xbdc9bf7f
.long 0xbf800000,0x3f0ebf55,0x3ec43f6d,0xbf7bbe48,0x3f80,0xbf55bf0e,0x3f6dbec4,0xbe483f7b
.long 0xbf35bf35,0x3f75be95,0xbe483f7b,0xbf46bf22,0xbf353f35,0xbe95bf75,0x3f7b3e48,0xbf223f46
.long 0xbf80,0x3ec43f6d,0xbf35bf35,0x3f6d3ec4,0xbf808000,0x3f6dbec4,0xbf353f35,0x3ec4bf6d
.long 0x3f35bf35,0xbe953f75,0xbe48bf7b,0x3f223f46,0xbf35bf35,0x3f753e95,0xbf7b3e48,0x3f46bf22
.long 0xbf80,0x3f6d3ec4,0xbf353f35,0xbec4bf6d,0xbf808000,0x3ec4bf6d,0x3f353f35,0xbf6d3ec4
.long 0x3f35bf35,0x3ef13f62,0xbf7b3e48,0x3dc9bf7f,0xbf35bf35,0x3f62bef1,0x3e483f7b,0xbf7fbdc9
.long 0x3f800000,0xbf553f0e,0x3ec4bf6d,0x3e483f7b,0xbf80,0x3f0e3f55,0xbf6dbec4,0x3f7bbe48
.long 0x3f353f35,0xbf7fbdc9,0x3f55bf0e,0xbe953f75,0x3f35bf35,0xbdc93f7f,0xbf0ebf55,0x3f753e95
.long 0x3f800000,0xbe483f7b,0xbf6dbec4,0x3f0ebf55,0xbf80,0x3f7b3e48,0xbec43f6d,0xbf55bf0e
.long 0x3f353f35,0xbf463f22,0xbf0ebf55,0x3f62bef1,0x3f35bf35,0x3f223f46,0xbf553f0e,0xbef1bf62
.long 0x3f80,0xbf80,0x3f80,0xbf80,0x3f808000,0xbf808000,0x3f808000,0xbf808000
.long 0xbec43f6d,0x3e95bf75,0xbe483f7b,0x3dc9bf7f,0x3f6d3ec4,0xbf75be95,0x3f7b3e48,0xbf7fbdc9
.long 0xbf80,0x3f353f35,0xbf800000,0x3f35bf35,0xbf808000,0x3f35bf35,0x3f80,0xbf35bf35
.long 0x3ec4bf6d,0x3ef13f62,0xbf7bbe48,0x3f46bf22,0xbf6dbec4,0x3f62bef1,0xbe483f7b,0xbf22bf46
.long 0xbf353f35,0x3f0ebf55,0xbec43f6d,0x3e48bf7b,0x3f353f35,0xbf55bf0e,0x3f6d3ec4,0xbf7bbe48
.long 0xbf6d3ec4,0x3f46bf22,0xbf0e3f55,0x3e95bf75,0x3ec43f6d,0xbf22bf46,0x3f553f0e,0xbf75be95
.long 0x3f35bf35,0x3e483f7b,0xbf6dbec4,0x3f55bf0e,0xbf35bf35,0x3f7bbe48,0xbec43f6d,0xbf0ebf55
.long 0x3f6dbec4,0xbdc93f7f,0xbf55bf0e,0x3f62bef1,0xbec4bf6d,0x3f7f3dc9,0xbf0e3f55,0xbef1bf62
.long 0xbf800000,0x3f6dbec4,0xbf353f35,0x3ec4bf6d,0x3f80,0xbec4bf6d,0x3f353f35,0xbf6dbec4
.long 0xbf6dbec4,0x3f7fbdc9,0xbf553f0e,0x3ef1bf62,0xbec43f6d,0xbdc9bf7f,0x3f0e3f55,0xbf62bef1
.long 0x3f800000,0xbec43f6d,0xbf35bf35,0x3f6dbec4,0xbf80,0x3f6d3ec4,0xbf353f35,0xbec4bf6d
.long 0x3f6d3ec4,0xbf223f46,0xbf0ebf55,0x3f75be95,0x3ec4bf6d,0x3f463f22,0xbf553f0e,0xbe95bf75
.long 0xbf35bf35,0x3f7b3e48,0xbf6d3ec4,0x3f0ebf55,0xbf353f35,0x3e48bf7b,0x3ec43f6d,0xbf55bf0e
.long 0xbec4bf6d,0x3f623ef1,0xbf7b3e48,0x3f22bf46,0xbf6d3ec4,0x3ef1bf62,0x3e483f7b,0xbf46bf22
.long 0x3f353f35,0xbf553f0e,0xbec4bf6d,0x3f7bbe48,0x3f35bf35,0x3f0e3f55,0xbf6d3ec4,0xbe48bf7b
.long 0x3ec43f6d,0xbf753e95,0xbe48bf7b,0x3f7fbdc9,0x3f6dbec4,0x3e953f75,0xbf7b3e48,0xbdc9bf7f
.long 0x3f80,0xbf800000,0xbf80,0x3f800000,0x3f808000,0x3f80,0xbf808000,0xbf80
.long 0x3f80,0xbf7f3dc9,0xbe48bf7b,0x3f75be95,0x3f808000,0x3dc93f7f,0xbf7b3e48,0xbe95bf75
.long 0x3f80,0xbf353f35,0xbf800000,0xbf35bf35,0x3f808000,0x3f353f35,0x3f80,0xbf353f35
.long 0x3f80,0xbf223f46,0xbf7b3e48,0xbf62bef1,0x3f808000,0x3f463f22,0x3e483f7b,0xbef13f62
.long 0x3f80,0xbf7b3e48,0xbec4bf6d,0x3f55bf0e,0x3f808000,0x3e483f7b,0xbf6d3ec4,0xbf0ebf55
.long 0x3f80,0xbf753e95,0xbf0ebf55,0x3f22bf46,0x3f808000,0x3e953f75,0xbf553f0e,0xbf46bf22
.long 0x3f80,0xbf0e3f55,0xbf6d3ec4,0xbf7bbe48,0x3f808000,0x3f553f0e,0x3ec43f6d,0xbe483f7b
.long 0x3f80,0xbef13f62,0xbf553f0e,0xbf7f3dc9,0x3f808000,0x3f623ef1,0x3f0e3f55,0x3dc93f7f
.long 0x3f80,0xbf6d3ec4,0xbf35bf35,0x3ec4bf6d,0x3f808000,0x3ec43f6d,0xbf353f35,0xbf6dbec4
.long 0x3f80,0xbf623ef1,0xbf55bf0e,0x3dc9bf7f,0x3f808000,0x3ef13f62,0xbf0e3f55,0xbf7fbdc9
.long 0x3f80,0xbec43f6d,0xbf353f35,0xbf6d3ec4,0x3f808000,0x3f6d3ec4,0x3f353f35,0x3ec43f6d
.long 0x3f80,0xbe953f75,0xbf0e3f55,0xbf463f22,0x3f808000,0x3f753e95,0x3f553f0e,0x3f223f46
.long 0x3f80,0xbf553f0e,0xbf6dbec4,0xbe48bf7b,0x3f808000,0x3f0e3f55,0xbec43f6d,0xbf7b3e48
.long 0x3f80,0xbf463f22,0xbf7bbe48,0xbef1bf62,0x3f808000,0x3f223f46,0xbe483f7b,0xbf623ef1
.long 0x3f80,0xbe483f7b,0xbec43f6d,0xbf0e3f55,0x3f808000,0x3f7b3e48,0x3f6d3ec4,0x3f553f0e
.long 0x3f80,0xbdc93f7f,0xbe483f7b,0xbe953f75,0x3f808000,0x3f7f3dc9,0x3f7b3e48,0x3f753e95
.long 0x3f80,0xbf800000,0xbf80,0x3f800000,0x3f808000,0x3f80,0xbf808000,0xbf80
.long 0x3ec43f6d,0xbf623ef1,0xbf0ebf55,0x3f46bf22,0x3f6dbec4,0x3ef13f62,0xbf553f0e,0xbf22bf46
.long 0xbf80,0x3f35bf35,0x3f800000,0x3f353f35,0xbf808000,0xbf35bf35,0xbf80,0x3f35bf35
.long 0xbec4bf6d,0x3e95bf75,0x3f55bf0e,0x3f7f3dc9,0xbf6d3ec4,0xbf75be95,0xbf0ebf55,0x3dc9bf7f
.long 0x3f353f35,0xbf0e3f55,0xbf6dbec4,0x3e48bf7b,0x3f35bf35,0x3f553f0e,0xbec43f6d,0xbf7bbe48
.long 0x3f6d3ec4,0xbdc93f7f,0xbf7b3e48,0xbef1bf62,0x3ec4bf6d,0x3f7f3dc9,0x3e483f7b,0xbf623ef1
.long 0xbf35bf35,0xbe48bf7b,0x3ec4bf6d,0x3f55bf0e,0xbf353f35,0xbf7b3e48,0xbf6dbec4,0xbf0ebf55
.long 0xbf6dbec4,0xbf22bf46,0xbe48bf7b,0x3e95bf75,0xbec43f6d,0xbf463f22,0xbf7b3e48,0xbf75be95
.long 0x3f800000,0x3ec43f6d,0xbf353f35,0xbf6dbec4,0xbf80,0x3f6dbec4,0x3f353f35,0xbec43f6d
.long 0x3f6dbec4,0x3f463f22,0xbe483f7b,0xbf753e95,0xbec4bf6d,0x3f22bf46,0x3f7b3e48,0x3e953f75
.long 0xbf800000,0xbf6dbec4,0xbf35bf35,0xbec4bf6d,0x3f80,0xbec43f6d,0xbf353f35,0xbf6d3ec4
.long 0xbf6d3ec4,0xbf7f3dc9,0xbf7bbe48,0xbf62bef1,0x3ec43f6d,0x3dc93f7f,0xbe483f7b,0xbef13f62
.long 0x3f35bf35,0x3f7b3e48,0x3ec43f6d,0xbf0e3f55,0xbf35bf35,0x3e48bf7b,0x3f6dbec4,0x3f553f0e
.long 0x3ec4bf6d,0x3f75be95,0x3f553f0e,0x3dc93f7f,0xbf6dbec4,0xbe95bf75,0x3f0ebf55,0x3f7fbdc9
.long 0xbf353f35,0xbf553f0e,0xbf6d3ec4,0xbf7b3e48,0x3f353f35,0x3f0e3f55,0x3ec43f6d,0x3e483f7b
.long 0xbec43f6d,0xbef13f62,0xbf0e3f55,0xbf223f46,0x3f6d3ec4,0x3f623ef1,0x3f553f0e,0x3f463f22
.long 0x3f80,0xbf800000,0xbf80,0x3f800000,0x3f808000,0x3f80,0xbf808000,0xbf80
.long 0x3f353f35,0xbf223f46,0xbf55bf0e,0x3ef1bf62,0x3f35bf35,0x3f463f22,0xbf0e3f55,0xbf62bef1
.long 0x3f80,0xbf353f35,0xbf800000,0xbf35bf35,0x3f808000,0x3f353f35,0x3f80,0xbf353f35
.long 0x3f353f35,0x3dc93f7f,0xbf0e3f55,0xbf753e95,0x3f35bf35,0x3f7fbdc9,0x3f553f0e,0x3e953f75
.long 0x3f800000,0x3e483f7b,0xbf6d3ec4,0xbf0ebf55,0xbf80,0x3f7bbe48,0x3ec43f6d,0xbf553f0e
.long 0x3f35bf35,0x3f623ef1,0xbe483f7b,0xbf7f3dc9,0xbf35bf35,0x3ef1bf62,0x3f7b3e48,0x3dc93f7f
.long 0x3f800000,0x3f553f0e,0x3ec43f6d,0xbe483f7b,0xbf80,0x3f0ebf55,0x3f6dbec4,0x3f7b3e48
.long 0x3f35bf35,0x3f75be95,0x3f7b3e48,0x3f463f22,0xbf35bf35,0xbe95bf75,0x3e48bf7b,0x3f22bf46
.long 0xbf80,0x3f6dbec4,0x3f353f35,0xbec43f6d,0xbf808000,0xbec4bf6d,0x3f35bf35,0x3f6d3ec4
.long 0xbf35bf35,0x3e95bf75,0x3f7bbe48,0x3f223f46,0xbf353f35,0xbf75be95,0xbe48bf7b,0x3f46bf22
.long 0xbf80,0x3ec4bf6d,0x3f35bf35,0x3f6dbec4,0xbf808000,0xbf6dbec4,0xbf35bf35,0xbec4bf6d
.long 0xbf35bf35,0xbef1bf62,0xbe48bf7b,0x3dc9bf7f,0xbf353f35,0xbf623ef1,0xbf7b3e48,0xbf7fbdc9
.long 0xbf800000,0xbf0ebf55,0x3ec4bf6d,0x3f7bbe48,0x3f80,0xbf553f0e,0xbf6dbec4,0xbe48bf7b
.long 0xbf353f35,0xbf7fbdc9,0xbf0ebf55,0x3e95bf75,0x3f353f35,0xbdc93f7f,0xbf553f0e,0xbf75be95
.long 0xbf800000,0xbf7bbe48,0xbf6dbec4,0xbf55bf0e,0x3f80,0xbe483f7b,0xbec43f6d,0xbf0e3f55
.long 0xbf353f35,0xbf463f22,0xbf553f0e,0xbf623ef1,0x3f353f35,0x3f223f46,0x3f0e3f55,0x3ef13f62
.long 0x3f80,0xbf800000,0xbf80,0x3f800000,0x3f808000,0x3f80,0xbf808000,0xbf80
.long 0x3f6d3ec4,0xbe953f75,0xbf7bbe48,0x3dc9bf7f,0x3ec4bf6d,0x3f753e95,0xbe483f7b,0xbf7fbdc9
.long 0xbf80,0x3f35bf35,0x3f800000,0x3f353f35,0xbf808000,0xbf35bf35,0xbf80,0x3f35bf35
.long 0xbf6dbec4,0xbef1bf62,0x3e48bf7b,0x3f46bf22,0xbec43f6d,0xbf623ef1,0xbf7bbe48,0xbf22bf46
.long 0x3f35bf35,0x3f553f0e,0xbec43f6d,0xbf7bbe48,0xbf35bf35,0x3f0ebf55,0x3f6d3ec4,0xbe483f7b
.long 0xbec4bf6d,0x3f46bf22,0x3f553f0e,0xbe953f75,0xbf6d3ec4,0xbf22bf46,0x3f0ebf55,0x3f753e95
.long 0xbf353f35,0xbf7b3e48,0xbf6dbec4,0xbf0ebf55,0x3f353f35,0x3e483f7b,0xbec43f6d,0xbf553f0e
.long 0x3ec43f6d,0xbdc93f7f,0xbf0e3f55,0xbf623ef1,0x3f6dbec4,0x3f7f3dc9,0x3f553f0e,0x3ef13f62
.long 0xbf800000,0xbec4bf6d,0x3f35bf35,0x3f6d3ec4,0x3f80,0xbf6d3ec4,0xbf35bf35,0x3ec4bf6d
.long 0xbec43f6d,0xbf7f3dc9,0xbf0ebf55,0x3ef1bf62,0x3f6d3ec4,0x3dc93f7f,0xbf553f0e,0xbf62bef1
.long 0x3f800000,0x3f6d3ec4,0x3f353f35,0x3ec43f6d,0xbf80,0x3ec4bf6d,0x3f35bf35,0x3f6dbec4
.long 0x3ec4bf6d,0x3f22bf46,0x3f55bf0e,0x3f75be95,0xbf6dbec4,0xbf46bf22,0xbf0ebf55,0xbe95bf75
.long 0x3f353f35,0xbe483f7b,0xbf6d3ec4,0xbf55bf0e,0x3f35bf35,0x3f7b3e48,0x3ec43f6d,0xbf0e3f55
.long 0x3f6dbec4,0x3f623ef1,0x3e483f7b,0xbf223f46,0xbec4bf6d,0x3ef1bf62,0x3f7bbe48,0x3f463f22
.long 0xbf35bf35,0xbf0ebf55,0xbec4bf6d,0xbe48bf7b,0xbf353f35,0xbf553f0e,0xbf6d3ec4,0xbf7b3e48
.long 0xbf6d3ec4,0xbf753e95,0xbf7b3e48,0xbf7f3dc9,0x3ec43f6d,0x3e953f75,0x3e483f7b,0x3dc93f7f
.long 0x3f80,0xbf800000,0xbf80,0x3f800000,0x3f808000,0x3f80,0xbf808000,0xbf80
.long 0x3f800000,0x3dc93f7f,0xbf7b3e48,0xbe95bf75,0xbf80,0x3f7fbdc9,0x3e483f7b,0xbf753e95
.long 0x3f80,0xbf353f35,0xbf800000,0xbf35bf35,0x3f808000,0x3f353f35,0x3f80,0xbf353f35
.long 0x3f800000,0x3f463f22,0x3e483f7b,0xbef13f62,0xbf80,0x3f22bf46,0x3f7bbe48,0x3f623ef1
.long 0xbf80,0x3f7bbe48,0x3ec43f6d,0xbf553f0e,0xbf808000,0xbe48bf7b,0x3f6dbec4,0x3f0e3f55
.long 0xbf800000,0xbe95bf75,0x3f55bf0e,0x3f463f22,0x3f80,0xbf753e95,0xbf0ebf55,0x3f22bf46
.long 0xbf80,0x3f0ebf55,0x3f6dbec4,0x3f7b3e48,0xbf808000,0xbf55bf0e,0xbec4bf6d,0x3e48bf7b
.long 0xbf800000,0xbf62bef1,0xbf0ebf55,0xbdc9bf7f,0x3f80,0xbef13f62,0xbf553f0e,0xbf7f3dc9
.long 0x3f80,0xbf6d3ec4,0xbf35bf35,0x3ec4bf6d,0x3f808000,0x3ec43f6d,0xbf353f35,0xbf6dbec4
.long 0x3f800000,0x3ef13f62,0xbf0e3f55,0xbf7fbdc9,0xbf80,0x3f62bef1,0x3f553f0e,0xbdc93f7f
.long 0x3f80,0xbec43f6d,0xbf353f35,0xbf6d3ec4,0x3f808000,0x3f6d3ec4,0x3f353f35,0x3ec43f6d
.long 0x3f800000,0x3f753e95,0x3f553f0e,0x3f223f46,0xbf80,0x3e95bf75,0x3f0ebf55,0x3f46bf22
.long 0xbf80,0x3f55bf0e,0x3f6d3ec4,0x3e483f7b,0xbf808000,0xbf0ebf55,0x3ec4bf6d,0x3f7bbe48
.long 0xbf800000,0xbf22bf46,0x3e48bf7b,0x3f62bef1,0x3f80,0xbf463f22,0xbf7bbe48,0xbef1bf62
.long 0xbf80,0x3e48bf7b,0x3ec4bf6d,0x3f0ebf55,0xbf808000,0xbf7bbe48,0xbf6dbec4,0xbf55bf0e
.long 0xbf800000,0xbf7fbdc9,0xbf7bbe48,0xbf75be95,0x3f80,0xbdc93f7f,0xbe483f7b,0xbe953f75
.long 0x3f80,0xbf800000,0xbf80,0x3f800000,0x3f808000,0x3f80,0xbf808000,0xbf80
.long 0x3f6dbec4,0x3ef13f62,0xbf553f0e,0xbf22bf46,0xbec4bf6d,0x3f62bef1,0x3f0e3f55,0xbf463f22
.long 0xbf80,0x3f35bf35,0x3f800000,0x3f353f35,0xbf808000,0xbf35bf35,0xbf80,0x3f35bf35
.long 0xbf6d3ec4,0xbf75be95,0xbf0ebf55,0x3dc9bf7f,0x3ec43f6d,0xbe953f75,0xbf553f0e,0xbf7fbdc9
.long 0xbf35bf35,0x3f0ebf55,0x3f6d3ec4,0xbe483f7b,0xbf353f35,0xbf55bf0e,0x3ec4bf6d,0x3f7b3e48
.long 0xbec43f6d,0xbf7fbdc9,0xbe48bf7b,0x3f62bef1,0x3f6d3ec4,0xbdc93f7f,0xbf7b3e48,0xbef1bf62
.long 0x3f353f35,0x3e483f7b,0xbec43f6d,0xbf553f0e,0x3f35bf35,0x3f7bbe48,0x3f6d3ec4,0x3f0e3f55
.long 0x3ec4bf6d,0x3f46bf22,0x3f7bbe48,0x3f753e95,0xbf6dbec4,0xbf22bf46,0xbe48bf7b,0x3e95bf75
.long 0x3f800000,0x3ec43f6d,0xbf353f35,0xbf6dbec4,0xbf80,0x3f6dbec4,0x3f353f35,0xbec43f6d
.long 0xbec4bf6d,0x3f22bf46,0x3f7b3e48,0x3e953f75,0xbf6d3ec4,0xbf46bf22,0x3e48bf7b,0x3f75be95
.long 0xbf800000,0xbf6dbec4,0xbf35bf35,0xbec4bf6d,0x3f80,0xbec43f6d,0xbf353f35,0xbf6d3ec4
.long 0x3ec43f6d,0x3dc93f7f,0xbe483f7b,0xbef13f62,0x3f6dbec4,0x3f7fbdc9,0x3f7b3e48,0x3f623ef1
.long 0xbf353f35,0xbf7bbe48,0xbec4bf6d,0x3f0ebf55,0x3f353f35,0xbe483f7b,0xbf6d3ec4,0xbf55bf0e
.long 0x3f6d3ec4,0x3e953f75,0xbf0e3f55,0xbf7f3dc9,0x3ec4bf6d,0x3f75be95,0x3f553f0e,0x3dc93f7f
.long 0x3f35bf35,0x3f55bf0e,0x3f6dbec4,0x3f7bbe48,0xbf35bf35,0xbf0ebf55,0xbec4bf6d,0xbe48bf7b
.long 0xbf6dbec4,0xbf62bef1,0xbf55bf0e,0xbf46bf22,0xbec43f6d,0xbef13f62,0xbf0e3f55,0xbf223f46
.long 0x3f80,0xbf800000,0xbf80,0x3f800000,0x3f808000,0x3f80,0xbf808000,0xbf80
.long 0x3f35bf35,0x3f463f22,0xbf0e3f55,0xbf62bef1,0xbf35bf35,0x3f22bf46,0x3f553f0e,0xbef13f62
.long 0x3f80,0xbf353f35,0xbf800000,0xbf35bf35,0x3f808000,0x3f353f35,0x3f80,0xbf353f35
.long 0x3f35bf35,0x3f7fbdc9,0x3f553f0e,0x3e953f75,0xbf35bf35,0xbdc9bf7f,0x3f0ebf55,0x3f75be95
.long 0xbf800000,0xbe48bf7b,0x3f6dbec4,0x3f0e3f55,0x3f80,0xbf7b3e48,0xbec4bf6d,0x3f55bf0e
.long 0x3f353f35,0xbef13f62,0xbf7bbe48,0xbdc9bf7f,0x3f35bf35,0x3f623ef1,0xbe483f7b,0xbf7f3dc9
.long 0xbf800000,0xbf55bf0e,0xbec4bf6d,0x3e48bf7b,0x3f80,0xbf0e3f55,0xbf6d3ec4,0xbf7bbe48
.long 0x3f353f35,0x3e953f75,0xbe483f7b,0xbf223f46,0x3f35bf35,0x3f75be95,0x3f7b3e48,0x3f463f22
.long 0xbf80,0x3f6dbec4,0x3f353f35,0xbec43f6d,0xbf808000,0xbec4bf6d,0x3f35bf35,0x3f6d3ec4
.long 0xbf353f35,0xbf75be95,0xbe48bf7b,0x3f46bf22,0x3f353f35,0xbe953f75,0xbf7b3e48,0xbf22bf46
.long 0xbf80,0x3ec4bf6d,0x3f35bf35,0x3f6dbec4,0xbf808000,0xbf6dbec4,0xbf35bf35,0xbec4bf6d
.long 0xbf353f35,0xbf623ef1,0xbf7b3e48,0xbf7fbdc9,0x3f353f35,0x3ef13f62,0x3e483f7b,0xbdc93f7f
.long 0x3f800000,0x3f0e3f55,0xbec43f6d,0xbf7b3e48,0xbf80,0x3f55bf0e,0x3f6d3ec4,0x3e483f7b
.long 0xbf35bf35,0x3dc9bf7f,0x3f55bf0e,0x3f753e95,0xbf353f35,0xbf7fbdc9,0xbf0ebf55,0x3e95bf75
.long 0x3f800000,0x3f7b3e48,0x3f6d3ec4,0x3f553f0e,0xbf80,0x3e48bf7b,0x3ec4bf6d,0x3f0ebf55
.long 0xbf35bf35,0xbf22bf46,0xbf0ebf55,0xbef1bf62,0xbf353f35,0xbf463f22,0xbf553f0e,0xbf623ef1
.long 0x3f80,0xbf800000,0xbf80,0x3f800000,0x3f808000,0x3f80,0xbf808000,0xbf80
.long 0x3ec4bf6d,0x3f753e95,0xbe483f7b,0xbf7fbdc9,0xbf6dbec4,0x3e95bf75,0x3f7b3e48,0xbdc93f7f
.long 0xbf80,0x3f35bf35,0x3f800000,0x3f353f35,0xbf808000,0xbf35bf35,0xbf80,0x3f35bf35
.long 0xbec43f6d,0xbf623ef1,0xbf7bbe48,0xbf22bf46,0x3f6d3ec4,0x3ef13f62,0xbe483f7b,0xbf463f22
.long 0xbf353f35,0xbf55bf0e,0x3ec4bf6d,0x3f7b3e48,0x3f353f35,0xbf0e3f55,0xbf6dbec4,0x3e48bf7b
.long 0x3f6dbec4,0x3f223f46,0xbf0e3f55,0xbf75be95,0xbec4bf6d,0x3f46bf22,0x3f553f0e,0xbe953f75
.long 0x3f35bf35,0x3f7bbe48,0x3f6d3ec4,0x3f0e3f55,0xbf35bf35,0xbe48bf7b,0x3ec4bf6d,0x3f55bf0e
.long 0xbf6d3ec4,0xbf7fbdc9,0xbf55bf0e,0xbef1bf62,0x3ec43f6d,0xbdc93f7f,0xbf0e3f55,0xbf623ef1
.long 0xbf800000,0xbec4bf6d,0x3f35bf35,0x3f6d3ec4,0x3f80,0xbf6d3ec4,0xbf35bf35,0x3ec4bf6d
.long 0x3f6d3ec4,0x3dc93f7f,0xbf553f0e,0xbf62bef1,0x3ec4bf6d,0x3f7fbdc9,0x3f0e3f55,0xbef13f62
.long 0x3f800000,0x3f6d3ec4,0x3f353f35,0x3ec43f6d,0xbf80,0x3ec4bf6d,0x3f35bf35,0x3f6dbec4
.long 0xbf6dbec4,0xbf46bf22,0xbf0ebf55,0xbe95bf75,0xbec43f6d,0xbf223f46,0xbf553f0e,0xbf753e95
.long 0xbf35bf35,0x3e48bf7b,0x3f6dbec4,0x3f553f0e,0xbf353f35,0xbf7bbe48,0xbec4bf6d,0x3f0ebf55
.long 0x3ec43f6d,0xbef13f62,0xbf7b3e48,0xbf46bf22,0x3f6dbec4,0x3f623ef1,0x3e483f7b,0xbf223f46
.long 0x3f353f35,0x3f0e3f55,0x3ec43f6d,0x3e483f7b,0x3f35bf35,0x3f55bf0e,0x3f6dbec4,0x3f7bbe48
.long 0xbec4bf6d,0xbe95bf75,0xbe48bf7b,0xbdc9bf7f,0xbf6d3ec4,0xbf753e95,0xbf7b3e48,0xbf7f3dc9
.long 0x3f80,0xbf800000,0xbf80,0x3f800000,0x3f808000,0x3f80,0xbf808000,0xbf80
.long 0xbf80,0x3f7fbdc9,0x3e483f7b,0xbf753e95,0xbf808000,0xbdc9bf7f,0x3f7bbe48,0x3e953f75
.long 0x3f80,0xbf353f35,0xbf800000,0xbf35bf35,0x3f808000,0x3f353f35,0x3f80,0xbf353f35
.long 0xbf80,0x3f22bf46,0x3f7bbe48,0x3f623ef1,0xbf808000,0xbf46bf22,0xbe48bf7b,0x3ef1bf62
.long 0x3f80,0xbf7b3e48,0xbec4bf6d,0x3f55bf0e,0x3f808000,0x3e483f7b,0xbf6d3ec4,0xbf0ebf55
.long 0xbf80,0x3f75be95,0x3f0e3f55,0xbf223f46,0xbf808000,0xbe95bf75,0x3f55bf0e,0x3f463f22
.long 0x3f80,0xbf0e3f55,0xbf6d3ec4,0xbf7bbe48,0x3f808000,0x3f553f0e,0x3ec43f6d,0xbe483f7b
.long 0xbf80,0x3ef1bf62,0x3f55bf0e,0x3f7fbdc9,0xbf808000,0xbf62bef1,0xbf0ebf55,0xbdc9bf7f
.long 0x3f80,0xbf6d3ec4,0xbf35bf35,0x3ec4bf6d,0x3f808000,0x3ec43f6d,0xbf353f35,0xbf6dbec4
.long 0xbf80,0x3f62bef1,0x3f553f0e,0xbdc93f7f,0xbf808000,0xbef1bf62,0x3f0ebf55,0x3f7f3dc9
.long 0x3f80,0xbec43f6d,0xbf353f35,0xbf6d3ec4,0x3f808000,0x3f6d3ec4,0x3f353f35,0x3ec43f6d
.long 0xbf80,0x3e95bf75,0x3f0ebf55,0x3f46bf22,0xbf808000,0xbf75be95,0xbf55bf0e,0xbf22bf46
.long 0x3f80,0xbf553f0e,0xbf6dbec4,0xbe48bf7b,0x3f808000,0x3f0e3f55,0xbec43f6d,0xbf7b3e48
.long 0xbf80,0x3f46bf22,0x3f7b3e48,0x3ef13f62,0xbf808000,0xbf22bf46,0x3e48bf7b,0x3f62bef1
.long 0x3f80,0xbe483f7b,0xbec43f6d,0xbf0e3f55,0x3f808000,0x3f7b3e48,0x3f6d3ec4,0x3f553f0e
.long 0xbf80,0x3dc9bf7f,0x3e48bf7b,0x3e95bf75,0xbf808000,0xbf7fbdc9,0xbf7bbe48,0xbf75be95
.long 0x3f80,0xbf800000,0xbf80,0x3f800000,0x3f808000,0x3f80,0xbf808000,0xbf80
.long 0xbec4bf6d,0x3f62bef1,0x3f0e3f55,0xbf463f22,0xbf6d3ec4,0xbef1bf62,0x3f55bf0e,0x3f223f46
.long 0xbf80,0x3f35bf35,0x3f800000,0x3f353f35,0xbf808000,0xbf35bf35,0xbf80,0x3f35bf35
.long 0x3ec43f6d,0xbe953f75,0xbf553f0e,0xbf7fbdc9,0x3f6dbec4,0x3f753e95,0x3f0e3f55,0xbdc93f7f
.long 0x3f353f35,0xbf0e3f55,0xbf6dbec4,0x3e48bf7b,0x3f35bf35,0x3f553f0e,0xbec43f6d,0xbf7bbe48
.long 0xbf6dbec4,0x3dc9bf7f,0x3f7bbe48,0x3ef13f62,0xbec43f6d,0xbf7fbdc9,0xbe48bf7b,0x3f62bef1
.long 0xbf35bf35,0xbe48bf7b,0x3ec4bf6d,0x3f55bf0e,0xbf353f35,0xbf7b3e48,0xbf6dbec4,0xbf0ebf55
.long 0x3f6d3ec4,0x3f223f46,0x3e483f7b,0xbe953f75,0x3ec4bf6d,0x3f46bf22,0x3f7bbe48,0x3f753e95
.long 0x3f800000,0x3ec43f6d,0xbf353f35,0xbf6dbec4,0xbf80,0x3f6dbec4,0x3f353f35,0xbec43f6d
.long 0xbf6d3ec4,0xbf46bf22,0x3e48bf7b,0x3f75be95,0x3ec43f6d,0xbf223f46,0xbf7bbe48,0xbe95bf75
.long 0xbf800000,0xbf6dbec4,0xbf35bf35,0xbec4bf6d,0x3f80,0xbec43f6d,0xbf353f35,0xbf6d3ec4
.long 0x3f6dbec4,0x3f7fbdc9,0x3f7b3e48,0x3f623ef1,0xbec4bf6d,0xbdc9bf7f,0x3e48bf7b,0x3ef1bf62
.long 0x3f35bf35,0x3f7b3e48,0x3ec43f6d,0xbf0e3f55,0xbf35bf35,0x3e48bf7b,0x3f6dbec4,0x3f553f0e
.long 0xbec43f6d,0xbf753e95,0xbf55bf0e,0xbdc9bf7f,0x3f6d3ec4,0x3e953f75,0xbf0e3f55,0xbf7f3dc9
.long 0xbf353f35,0xbf553f0e,0xbf6d3ec4,0xbf7b3e48,0x3f353f35,0x3f0e3f55,0x3ec43f6d,0x3e483f7b
.long 0x3ec4bf6d,0x3ef1bf62,0x3f0ebf55,0x3f22bf46,0xbf6dbec4,0xbf62bef1,0xbf55bf0e,0xbf46bf22
.long 0x3f80,0xbf800000,0xbf80,0x3f800000,0x3f808000,0x3f80,0xbf808000,0xbf80
.long 0xbf35bf35,0x3f22bf46,0x3f553f0e,0xbef13f62,0xbf353f35,0xbf46bf22,0x3f0ebf55,0x3f623ef1
.long 0x3f80,0xbf353f35,0xbf800000,0xbf35bf35,0x3f808000,0x3f353f35,0x3f80,0xbf353f35
.long 0xbf35bf35,0xbdc9bf7f,0x3f0ebf55,0x3f75be95,0xbf353f35,0xbf7f3dc9,0xbf55bf0e,0xbe95bf75
.long 0x3f800000,0x3e483f7b,0xbf6d3ec4,0xbf0ebf55,0xbf80,0x3f7bbe48,0x3ec43f6d,0xbf553f0e
.long 0xbf353f35,0xbf62bef1,0x3e48bf7b,0x3f7fbdc9,0x3f353f35,0xbef13f62,0xbf7bbe48,0xbdc9bf7f
.long 0x3f800000,0x3f553f0e,0x3ec43f6d,0xbe483f7b,0xbf80,0x3f0ebf55,0x3f6dbec4,0x3f7b3e48
.long 0xbf353f35,0xbf753e95,0xbf7bbe48,0xbf46bf22,0x3f353f35,0x3e953f75,0xbe483f7b,0xbf223f46
.long 0xbf80,0x3f6dbec4,0x3f353f35,0xbec43f6d,0xbf808000,0xbec4bf6d,0x3f35bf35,0x3f6d3ec4
.long 0x3f353f35,0xbe953f75,0xbf7b3e48,0xbf22bf46,0x3f35bf35,0x3f753e95,0x3e483f7b,0xbf463f22
.long 0xbf80,0x3ec4bf6d,0x3f35bf35,0x3f6dbec4,0xbf808000,0xbf6dbec4,0xbf35bf35,0xbec4bf6d
.long 0x3f353f35,0x3ef13f62,0x3e483f7b,0xbdc93f7f,0x3f35bf35,0x3f62bef1,0x3f7bbe48,0x3f7f3dc9
.long 0xbf800000,0xbf0ebf55,0x3ec4bf6d,0x3f7bbe48,0x3f80,0xbf553f0e,0xbf6dbec4,0xbe48bf7b
.long 0x3f35bf35,0x3f7f3dc9,0x3f0e3f55,0xbe953f75,0xbf35bf35,0x3dc9bf7f,0x3f55bf0e,0x3f753e95
.long 0xbf800000,0xbf7bbe48,0xbf6dbec4,0xbf55bf0e,0x3f80,0xbe483f7b,0xbec43f6d,0xbf0e3f55
.long 0x3f35bf35,0x3f46bf22,0x3f55bf0e,0x3f62bef1,0xbf35bf35,0xbf22bf46,0xbf0ebf55,0xbef1bf62
.long 0x3f80,0xbf800000,0xbf80,0x3f800000,0x3f808000,0x3f80,0xbf808000,0xbf80
.long 0xbf6dbec4,0x3e95bf75,0x3f7b3e48,0xbdc93f7f,0xbec43f6d,0xbf75be95,0x3e48bf7b,0x3f7f3dc9
.long 0xbf80,0x3f35bf35,0x3f800000,0x3f353f35,0xbf808000,0xbf35bf35,0xbf80,0x3f35bf35
.long 0x3f6d3ec4,0x3ef13f62,0xbe483f7b,0xbf463f22,0x3ec4bf6d,0x3f62bef1,0x3f7b3e48,0x3f223f46
.long 0x3f35bf35,0x3f553f0e,0xbec43f6d,0xbf7bbe48,0xbf35bf35,0x3f0ebf55,0x3f6d3ec4,0xbe483f7b
.long 0x3ec43f6d,0xbf463f22,0xbf55bf0e,0x3e95bf75,0x3f6dbec4,0x3f223f46,0xbf0e3f55,0xbf75be95
.long 0xbf353f35,0xbf7b3e48,0xbf6dbec4,0xbf0ebf55,0x3f353f35,0x3e483f7b,0xbec43f6d,0xbf553f0e
.long 0xbec4bf6d,0x3dc9bf7f,0x3f0ebf55,0x3f62bef1,0xbf6d3ec4,0xbf7fbdc9,0xbf55bf0e,0xbef1bf62
.long 0xbf800000,0xbec4bf6d,0x3f35bf35,0x3f6d3ec4,0x3f80,0xbf6d3ec4,0xbf35bf35,0x3ec4bf6d
.long 0x3ec4bf6d,0x3f7fbdc9,0x3f0e3f55,0xbef13f62,0xbf6dbec4,0xbdc9bf7f,0x3f55bf0e,0x3f623ef1
.long 0x3f800000,0x3f6d3ec4,0x3f353f35,0x3ec43f6d,0xbf80,0x3ec4bf6d,0x3f35bf35,0x3f6dbec4
.long 0xbec43f6d,0xbf223f46,0xbf553f0e,0xbf753e95,0x3f6d3ec4,0x3f463f22,0x3f0e3f55,0x3e953f75
.long 0x3f353f35,0xbe483f7b,0xbf6d3ec4,0xbf55bf0e,0x3f35bf35,0x3f7b3e48,0x3ec43f6d,0xbf0e3f55
.long 0xbf6d3ec4,0xbf62bef1,0xbe48bf7b,0x3f22bf46,0x3ec43f6d,0xbef13f62,0xbf7b3e48,0xbf46bf22
.long 0xbf35bf35,0xbf0ebf55,0xbec4bf6d,0xbe48bf7b,0xbf353f35,0xbf553f0e,0xbf6d3ec4,0xbf7b3e48
.long 0x3f6dbec4,0x3f75be95,0x3f7bbe48,0x3f7fbdc9,0xbec4bf6d,0xbe95bf75,0xbe48bf7b,0xbdc9bf7f
.long 0x3f80,0xbf800000,0xbf80,0x3f800000,0x3f808000,0x3f80,0xbf808000,0xbf80
.long 0xbf800000,0xbdc9bf7f,0x3f7bbe48,0x3e953f75,0x3f80,0xbf7f3dc9,0xbe48bf7b,0x3f75be95
.long 0x3f80,0xbf353f35,0xbf800000,0xbf35bf35,0x3f808000,0x3f353f35,0x3f80,0xbf353f35
.long 0xbf800000,0xbf46bf22,0xbe48bf7b,0x3ef1bf62,0x3f80,0xbf223f46,0xbf7b3e48,0xbf62bef1
.long 0xbf80,0x3f7bbe48,0x3ec43f6d,0xbf553f0e,0xbf808000,0xbe48bf7b,0x3f6dbec4,0x3f0e3f55
.long 0x3f800000,0x3e953f75,0xbf553f0e,0xbf46bf22,0xbf80,0x3f75be95,0x3f0e3f55,0xbf223f46
.long 0xbf80,0x3f0ebf55,0x3f6dbec4,0x3f7b3e48,0xbf808000,0xbf55bf0e,0xbec4bf6d,0x3e48bf7b
.long 0x3f800000,0x3f623ef1,0x3f0e3f55,0x3dc93f7f,0xbf80,0x3ef1bf62,0x3f55bf0e,0x3f7fbdc9
.long 0x3f80,0xbf6d3ec4,0xbf35bf35,0x3ec4bf6d,0x3f808000,0x3ec43f6d,0xbf353f35,0xbf6dbec4
.long 0xbf800000,0xbef1bf62,0x3f0ebf55,0x3f7f3dc9,0x3f80,0xbf623ef1,0xbf55bf0e,0x3dc9bf7f
.long 0x3f80,0xbec43f6d,0xbf353f35,0xbf6d3ec4,0x3f808000,0x3f6d3ec4,0x3f353f35,0x3ec43f6d
.long 0xbf800000,0xbf75be95,0xbf55bf0e,0xbf22bf46,0x3f80,0xbe953f75,0xbf0e3f55,0xbf463f22
.long 0xbf80,0x3f55bf0e,0x3f6d3ec4,0x3e483f7b,0xbf808000,0xbf0ebf55,0x3ec4bf6d,0x3f7bbe48
.long 0x3f800000,0x3f223f46,0xbe483f7b,0xbf623ef1,0xbf80,0x3f46bf22,0x3f7b3e48,0x3ef13f62
.long 0xbf80,0x3e48bf7b,0x3ec4bf6d,0x3f0ebf55,0xbf808000,0xbf7bbe48,0xbf6dbec4,0xbf55bf0e
.long 0x3f800000,0x3f7f3dc9,0x3f7b3e48,0x3f753e95,0xbf80,0x3dc9bf7f,0x3e48bf7b,0x3e95bf75
.long 0x3f80,0xbf800000,0xbf80,0x3f800000,0x3f808000,0x3f80,0xbf808000,0xbf80
.long 0xbf6d3ec4,0xbef1bf62,0x3f55bf0e,0x3f223f46,0x3ec43f6d,0xbf623ef1,0xbf0ebf55,0x3f46bf22
.long 0xbf80,0x3f35bf35,0x3f800000,0x3f353f35,0xbf808000,0xbf35bf35,0xbf80,0x3f35bf35
.long 0x3f6dbec4,0x3f753e95,0x3f0e3f55,0xbdc93f7f,0xbec4bf6d,0x3e95bf75,0x3f55bf0e,0x3f7f3dc9
.long 0xbf35bf35,0x3f0ebf55,0x3f6d3ec4,0xbe483f7b,0xbf353f35,0xbf55bf0e,0x3ec4bf6d,0x3f7b3e48
.long 0x3ec4bf6d,0x3f7f3dc9,0x3e483f7b,0xbf623ef1,0xbf6dbec4,0x3dc9bf7f,0x3f7bbe48,0x3ef13f62
.long 0x3f353f35,0x3e483f7b,0xbec43f6d,0xbf553f0e,0x3f35bf35,0x3f7bbe48,0x3f6d3ec4,0x3f0e3f55
.long 0xbec43f6d,0xbf463f22,0xbf7b3e48,0xbf75be95,0x3f6d3ec4,0x3f223f46,0x3e483f7b,0xbe953f75
.long 0x3f800000,0x3ec43f6d,0xbf353f35,0xbf6dbec4,0xbf80,0x3f6dbec4,0x3f353f35,0xbec43f6d
.long 0x3ec43f6d,0xbf223f46,0xbf7bbe48,0xbe95bf75,0x3f6dbec4,0x3f463f22,0xbe483f7b,0xbf753e95
.long 0xbf800000,0xbf6dbec4,0xbf35bf35,0xbec4bf6d,0x3f80,0xbec43f6d,0xbf353f35,0xbf6d3ec4
.long 0xbec4bf6d,0xbdc9bf7f,0x3e48bf7b,0x3ef1bf62,0xbf6d3ec4,0xbf7f3dc9,0xbf7bbe48,0xbf62bef1
.long 0xbf353f35,0xbf7bbe48,0xbec4bf6d,0x3f0ebf55,0x3f353f35,0xbe483f7b,0xbf6d3ec4,0xbf55bf0e
.long 0xbf6dbec4,0xbe95bf75,0x3f0ebf55,0x3f7fbdc9,0xbec43f6d,0xbf753e95,0xbf55bf0e,0xbdc9bf7f
.long 0x3f35bf35,0x3f55bf0e,0x3f6dbec4,0x3f7bbe48,0xbf35bf35,0xbf0ebf55,0xbec4bf6d,0xbe48bf7b
.long 0x3f6d3ec4,0x3f623ef1,0x3f553f0e,0x3f463f22,0x3ec4bf6d,0x3ef1bf62,0x3f0ebf55,0x3f22bf46
.long 0x3f80,0xbf800000,0xbf80,0x3f800000,0x3f808000,0x3f80,0xbf808000,0xbf80
.long 0xbf353f35,0xbf46bf22,0x3f0ebf55,0x3f623ef1,0x3f353f35,0xbf223f46,0xbf55bf0e,0x3ef1bf62
.long 0x3f80,0xbf353f35,0xbf800000,0xbf35bf35,0x3f808000,0x3f353f35,0x3f80,0xbf353f35
.long 0xbf353f35,0xbf7f3dc9,0xbf55bf0e,0xbe95bf75,0x3f353f35,0x3dc93f7f,0xbf0e3f55,0xbf753e95
.long 0xbf800000,0xbe48bf7b,0x3f6dbec4,0x3f0e3f55,0x3f80,0xbf7b3e48,0xbec4bf6d,0x3f55bf0e
.long 0xbf35bf35,0x3ef1bf62,0x3f7b3e48,0x3dc93f7f,0xbf353f35,0xbf62bef1,0x3e48bf7b,0x3f7fbdc9
.long 0xbf800000,0xbf55bf0e,0xbec4bf6d,0x3e48bf7b,0x3f80,0xbf0e3f55,0xbf6d3ec4,0xbf7bbe48
.long 0xbf35bf35,0xbe95bf75,0x3e48bf7b,0x3f22bf46,0xbf353f35,0xbf753e95,0xbf7bbe48,0xbf46bf22
.long 0xbf80,0x3f6dbec4,0x3f353f35,0xbec43f6d,0xbf808000,0xbec4bf6d,0x3f35bf35,0x3f6d3ec4
.long 0x3f35bf35,0x3f753e95,0x3e483f7b,0xbf463f22,0xbf35bf35,0x3e95bf75,0x3f7bbe48,0x3f223f46
.long 0xbf80,0x3ec4bf6d,0x3f35bf35,0x3f6dbec4,0xbf808000,0xbf6dbec4,0xbf35bf35,0xbec4bf6d
.long 0x3f35bf35,0x3f62bef1,0x3f7bbe48,0x3f7f3dc9,0xbf35bf35,0xbef1bf62,0xbe48bf7b,0x3dc9bf7f
.long 0x3f800000,0x3f0e3f55,0xbec43f6d,0xbf7b3e48,0xbf80,0x3f55bf0e,0x3f6d3ec4,0x3e483f7b
.long 0x3f353f35,0xbdc93f7f,0xbf553f0e,0xbf75be95,0x3f35bf35,0x3f7f3dc9,0x3f0e3f55,0xbe953f75
.long 0x3f800000,0x3f7b3e48,0x3f6d3ec4,0x3f553f0e,0xbf80,0x3e48bf7b,0x3ec4bf6d,0x3f0ebf55
.long 0x3f353f35,0x3f223f46,0x3f0e3f55,0x3ef13f62,0x3f35bf35,0x3f46bf22,0x3f55bf0e,0x3f62bef1
.long 0x3f80,0xbf800000,0xbf80,0x3f800000,0x3f808000,0x3f80,0xbf808000,0xbf80
.long 0xbec43f6d,0xbf75be95,0x3e48bf7b,0x3f7f3dc9,0x3f6d3ec4,0xbe953f75,0xbf7bbe48,0x3dc9bf7f
.long 0xbf80,0x3f35bf35,0x3f800000,0x3f353f35,0xbf808000,0xbf35bf35,0xbf80,0x3f35bf35
.long 0x3ec4bf6d,0x3f62bef1,0x3f7b3e48,0x3f223f46,0xbf6dbec4,0xbef1bf62,0x3e48bf7b,0x3f46bf22
.long 0xbf353f35,0xbf55bf0e,0x3ec4bf6d,0x3f7b3e48,0x3f353f35,0xbf0e3f55,0xbf6dbec4,0x3e48bf7b
.long 0xbf6d3ec4,0xbf22bf46,0x3f0ebf55,0x3f753e95,0x3ec43f6d,0xbf463f22,0xbf55bf0e,0x3e95bf75
.long 0x3f35bf35,0x3f7bbe48,0x3f6d3ec4,0x3f0e3f55,0xbf35bf35,0xbe48bf7b,0x3ec4bf6d,0x3f55bf0e
.long 0x3f6dbec4,0x3f7f3dc9,0x3f553f0e,0x3ef13f62,0xbec4bf6d,0x3dc9bf7f,0x3f0ebf55,0x3f62bef1
.long 0xbf800000,0xbec4bf6d,0x3f35bf35,0x3f6d3ec4,0x3f80,0xbf6d3ec4,0xbf35bf35,0x3ec4bf6d
.long 0xbf6dbec4,0xbdc9bf7f,0x3f55bf0e,0x3f623ef1,0xbec43f6d,0xbf7f3dc9,0xbf0ebf55,0x3ef1bf62
.long 0x3f800000,0x3f6d3ec4,0x3f353f35,0x3ec43f6d,0xbf80,0x3ec4bf6d,0x3f35bf35,0x3f6dbec4
.long 0x3f6d3ec4,0x3f463f22,0x3f0e3f55,0x3e953f75,0x3ec4bf6d,0x3f22bf46,0x3f55bf0e,0x3f75be95
.long 0xbf35bf35,0x3e48bf7b,0x3f6dbec4,0x3f553f0e,0xbf353f35,0xbf7bbe48,0xbec4bf6d,0x3f0ebf55
.long 0xbec4bf6d,0x3ef1bf62,0x3f7bbe48,0x3f463f22,0xbf6d3ec4,0xbf62bef1,0xbe48bf7b,0x3f22bf46
.long 0x3f353f35,0x3f0e3f55,0x3ec43f6d,0x3e483f7b,0x3f35bf35,0x3f55bf0e,0x3f6dbec4,0x3f7bbe48
.long 0x3ec43f6d,0x3e953f75,0x3e483f7b,0x3dc93f7f,0x3f6dbec4,0x3f75be95,0x3f7bbe48,0x3f7fbdc9
.long 0x3f800000,0x80000000,0x3f800000,0x80000000,0x3f800000,0x80000000,0x3f7fffb1,0xbb490fc6
.long 0x3f800000,0x80000000,0x3f7ffec4,0xbbc90f88,0x3f800000,0x80000000,0x3f7ffd39,0xbc16cb58
.long 0x3f800000,0x80000000,0x3f7ffb11,0xbc490e90,0x3f800000,0x80000000,0x3f7ff84a,0xbc7b514b
.long 0x3f800000,0x80000000,0x3f7ff4e6,0xbc96c9b6,0x3f800000,0x80000000,0x3f7ff0e3,0xbcafea69
.long 0x3f800000,0x80000000,0x3f7fec43,0xbcc90ab0,0x3f800000,0x80000000,0x3f7fe705,0xbce22a7a
.long 0x3f800000,0x80000000,0x3f7fe129,0xbcfb49ba,0x3f800000,0x80000000,0x3f7fdaaf,0xbd0a342f
.long 0x3f800000,0x80000000,0x3f7fd397,0xbd16c32c,0x3f800000,0x80000000,0x3f7fcbe2,0xbd2351cb
.long 0x3f800000,0x80000000,0x3f7fc38f,0xbd2fe007,0x3f800000,0x80000000,0x3f7fba9e,0xbd3c6dd5
.long 0x3f800000,0x80000000,0x3f7fb10f,0xbd48fb30,0x3f800000,0x80000000,0x3f7fa6e3,0xbd55880e
.long 0x3f800000,0x80000000,0x3f7f9c18,0xbd621469,0x3f800000,0x80000000,0x3f7f90b1,0xbd6ea038
.long 0x3f800000,0x80000000,0x3f7f84ab,0xbd7b2b74,0x3f800000,0x80000000,0x3f7f7808,0xbd83db0a
.long 0x3f800000,0x80000000,0x3f7f6ac7,0xbd8a200a,0x3f800000,0x80000000,0x3f7f5ce9,0xbd9064b4
.long 0x3f800000,0x80000000,0x3f7f4e6d,0xbd96a905,0x3f800000,0x80000000,0x3f7f3f54,0xbd9cecf9
.long 0x3f800000,0x80000000,0x3f7f2f9d,0xbda3308c,0x3f800000,0x80000000,0x3f7f1f49,0xbda973ba
.long 0x3f800000,0x80000000,0x3f7f0e58,0xbdafb680,0x3f800000,0x80000000,0x3f7efcc9,0xbdb5f8da
.long 0x3f800000,0x80000000,0x3f7eea9d,0xbdbc3ac3,0x3f800000,0x80000000,0x3f7ed7d4,0xbdc27c39
.long 0x3f800000,0x80000000,0x3f800000,0x80000000,0x3f7fec43,0xbcc90ab0,0x3f7fe705,0xbce22a7a
.long 0x3f7fb10f,0xbd48fb30,0x3f7f9c18,0xbd621469,0x3f7f4e6d,0xbd96a905,0x3f7f1f49,0xbda973ba
.long 0x3f7ec46d,0xbdc8bd36,0x3f7e70b0,0xbde1bc2e,0x3f7e1324,0xbdfab273,0x3f7d906e,0xbe0cec4a
.long 0x3f7d3aac,0xbe164083,0x3f7c7eb0,0xbe28defc,0x3f7c3b28,0xbe2f10a2,0x3f7b3bab,0xbe44b0b9
.long 0x3f7b14be,0xbe47c5c2,0x3f79c79d,0xbe605c13,0x3f79c79d,0xbe605c13,0x3f7822d1,0xbe7bdba4
.long 0x3f7853f8,0xbe78cfcc,0x3f764d97,0xbe8b9507,0x3f76ba07,0xbe888e93,0x3f74484b,0xbe9920fe
.long 0x3f74fa0b,0xbe94a031,0x3f721352,0xbea68f12,0x3f731447,0xbea09ae5,0x3f6faf1b,0xbeb3dca5
.long 0x3f710908,0xbeac7cd4,0x3f6d1c1d,0xbec1071e,0x3f6ed89e,0xbeb8442a,0x3f6a5ad9,0xbece0bea
.long 0x3f6c835e,0xbec3ef15,0x3f676bd8,0xbedae880,0x3f6a09a7,0xbecf7bca,0x3f644fac,0xbee79a5d
.long 0x3f676bd8,0xbedae880,0x3f6106f2,0xbef41f07,0x3f64aa59,0xbee63375,0x3f5d924d,0xbf003a06
.long 0x3f61c598,0xbef15aea,0x3f59f26a,0xbf064b82,0x3f5ebe05,0xbefc5d27,0x3f5627fe,0xbf0c42c9
.long 0x3f5b941a,0xbf039c3d,0x3f5233c6,0xbf121eb0,0x3f584853,0xbf08f59b,0x3f4e1689,0xbf17de12
.long 0x3f54db31,0xbf0e39da,0x3f49d112,0xbf1d7fd1,0x3f514d3d,0xbf13682a,0x3f456439,0xbf2302d3
.long 0x3f4d9f02,0xbf187fc0,0x3f40d0da,0xbf286605,0x3f49d112,0xbf1d7fd1,0x3f3c17d9,0xbf2da859
.long 0x3f45e403,0xbf226799,0x3f373a23,0xbf32c8c9,0x3f41d870,0xbf273656,0x3f3238aa,0xbf37c655
.long 0x3f3daef9,0xbf2beb4a,0x3f2d1469,0xbf3ca003,0x3f396842,0xbf3085bb,0x3f27ce61,0xbf4154e1
.long 0x3f800000,0x80000000,0x3f800000,0x80000000,0x3f7ffec4,0xbbc90f88,0x3f7ffd39,0xbc16cb58
.long 0x3f7ffb11,0xbc490e90,0x3f7ff4e6,0xbc96c9b6,0x3f7ff4e6,0xbc96c9b6,0x3f7fe705,0xbce22a7a
.long 0x3f7fec43,0xbcc90ab0,0x3f7fd397,0xbd16c32c,0x3f7fe129,0xbcfb49ba,0x3f7fba9e,0xbd3c6dd5
.long 0x3f7fd397,0xbd16c32c,0x3f7f9c18,0xbd621469,0x3f7fc38f,0xbd2fe007,0x3f7f7808,0xbd83db0a
.long 0x3f7fb10f,0xbd48fb30,0x3f7f4e6d,0xbd96a905,0x3f7f9c18,0xbd621469,0x3f7f1f49,0xbda973ba
.long 0x3f7f84ab,0xbd7b2b74,0x3f7eea9d,0xbdbc3ac3,0x3f7f6ac7,0xbd8a200a,0x3f7eb069,0xbdcefdb7
.long 0x3f7f4e6d,0xbd96a905,0x3f7e70b0,0xbde1bc2e,0x3f7f2f9d,0xbda3308c,0x3f7e2b72,0xbdf475c0
.long 0x3f7f0e58,0xbdafb680,0x3f7de0b1,0xbe039502,0x3f7eea9d,0xbdbc3ac3,0x3f7d906e,0xbe0cec4a
.long 0x3f7ec46d,0xbdc8bd36,0x3f7d3aac,0xbe164083,0x3f7e9bc9,0xbdd53db9,0x3f7cdf6c,0xbe1f917b
.long 0x3f7e70b0,0xbde1bc2e,0x3f7c7eb0,0xbe28defc,0x3f7e4323,0xbdee3876,0x3f7c187a,0xbe3228d4
.long 0x3f7e1324,0xbdfab273,0x3f7baccd,0xbe3b6ecf,0x3f7de0b1,0xbe039502,0x3f7b3bab,0xbe44b0b9
.long 0x3f7dabcc,0xbe09cf86,0x3f7ac516,0xbe4dee60,0x3f7d7474,0xbe1008b7,0x3f7a4910,0xbe57278f
.long 0x3f7d3aac,0xbe164083,0x3f79c79d,0xbe605c13,0x3f7cfe73,0xbe1c76de,0x3f7940c0,0xbe698bba
.long 0x3f7cbfc9,0xbe22abb6,0x3f78b47b,0xbe72b651,0x3f7c7eb0,0xbe28defc,0x3f7822d1,0xbe7bdba4
.long 0x3f7c3b28,0xbe2f10a2,0x3f778bc5,0xbe827dc0,0x3f7bf531,0xbe354098,0x3f76ef5b,0xbe870ada
.long 0x3f7baccd,0xbe3b6ecf,0x3f764d97,0xbe8b9507,0x3f7b61fc,0xbe419b37,0x3f75a67b,0xbe901c2c
.long 0x3f800000,0x80000000,0x3f800000,0x80000000,0x3f7fe129,0xbcfb49ba,0x3f7fdaaf,0xbd0a342f
.long 0x3f7f84ab,0xbd7b2b74,0x3f7f6ac7,0xbd8a200a,0x3f7eea9d,0xbdbc3ac3,0x3f7eb069,0xbdcefdb7
.long 0x3f7e1324,0xbdfab273,0x3f7dabcc,0xbe09cf86,0x3f7cfe73,0xbe1c76de,0x3f7c5d3a,0xbe2bf804
.long 0x3f7baccd,0xbe3b6ecf,0x3f7ac516,0xbe4dee60,0x3f7a1e84,0xbe5a3997,0x3f78e3d6,0xbe6fa8b2
.long 0x3f7853f8,0xbe78cfcc,0x3f76ba07,0xbe888e93,0x3f764d97,0xbe8b9507,0x3f74484b,0xbe9920fe
.long 0x3f740bdd,0xbe9aa086,0x3f718f57,0xbea986c4,0x3f718f57,0xbea986c4,0x3f6e8ff8,0xbeb9bb1e
.long 0x3f6ed89e,0xbeb8442a,0x3f6b4b0c,0xbec9b953,0x3f6be858,0xbec6d529,0x3f67c187,0xbed97cb9
.long 0x3f68bf3c,0xbed53641,0x3f63f473,0xbee900b7,0x3f655e0b,0xbee363fa,0x3f5fe4e9,0xbef840c8
.long 0x3f61c598,0xbef15aea,0x3f5b941a,0xbf039c3d,0x3f5df6be,0xbeff17b2,0x3f570348,0xbf0af1b7
.long 0x3f59f26a,0xbf064b82,0x3f5233c6,0xbf121eb0,0x3f55b993,0xbf0cead0,0x3f4d26fd,0xbf19210f
.long 0x3f514d3d,0xbf13682a,0x3f47de65,0xbf1ff6cb,0x3f4cae79,0xbf19c200,0x3f425b89,0xbf269de3
.long 0x3f47de65,0xbf1ff6cb,0x3f3ca003,0xbf2d1469,0x3f42de29,0xbf26050a,0x3f36ad7f,0xbf33587a
.long 0x3f3daef9,0xbf2beb4a,0x3f3085bb,0xbf396842,0x3f385216,0xbf31a81d,0x3f2a2a80,0xbf3f41fc
.long 0x3f32c8c9,0xbf373a23,0x3f239da9,0xbf44e3f5,0x3f2d1469,0xbf3ca003,0x3f1ce11f,0xbf4a4c87
.long 0x3f273656,0xbf41d870,0x3f15f6d9,0xbf4f7a1f,0x3f212ff9,0xbf46e22a,0x3f0ee0db,0xbf546b3b
.long 0x3f1b02c6,0xbf4bbbf8,0x3f07a136,0xbf591e6a,0x3f14b039,0xbf5064af,0x3f003a06,0xbf5d924d
.long 0x3f800000,0x80000000,0x3f800000,0x80000000,0x3f7ffb11,0xbc490e90,0x3f7ff84a,0xbc7b514b
.long 0x3f7fec43,0xbcc90ab0,0x3f7fe129,0xbcfb49ba,0x3f7fd397,0xbd16c32c,0x3f7fba9e,0xbd3c6dd5
.long 0x3f7fb10f,0xbd48fb30,0x3f7f84ab,0xbd7b2b74,0x3f7f84ab,0xbd7b2b74,0x3f7f3f54,0xbd9cecf9
.long 0x3f7f4e6d,0xbd96a905,0x3f7eea9d,0xbdbc3ac3,0x3f7f0e58,0xbdafb680,0x3f7e868b,0xbddb7d37
.long 0x3f7ec46d,0xbdc8bd36,0x3f7e1324,0xbdfab273,0x3f7e70b0,0xbde1bc2e,0x3f7d906e,0xbe0cec4a
.long 0x3f7e1324,0xbdfab273,0x3f7cfe73,0xbe1c76de,0x3f7dabcc,0xbe09cf86,0x3f7c5d3a,0xbe2bf804
.long 0x3f7d3aac,0xbe164083,0x3f7baccd,0xbe3b6ecf,0x3f7cbfc9,0xbe22abb6,0x3f7aed37,0xbe4ada4f
.long 0x3f7c3b28,0xbe2f10a2,0x3f7a1e84,0xbe5a3997,0x3f7baccd,0xbe3b6ecf,0x3f7940c0,0xbe698bba
.long 0x3f7b14be,0xbe47c5c2,0x3f7853f8,0xbe78cfcc,0x3f7a7302,0xbe541501,0x3f77583a,0xbe840270
.long 0x3f79c79d,0xbe605c13,0x3f764d97,0xbe8b9507,0x3f791298,0xbe6c9a7f,0x3f75341d,0xbe931f35
.long 0x3f7853f8,0xbe78cfcc,0x3f740bdd,0xbe9aa086,0x3f778bc5,0xbe827dc0,0x3f72d4eb,0xbea21887
.long 0x3f76ba07,0xbe888e93,0x3f718f57,0xbea986c4,0x3f75dec6,0xbe8e9a22,0x3f703b37,0xbeb0eacb
.long 0x3f74fa0b,0xbe94a031,0x3f6ed89e,0xbeb8442a,0x3f740bdd,0xbe9aa086,0x3f6d67a1,0xbebf926f
.long 0x3f731447,0xbea09ae5,0x3f6be858,0xbec6d529,0x3f721352,0xbea68f12,0x3f6a5ad9,0xbece0bea
.long 0x3f710908,0xbeac7cd4,0x3f68bf3c,0xbed53641,0x3f6ff573,0xbeb263ef,0x3f671599,0xbedc53c1
.long 0x3f6ed89e,0xbeb8442a,0x3f655e0b,0xbee363fa,0x3f6db293,0xbebe1d4a,0x3f6398ac,0xbeea6681
.long 0x3f800000,0x80000000,0x3f800000,0x80000000,0x3f7fd397,0xbd16c32c,0x3f7fcbe2,0xbd2351cb
.long 0x3f7f4e6d,0xbd96a905,0x3f7f2f9d,0xbda3308c,0x3f7e70b0,0xbde1bc2e,0x3f7e2b72,0xbdf475c0
.long 0x3f7d3aac,0xbe164083,0x3f7cbfc9,0xbe22abb6,0x3f7baccd,0xbe3b6ecf,0x3f7aed37,0xbe4ada4f
.long 0x3f79c79d,0xbe605c13,0x3f78b47b,0xbe72b651,0x3f778bc5,0xbe827dc0,0x3f76167a,0xbe8d17c0
.long 0x3f74fa0b,0xbe94a031,0x3f731447,0xbea09ae5,0x3f721352,0xbea68f12,0x3f6faf1b,0xbeb3dca5
.long 0x3f6ed89e,0xbeb8442a,0x3f6be858,0xbec6d529,0x3f6b4b0c,0xbec9b953,0x3f67c187,0xbed97cb9
.long 0x3f676bd8,0xbedae880,0x3f633c5a,0xbeebcbbb,0x3f633c5a,0xbeebcbbb,0x3f5e5aa6,0xbefdbabb
.long 0x3f5ebe05,0xbefc5d27,0x3f591e6a,0xbf07a136,0x3f59f26a,0xbf064b82,0x3f5389c7,0xbf102dd5
.long 0x3f54db31,0xbf0e39da,0x3f4d9f02,0xbf187fc0,0x3f4f7a1f,0xbf15f6d9,0x3f476085,0xbf209393
.long 0x3f49d112,0xbf1d7fd1,0x3f40d0da,0xbf286605,0x3f43e200,0xbf24d225,0x3f39f2ac,0xbf2ff3e6
.long 0x3f3daef9,0xbf2beb4a,0x3f32c8c9,0xbf373a23,0x3f373a23,0xbf32c8c9,0x3f2b561b,0xbf3e35c5
.long 0x3f3085bb,0xbf396842,0x3f239da9,0xbf44e3f5,0x3f299415,0xbf3fc767,0x3f1ba299,0xbf4b41fa
.long 0x3f226799,0xbf45e403,0x3f13682a,0xbf514d3d,0x3f1b02c6,0xbf4bbbf8,0x3f0af1b7,0xbf570348
.long 0x3f13682a,0xbf514d3d,0x3f0242b1,0xbf5c61c7,0x3f0b9a6b,0xbf5695e5,0x3ef2bd43,0xbf61668a
.long 0x3f039c3d,0xbf5b941a,0x3ee0924f,0xbf660f88,0x3ef6e0cb,0xbf604621,0x3ece0bea,0xbf6a5ad9
.long 0x3ee63375,0xbf64aa59,0x3ebb31a0,0xbf6e46be,0x3ed53641,0xbf68bf3c,0x3ea80b1f,0xbf71d19f
.long 0x3f800000,0x80000000,0x3f800000,0x80000000,0x3f7ff4e6,0xbc96c9b6,0x3f7ff0e3,0xbcafea69
.long 0x3f7fd397,0xbd16c32c,0x3f7fc38f,0xbd2fe007,0x3f7f9c18,0xbd621469,0x3f7f7808,0xbd83db0a
.long 0x3f7f4e6d,0xbd96a905,0x3f7f0e58,0xbdafb680,0x3f7eea9d,0xbdbc3ac3,0x3f7e868b,0xbddb7d37
.long 0x3f7e70b0,0xbde1bc2e,0x3f7de0b1,0xbe039502,0x3f7de0b1,0xbe039502,0x3f7d1cdd,0xbe195be0
.long 0x3f7d3aac,0xbe164083,0x3f7c3b28,0xbe2f10a2,0x3f7c7eb0,0xbe28defc,0x3f7b3bab,0xbe44b0b9
.long 0x3f7baccd,0xbe3b6ecf,0x3f7a1e84,0xbe5a3997,0x3f7ac516,0xbe4dee60,0x3f78e3d6,0xbe6fa8b2
.long 0x3f79c79d,0xbe605c13,0x3f778bc5,0xbe827dc0,0x3f78b47b,0xbe72b651,0x3f76167a,0xbe8d17c0
.long 0x3f778bc5,0xbe827dc0,0x3f748422,0xbe97a117,0x3f764d97,0xbe8b9507,0x3f72d4eb,0xbea21887
.long 0x3f74fa0b,0xbe94a031,0x3f710908,0xbeac7cd4,0x3f73913f,0xbe9d9e78,0x3f6f20b0,0xbeb6ccc3
.long 0x3f721352,0xbea68f12,0x3f6d1c1d,0xbec1071e,0x3f708066,0xbeaf713a,0x3f6afb8c,0xbecb2aae
.long 0x3f6ed89e,0xbeb8442a,0x3f68bf3c,0xbed53641,0x3f6d1c1d,0xbec1071e,0x3f666771,0xbedf28a9
.long 0x3f6b4b0c,0xbec9b953,0x3f63f473,0xbee900b7,0x3f696591,0xbed25a09,0x3f61668a,0xbef2bd43
.long 0x3f676bd8,0xbedae880,0x3f5ebe05,0xbefc5d27,0x3f655e0b,0xbee363fa,0x3f5bfb34,0xbf02ef9f
.long 0x3f633c5a,0xbeebcbbb,0x3f591e6a,0xbf07a136,0x3f6106f2,0xbef41f07,0x3f5627fe,0xbf0c42c9
.long 0x3f5ebe05,0xbefc5d27,0x3f531849,0xbf10d3cd,0x3f5c61c7,0xbf0242b1,0x3f4fefa8,0xbf1553b7
.long 0x3f59f26a,0xbf064b82,0x3f4cae79,0xbf19c200,0x3f577026,0xbf0a48ad,0x3f495521,0xbf1e1e22
.long 0x3f800000,0x80000000,0x3f800000,0x80000000,0x3f7fc38f,0xbd2fe007,0x3f7fba9e,0xbd3c6dd5
.long 0x3f7f0e58,0xbdafb680,0x3f7eea9d,0xbdbc3ac3,0x3f7de0b1,0xbe039502,0x3f7d906e,0xbe0cec4a
.long 0x3f7c3b28,0xbe2f10a2,0x3f7baccd,0xbe3b6ecf,0x3f7a1e84,0xbe5a3997,0x3f7940c0,0xbe698bba
.long 0x3f778bc5,0xbe827dc0,0x3f764d97,0xbe8b9507,0x3f748422,0xbe97a117,0x3f72d4eb,0xbea21887
.long 0x3f710908,0xbeac7cd4,0x3f6ed89e,0xbeb8442a,0x3f6d1c1d,0xbec1071e,0x3f6a5ad9,0xbece0bea
.long 0x3f68bf3c,0xbed53641,0x3f655e0b,0xbee363fa,0x3f63f473,0xbee900b7,0x3f5fe4e9,0xbef840c8
.long 0x3f5ebe05,0xbefc5d27,0x3f59f26a,0xbf064b82,0x3f591e6a,0xbf07a136,0x3f5389c7,0xbf102dd5
.long 0x3f531849,0xbf10d3cd,0x3f4cae79,0xbf19c200,0x3f4cae79,0xbf19c200,0x3f456439,0xbf2302d3
.long 0x3f45e403,0xbf226799,0x3f3daef9,0xbf2beb4a,0x3f3ebc1b,0xbf2ac082,0x3f3592e7,0xbf34768f
.long 0x3f373a23,0xbf32c8c9,0x3f2d1469,0xbf3ca003,0x3f2f61a5,0xbf3a7ca4,0x3f24381a,0xbf446337
.long 0x3f273656,0xbf41d870,0x3f1b02c6,0xbf4bbbf8,0x3f1ebc12,0xbf48d8b3,0x3f11796b,0xbf52a649
.long 0x3f15f6d9,0xbf4f7a1f,0x3f07a136,0xbf591e6a,0x3f0cead0,0xbf55b993,0x3efafef7,0xbf5f20db
.long 0x3f039c3d,0xbf5b941a,0x3ee63375,0xbf64aa59,0x3ef41f07,0xbf6106f2,0x3ed0eb2a,0xbf69b7e4
.long 0x3ee0924f,0xbf660f88,0x3ebb31a0,0xbf6e46be,0x3ecc9b8b,0xbf6aab7b,0x3ea5129f,0xbf725470
.long 0x3eb8442a,0xbf6ed89e,0x3e8e9a22,0xbf75dec6,0x3ea395c5,0xbf7294f8,0x3e6fa8b2,0xbf78e3d6
.long 0x3e8e9a22,0xbf75dec6,0x3e419b37,0xbf7b61fc,0x3e72b651,0xbf78b47b,0x3e1324ca,0xbf7d57de
.long 0x3f800000,0x80000000,0x3f7ec46d,0xbdc8bd36,0x3f800000,0x80000000,0x3f7eb069,0xbdcefdb7
.long 0x3f800000,0x80000000,0x3f7e9bc9,0xbdd53db9,0x3f800000,0x80000000,0x3f7e868b,0xbddb7d37
.long 0x3f800000,0x80000000,0x3f7e70b0,0xbde1bc2e,0x3f800000,0x80000000,0x3f7e5a38,0xbde7fa9a
.long 0x3f800000,0x80000000,0x3f7e4323,0xbdee3876,0x3f800000,0x80000000,0x3f7e2b72,0xbdf475c0
.long 0x3f800000,0x80000000,0x3f7e1324,0xbdfab273,0x3f800000,0x80000000,0x3f7dfa38,0xbe007745
.long 0x3f800000,0x80000000,0x3f7de0b1,0xbe039502,0x3f800000,0x80000000,0x3f7dc68c,0xbe06b26e
.long 0x3f800000,0x80000000,0x3f7dabcc,0xbe09cf86,0x3f800000,0x80000000,0x3f7d906e,0xbe0cec4a
.long 0x3f800000,0x80000000,0x3f7d7474,0xbe1008b7,0x3f800000,0x80000000,0x3f7d57de,0xbe1324ca
.long 0x3f800000,0x80000000,0x3f7d3aac,0xbe164083,0x3f800000,0x80000000,0x3f7d1cdd,0xbe195be0
.long 0x3f800000,0x80000000,0x3f7cfe73,0xbe1c76de,0x3f800000,0x80000000,0x3f7cdf6c,0xbe1f917b
.long 0x3f800000,0x80000000,0x3f7cbfc9,0xbe22abb6,0x3f800000,0x80000000,0x3f7c9f8a,0xbe25c58c
.long 0x3f800000,0x80000000,0x3f7c7eb0,0xbe28defc,0x3f800000,0x80000000,0x3f7c5d3a,0xbe2bf804
.long 0x3f800000,0x80000000,0x3f7c3b28,0xbe2f10a2,0x3f800000,0x80000000,0x3f7c187a,0xbe3228d4
.long 0x3f800000,0x80000000,0x3f7bf531,0xbe354098,0x3f800000,0x80000000,0x3f7bd14d,0xbe3857ec
.long 0x3f800000,0x80000000,0x3f7baccd,0xbe3b6ecf,0x3f800000,0x80000000,0x3f7b87b2,0xbe3e853e
.long 0x3f800000,0x80000000,0x3f7b61fc,0xbe419b37,0x3f800000,0x80000000,0x3f7b3bab,0xbe44b0b9
.long 0x3f3504f3,0xbf3504f3,0x3f226799,0xbf45e403,0x3f3085bb,0xbf396842,0x3f1ce11f,0xbf4a4c87
.long 0x3f2beb4a,0xbf3daef9,0x3f173c07,0xbf4e8d90,0x3f273656,0xbf41d870,0x3f11796b,0xbf52a649
.long 0x3f226799,0xbf45e403,0x3f0b9a6b,0xbf5695e5,0x3f1d7fd1,0xbf49d112,0x3f05a02c,0xbf5a5ba0
.long 0x3f187fc0,0xbf4d9f02,0x3eff17b2,0xbf5df6be,0x3f13682a,0xbf514d3d,0x3ef2bd43,0xbf61668a
.long 0x3f0e39da,0xbf54db31,0x3ee63375,0xbf64aa59,0x3f08f59b,0xbf584853,0x3ed97cb9,0xbf67c187
.long 0x3f039c3d,0xbf5b941a,0x3ecc9b8b,0xbf6aab7b,0x3efc5d27,0xbf5ebe05,0x3ebf926f,0xbf6d67a1
.long 0x3ef15aea,0xbf61c598,0x3eb263ef,0xbf6ff573,0x3ee63375,0xbf64aa59,0x3ea5129f,0xbf725470
.long 0x3edae880,0xbf676bd8,0x3e97a117,0xbf748422,0x3ecf7bca,0xbf6a09a7,0x3e8a11f7,0xbf76841b
.long 0x3ec3ef15,0xbf6c835e,0x3e78cfcc,0xbf7853f8,0x3eb8442a,0xbf6ed89e,0x3e5d4b1a,0xbf79f35e
.long 0x3eac7cd4,0xbf710908,0x3e419b37,0xbf7b61fc,0x3ea09ae5,0xbf731447,0x3e25c58c,0xbf7c9f8a
.long 0x3e94a031,0xbf74fa0b,0x3e09cf86,0xbf7dabcc,0x3e888e93,0xbf76ba07,0x3ddb7d37,0xbf7e868b
.long 0x3e78cfcc,0xbf7853f8,0x3da3308c,0xbf7f2f9d,0x3e605c13,0xbf79c79d,0x3d55880e,0xbf7fa6e3
.long 0x3e47c5c2,0xbf7b14be,0x3cc90ab0,0xbf7fec43,0x3e2f10a2,0xbf7c3b28,0xbb490fc6,0xbf7fffb1
.long 0x3e164083,0xbf7d3aac,0xbcfb49ba,0xbf7fe129,0x3dfab273,0xbf7e1324,0xbd6ea038,0xbf7f90b1
.long 0x3dc8bd36,0xbf7ec46d,0xbdafb680,0xbf7f0e58,0x3d96a905,0xbf7f4e6d,0xbde7fa9a,0xbf7e5a38
.long 0x3d48fb30,0xbf7fb10f,0xbe1008b7,0xbf7d7474,0x3cc90ab0,0xbf7fec43,0xbe2bf804,0xbf7c5d3a
.long 0x3f7b14be,0xbe47c5c2,0x3f74fa0b,0xbe94a031,0x3f7ac516,0xbe4dee60,0x3f74484b,0xbe9920fe
.long 0x3f7a7302,0xbe541501,0x3f73913f,0xbe9d9e78,0x3f7a1e84,0xbe5a3997,0x3f72d4eb,0xbea21887
.long 0x3f79c79d,0xbe605c13,0x3f721352,0xbea68f12,0x3f796e4e,0xbe667c66,0x3f714c7a,0xbeab0201
.long 0x3f791298,0xbe6c9a7f,0x3f708066,0xbeaf713a,0x3f78b47b,0xbe72b651,0x3f6faf1b,0xbeb3dca5
.long 0x3f7853f8,0xbe78cfcc,0x3f6ed89e,0xbeb8442a,0x3f77f110,0xbe7ee6e1,0x3f6dfcf2,0xbebca7af
.long 0x3f778bc5,0xbe827dc0,0x3f6d1c1d,0xbec1071e,0x3f772417,0xbe8586ce,0x3f6c3624,0xbec5625c
.long 0x3f76ba07,0xbe888e93,0x3f6b4b0c,0xbec9b953,0x3f764d97,0xbe8b9507,0x3f6a5ad9,0xbece0bea
.long 0x3f75dec6,0xbe8e9a22,0x3f696591,0xbed25a09,0x3f756d97,0xbe919ddd,0x3f686b39,0xbed6a399
.long 0x3f74fa0b,0xbe94a031,0x3f676bd8,0xbedae880,0x3f748422,0xbe97a117,0x3f666771,0xbedf28a9
.long 0x3f740bdd,0xbe9aa086,0x3f655e0b,0xbee363fa,0x3f73913f,0xbe9d9e78,0x3f644fac,0xbee79a5d
.long 0x3f731447,0xbea09ae5,0x3f633c5a,0xbeebcbbb,0x3f7294f8,0xbea395c5,0x3f62241a,0xbeeff7fb
.long 0x3f721352,0xbea68f12,0x3f6106f2,0xbef41f07,0x3f718f57,0xbea986c4,0x3f5fe4e9,0xbef840c8
.long 0x3f710908,0xbeac7cd4,0x3f5ebe05,0xbefc5d27,0x3f708066,0xbeaf713a,0x3f5d924d,0xbf003a06
.long 0x3f6ff573,0xbeb263ef,0x3f5c61c7,0xbf0242b1,0x3f6f6830,0xbeb554ec,0x3f5b2c79,0xbf044889
.long 0x3f6ed89e,0xbeb8442a,0x3f59f26a,0xbf064b82,0x3f6e46be,0xbebb31a0,0x3f58b3a1,0xbf084b92
.long 0x3f6db293,0xbebe1d4a,0x3f577026,0xbf0a48ad,0x3f6d1c1d,0xbec1071e,0x3f5627fe,0xbf0c42c9
.long 0x3f0e39da,0xbf54db31,0x3ef15aea,0xbf61c598,0x3f07a136,0xbf591e6a,0x3ee1fb6a,0xbf65b710
.long 0x3f00e7e4,0xbf5d2d53,0x3ed25a09,0xbf696591,0x3ef41f07,0xbf6106f2,0x3ec27b55,0xbf6cd007
.long 0x3ee63375,0xbf64aa59,0x3eb263ef,0xbf6ff573,0x3ed8106b,0xbf6816a8,0x3ea21887,0xbf72d4eb
.long 0x3ec9b953,0xbf6b4b0c,0x3e919ddd,0xbf756d97,0x3ebb31a0,0xbf6e46be,0x3e80f8c0,0xbf77beb7
.long 0x3eac7cd4,0xbf710908,0x3e605c13,0xbf79c79d,0x3e9d9e78,0xbf73913f,0x3e3e853e,0xbf7b87b2
.long 0x3e8e9a22,0xbf75dec6,0x3e1c76de,0xbf7cfe73,0x3e7ee6e1,0xbf77f110,0x3df475c0,0xbf7e2b72
.long 0x3e605c13,0xbf79c79d,0x3dafb680,0xbf7f0e58,0x3e419b37,0xbf7b61fc,0x3d55880e,0xbf7fa6e3
.long 0x3e22abb6,0xbf7cbfc9,0x3c96c9b6,0xbf7ff4e6,0x3e039502,0xbf7de0b1,0xbc7b514b,0xbf7ff84a
.long 0x3dc8bd36,0xbf7ec46d,0xbd48fb30,0xbf7fb10f,0x3d8a200a,0xbf7f6ac7,0xbda973ba,0xbf7f1f49
.long 0x3d16c32c,0xbf7fd397,0xbdee3876,0xbf7e4323,0x3bc90f88,0xbf7ffec4,0xbe195be0,0xbf7d1cdd
.long 0xbcc90ab0,0xbf7fec43,0xbe3b6ecf,0xbf7baccd,0xbd621469,0xbf7f9c18,0xbe5d4b1a,0xbf79f35e
.long 0xbdafb680,0xbf7f0e58,0xbe7ee6e1,0xbf77f110,0xbdee3876,0xbf7e4323,0xbe901c2c,0xbf75a67b
.long 0xbe164083,0xbf7d3aac,0xbea09ae5,0xbf731447,0xbe354098,0xbf7bf531,0xbeb0eacb,0xbf703b37
.long 0xbe541501,0xbf7a7302,0xbec1071e,0xbf6d1c1d,0xbe72b651,0xbf78b47b,0xbed0eb2a,0xbf69b7e4
.long 0xbe888e93,0xbf76ba07,0xbee0924f,0xbf660f88,0xbe97a117,0xbf748422,0xbeeff7fb,0xbf62241a
.long 0xbea68f12,0xbf721352,0xbeff17b2,0xbf5df6be,0xbeb554ec,0xbf6f6830,0xbf06f686,0xbf5988ad
.long 0x3f6c835e,0xbec3ef15,0x3f61c598,0xbef15aea,0x3f6b4b0c,0xbec9b953,0x3f5fe4e9,0xbef840c8
.long 0x3f6a09a7,0xbecf7bca,0x3f5df6be,0xbeff17b2,0x3f68bf3c,0xbed53641,0x3f5bfb34,0xbf02ef9f
.long 0x3f676bd8,0xbedae880,0x3f59f26a,0xbf064b82,0x3f660f88,0xbee0924f,0x3f57dc7f,0xbf099f4e
.long 0x3f64aa59,0xbee63375,0x3f55b993,0xbf0cead0,0x3f633c5a,0xbeebcbbb,0x3f5389c7,0xbf102dd5
.long 0x3f61c598,0xbef15aea,0x3f514d3d,0xbf13682a,0x3f604621,0xbef6e0cb,0x3f4f0417,0xbf16999f
.long 0x3f5ebe05,0xbefc5d27,0x3f4cae79,0xbf19c200,0x3f5d2d53,0xbf00e7e4,0x3f4a4c87,0xbf1ce11f
.long 0x3f5b941a,0xbf039c3d,0x3f47de65,0xbf1ff6cb,0x3f59f26a,0xbf064b82,0x3f456439,0xbf2302d3
.long 0x3f584853,0xbf08f59b,0x3f42de29,0xbf26050a,0x3f5695e5,0xbf0b9a6b,0x3f404c5c,0xbf28fd41
.long 0x3f54db31,0xbf0e39da,0x3f3daef9,0xbf2beb4a,0x3f531849,0xbf10d3cd,0x3f3b0629,0xbf2ecef7
.long 0x3f514d3d,0xbf13682a,0x3f385216,0xbf31a81d,0x3f4f7a1f,0xbf15f6d9,0x3f3592e7,0xbf34768f
.long 0x3f4d9f02,0xbf187fc0,0x3f32c8c9,0xbf373a23,0x3f4bbbf8,0xbf1b02c6,0x3f2ff3e6,0xbf39f2ac
.long 0x3f49d112,0xbf1d7fd1,0x3f2d1469,0xbf3ca003,0x3f47de65,0xbf1ff6cb,0x3f2a2a80,0xbf3f41fc
.long 0x3f45e403,0xbf226799,0x3f273656,0xbf41d870,0x3f43e200,0xbf24d225,0x3f24381a,0xbf446337
.long 0x3f41d870,0xbf273656,0x3f212ff9,0xbf46e22a,0x3f3fc767,0xbf299415,0x3f1e1e22,0xbf495521
.long 0x3f3daef9,0xbf2beb4a,0x3f1b02c6,0xbf4bbbf8,0x3f3b8f3b,0xbf2e3bde,0x3f17de12,0xbf4e1689
.long 0x3f396842,0xbf3085bb,0x3f14b039,0xbf5064af,0x3f373a23,0xbf32c8c9,0x3f11796b,0xbf52a649
.long 0x3ec3ef15,0xbf6c835e,0x3e94a031,0xbf74fa0b,0x3eb263ef,0xbf6ff573,0x3e80f8c0,0xbf77beb7
.long 0x3ea09ae5,0xbf731447,0x3e5a3997,0xbf7a1e84,0x3e8e9a22,0xbf75dec6,0x3e3228d4,0xbf7c187a
.long 0x3e78cfcc,0xbf7853f8,0x3e09cf86,0xbf7dabcc,0x3e541501,0xbf7a7302,0x3dc27c39,0xbf7ed7d4
.long 0x3e2f10a2,0xbf7c3b28,0x3d621469,0xbf7f9c18,0x3e09cf86,0xbf7dabcc,0x3c7b514b,0xbf7ff84a
.long 0x3dc8bd36,0xbf7ec46d,0xbcc90ab0,0xbf7fec43,0x3d7b2b74,0xbf7f84ab,0xbd83db0a,0xbf7f7808
.long 0x3cc90ab0,0xbf7fec43,0xbdd53db9,0xbf7e9bc9,0xbc490e90,0xbf7ffb11,0xbe1324ca,0xbf7d57de
.long 0xbd48fb30,0xbf7fb10f,0xbe3b6ecf,0xbf7baccd,0xbdafb680,0xbf7f0e58,0xbe636c83,0xbf799b43
.long 0xbdfab273,0xbf7e1324,0xbe8586ce,0xbf772417,0xbe22abb6,0xbf7cbfc9,0xbe9920fe,0xbf74484b
.long 0xbe47c5c2,0xbf7b14be,0xbeac7cd4,0xbf710908,0xbe6c9a7f,0xbf791298,0xbebf926f,0xbf6d67a1
.long 0xbe888e93,0xbf76ba07,0xbed25a09,0xbf696591,0xbe9aa086,0xbf740bdd,0xbee4cbfe,0xbf650479
.long 0xbeac7cd4,0xbf710908,0xbef6e0cb,0xbf604621,0xbebe1d4a,0xbf6db293,0xbf044889,0xbf5b2c79
.long 0xbecf7bca,0xbf6a09a7,0xbf0cead0,0xbf55b993,0xbee0924f,0xbf660f88,0xbf1553b7,0xbf4fefa8
.long 0xbef15aea,0xbf61c598,0xbf1d7fd1,0xbf49d112,0xbf00e7e4,0xbf5d2d53,0xbf256bcb,0xbf436051
.long 0xbf08f59b,0xbf584853,0xbf2d1469,0xbf3ca003,0xbf10d3cd,0xbf531849,0xbf34768f,0xbf3592e7
.long 0xbf187fc0,0xbf4d9f02,0xbf3b8f3b,0xbf2e3bde,0xbf1ff6cb,0xbf47de65,0xbf425b89,0xbf269de3
.long 0xbf273656,0xbf41d870,0xbf48d8b3,0xbf1ebc12,0xbf2e3bde,0xbf3b8f3b,0xbf4f0417,0xbf16999f
.long 0x3f54db31,0xbf0e39da,0x3f45e403,0xbf226799,0x3f5233c6,0xbf121eb0,0x3f425b89,0xbf269de3
.long 0x3f4f7a1f,0xbf15f6d9,0x3f3ebc1b,0xbf2ac082,0x3f4cae79,0xbf19c200,0x3f3b0629,0xbf2ecef7
.long 0x3f49d112,0xbf1d7fd1,0x3f373a23,0xbf32c8c9,0x3f46e22a,0xbf212ff9,0x3f33587a,0xbf36ad7f
.long 0x3f43e200,0xbf24d225,0x3f2f61a5,0xbf3a7ca4,0x3f40d0da,0xbf286605,0x3f2b561b,0xbf3e35c5
.long 0x3f3daef9,0xbf2beb4a,0x3f273656,0xbf41d870,0x3f3a7ca4,0xbf2f61a5,0x3f2302d3,0xbf456439
.long 0x3f373a23,0xbf32c8c9,0x3f1ebc12,0xbf48d8b3,0x3f33e7bc,0xbf36206c,0x3f1a6293,0xbf4c3578
.long 0x3f3085bb,0xbf396842,0x3f15f6d9,0xbf4f7a1f,0x3f2d1469,0xbf3ca003,0x3f11796b,0xbf52a649
.long 0x3f299415,0xbf3fc767,0x3f0cead0,0xbf55b993,0x3f26050a,0xbf42de29,0x3f084b92,0xbf58b3a1
.long 0x3f226799,0xbf45e403,0x3f039c3d,0xbf5b941a,0x3f1ebc12,0xbf48d8b3,0x3efdbabb,0xbf5e5aa6
.long 0x3f1b02c6,0xbf4bbbf8,0x3ef41f07,0xbf6106f2,0x3f173c07,0xbf4e8d90,0x3eea6681,0xbf6398ac
.long 0x3f13682a,0xbf514d3d,0x3ee0924f,0xbf660f88,0x3f0f8784,0xbf53fac3,0x3ed6a399,0xbf686b39
.long 0x3f0b9a6b,0xbf5695e5,0x3ecc9b8b,0xbf6aab7b,0x3f07a136,0xbf591e6a,0x3ec27b55,0xbf6cd007
.long 0x3f039c3d,0xbf5b941a,0x3eb8442a,0xbf6ed89e,0x3eff17b2,0xbf5df6be,0x3eadf73c,0xbf70c501
.long 0x3ef6e0cb,0xbf604621,0x3ea395c5,0xbf7294f8,0x3eee9479,0xbf628210,0x3e9920fe,0xbf74484b
.long 0x3ee63375,0xbf64aa59,0x3e8e9a22,0xbf75dec6,0x3eddbe79,0xbf66becc,0x3e840270,0xbf77583a
.long 0x3ed53641,0xbf68bf3c,0x3e72b651,0xbf78b47b,0x3ecc9b8b,0xbf6aab7b,0x3e5d4b1a,0xbf79f35e
.long 0x3e47c5c2,0xbf7b14be,0x3dc8bd36,0xbf7ec46d,0x3e1c76de,0xbf7cfe73,0x3d55880e,0xbf7fa6e3
.long 0x3de1bc2e,0xbf7e70b0,0x3bc90f88,0xbf7ffec4,0x3d8a200a,0xbf7f6ac7,0xbd2351cb,0xbf7fcbe2
.long 0x3cc90ab0,0xbf7fec43,0xbdafb680,0xbf7f0e58,0xbc96c9b6,0xbf7ff4e6,0xbe06b26e,0xbf7dc68c
.long 0xbd7b2b74,0xbf7f84ab,0xbe354098,0xbf7bf531,0xbdd53db9,0xbf7e9bc9,0xbe636c83,0xbf799b43
.long 0xbe164083,0xbf7d3aac,0xbe888e93,0xbf76ba07,0xbe419b37,0xbf7b61fc,0xbe9f1cdf,0xbf73530e
.long 0xbe6c9a7f,0xbf791298,0xbeb554ec,0xbf6f6830,0xbe8b9507,0xbf764d97,0xbecb2aae,0xbf6afb8c
.long 0xbea09ae5,0xbf731447,0xbee0924f,0xbf660f88,0xbeb554ec,0xbf6f6830,0xbef58035,0xbf60a6cf
.long 0xbec9b953,0xbf6b4b0c,0xbf04f484,0xbf5ac450,0xbeddbe79,0xbf66becc,0xbf0ee0db,0xbf546b3b
.long 0xbef15aea,0xbf61c598,0xbf187fc0,0xbf4d9f02,0xbf0242b1,0xbf5c61c7,0xbf21cbfb,0xbf466354
.long 0xbf0b9a6b,0xbf5695e5,0xbf2ac082,0xbf3ebc1b,0xbf14b039,0xbf5064af,0xbf33587a,0xbf36ad7f
.long 0xbf1d7fd1,0xbf49d112,0xbf3b8f3b,0xbf2e3bde,0xbf26050a,0xbf42de29,0xbf436051,0xbf256bcb
.long 0xbf2e3bde,0xbf3b8f3b,0xbf4ac77f,0xbf1c420c,0xbf36206c,0xbf33e7bc,0xbf51c0c2,0xbf12c39a
.long 0xbf3daef9,0xbf2beb4a,0xbf584853,0xbf08f59b,0xbf44e3f5,0xbf239da9,0xbf5e5aa6,0xbefdbabb
.long 0xbf4bbbf8,0xbf1b02c6,0xbf63f473,0xbee900b7,0xbf5233c6,0xbf121eb0,0xbf6912ae,0xbed3c867
.long 0xbf584853,0xbf08f59b,0xbf6db293,0xbebe1d4a,0xbf5df6be,0xbeff17b2,0xbf71d19f,0xbea80b1f
.long 0xbf633c5a,0xbeebcbbb,0xbf756d97,0xbe919ddd,0xbf6816a8,0xbed8106b,0xbf788486,0xbe75c35a
.long 0x3f800000,0x80000000,0x3f800000,0x80000000,0x3f7fb10f,0xbd48fb30,0x3f7fa6e3,0xbd55880e
.long 0x3f7ec46d,0xbdc8bd36,0x3f7e9bc9,0xbdd53db9,0x3f7d3aac,0xbe164083,0x3f7cdf6c,0xbe1f917b
.long 0x3f7b14be,0xbe47c5c2,0x3f7a7302,0xbe541501,0x3f7853f8,0xbe78cfcc,0x3f77583a,0xbe840270
.long 0x3f74fa0b,0xbe94a031,0x3f73913f,0xbe9d9e78,0x3f710908,0xbeac7cd4,0x3f6f20b0,0xbeb6ccc3
.long 0x3f6c835e,0xbec3ef15,0x3f6a09a7,0xbecf7bca,0x3f676bd8,0xbedae880,0x3f644fac,0xbee79a5d
.long 0x3f61c598,0xbef15aea,0x3f5df6be,0xbeff17b2,0x3f5b941a,0xbf039c3d,0x3f570348,0xbf0af1b7
.long 0x3f54db31,0xbf0e39da,0x3f4f7a1f,0xbf15f6d9,0x3f4d9f02,0xbf187fc0,0x3f476085,0xbf209393
.long 0x3f45e403,0xbf226799,0x3f3ebc1b,0xbf2ac082,0x3f3daef9,0xbf2beb4a,0x3f3592e7,0xbf34768f
.long 0x3f3504f3,0xbf3504f3,0x3f2beb4a,0xbf3daef9,0x3f2beb4a,0xbf3daef9,0x3f21cbfb,0xbf466354
.long 0x3f226799,0xbf45e403,0x3f173c07,0xbf4e8d90,0x3f187fc0,0xbf4d9f02,0x3f0c42c9,0xbf5627fe
.long 0x3f0e39da,0xbf54db31,0x3f00e7e4,0xbf5d2d53,0x3f039c3d,0xbf5b941a,0x3eea6681,0xbf6398ac
.long 0x3ef15aea,0xbf61c598,0x3ed25a09,0xbf696591,0x3edae880,0xbf676bd8,0x3eb9bb1e,0xbf6e8ff8
.long 0x3ec3ef15,0xbf6c835e,0x3ea09ae5,0xbf731447,0x3eac7cd4,0xbf710908,0x3e870ada,0xbf76ef5b
.long 0x3e94a031,0xbf74fa0b,0x3e5a3997,0xbf7a1e84,0x3e78cfcc,0xbf7853f8,0x3e25c58c,0xbf7c9f8a
.long 0x3e47c5c2,0xbf7b14be,0x3de1bc2e,0xbf7e70b0,0x3e164083,0xbf7d3aac,0x3d6ea038,0xbf7f90b1
.long 0x3dc8bd36,0xbf7ec46d,0x3bc90f88,0xbf7ffec4,0x3d48fb30,0xbf7fb10f,0xbd3c6dd5,0xbf7fba9e
.long 0x3f800000,0x80000000,0x3f800000,0x80000000,0x3f7f4e6d,0xbd96a905,0x3f7f3f54,0xbd9cecf9
.long 0x3f7d3aac,0xbe164083,0x3f7cfe73,0xbe1c76de,0x3f79c79d,0xbe605c13,0x3f7940c0,0xbe698bba
.long 0x3f74fa0b,0xbe94a031,0x3f740bdd,0xbe9aa086,0x3f6ed89e,0xbeb8442a,0x3f6d67a1,0xbebf926f
.long 0x3f676bd8,0xbedae880,0x3f655e0b,0xbee363fa,0x3f5ebe05,0xbefc5d27,0x3f5bfb34,0xbf02ef9f
.long 0x3f54db31,0xbf0e39da,0x3f514d3d,0xbf13682a,0x3f49d112,0xbf1d7fd1,0x3f456439,0xbf2302d3
.long 0x3f3daef9,0xbf2beb4a,0x3f385216,0xbf31a81d,0x3f3085bb,0xbf396842,0x3f2a2a80,0xbf3f41fc
.long 0x3f226799,0xbf45e403,0x3f1b02c6,0xbf4bbbf8,0x3f13682a,0xbf514d3d,0x3f0af1b7,0xbf570348
.long 0x3f039c3d,0xbf5b941a,0x3ef41f07,0xbf6106f2,0x3ee63375,0xbf64aa59,0x3ed0eb2a,0xbf69b7e4
.long 0x3ec3ef15,0xbf6c835e,0x3eac7cd4,0xbf710908,0x3ea09ae5,0xbf731447,0x3e870ada,0xbf76ef5b
.long 0x3e78cfcc,0xbf7853f8,0x3e419b37,0xbf7b61fc,0x3e2f10a2,0xbf7c3b28,0x3de7fa9a,0xbf7e5a38
.long 0x3dc8bd36,0xbf7ec46d,0x3d16c32c,0xbf7fd397,0x3cc90ab0,0xbf7fec43,0xbd2351cb,0xbf7fcbe2
.long 0xbd48fb30,0xbf7fb10f,0xbdee3876,0xbf7e4323,0xbdfab273,0xbf7e1324,0xbe44b0b9,0xbf7b3bab
.long 0xbe47c5c2,0xbf7b14be,0xbe888e93,0xbf76ba07,0xbe888e93,0xbf76ba07,0xbeadf73c,0xbf70c501
.long 0xbeac7cd4,0xbf710908,0xbed25a09,0xbf696591,0xbecf7bca,0xbf6a09a7,0xbef58035,0xbf60a6cf
.long 0xbef15aea,0xbf61c598,0xbf0b9a6b,0xbf5695e5,0xbf08f59b,0xbf584853,0xbf1ba299,0xbf4b41fa
.long 0xbf187fc0,0xbf4d9f02,0xbf2ac082,0xbf3ebc1b,0xbf273656,0xbf41d870,0xbf38dd65,0xbf311722
.long 0x3f800000,0x80000000,0x3f800000,0x80000000,0x3f7f9c18,0xbd621469,0x3f7f90b1,0xbd6ea038
.long 0x3f7e70b0,0xbde1bc2e,0x3f7e4323,0xbdee3876,0x3f7c7eb0,0xbe28defc,0x3f7c187a,0xbe3228d4
.long 0x3f79c79d,0xbe605c13,0x3f791298,0xbe6c9a7f,0x3f764d97,0xbe8b9507,0x3f75341d,0xbe931f35
.long 0x3f721352,0xbea68f12,0x3f708066,0xbeaf713a,0x3f6d1c1d,0xbec1071e,0x3f6afb8c,0xbecb2aae
.long 0x3f676bd8,0xbedae880,0x3f64aa59,0xbee63375,0x3f6106f2,0xbef41f07,0x3f5d924d,0xbf003a06
.long 0x3f59f26a,0xbf064b82,0x3f55b993,0xbf0cead0,0x3f5233c6,0xbf121eb0,0x3f4d26fd,0xbf19210f
.long 0x3f49d112,0xbf1d7fd1,0x3f43e200,0xbf24d225,0x3f40d0da,0xbf286605,0x3f39f2ac,0xbf2ff3e6
.long 0x3f373a23,0xbf32c8c9,0x3f2f61a5,0xbf3a7ca4,0x3f2d1469,0xbf3ca003,0x3f24381a,0xbf446337
.long 0x3f226799,0xbf45e403,0x3f187fc0,0xbf4d9f02,0x3f173c07,0xbf4e8d90,0x3f0c42c9,0xbf5627fe
.long 0x3f0b9a6b,0xbf5695e5,0x3eff17b2,0xbf5df6be,0x3eff17b2,0xbf5df6be,0x3ee4cbfe,0xbf650479
.long 0x3ee63375,0xbf64aa59,0x3ec9b953,0xbf6b4b0c,0x3ecc9b8b,0xbf6aab7b,0x3eadf73c,0xbf70c501
.long 0x3eb263ef,0xbf6ff573,0x3e919ddd,0xbf756d97,0x3e97a117,0xbf748422,0x3e698bba,0xbf7940c0
.long 0x3e78cfcc,0xbf7853f8,0x3e2f10a2,0xbf7c3b28,0x3e419b37,0xbf7b61fc,0x3de7fa9a,0xbf7e5a38
.long 0x3e09cf86,0xbf7dabcc,0x3d621469,0xbf7f9c18,0x3da3308c,0xbf7f2f9d,0xbb490fc6,0xbf7fffb1
.long 0x3cc90ab0,0xbf7fec43,0xbd7b2b74,0xbf7f84ab,0xbcfb49ba,0xbf7fe129,0xbdf475c0,0xbf7e2b72
.long 0xbdafb680,0xbf7f0e58,0xbe354098,0xbf7bf531,0xbe1008b7,0xbf7d7474,0xbe6fa8b2,0xbf78e3d6
.long 0x3f800000,0x80000000,0x3f800000,0x80000000,0x3f7f2f9d,0xbda3308c,0x3f7f1f49,0xbda973ba
.long 0x3f7cbfc9,0xbe22abb6,0x3f7c7eb0,0xbe28defc,0x3f78b47b,0xbe72b651,0x3f7822d1,0xbe7bdba4
.long 0x3f731447,0xbea09ae5,0x3f721352,0xbea68f12,0x3f6be858,0xbec6d529,0x3f6a5ad9,0xbece0bea
.long 0x3f633c5a,0xbeebcbbb,0x3f6106f2,0xbef41f07,0x3f591e6a,0xbf07a136,0x3f5627fe,0xbf0c42c9
.long 0x3f4d9f02,0xbf187fc0,0x3f49d112,0xbf1d7fd1,0x3f40d0da,0xbf286605,0x3f3c17d9,0xbf2da859
.long 0x3f32c8c9,0xbf373a23,0x3f2d1469,0xbf3ca003,0x3f239da9,0xbf44e3f5,0x3f1ce11f,0xbf4a4c87
.long 0x3f13682a,0xbf514d3d,0x3f0b9a6b,0xbf5695e5,0x3f0242b1,0xbf5c61c7,0x3ef2bd43,0xbf61668a
.long 0x3ee0924f,0xbf660f88,0x3ecc9b8b,0xbf6aab7b,0x3ebb31a0,0xbf6e46be,0x3ea5129f,0xbf725470
.long 0x3e94a031,0xbf74fa0b,0x3e78cfcc,0xbf7853f8,0x3e5a3997,0xbf7a1e84,0x3e25c58c,0xbf7c9f8a
.long 0x3e09cf86,0xbf7dabcc,0x3da3308c,0xbf7f2f9d,0x3d621469,0xbf7f9c18,0xbb490fc6,0xbf7fffb1
.long 0xbcc90ab0,0xbf7fec43,0xbdafb680,0xbf7f0e58,0xbdd53db9,0xbf7e9bc9,0xbe2bf804,0xbf7c5d3a
.long 0xbe3b6ecf,0xbf7baccd,0xbe7ee6e1,0xbf77f110,0xbe8586ce,0xbf772417,0xbea80b1f,0xbf71d19f
.long 0xbeac7cd4,0xbf710908,0xbecf7bca,0xbf6a09a7,0xbed25a09,0xbf696591,0xbef58035,0xbf60a6cf
.long 0xbef6e0cb,0xbf604621,0xbf0cead0,0xbf55b993,0xbf0cead0,0xbf55b993,0xbf1e1e22,0xbf495521
.long 0xbf1d7fd1,0xbf49d112,0xbf2e3bde,0xbf3b8f3b,0xbf2d1469,0xbf3ca003,0xbf3d27b8,0xbf2c800f
.long 0xbf3b8f3b,0xbf2e3bde,0xbf4ac77f,0xbf1c420c,0xbf48d8b3,0xbf1ebc12,0xbf570348,0xbf0af1b7
.long 0x3f800000,0x80000000,0x3f800000,0x80000000,0x3f7f84ab,0xbd7b2b74,0x3f7f7808,0xbd83db0a
.long 0x3f7e1324,0xbdfab273,0x3f7de0b1,0xbe039502,0x3f7baccd,0xbe3b6ecf,0x3f7b3bab,0xbe44b0b9
.long 0x3f7853f8,0xbe78cfcc,0x3f778bc5,0xbe827dc0,0x3f740bdd,0xbe9aa086,0x3f72d4eb,0xbea21887
.long 0x3f6ed89e,0xbeb8442a,0x3f6d1c1d,0xbec1071e,0x3f68bf3c,0xbed53641,0x3f666771,0xbedf28a9
.long 0x3f61c598,0xbef15aea,0x3f5ebe05,0xbefc5d27,0x3f59f26a,0xbf064b82,0x3f5627fe,0xbf0c42c9
.long 0x3f514d3d,0xbf13682a,0x3f4cae79,0xbf19c200,0x3f47de65,0xbf1ff6cb,0x3f425b89,0xbf269de3
.long 0x3f3daef9,0xbf2beb4a,0x3f373a23,0xbf32c8c9,0x3f32c8c9,0xbf373a23,0x3f2b561b,0xbf3e35c5
.long 0x3f273656,0xbf41d870,0x3f1ebc12,0xbf48d8b3,0x3f1b02c6,0xbf4bbbf8,0x3f11796b,0xbf52a649
.long 0x3f0e39da,0xbf54db31,0x3f039c3d,0xbf5b941a,0x3f00e7e4,0xbf5d2d53,0x3eea6681,0xbf6398ac
.long 0x3ee63375,0xbf64aa59,0x3ecc9b8b,0xbf6aab7b,0x3ec9b953,0xbf6b4b0c,0x3eadf73c,0xbf70c501
.long 0x3eac7cd4,0xbf710908,0x3e8e9a22,0xbf75dec6,0x3e8e9a22,0xbf75dec6,0x3e5d4b1a,0xbf79f35e
.long 0x3e605c13,0xbf79c79d,0x3e1c76de,0xbf7cfe73,0x3e22abb6,0xbf7cbfc9,0x3db5f8da,0xbf7efcc9
.long 0x3dc8bd36,0xbf7ec46d,0x3cc90ab0,0xbf7fec43,0x3d16c32c,0xbf7fd397,0xbd2351cb,0xbf7fcbe2
.long 0xbcc90ab0,0xbf7fec43,0xbdd53db9,0xbf7e9bc9,0xbdafb680,0xbf7f0e58,0xbe2bf804,0xbf7c5d3a
.long 0xbe164083,0xbf7d3aac,0xbe6c9a7f,0xbf791298,0xbe541501,0xbf7a7302,0xbe9620d2,0xbf74bf62
.long 0xbe888e93,0xbf76ba07,0xbeb554ec,0xbf6f6830,0xbea68f12,0xbf721352,0xbed3c867,0xbf6912ae
.long 0x3f800000,0x80000000,0x3f800000,0x80000000,0x3f7f0e58,0xbdafb680,0x3f7efcc9,0xbdb5f8da
.long 0x3f7c3b28,0xbe2f10a2,0x3f7bf531,0xbe354098,0x3f778bc5,0xbe827dc0,0x3f76ef5b,0xbe870ada
.long 0x3f710908,0xbeac7cd4,0x3f6ff573,0xbeb263ef,0x3f68bf3c,0xbed53641,0x3f671599,0xbedc53c1
.long 0x3f5ebe05,0xbefc5d27,0x3f5c61c7,0xbf0242b1,0x3f531849,0xbf10d3cd,0x3f4fefa8,0xbf1553b7
.long 0x3f45e403,0xbf226799,0x3f41d870,0xbf273656,0x3f373a23,0xbf32c8c9,0x3f3238aa,0xbf37c655
.long 0x3f273656,0xbf41d870,0x3f212ff9,0xbf46e22a,0x3f15f6d9,0xbf4f7a1f,0x3f0ee0db,0xbf546b3b
.long 0x3f039c3d,0xbf5b941a,0x3ef6e0cb,0xbf604621,0x3ee0924f,0xbf660f88,0x3ece0bea,0xbf6a5ad9
.long 0x3eb8442a,0xbf6ed89e,0x3ea395c5,0xbf7294f8,0x3e8e9a22,0xbf75dec6,0x3e6fa8b2,0xbf78e3d6
.long 0x3e47c5c2,0xbf7b14be,0x3e164083,0xbf7d3aac,0x3de1bc2e,0xbf7e70b0,0x3d6ea038,0xbf7f90b1
.long 0x3cc90ab0,0xbf7fec43,0xbcfb49ba,0xbf7fe129,0xbd7b2b74,0xbf7f84ab,0xbdf475c0,0xbf7e2b72
.long 0xbe164083,0xbf7d3aac,0xbe541501,0xbf7a7302,0xbe6c9a7f,0xbf791298,0xbe9620d2,0xbf74bf62
.long 0xbea09ae5,0xbf731447,0xbec1071e,0xbf6d1c1d,0xbec9b953,0xbf6b4b0c,0xbeea6681,0xbf6398ac
.long 0xbef15aea,0xbf61c598,0xbf08f59b,0xbf584853,0xbf0b9a6b,0xbf5695e5,0xbf1ba299,0xbf4b41fa
.long 0xbf1d7fd1,0xbf49d112,0xbf2d1469,0xbf3ca003,0xbf2e3bde,0xbf3b8f3b,0xbf3d27b8,0xbf2c800f
.long 0xbf3daef9,0xbf2beb4a,0xbf4bbbf8,0xbf1b02c6,0xbf4bbbf8,0xbf1b02c6,0xbf58b3a1,0xbf084b92
.long 0xbf584853,0xbf08f59b,0xbf63f473,0xbee900b7,0xbf633c5a,0xbeebcbbb,0xbf6d67a1,0xbebf926f
.long 0x3f800000,0x80000000,0x3f800000,0x80000000,0x3f7f6ac7,0xbd8a200a,0x3f7f5ce9,0xbd9064b4
.long 0x3f7dabcc,0xbe09cf86,0x3f7d7474,0xbe1008b7,0x3f7ac516,0xbe4dee60,0x3f7a4910,0xbe57278f
.long 0x3f76ba07,0xbe888e93,0x3f75dec6,0xbe8e9a22,0x3f718f57,0xbea986c4,0x3f703b37,0xbeb0eacb
.long 0x3f6b4b0c,0xbec9b953,0x3f696591,0xbed25a09,0x3f63f473,0xbee900b7,0x3f61668a,0xbef2bd43
.long 0x3f5b941a,0xbf039c3d,0x3f584853,0xbf08f59b,0x3f5233c6,0xbf121eb0,0x3f4e1689,0xbf17de12
.long 0x3f47de65,0xbf1ff6cb,0x3f42de29,0xbf26050a,0x3f3ca003,0xbf2d1469,0x3f36ad7f,0xbf33587a
.long 0x3f3085bb,0xbf396842,0x3f299415,0xbf3fc767,0x3f239da9,0xbf44e3f5,0x3f1ba299,0xbf4b41fa
.long 0x3f15f6d9,0xbf4f7a1f,0x3f0cead0,0xbf55b993,0x3f07a136,0xbf591e6a,0x3efafef7,0xbf5f20db
.long 0x3ef15aea,0xbf61c598,0x3edae880,0xbf676bd8,0x3ed25a09,0xbf696591,0x3eb9bb1e,0xbf6e8ff8
.long 0x3eb263ef,0xbf6ff573,0x3e97a117,0xbf748422,0x3e919ddd,0xbf756d97,0x3e698bba,0xbf7940c0
.long 0x3e605c13,0xbf79c79d,0x3e22abb6,0xbf7cbfc9,0x3e1c76de,0xbf7cfe73,0x3db5f8da,0xbf7efcc9
.long 0x3dafb680,0xbf7f0e58,0x3c96c9b6,0xbf7ff4e6,0x3c96c9b6,0xbf7ff4e6,0xbd55880e,0xbf7fa6e3
.long 0xbd48fb30,0xbf7fb10f,0xbdfab273,0xbf7e1324,0xbdee3876,0xbf7e4323,0xbe44b0b9,0xbf7b3bab
.long 0xbe3b6ecf,0xbf7baccd,0xbe8586ce,0xbf772417,0xbe7ee6e1,0xbf77f110,0xbea80b1f,0xbf71d19f
.long 0xbea09ae5,0xbf731447,0xbec9b953,0xbf6b4b0c,0xbec1071e,0xbf6d1c1d,0xbeea6681,0xbf6398ac
.long 0xbee0924f,0xbf660f88,0xbf04f484,0xbf5ac450,0xbeff17b2,0xbf5df6be,0xbf140c5f,0xbf50d937
.long 0x3f800000,0x80000000,0x3f800000,0x80000000,0x3f7eea9d,0xbdbc3ac3,0x3f7ed7d4,0xbdc27c39
.long 0x3f7baccd,0xbe3b6ecf,0x3f7b61fc,0xbe419b37,0x3f764d97,0xbe8b9507,0x3f75a67b,0xbe901c2c
.long 0x3f6ed89e,0xbeb8442a,0x3f6db293,0xbebe1d4a,0x3f655e0b,0xbee363fa,0x3f6398ac,0xbeea6681
.long 0x3f59f26a,0xbf064b82,0x3f577026,0xbf0a48ad,0x3f4cae79,0xbf19c200,0x3f495521,0xbf1e1e22
.long 0x3f3daef9,0xbf2beb4a,0x3f396842,0xbf3085bb,0x3f2d1469,0xbf3ca003,0x3f27ce61,0xbf4154e1
.long 0x3f1b02c6,0xbf4bbbf8,0x3f14b039,0xbf5064af,0x3f07a136,0xbf591e6a,0x3f003a06,0xbf5d924d
.long 0x3ee63375,0xbf64aa59,0x3ed53641,0xbf68bf3c,0x3ebb31a0,0xbf6e46be,0x3ea80b1f,0xbf71d19f
.long 0x3e8e9a22,0xbf75dec6,0x3e72b651,0xbf78b47b,0x3e419b37,0xbf7b61fc,0x3e1324ca,0xbf7d57de
.long 0x3dc8bd36,0xbf7ec46d,0x3d48fb30,0xbf7fb10f,0x3bc90f88,0xbf7ffec4,0xbd3c6dd5,0xbf7fba9e
.long 0xbdafb680,0xbf7f0e58,0xbe1008b7,0xbf7d7474,0xbe354098,0xbf7bf531,0xbe6fa8b2,0xbf78e3d6
.long 0xbe888e93,0xbf76ba07,0xbea68f12,0xbf721352,0xbeb554ec,0xbf6f6830,0xbed3c867,0xbf6912ae
.long 0xbee0924f,0xbf660f88,0xbeff17b2,0xbf5df6be,0xbf04f484,0xbf5ac450,0xbf140c5f,0xbf50d937
.long 0xbf187fc0,0xbf4d9f02,0xbf273656,0xbf41d870,0xbf2ac082,0xbf3ebc1b,0xbf38dd65,0xbf311722
.long 0xbf3b8f3b,0xbf2e3bde,0xbf48d8b3,0xbf1ebc12,0xbf4ac77f,0xbf1c420c,0xbf570348,0xbf0af1b7
.long 0xbf584853,0xbf08f59b,0xbf633c5a,0xbeebcbbb,0xbf63f473,0xbee900b7,0xbf6d67a1,0xbebf926f
.long 0xbf6db293,0xbebe1d4a,0xbf756d97,0xbe919ddd,0xbf756d97,0xbe919ddd,0xbf7b3bab,0xbe44b0b9
.long 0x248d3132,0xbf800000,0xbdc8bd36,0xbf7ec46d,0xbd48fb30,0xbf7fb10f,0xbe195be0,0xbf7d1cdd
.long 0xbdc8bd36,0xbf7ec46d,0xbe4dee60,0xbf7ac516,0xbe164083,0xbf7d3aac,0xbe80f8c0,0xbf77beb7
.long 0xbe47c5c2,0xbf7b14be,0xbe9aa086,0xbf740bdd,0xbe78cfcc,0xbf7853f8,0xbeb3dca5,0xbf6faf1b
.long 0xbe94a031,0xbf74fa0b,0xbecc9b8b,0xbf6aab7b,0xbeac7cd4,0xbf710908,0xbee4cbfe,0xbf650479
.long 0xbec3ef15,0xbf6c835e,0xbefc5d27,0xbf5ebe05,0xbedae880,0xbf676bd8,0xbf099f4e,0xbf57dc7f
.long 0xbef15aea,0xbf61c598,0xbf14b039,0xbf5064af,0xbf039c3d,0xbf5b941a,0xbf1f599f,0xbf485bca
.long 0xbf0e39da,0xbf54db31,0xbf299415,0xbf3fc767,0xbf187fc0,0xbf4d9f02,0xbf33587a,0xbf36ad7f
.long 0xbf226799,0xbf45e403,0xbf3ca003,0xbf2d1469,0xbf2beb4a,0xbf3daef9,0xbf456439,0xbf2302d3
.long 0xbf3504f3,0xbf3504f3,0xbf4d9f02,0xbf187fc0,0xbf3daef9,0xbf2beb4a,0xbf554aa4,0xbf0d9281
.long 0xbf45e403,0xbf226799,0xbf5c61c7,0xbf0242b1,0xbf4d9f02,0xbf187fc0,0xbf62df7b,0xbeed3063
.long 0xbf54db31,0xbf0e39da,0xbf68bf3c,0xbed53641,0xbf5b941a,0xbf039c3d,0xbf6dfcf2,0xbebca7af
.long 0xbf61c598,0xbef15aea,0xbf7294f8,0xbea395c5,0xbf676bd8,0xbedae880,0xbf76841b,0xbe8a11f7
.long 0xbf6c835e,0xbec3ef15,0xbf79c79d,0xbe605c13,0xbf710908,0xbeac7cd4,0xbf7c5d3a,0xbe2bf804
.long 0xbf74fa0b,0xbe94a031,0xbf7e4323,0xbdee3876,0xbf7853f8,0xbe78cfcc,0xbf7f7808,0xbd83db0a
.long 0xbf7b14be,0xbe47c5c2,0xbf7ffb11,0xbc490e90,0xbf7d3aac,0xbe164083,0xbf7fcbe2,0x3d2351cb
.long 0xbf7ec46d,0xbdc8bd36,0xbf7eea9d,0x3dbc3ac3,0xbf7fb10f,0xbd48fb30,0xbf7d57de,0x3e1324ca
.long 0xbf3504f3,0xbf3504f3,0xbf45e403,0xbf226799,0xbf41d870,0xbf273656,0xbf51c0c2,0xbf12c39a
.long 0xbf4d9f02,0xbf187fc0,0xbf5c61c7,0xbf0242b1,0xbf584853,0xbf08f59b,0xbf65b710,0xbee1fb6a
.long 0xbf61c598,0xbef15aea,0xbf6db293,0xbebe1d4a,0xbf6a09a7,0xbecf7bca,0xbf74484b,0xbe9920fe
.long 0xbf710908,0xbeac7cd4,0xbf796e4e,0xbe667c66,0xbf76ba07,0xbe888e93,0xbf7d1cdd,0xbe195be0
.long 0xbf7b14be,0xbe47c5c2,0xbf7f4e6d,0xbd96a905,0xbf7e1324,0xbdfab273,0xbf7fffb1,0x3b490fc6
.long 0xbf7fb10f,0xbd48fb30,0xbf7f2f9d,0x3da3308c,0xbf7fec43,0x3cc90ab0,0xbf7cdf6c,0x3e1f917b
.long 0xbf7ec46d,0x3dc8bd36,0xbf791298,0x3e6c9a7f,0xbf7c3b28,0x3e2f10a2,0xbf73ced9,0x3e9c1faf
.long 0xbf7853f8,0x3e78cfcc,0xbf6d1c1d,0x3ec1071e,0xbf731447,0x3ea09ae5,0xbf650479,0x3ee4cbfe
.long 0xbf6c835e,0x3ec3ef15,0xbf5b941a,0x3f039c3d,0xbf64aa59,0x3ee63375,0xbf50d937,0x3f140c5f
.long 0xbf5b941a,0x3f039c3d,0xbf44e3f5,0x3f239da9,0xbf514d3d,0x3f13682a,0xbf37c655,0x3f3238aa
.long 0xbf45e403,0x3f226799,0xbf299415,0x3f3fc767,0xbf396842,0x3f3085bb,0xbf1a6293,0x3f4c3578
.long 0xbf2beb4a,0x3f3daef9,0xbf0a48ad,0x3f577026,0xbf1d7fd1,0x3f49d112,0xbef2bd43,0x3f61668a
.long 0xbf0e39da,0x3f54db31,0xbecf7bca,0x3f6a09a7,0xbefc5d27,0x3f5ebe05,0xbeab0201,0x3f714c7a
.long 0xbedae880,0x3f676bd8,0xbe8586ce,0x3f772417,0xbeb8442a,0x3f6ed89e,0xbe3e853e,0x3f7b87b2
.long 0xbe94a031,0x3f74fa0b,0xbde1bc2e,0x3f7e70b0,0xbe605c13,0x3f79c79d,0xbd0a342f,0x3f7fdaaf
.long 0xbe164083,0x3f7d3aac,0x3d2fe007,0x3f7fc38f,0xbd96a905,0x3f7f4e6d,0x3df475c0,0x3f7e2b72
.long 0xbe47c5c2,0xbf7b14be,0xbe94a031,0xbf74fa0b,0xbe7ee6e1,0xbf77f110,0xbeb0eacb,0xbf703b37
.long 0xbe9aa086,0xbf740bdd,0xbecc9b8b,0xbf6aab7b,0xbeb554ec,0xbf6f6830,0xbee79a5d,0xbf644fac
.long 0xbecf7bca,0xbf6a09a7,0xbf00e7e4,0xbf5d2d53,0xbee900b7,0xbf63f473,0xbf0d9281,0xbf554aa4
.long 0xbf00e7e4,0xbf5d2d53,0xbf19c200,0xbf4cae79,0xbf0cead0,0xbf55b993,0xbf256bcb,0xbf436051
.long 0xbf187fc0,0xbf4d9f02,0xbf3085bb,0xbf396842,0xbf239da9,0xbf44e3f5,0xbf3b0629,0xbf2ecef7
.long 0xbf2e3bde,0xbf3b8f3b,0xbf44e3f5,0xbf239da9,0xbf385216,0xbf31a81d,0xbf4e1689,0xbf17de12
.long 0xbf41d870,0xbf273656,0xbf5695e5,0xbf0b9a6b,0xbf4ac77f,0xbf1c420c,0xbf5e5aa6,0xbefdbabb
.long 0xbf531849,0xbf10d3cd,0xbf655e0b,0xbee363fa,0xbf5ac450,0xbf04f484,0xbf6b99fb,0xbec8477c
.long 0xbf61c598,0xbef15aea,0xbf710908,0xbeac7cd4,0xbf6816a8,0xbed8106b,0xbf75a67b,0xbe901c2c
.long 0xbf6db293,0xbebe1d4a,0xbf796e4e,0xbe667c66,0xbf7294f8,0xbea395c5,0xbf7c5d3a,0xbe2bf804
.long 0xbf76ba07,0xbe888e93,0xbf7e70b0,0xbde1bc2e,0xbf7a1e84,0xbe5a3997,0xbf7fa6e3,0xbd55880e
.long 0xbf7cbfc9,0xbe22abb6,0xbf7ffec4,0x3bc90f88,0xbf7e9bc9,0xbdd53db9,0xbf7f7808,0x3d83db0a
.long 0xbf7fb10f,0xbd48fb30,0xbf7e1324,0x3dfab273,0xbf7ffec4,0x3bc90f88,0xbf7bd14d,0x3e3857ec
.long 0xbf7f84ab,0x3d7b2b74,0xbf78b47b,0x3e72b651,0xbf7e4323,0x3dee3876,0xbf74bf62,0x3e9620d2
.long 0xbf7c3b28,0x3e2f10a2,0xbf6ff573,0x3eb263ef,0xbf796e4e,0x3e667c66,0xbf6a5ad9,0x3ece0bea
.long 0xbf75dec6,0x3e8e9a22,0xbf63f473,0x3ee900b7,0xbf718f57,0x3ea986c4,0xbf5cc7d1,0x3f019573
.long 0xbf54db31,0xbf0e39da,0xbf61c598,0xbef15aea,0xbf5f8327,0xbef9a02d,0xbf6afb8c,0xbecb2aae
.long 0xbf68bf3c,0xbed53641,0xbf7294f8,0xbea395c5,0xbf708066,0xbeaf713a,0xbf788486,0xbe75c35a
.long 0xbf76ba07,0xbe888e93,0xbf7cbfc9,0xbe22abb6,0xbf7b61fc,0xbe419b37,0xbf7f3f54,0xbd9cecf9
.long 0xbf7e70b0,0xbde1bc2e,0xbf7ffec4,0x3bc90f88,0xbf7fe129,0xbcfb49ba,0xbf7efcc9,0x3db5f8da
.long 0xbf7fb10f,0x3d48fb30,0xbf7c3b28,0x3e2f10a2,0xbf7de0b1,0x3e039502,0xbf77beb7,0x3e80f8c0
.long 0xbf7a7302,0x3e541501,0xbf718f57,0x3ea986c4,0xbf756d97,0x3e919ddd,0xbf69b7e4,0x3ed0eb2a
.long 0xbf6ed89e,0x3eb8442a,0xbf604621,0x3ef6e0cb,0xbf66becc,0x3eddbe79,0xbf554aa4,0x3f0d9281
.long 0xbf5d2d53,0x3f00e7e4,0xbf48d8b3,0x3f1ebc12,0xbf5233c6,0x3f121eb0,0xbf3b0629,0x3f2ecef7
.long 0xbf45e403,0x3f226799,0xbf2beb4a,0x3f3daef9,0xbf385216,0x3f31a81d,0xbf1ba299,0x3f4b41fa
.long 0xbf299415,0x3f3fc767,0xbf0a48ad,0x3f577026,0xbf19c200,0x3f4cae79,0xbeeff7fb,0x3f62241a
.long 0xbf08f59b,0x3f584853,0xbec9b953,0x3f6b4b0c,0xbeee9479,0x3f628210,0xbea21887,0x3f72d4eb
.long 0xbec9b953,0x3f6b4b0c,0xbe72b651,0x3f78b47b,0xbea395c5,0x3f7294f8,0xbe1f917b,0x3f7cdf6c
.long 0xbe78cfcc,0x3f7853f8,0xbd96a905,0x3f7f4e6d,0xbe28defc,0x3f7c7eb0,0x3c16cb58,0x3f7ffd39
.long 0xbdafb680,0x3f7f0e58,0x3dbc3ac3,0x3f7eea9d,0xbbc90f88,0x3f7ffec4,0x3e3228d4,0x3f7c187a
.long 0x3d96a905,0x3f7f4e6d,0x3e827dc0,0x3f778bc5,0x3e1c76de,0x3f7cfe73,0x3eab0201,0x3f714c7a
.long 0x3e6c9a7f,0x3f791298,0x3ed25a09,0x3f696591,0x3e9d9e78,0x3f73913f,0x3ef840c8,0x3f5fe4e9
.long 0xbec3ef15,0xbf6c835e,0xbef15aea,0xbf61c598,0xbee0924f,0xbf660f88,0xbf06f686,0xbf5988ad
.long 0xbefc5d27,0xbf5ebe05,0xbf14b039,0xbf5064af,0xbf0b9a6b,0xbf5695e5,0xbf21cbfb,0xbf466354
.long 0xbf187fc0,0xbf4d9f02,0xbf2e3bde,0xbf3b8f3b,0xbf24d225,0xbf43e200,0xbf39f2ac,0xbf2ff3e6
.long 0xbf3085bb,0xbf396842,0xbf44e3f5,0xbf239da9,0xbf3b8f3b,0xbf2e3bde,0xbf4f0417,0xbf16999f
.long 0xbf45e403,0xbf226799,0xbf584853,0xbf08f59b,0xbf4f7a1f,0xbf15f6d9,0xbf60a6cf,0xbef58035
.long 0xbf584853,0xbf08f59b,0xbf6816a8,0xbed8106b,0xbf604621,0xbef6e0cb,0xbf6e8ff8,0xbeb9bb1e
.long 0xbf676bd8,0xbedae880,0xbf740bdd,0xbe9aa086,0xbf6db293,0xbebe1d4a,0xbf788486,0xbe75c35a
.long 0xbf731447,0xbea09ae5,0xbf7bf531,0xbe354098,0xbf778bc5,0xbe827dc0,0xbf7e5a38,0xbde7fa9a
.long 0xbf7b14be,0xbe47c5c2,0xbf7fb10f,0xbd48fb30,0xbf7dabcc,0xbe09cf86,0xbf7ff84a,0x3c7b514b
.long 0xbf7f4e6d,0xbd96a905,0xbf7f2f9d,0x3da3308c,0xbf7ffb11,0xbc490e90,0xbf7d57de,0x3e1324ca
.long 0xbf7fb10f,0x3d48fb30,0xbf7a7302,0x3e541501,0xbf7e70b0,0x3de1bc2e,0xbf76841b,0x3e8a11f7
.long 0xbf7c3b28,0x3e2f10a2,0xbf718f57,0x3ea986c4,0xbf791298,0x3e6c9a7f,0xbf6b99fb,0x3ec8477c
.long 0xbf74fa0b,0x3e94a031,0xbf64aa59,0x3ee63375,0xbf6ff573,0x3eb263ef,0xbf5cc7d1,0x3f019573
.long 0xbf6a09a7,0x3ecf7bca,0xbf53fac3,0x3f0f8784,0xbf633c5a,0x3eebcbbb,0xbf4a4c87,0x3f1ce11f
.long 0xbf5b941a,0x3f039c3d,0xbf3fc767,0x3f299415,0xbf531849,0x3f10d3cd,0xbf34768f,0x3f3592e7
.long 0xbf49d112,0x3f1d7fd1,0xbf286605,0x3f40d0da,0xbf3fc767,0x3f299415,0xbf1ba299,0x3f4b41fa
.long 0xbf6c835e,0xbec3ef15,0xbf74fa0b,0xbe94a031,0xbf740bdd,0xbe9aa086,0xbf7a9c59,0xbe5101f1
.long 0xbf79c79d,0xbe605c13,0xbf7e4323,0xbdee3876,0xbf7dabcc,0xbe09cf86,0xbf7fe705,0xbce22a7a
.long 0xbf7fb10f,0xbd48fb30,0xbf7f84ab,0x3d7b2b74,0xbf7fd397,0x3d16c32c,0xbf7d1cdd,0x3e195be0
.long 0xbf7e1324,0x3dfab273,0xbf78b47b,0x3e72b651,0xbf7a7302,0x3e541501,0xbf725470,0x3ea5129f
.long 0xbf74fa0b,0x3e94a031,0xbf6a09a7,0x3ecf7bca,0xbf6db293,0x3ebe1d4a,0xbf5fe4e9,0x3ef840c8
.long 0xbf64aa59,0x3ee63375,0xbf53fac3,0x3f0f8784,0xbf59f26a,0x3f064b82,0xbf466354,0x3f21cbfb
.long 0xbf4d9f02,0x3f187fc0,0xbf373a23,0x3f32c8c9,0xbf3fc767,0x3f299415,0xbf269de3,0x3f425b89
.long 0xbf3085bb,0x3f396842,0xbf14b039,0x3f5064af,0xbf1ff6cb,0x3f47de65,0xbf019573,0x3f5cc7d1
.long 0xbf0e39da,0x3f54db31,0xbedae880,0x3f676bd8,0xbef6e0cb,0x3f604621,0xbeb0eacb,0x3f703b37
.long 0xbecf7bca,0x3f6a09a7,0xbe8586ce,0x3f772417,0xbea68f12,0x3f721352,0xbe3228d4,0x3f7c187a
.long 0xbe78cfcc,0x3f7853f8,0xbdafb680,0x3f7f0e58,0xbe22abb6,0x3f7cbfc9,0x3b490fc6,0x3f7fffb1
.long 0xbd96a905,0x3f7f4e6d,0x3dbc3ac3,0x3f7eea9d,0x3c490e90,0x3f7ffb11,0x3e3857ec,0x3f7bd14d
.long 0x3dc8bd36,0x3f7ec46d,0x3e888e93,0x3f76ba07,0x3e3b6ecf,0x3f7baccd,0x3eb3dca5,0x3f6faf1b
.long 0x3e888e93,0x3f76ba07,0x3eddbe79,0x3f66becc,0x3eb263ef,0x3f6ff573,0x3f02ef9f,0x3f5bfb34
.long 0x3edae880,0x3f676bd8,0x3f15f6d9,0x3f4f7a1f,0x3f00e7e4,0x3f5d2d53,0x3f27ce61,0x3f4154e1
.long 0x3f13682a,0x3f514d3d,0x3f385216,0x3f31a81d,0x3f24d225,0x3f43e200,0x3f476085,0x3f209393
.long 0xbf0e39da,0xbf54db31,0xbf226799,0xbf45e403,0xbf1c420c,0xbf4ac77f,0xbf2ff3e6,0xbf39f2ac
.long 0xbf299415,0xbf3fc767,0xbf3ca003,0xbf2d1469,0xbf36206c,0xbf33e7bc,0xbf485bca,0xbf1f599f
.long 0xbf41d870,0xbf273656,0xbf531849,0xbf10d3cd,0xbf4cae79,0xbf19c200,0xbf5cc7d1,0xbf019573
.long 0xbf5695e5,0xbf0b9a6b,0xbf655e0b,0xbee363fa,0xbf5f8327,0xbef9a02d,0xbf6cd007,0xbec27b55
.long 0xbf676bd8,0xbedae880,0xbf731447,0xbea09ae5,0xbf6e46be,0xbebb31a0,0xbf7822d1,0xbe7bdba4
.long 0xbf740bdd,0xbe9aa086,0xbf7bf531,0xbe354098,0xbf78b47b,0xbe72b651,0xbf7e868b,0xbddb7d37
.long 0xbf7c3b28,0xbe2f10a2,0xbf7fd397,0xbd16c32c,0xbf7e9bc9,0xbdd53db9,0xbf7fdaaf,0x3d0a342f
.long 0xbf7fd397,0xbd16c32c,0xbf7e9bc9,0x3dd53db9,0xbf7fe129,0x3cfb49ba,0xbf7c187a,0x3e3228d4
.long 0xbf7ec46d,0x3dc8bd36,0xbf7853f8,0x3e78cfcc,0xbf7c7eb0,0x3e28defc,0xbf73530e,0x3e9f1cdf
.long 0xbf791298,0x3e6c9a7f,0xbf6d1c1d,0x3ec1071e,0xbf748422,0x3e97a117,0xbf65b710,0x3ee1fb6a
.long 0xbf6ed89e,0x3eb8442a,0xbf5d2d53,0x3f00e7e4,0xbf6816a8,0x3ed8106b,0xbf5389c7,0x3f102dd5
.long 0xbf604621,0x3ef6e0cb,0xbf48d8b3,0x3f1ebc12,0xbf577026,0x3f0a48ad,0xbf3d27b8,0x3f2c800f
.long 0xbf4d9f02,0x3f187fc0,0xbf3085bb,0x3f396842,0xbf42de29,0x3f26050a,0xbf2302d3,0x3f456439
.long 0xbf373a23,0x3f32c8c9,0xbf14b039,0x3f5064af,0xbf2ac082,0x3f3ebc1b,0xbf05a02c,0x3f5a5ba0
.long 0xbf1d7fd1,0x3f49d112,0xbeebcbbb,0x3f633c5a,0xbf0f8784,0x3f53fac3,0xbecb2aae,0x3f6afb8c
.long 0xbf00e7e4,0x3f5d2d53,0xbea986c4,0x3f718f57,0xbee363fa,0x3f655e0b,0xbe870ada,0x3f76ef5b
.long 0xbf7b14be,0xbe47c5c2,0xbf7ec46d,0xbdc8bd36,0xbf7e9bc9,0xbdd53db9,0xbf7fffb1,0xbb490fc6
.long 0xbf7ffb11,0xbc490e90,0xbf7eea9d,0x3dbc3ac3,0xbf7f2f9d,0x3da3308c,0xbf7b87b2,0x3e3e853e
.long 0xbf7c3b28,0x3e2f10a2,0xbf75dec6,0x3e8e9a22,0xbf772417,0x3e8586ce,0xbf6dfcf2,0x3ebca7af
.long 0xbf6ff573,0x3eb263ef,0xbf63f473,0x3ee900b7,0xbf66becc,0x3eddbe79,0xbf57dc7f,0x3f099f4e
.long 0xbf5b941a,0x3f039c3d,0xbf49d112,0x3f1d7fd1,0xbf4e8d90,0x3f173c07,0xbf39f2ac,0x3f2ff3e6
.long 0xbf3fc767,0x3f299415,0xbf286605,0x3f40d0da,0xbf2f61a5,0x3f3a7ca4,0xbf1553b7,0x3f4fefa8
.long 0xbf1d7fd1,0x3f49d112,0xbf00e7e4,0x3f5d2d53,0xbf0a48ad,0x3f577026,0xbed6a399,0x3f686b39
.long 0xbeebcbbb,0x3f633c5a,0xbea986c4,0x3f718f57,0xbec1071e,0x3f6d1c1d,0xbe75c35a,0x3f788486
.long 0xbe94a031,0x3f74fa0b,0xbe164083,0x3f7d3aac,0xbe4dee60,0x3f7ac516,0xbd55880e,0x3f7fa6e3
.long 0xbde1bc2e,0x3f7e70b0,0x3d2fe007,0x3f7fc38f,0xbc96c9b6,0x3f7ff4e6,0x3e0cec4a,0x3f7d906e
.long 0x3d96a905,0x3f7f4e6d,0x3e6c9a7f,0x3f791298,0x3e28defc,0x3f7c7eb0,0x3ea5129f,0x3f725470
.long 0x3e827dc0,0x3f778bc5,0x3ed25a09,0x3f696591,0x3eaf713a,0x3f708066,0x3efdbabb,0x3f5e5aa6
.long 0x3edae880,0x3f676bd8,0x3f13682a,0x3f514d3d,0x3f0242b1,0x3f5c61c7,0x3f269de3,0x3f425b89
.long 0x3f15f6d9,0x3f4f7a1f,0x3f385216,0x3f31a81d,0x3f286605,0x3f40d0da,0x3f485bca,0x3f1f599f
.long 0x3f396842,0x3f3085bb,0x3f5695e5,0x3f0b9a6b,0x3f48d8b3,0x3f1ebc12,0x3f62df7b,0x3eed3063
.long 0x3f5695e5,0x3f0b9a6b,0x3f6d1c1d,0x3ec1071e,0x3f628210,0x3eee9479,0x3f75341d,0x3e931f35
.long 0x36124925,0x80000000,0x36124925,0x80000000,0x36124925,0x80000000,0x361248f7,0xb1e5c8e2
.long 0x36124925,0x80000000,0x36124870,0xb265c89b,0x36124925,0x80000000,0x3612478f,0xb2ac561c
.long 0x36124925,0x80000000,0x36124653,0xb2e5c780,0x36124925,0x80000000,0x361244bd,0xb30f9c2b
.long 0x36124925,0x80000000,0x361242cc,0xb32c543e,0x36124925,0x80000000,0x36124082,0xb3490be6
.long 0x36124925,0x80000000,0x36123ddd,0xb365c312,0x36124925,0x80000000,0x36123ade,0xb3813cd8
.long 0x36124925,0x80000000,0x36123785,0xb38f97d8,0x36124925,0x80000000,0x361233d2,0xb39df27f
.long 0x36124925,0x80000000,0x36122fc4,0xb3ac4cc4,0x36124925,0x80000000,0x36122b5d,0xb3baa69f
.long 0x36124925,0x80000000,0x3612269b,0xb3c90008,0x36124925,0x80000000,0x3612217f,0xb3d758f4
.long 0x36124925,0x80000000,0x36121c09,0xb3e5b15b,0x36124925,0x80000000,0x36121638,0xb3f40934
.long 0x36124925,0x80000000,0x3612100e,0xb401303c,0x36124925,0x80000000,0x3612098a,0xb4085b8e
.long 0x36124925,0x80000000,0x361202ab,0xb40f868b,0x36124925,0x80000000,0x3611fb72,0xb416b131
.long 0x36124925,0x80000000,0x3611f3e0,0xb41ddb79,0x36124925,0x80000000,0x3611ebf3,0xb4250560
.long 0x36124925,0x80000000,0x3611e3ac,0xb42c2ee1,0x36124925,0x80000000,0x3611db0c,0xb43357f8
.long 0x36124925,0x80000000,0x3611d211,0xb43a80a0,0x36124925,0x80000000,0x3611c8bc,0xb441a8d5
.long 0x36124925,0x80000000,0x3611bf0e,0xb448d093,0x36124925,0x80000000,0x3611b505,0xb44ff7d5
.long 0x36124925,0x80000000,0x3611aaa3,0xb4571e96,0x36124925,0x80000000,0x36119fe7,0xb45e44d3
.long 0x36124925,0x80000000,0x36124925,0x80000000,0x36123ddd,0xb365c312,0x36123ade,0xb3813cd8
.long 0x36121c09,0xb3e5b15b,0x3612100e,0xb401303c,0x3611e3ac,0xb42c2ee1,0x3611c8bc,0xb441a8d5
.long 0x361194d1,0xb4656a87,0x361164f7,0xb480fdd1,0x36112f82,0xb48f4166,0x3610e4d1,0xb4a10e0b
.long 0x3610b3d0,0xb4abb772,0x36104865,0xb4c0fed7,0x361021ce,0xb4c81302,0x360f8fcf,0xb4e0c9f8
.long 0x360f7991,0xb4e44fb9,0x360ebb35,0xb500349d,0x360ebb35,0xb500349d,0x360dcac0,0xb50feb39
.long 0x360de6d7,0xb50e2d99,0x360cbe9f,0xb51f85bf,0x360cfc96,0xb51c10a8,0x360b9706,0xb52f0122
.long 0x360bfc98,0xb529dba6,0x360a542f,0xb53e5a5e,0x360ae704,0xb5378c73,0x3608f659,0xb54d8e73
.long 0x3609bc05,0xb54520f2,0x36077dc8,0xb55c9a6b,0x36087bc8,0xb552970b,0x3605eac5,0xb56b7b55
.long 0x3607267f,0xb55fecab,0x36043da0,0xb57a2e49,0x3605bc5f,0xb56d1fc2,0x360276ac,0xb5845835
.long 0x36043da0,0xb57a2e49,0x36009641,0xb58b7f72,0x3602aa7c,0xb5838b1e,0x35fd397d,0xb5928b75
.long 0x36010332,0xb589eacf,0x35f9150b,0xb5997ade,0x35fe9006,0xb590353b,0x35f4bffe,0xb5a04c53
.long 0x35faf267,0xb596696a,0x35f03b2c,0xb5a6fe80,0x35f72e15,0xb59c8668,0x35eb8777,0xb5ad9015
.long 0x35f343a6,0xb5a28b42,0x35e6a5cc,0xb5b3ffcb,0x35ef33b3,0xb5a8770c,0x35e1971d,0xb5ba4c5f
.long 0x35eafede,0xb5ae48db,0x35dc5c66,0xb5c07498,0x35e6a5cc,0xb5b3ffcb,0x35d6f6af,0xb5c67741
.long 0x35e22928,0xb5b99af8,0x35d16703,0xb5cc532f,0x35dd89a5,0xb5bf1987,0x35cbae79,0xb5d2073c
.long 0x35d8c7f8,0xb5c47a9d,0x35c5ce2f,0xb5d7924c,0x35d3e4dd,0xb5c9bd68,0x35bfc74a,0xb5dcf34a
.long 0x36124925,0x80000000,0x36124925,0x80000000,0x36124870,0xb265c89b,0x3612478f,0xb2ac561c
.long 0x36124653,0xb2e5c780,0x361242cc,0xb32c543e,0x361242cc,0xb32c543e,0x36123ade,0xb3813cd8
.long 0x36123ddd,0xb365c312,0x36122fc4,0xb3ac4cc4,0x36123785,0xb38f97d8,0x3612217f,0xb3d758f4
.long 0x36122fc4,0xb3ac4cc4,0x3612100e,0xb401303c,0x3612269b,0xb3c90008,0x3611fb72,0xb416b131
.long 0x36121c09,0xb3e5b15b,0x3611e3ac,0xb42c2ee1,0x3612100e,0xb401303c,0x3611c8bc,0xb441a8d5
.long 0x361202ab,0xb40f868b,0x3611aaa3,0xb4571e96,0x3611f3e0,0xb41ddb79,0x36118961,0xb46c8fad
.long 0x3611e3ac,0xb42c2ee1,0x361164f7,0xb480fdd1,0x3611d211,0xb43a80a0,0x36113d66,0xb48bb100
.long 0x3611bf0e,0xb448d093,0x361112ae,0xb4966127,0x3611aaa3,0xb4571e96,0x3610e4d1,0xb4a10e0b
.long 0x361194d1,0xb4656a87,0x3610b3d0,0xb4abb772,0x36117d97,0xb473b441,0x36107fab,0xb4b65d1f
.long 0x361164f7,0xb480fdd1,0x36104865,0xb4c0fed7,0x36114af0,0xb4882044,0x36100dfd,0xb4cb9c60
.long 0x36112f82,0xb48f4166,0x360fd075,0xb4d6357f,0x361112ae,0xb4966127,0x360f8fcf,0xb4e0c9f8
.long 0x3610f474,0xb49d7f75,0x360f4c0c,0xb4eb5992,0x3610d4d5,0xb4a49c3e,0x360f052e,0xb4f5e411
.long 0x3610b3d0,0xb4abb772,0x360ebb35,0xb500349d,0x36109166,0xb4b2d0fd,0x360e6e25,0xb505746b
.long 0x36106d98,0xb4b9e8cf,0x360e1dfd,0xb50ab153,0x36104865,0xb4c0fed7,0x360dcac0,0xb50feb39
.long 0x361021ce,0xb4c81302,0x360d7471,0xb5152201,0x360ff9d3,0xb4cf2540,0x360d1b10,0xb51a558c
.long 0x360fd075,0xb4d6357f,0x360cbe9f,0xb51f85bf,0x360fa5b5,0xb4dd43ad,0x360c5f21,0xb524b27c
.long 0x36124925,0x80000000,0x36124925,0x80000000,0x36123785,0xb38f97d8,0x361233d2,0xb39df27f
.long 0x361202ab,0xb40f868b,0x3611f3e0,0xb41ddb79,0x3611aaa3,0xb4571e96,0x36118961,0xb46c8fad
.long 0x36112f82,0xb48f4166,0x3610f474,0xb49d7f75,0x36109166,0xb4b2d0fd,0x36103546,0xb4c48929
.long 0x360fd075,0xb4d6357f,0x360f4c0c,0xb4eb5992,0x360eecde,0xb4f96664,0x360e390d,0xb508f2af
.long 0x360de6d7,0xb50e2d99,0x360cfc96,0xb51c10a8,0x360cbe9f,0xb51f85bf,0x360b9706,0xb52f0122
.long 0x360b747e,0xb530b775,0x360a08c4,0xb541be97,0x360a08c4,0xb541be97,0x36085244,0xb5544390
.long 0x36087bc8,0xb552970b,0x36067407,0xb5668aa8,0x3606cde9,0xb5633cc2,0x36046e96,0xb5788e8a
.long 0x3604ff90,0xb573abb8,0x3602428b,0xb58524fb,0x3603112b,0xb581effd,0x35ffe10a,0xb58ddbe0
.long 0x36010332,0xb589eacf,0x35faf267,0xb596696a,0x35fdac47,0xb591c466,0x35f5ba9b,0xb59ecb1a
.long 0x35f9150b,0xb5997ade,0x35f03b2c,0xb5a6fe80,0x35f441cc,0xb5a10c5c,0x35ea75b4,0xb5af0136
.long 0x35ef33b3,0xb5a8770c,0x35e46be1,0xb5b6d0e8,0x35e9ebf9,0xb5afb925,0x35de1f77,0xb5be6b4d
.long 0x35e46be1,0xb5b6d0e8,0x35d7924c,0xb5c5ce2f,0x35deb4c1,0xb5bdbc9e,0x35d0c649,0xb5ccf767
.long 0x35d8c7f8,0xb5c47a9d,0x35c9bd68,0xb5d3e4dd,0x35d2a6f4,0xb5cb0946,0x35c279b6,0xb5da948e
.long 0x35cc532f,0xb5d16703,0x35bafd53,0xb5e10486,0x35c5ce2f,0xb5d7924c,0x35b34a6d,0xb5e732e4
.long 0x35bf1987,0xb5dd89a5,0x35ab6341,0xb5ed1ddb,0x35b836d3,0xb5e34b9d,0x35a34a1f,0xb5f2c3b2
.long 0x35b127bd,0xb5e8d6d2,0x359b0162,0xb5f822c3,0x35a9edf8,0xb5ee29ed,0x35928b75,0xb5fd397d
.long 0x36124925,0x80000000,0x36124925,0x80000000,0x36124653,0xb2e5c780,0x361244bd,0xb30f9c2b
.long 0x36123ddd,0xb365c312,0x36123785,0xb38f97d8,0x36122fc4,0xb3ac4cc4,0x3612217f,0xb3d758f4
.long 0x36121c09,0xb3e5b15b,0x361202ab,0xb40f868b,0x361202ab,0xb40f868b,0x3611db0c,0xb43357f8
.long 0x3611e3ac,0xb42c2ee1,0x3611aaa3,0xb4571e96,0x3611bf0e,0xb448d093,0x36117174,0xb47ad83f
.long 0x361194d1,0xb4656a87,0x36112f82,0xb48f4166,0x361164f7,0xb480fdd1,0x3610e4d1,0xb4a10e0b
.long 0x36112f82,0xb48f4166,0x36109166,0xb4b2d0fd,0x3610f474,0xb49d7f75,0x36103546,0xb4c48929
.long 0x3610b3d0,0xb4abb772,0x360fd075,0xb4d6357f,0x36106d98,0xb4b9e8cf,0x360f62fb,0xb4e7d4ed
.long 0x361021ce,0xb4c81302,0x360eecde,0xb4f96664,0x360fd075,0xb4d6357f,0x360e6e25,0xb505746b
.long 0x360f7991,0xb4e44fb9,0x360de6d7,0xb50e2d99,0x360f1d26,0xb4f26126,0x360d56fd,0xb516de37
.long 0x360ebb35,0xb500349d,0x360cbe9f,0xb51f85bf,0x360e53c4,0xb50733b6,0x360c1dc7,0xb52823aa
.long 0x360de6d7,0xb50e2d99,0x360b747e,0xb530b775,0x360d7471,0xb5152201,0x360ac2cf,0xb539409a
.long 0x360cfc96,0xb51c10a8,0x360a08c4,0xb541be97,0x360c7f4d,0xb522f94b,0x36094668,0xb54a30e8
.long 0x360bfc98,0xb529dba6,0x36087bc8,0xb552970b,0x360b747e,0xb530b775,0x3607a8ef,0xb55af07e
.long 0x360ae704,0xb5378c73,0x3606cde9,0xb5633cc2,0x360a542f,0xb53e5a5e,0x3605eac5,0xb56b7b55
.long 0x3609bc05,0xb54520f2,0x3604ff90,0xb573abb8,0x36091e8b,0xb54bdfec,0x36040c58,0xb57bcd6e
.long 0x36087bc8,0xb552970b,0x3603112b,0xb581effd,0x3607d3c2,0xb559460b,0x36020e19,0xb585f16e
.long 0x36124925,0x80000000,0x36124925,0x80000000,0x36122fc4,0xb3ac4cc4,0x36122b5d,0xb3baa69f
.long 0x3611e3ac,0xb42c2ee1,0x3611d211,0xb43a80a0,0x361164f7,0xb480fdd1,0x36113d66,0xb48bb100
.long 0x3610b3d0,0xb4abb772,0x36106d98,0xb4b9e8cf,0x360fd075,0xb4d6357f,0x360f62fb,0xb4e7d4ed
.long 0x360ebb35,0xb500349d,0x360e1dfd,0xb50ab153,0x360d7471,0xb5152201,0x360c9f21,0xb5213fb7
.long 0x360bfc98,0xb529dba6,0x360ae704,0xb5378c73,0x360a542f,0xb53e5a5e,0x3608f659,0xb54d8e73
.long 0x36087bc8,0xb552970b,0x3606cde9,0xb5633cc2,0x36067407,0xb5668aa8,0x36046e96,0xb5788e8a
.long 0x36043da0,0xb57a2e49,0x3601d958,0xb586bd8f,0x3601d958,0xb586bd8f,0x35fe1e75,0xb590fcfd
.long 0x35fe9006,0xb590353b,0x35f822c3,0xb59b0162,0x35f9150b,0xb5997ade,0x35f1c208,0xb5a4c6aa
.long 0x35f343a6,0xb5a28b42,0x35eafede,0xb5ae48db,0x35ed1ddb,0xb5ab6341,0x35e3dc06,0xb5b78416
.long 0x35e6a5cc,0xb5b3ffcb,0x35dc5c66,0xb5c07498,0x35dfddb7,0xb5bc5de1,0x35d4830e,0xb5c916be
.long 0x35d8c7f8,0xb5c47a9d,0x35cc532f,0xb5d16703,0x35d16703,0xb5cc532f,0x35c3d01e,0xb5d96206
.long 0x35c9bd68,0xb5d3e4dd,0x35bafd53,0xb5e10486,0x35c1cdce,0xb5db2d08,0x35b1de66,0xb5e84b67
.long 0x35b99af8,0xb5e22928,0x35a8770c,0xb5ef33b3,0x35b127bd,0xb5e8d6d2,0x359ecb1a,0xb5f5ba9b
.long 0x35a8770c,0xb5ef33b3,0x3594de81,0xb5fbdd75,0x359f8be8,0xb5f53d98,0x358ab54b,0xb600cce1
.long 0x3596696a,0xb5faf267,0x3580539b,0xb6037697,0x358d12bd,0xb6002813,0x356b7b55,0xb605eac5
.long 0x35838b1e,0xb602aa7c,0x3555ef93,0xb608286d,0x3573abb8,0xb604ff90,0x35400cb6,0xb60a2ea4
.long 0x36124925,0x80000000,0x36124925,0x80000000,0x361242cc,0xb32c543e,0x36124082,0xb3490be6
.long 0x36122fc4,0xb3ac4cc4,0x3612269b,0xb3c90008,0x3612100e,0xb401303c,0x3611fb72,0xb416b131
.long 0x3611e3ac,0xb42c2ee1,0x3611bf0e,0xb448d093,0x3611aaa3,0xb4571e96,0x36117174,0xb47ad83f
.long 0x361164f7,0xb480fdd1,0x361112ae,0xb4966127,0x361112ae,0xb4966127,0x3610a2c8,0xb4af446d
.long 0x3610b3d0,0xb4abb772,0x361021ce,0xb4c81302,0x36104865,0xb4c0fed7,0x360f8fcf,0xb4e0c9f8
.long 0x360fd075,0xb4d6357f,0x360eecde,0xb4f96664,0x360f4c0c,0xb4eb5992,0x360e390d,0xb508f2af
.long 0x360ebb35,0xb500349d,0x360d7471,0xb5152201,0x360e1dfd,0xb50ab153,0x360c9f21,0xb5213fb7
.long 0x360d7471,0xb5152201,0x360bb938,0xb52d4a63,0x360cbe9f,0xb51f85bf,0x360ac2cf,0xb539409a
.long 0x360bfc98,0xb529dba6,0x3609bc05,0xb54520f2,0x360b2e6d,0xb53422d2,0x3608a4f7,0xb550ea04
.long 0x360a542f,0xb53e5a5e,0x36077dc8,0xb55c9a6b,0x36096df1,0xb5488167,0x36064699,0xb56830c7
.long 0x36087bc8,0xb552970b,0x3604ff90,0xb573abb8,0x36077dc8,0xb55c9a6b,0x3603a8d3,0xb57f09e5
.long 0x36067407,0xb5668aa8,0x3602428b,0xb58524fb,0x36055e9c,0xb57066e6,0x3600cce1,0xb58ab54b
.long 0x36043da0,0xb57a2e49,0x35fe9006,0xb590353b,0x3603112b,0xb581effd,0x35fb683c,0xb595a424
.long 0x3601d958,0xb586bd8f,0x35f822c3,0xb59b0162,0x36009641,0xb58b7f72,0x35f4bffe,0xb5a04c53
.long 0x35fe9006,0xb590353b,0x35f14053,0xb5a58458,0x35fbdd75,0xb594de81,0x35eda42d,0xb5aaa8d1
.long 0x35f9150b,0xb5997ade,0x35e9ebf9,0xb5afb925,0x35f63706,0xb59e09eb,0x35e61826,0xb5b4b4b9
.long 0x36124925,0x80000000,0x36124925,0x80000000,0x3612269b,0xb3c90008,0x3612217f,0xb3d758f4
.long 0x3611bf0e,0xb448d093,0x3611aaa3,0xb4571e96,0x361112ae,0xb4966127,0x3610e4d1,0xb4a10e0b
.long 0x361021ce,0xb4c81302,0x360fd075,0xb4d6357f,0x360eecde,0xb4f96664,0x360e6e25,0xb505746b
.long 0x360d7471,0xb5152201,0x360cbe9f,0xb51f85bf,0x360bb938,0xb52d4a63,0x360ac2cf,0xb539409a
.long 0x3609bc05,0xb54520f2,0x36087bc8,0xb552970b,0x36077dc8,0xb55c9a6b,0x3605eac5,0xb56b7b55
.long 0x3604ff90,0xb573abb8,0x3603112b,0xb581effd,0x3602428b,0xb58524fb,0x35ffe10a,0xb58ddbe0
.long 0x35fe9006,0xb590353b,0x35f9150b,0xb5997ade,0x35f822c3,0xb59b0162,0x35f1c208,0xb5a4c6aa
.long 0x35f14053,0xb5a58458,0x35e9ebf9,0xb5afb925,0x35e9ebf9,0xb5afb925,0x35e1971d,0xb5ba4c5f
.long 0x35e22928,0xb5b99af8,0x35d8c7f8,0xb5c47a9d,0x35d9fb8d,0xb5c32527,0x35cf8352,0xb5ce3e5b
.long 0x35d16703,0xb5cc532f,0x35c5ce2f,0xb5d7924c,0x35c86f98,0xb5d520bc,0x35bbadd4,0xb5e07164
.long 0x35bf1987,0xb5dd89a5,0x35b127bd,0xb5e8d6d2,0x35b56939,0xb5e589f2,0x35a6419f,0xb5f0be0a
.long 0x35ab6341,0xb5ed1ddb,0x359b0162,0xb5f822c3,0x35a10c5c,0xb5f441cc,0x358f6d20,0xb5ff00fa
.long 0x3596696a,0xb5faf267,0x35838b1e,0xb602aa7c,0x358b7f72,0xb6009641,0x356ec39e,0xb6058da7
.long 0x3580539b,0xb6037697,0x3555ef93,0xb608286d,0x3569d656,0xb60618d8,0x353ca791,0xb60a7965
.long 0x3552970b,0xb6087bc8,0x3522f94b,0xb60c7f4d,0x353af44f,0xb60a9e45,0x3508f2af,0xb60e390d
.long 0x3522f94b,0xb60c7f4d,0x34dd43ad,0xb60fa5b5,0x350ab153,0xb60e1dfd,0x34a82a0c,0xb610c47f
.long 0x36124925,0x80000000,0x36124925,0x80000000,0x36121c09,0xb3e5b15b,0x36121638,0xb3f40934
.long 0x361194d1,0xb4656a87,0x36117d97,0xb473b441,0x3610b3d0,0xb4abb772,0x36107fab,0xb4b65d1f
.long 0x360f7991,0xb4e44fb9,0x360f1d26,0xb4f26126,0x360de6d7,0xb50e2d99,0x360d56fd,0xb516de37
.long 0x360bfc98,0xb529dba6,0x360b2e6d,0xb53422d2,0x3609bc05,0xb54520f2,0x3608a4f7,0xb550ea04
.long 0x3607267f,0xb55fecab,0x3605bc5f,0xb56d1fc2,0x36043da0,0xb57a2e49,0x360276ac,0xb5845835
.long 0x36010332,0xb589eacf,0x35fdac47,0xb591c466,0x35faf267,0xb596696a,0x35f5ba9b,0xb59ecb1a
.long 0x35f343a6,0xb5a28b42,0x35ed1ddb,0xb5ab6341,0x35eafede,0xb5ae48db,0x35e3dc06,0xb5b78416
.long 0x35e22928,0xb5b99af8,0x35d9fb8d,0xb5c32527,0x35d8c7f8,0xb5c47a9d,0x35cf8352,0xb5ce3e5b
.long 0x35cee116,0xb5cee116,0x35c47a9d,0xb5d8c7f8,0x35c47a9d,0xb5d8c7f8,0x35b8e91f,0xb5e2baa9
.long 0x35b99af8,0xb5e22928,0x35acd6e4,0xb5ec0f80,0x35ae48db,0xb5eafede,0x35a04c53,0xb5f4bffe
.long 0x35a28b42,0xb5f343a6,0x35935229,0xb5fcc616,0x3596696a,0xb5faf267,0x3585f16e,0xb6020e19
.long 0x3589eacf,0xb6010332,0x357066e6,0xb6055e9c,0x357a2e49,0xb6043da0,0x35544390,0xb6085244
.long 0x355fecab,0xb607267f,0x35378c73,0xb60ae704,0x354520f2,0xb609bc05,0x351a558c,0xb60d1b10
.long 0x3529dba6,0xb60bfc98,0x34f96664,0xb60eecde,0x350e2d99,0xb60de6d7,0x34bd740e,0xb6105b2b
.long 0x34e44fb9,0xb60f7991,0x3480fdd1,0xb61164f7,0x34abb772,0xb610b3d0,0x34085b8e,0xb612098a
.long 0x34656a87,0xb61194d1,0x3265c89b,0xb6124870,0x33e5b15b,0xb6121c09,0xb3d758f4,0xb612217f
.long 0x36124925,0x80000000,0x36124925,0x80000000,0x3611e3ac,0xb42c2ee1,0x3611db0c,0xb43357f8
.long 0x3610b3d0,0xb4abb772,0x36109166,0xb4b2d0fd,0x360ebb35,0xb500349d,0x360e6e25,0xb505746b
.long 0x360bfc98,0xb529dba6,0x360b747e,0xb530b775,0x36087bc8,0xb552970b,0x3607a8ef,0xb55af07e
.long 0x36043da0,0xb57a2e49,0x3603112b,0xb581effd,0x35fe9006,0xb590353b,0x35fb683c,0xb595a424
.long 0x35f343a6,0xb5a28b42,0x35ef33b3,0xb5a8770c,0x35e6a5cc,0xb5b3ffcb,0x35e1971d,0xb5ba4c5f
.long 0x35d8c7f8,0xb5c47a9d,0x35d2a6f4,0xb5cb0946,0x35c9bd68,0xb5d3e4dd,0x35c279b6,0xb5da948e
.long 0x35b99af8,0xb5e22928,0x35b127bd,0xb5e8d6d2,0x35a8770c,0xb5ef33b3,0x359ecb1a,0xb5f5ba9b
.long 0x3596696a,0xb5faf267,0x358b7f72,0xb6009641,0x35838b1e,0xb602aa7c,0x356ec39e,0xb6058da7
.long 0x355fecab,0xb607267f,0x354520f2,0xb609bc05,0x35378c73,0xb60ae704,0x351a558c,0xb60d1b10
.long 0x350e2d99,0xb60de6d7,0x34dd43ad,0xb60fa5b5,0x34c81302,0xb61021ce,0x34848f33,0xb6115820
.long 0x34656a87,0xb61194d1,0x33ac4cc4,0xb6122fc4,0x3365c312,0xb6123ddd,0xb3baa69f,0xb6122b5d
.long 0xb3e5b15b,0xb6121c09,0xb4882044,0xb6114af0,0xb48f4166,0xb6112f82,0xb4e0c9f8,0xb60f8fcf
.long 0xb4e44fb9,0xb60f7991,0xb51c10a8,0xb60cfc96,0xb51c10a8,0xb60cfc96,0xb546d16a,0xb6099525
.long 0xb54520f2,0xb609bc05,0xb57066e6,0xb6055e9c,0xb56d1fc2,0xb605bc5f,0xb58c4943,0xb6005f52
.long 0xb589eacf,0xb6010332,0xb59f8be8,0xb5f53d98,0xb59c8668,0xb5f72e15,0xb5b1de66,0xb5e84b67
.long 0xb5ae48db,0xb5eafede,0xb5c32527,0xb5d9fb8d,0xb5bf1987,0xb5dd89a5,0xb5d3462a,0xb5ca6395
.long 0x36124925,0x80000000,0x36124925,0x80000000,0x3612100e,0xb401303c,0x3612098a,0xb4085b8e
.long 0x361164f7,0xb480fdd1,0x36114af0,0xb4882044,0x36104865,0xb4c0fed7,0x36100dfd,0xb4cb9c60
.long 0x360ebb35,0xb500349d,0x360e53c4,0xb50733b6,0x360cbe9f,0xb51f85bf,0x360c1dc7,0xb52823aa
.long 0x360a542f,0xb53e5a5e,0x36096df1,0xb5488167,0x36077dc8,0xb55c9a6b,0x36064699,0xb56830c7
.long 0x36043da0,0xb57a2e49,0x3602aa7c,0xb5838b1e,0x36009641,0xb58b7f72,0x35fd397d,0xb5928b75
.long 0x35f9150b,0xb5997ade,0x35f441cc,0xb5a10c5c,0x35f03b2c,0xb5a6fe80,0x35ea75b4,0xb5af0136
.long 0x35e6a5cc,0xb5b3ffcb,0x35dfddb7,0xb5bc5de1,0x35dc5c66,0xb5c07498,0x35d4830e,0xb5c916be
.long 0x35d16703,0xb5cc532f,0x35c86f98,0xb5d520bc,0x35c5ce2f,0xb5d7924c,0x35bbadd4,0xb5e07164
.long 0x35b99af8,0xb5e22928,0x35ae48db,0xb5eafede,0x35acd6e4,0xb5ec0f80,0x35a04c53,0xb5f4bffe
.long 0x359f8be8,0xb5f53d98,0x3591c466,0xb5fdac47,0x3591c466,0xb5fdac47,0x3582bdb6,0xb602ddfc
.long 0x35838b1e,0xb602aa7c,0x35668aa8,0xb6067407,0x3569d656,0xb60618d8,0x3546d16a,0xb6099525
.long 0x354bdfec,0xb6091e8b,0x35266b46,0xb60c3ea0,0x352d4a63,0xb60bb938,0x3505746b,0xb60e6e25
.long 0x350e2d99,0xb60de6d7,0x34c81302,0xb61021ce,0x34dd43ad,0xb60fa5b5,0x34848f33,0xb6115820
.long 0x349d7f75,0xb610f474,0x3401303c,0xb612100e,0x343a80a0,0xb611d211,0xb1e5c8e2,0xb61248f7
.long 0x3365c312,0xb6123ddd,0xb40f868b,0xb61202ab,0xb38f97d8,0xb6123785,0xb48bb100,0xb6113d66
.long 0xb448d093,0xb611bf0e,0xb4cf2540,0xb60ff9d3,0xb4a49c3e,0xb610d4d5,0xb508f2af,0xb60e390d
.long 0x36124925,0x80000000,0x36124925,0x80000000,0x3611d211,0xb43a80a0,0x3611c8bc,0xb441a8d5
.long 0x36106d98,0xb4b9e8cf,0x36104865,0xb4c0fed7,0x360e1dfd,0xb50ab153,0x360dcac0,0xb50feb39
.long 0x360ae704,0xb5378c73,0x360a542f,0xb53e5a5e,0x3606cde9,0xb5633cc2,0x3605eac5,0xb56b7b55
.long 0x3601d958,0xb586bd8f,0x36009641,0xb58b7f72,0x35f822c3,0xb59b0162,0x35f4bffe,0xb5a04c53
.long 0x35eafede,0xb5ae48db,0x35e6a5cc,0xb5b3ffcb,0x35dc5c66,0xb5c07498,0x35d6f6af,0xb5c67741
.long 0x35cc532f,0xb5d16703,0x35c5ce2f,0xb5d7924c,0x35bafd53,0xb5e10486,0x35b34a6d,0xb5e732e4
.long 0x35a8770c,0xb5ef33b3,0x359f8be8,0xb5f53d98,0x3594de81,0xb5fbdd75,0x358ab54b,0xb600cce1
.long 0x3580539b,0xb6037697,0x3569d656,0xb60618d8,0x3555ef93,0xb608286d,0x353ca791,0xb60a7965
.long 0x3529dba6,0xb60bfc98,0x350e2d99,0xb60de6d7,0x34f96664,0xb60eecde,0x34bd740e,0xb6105b2b
.long 0x349d7f75,0xb610f474,0x343a80a0,0xb611d211,0x3401303c,0xb612100e,0xb1e5c8e2,0xb61248f7
.long 0xb365c312,0xb6123ddd,0xb448d093,0xb611bf0e,0xb473b441,0xb6117d97,0xb4c48929,0xb6103546
.long 0xb4d6357f,0xb60fd075,0xb511a880,0xb60dae53,0xb5189a11,0xb60d3932,0xb5400cb6,0xb60a2ea4
.long 0xb54520f2,0xb609bc05,0xb56d1fc2,0xb605bc5f,0xb57066e6,0xb6055e9c,0xb58c4943,0xb6005f52
.long 0xb58d12bd,0xb6002813,0xb5a10c5c,0xb5f441cc,0xb5a10c5c,0xb5f441cc,0xb5b4b4b9,0xb5e61826
.long 0xb5b3ffcb,0xb5e6a5cc,0xb5c71fd9,0xb5d65a8d,0xb5c5ce2f,0xb5d7924c,0xb5d82d65,0xb5c524a3
.long 0xb5d65a8d,0xb5c71fd9,0xb5e7bf6d,0xb5b294a0,0xb5e589f2,0xb5b56939,0xb5f5ba9b,0xb59ecb1a
.long 0x36124925,0x80000000,0x36124925,0x80000000,0x361202ab,0xb40f868b,0x3611fb72,0xb416b131
.long 0x36112f82,0xb48f4166,0x361112ae,0xb4966127,0x360fd075,0xb4d6357f,0x360f8fcf,0xb4e0c9f8
.long 0x360de6d7,0xb50e2d99,0x360d7471,0xb5152201,0x360b747e,0xb530b775,0x360ac2cf,0xb539409a
.long 0x36087bc8,0xb552970b,0x36077dc8,0xb55c9a6b,0x3604ff90,0xb573abb8,0x3603a8d3,0xb57f09e5
.long 0x36010332,0xb589eacf,0x35fe9006,0xb590353b,0x35f9150b,0xb5997ade,0x35f4bffe,0xb5a04c53
.long 0x35ef33b3,0xb5a8770c,0x35e9ebf9,0xb5afb925,0x35e46be1,0xb5b6d0e8,0x35de1f77,0xb5be6b4d
.long 0x35d8c7f8,0xb5c47a9d,0x35d16703,0xb5cc532f,0x35cc532f,0xb5d16703,0x35c3d01e,0xb5d96206
.long 0x35bf1987,0xb5dd89a5,0x35b56939,0xb5e589f2,0x35b127bd,0xb5e8d6d2,0x35a6419f,0xb5f0be0a
.long 0x35a28b42,0xb5f343a6,0x3596696a,0xb5faf267,0x35935229,0xb5fcc616,0x3585f16e,0xb6020e19
.long 0x35838b1e,0xb602aa7c,0x3569d656,0xb60618d8,0x35668aa8,0xb6067407,0x3546d16a,0xb6099525
.long 0x354520f2,0xb609bc05,0x3522f94b,0xb60c7f4d,0x3522f94b,0xb60c7f4d,0x34fce81d,0xb60ed436
.long 0x3500349d,0xb60ebb35,0x34b2d0fd,0xb6109166,0x34b9e8cf,0xb6106d98,0x344ff7d5,0xb611b505
.long 0x34656a87,0xb61194d1,0x3365c312,0xb6123ddd,0x33ac4cc4,0xb6122fc4,0xb3baa69f,0xb6122b5d
.long 0xb365c312,0xb6123ddd,0xb473b441,0xb6117d97,0xb448d093,0xb611bf0e,0xb4c48929,0xb6103546
.long 0xb4abb772,0xb610b3d0,0xb50733b6,0xb60e53c4,0xb4f26126,0xb60f1d26,0xb52b933a,0xb60bdb13
.long 0xb51c10a8,0xb60cfc96,0xb54f3c7b,0xb608cdd2,0xb53e5a5e,0xb60a542f,0xb572099a,0xb6052f3f
.long 0x36124925,0x80000000,0x36124925,0x80000000,0x3611bf0e,0xb448d093,0x3611b505,0xb44ff7d5
.long 0x361021ce,0xb4c81302,0x360ff9d3,0xb4cf2540,0x360d7471,0xb5152201,0x360d1b10,0xb51a558c
.long 0x3609bc05,0xb54520f2,0x36091e8b,0xb54bdfec,0x3604ff90,0xb573abb8,0x36040c58,0xb57bcd6e
.long 0x35fe9006,0xb590353b,0x35fbdd75,0xb594de81,0x35f14053,0xb5a58458,0x35eda42d,0xb5aaa8d1
.long 0x35e22928,0xb5b99af8,0x35dd89a5,0xb5bf1987,0x35d16703,0xb5cc532f,0x35cbae79,0xb5d2073c
.long 0x35bf1987,0xb5dd89a5,0x35b836d3,0xb5e34b9d,0x35ab6341,0xb5ed1ddb,0x35a34a1f,0xb5f2c3b2
.long 0x3596696a,0xb5faf267,0x358d12bd,0xb6002813,0x3580539b,0xb6037697,0x356b7b55,0xb605eac5
.long 0x3552970b,0xb6087bc8,0x353af44f,0xb60a9e45,0x3522f94b,0xb60c7f4d,0x3508f2af,0xb60e390d
.long 0x34e44fb9,0xb60f7991,0x34abb772,0xb610b3d0,0x3480fdd1,0xb61164f7,0x34085b8e,0xb612098a
.long 0x3365c312,0xb6123ddd,0xb38f97d8,0xb6123785,0xb40f868b,0xb61202ab,0xb48bb100,0xb6113d66
.long 0xb4abb772,0xb610b3d0,0xb4f26126,0xb60f1d26,0xb50733b6,0xb60e53c4,0xb52b933a,0xb60bdb13
.long 0xb5378c73,0xb60ae704,0xb55c9a6b,0xb6077dc8,0xb5668aa8,0xb6067407,0xb585f16e,0xb6020e19
.long 0xb589eacf,0xb6010332,0xb59c8668,0xb5f72e15,0xb59f8be8,0xb5f53d98,0xb5b1de66,0xb5e84b67
.long 0xb5b3ffcb,0xb5e6a5cc,0xb5c5ce2f,0xb5d7924c,0xb5c71fd9,0xb5d65a8d,0xb5d82d65,0xb5c524a3
.long 0xb5d8c7f8,0xb5c47a9d,0xb5e8d6d2,0xb5b127bd,0xb5e8d6d2,0xb5b127bd,0xb5f7a8b8,0xb59bc415
.long 0xb5f72e15,0xb59c8668,0xb602428b,0xb58524fb,0xb601d958,0xb586bd8f,0xb607a8ef,0xb55af07e
.long 0x36124925,0x80000000,0x36124925,0x80000000,0x3611f3e0,0xb41ddb79,0x3611ebf3,0xb4250560
.long 0x3610f474,0xb49d7f75,0x3610d4d5,0xb4a49c3e,0x360f4c0c,0xb4eb5992,0x360f052e,0xb4f5e411
.long 0x360cfc96,0xb51c10a8,0x360c7f4d,0xb522f94b,0x360a08c4,0xb541be97,0x36094668,0xb54a30e8
.long 0x36067407,0xb5668aa8,0x36055e9c,0xb57066e6,0x3602428b,0xb58524fb,0x3600cce1,0xb58ab54b
.long 0x35faf267,0xb596696a,0x35f72e15,0xb59c8668,0x35f03b2c,0xb5a6fe80,0x35eb8777,0xb5ad9015
.long 0x35e46be1,0xb5b6d0e8,0x35deb4c1,0xb5bdbc9e,0x35d7924c,0xb5c5ce2f,0x35d0c649,0xb5ccf767
.long 0x35c9bd68,0xb5d3e4dd,0x35c1cdce,0xb5db2d08,0x35bafd53,0xb5e10486,0x35b1de66,0xb5e84b67
.long 0x35ab6341,0xb5ed1ddb,0x35a10c5c,0xb5f441cc,0x359b0162,0xb5f822c3,0x358f6d20,0xb5ff00fa
.long 0x3589eacf,0xb6010332,0x357a2e49,0xb6043da0,0x357066e6,0xb6055e9c,0x35544390,0xb6085244
.long 0x354bdfec,0xb6091e8b,0x352d4a63,0xb60bb938,0x35266b46,0xb60c3ea0,0x3505746b,0xb60e6e25
.long 0x3500349d,0xb60ebb35,0x34b9e8cf,0xb6106d98,0x34b2d0fd,0xb6109166,0x344ff7d5,0xb611b505
.long 0x3448d093,0xb611bf0e,0x332c543e,0xb61242cc,0x332c543e,0xb61242cc,0xb3f40934,0xb6121638
.long 0xb3e5b15b,0xb6121c09,0xb48f4166,0xb6112f82,0xb4882044,0xb6114af0,0xb4e0c9f8,0xb60f8fcf
.long 0xb4d6357f,0xb60fd075,0xb5189a11,0xb60d3932,0xb511a880,0xb60dae53,0xb5400cb6,0xb60a2ea4
.long 0xb5378c73,0xb60ae704,0xb5668aa8,0xb6067407,0xb55c9a6b,0xb6077dc8,0xb585f16e,0xb6020e19
.long 0xb580539b,0xb6037697,0xb597f2e0,0xb5fa04ee,0xb591c466,0xb5fdac47,0xb5a932b6,0xb5eeaf1a
.long 0x36124925,0x80000000,0x36124925,0x80000000,0x3611aaa3,0xb4571e96,0x36119fe7,0xb45e44d3
.long 0x360fd075,0xb4d6357f,0x360fa5b5,0xb4dd43ad,0x360cbe9f,0xb51f85bf,0x360c5f21,0xb524b27c
.long 0x36087bc8,0xb552970b,0x3607d3c2,0xb559460b,0x3603112b,0xb581effd,0x36020e19,0xb585f16e
.long 0x35f9150b,0xb5997ade,0x35f63706,0xb59e09eb,0x35e9ebf9,0xb5afb925,0x35e61826,0xb5b4b4b9
.long 0x35d8c7f8,0xb5c47a9d,0x35d3e4dd,0xb5c9bd68,0x35c5ce2f,0xb5d7924c,0x35bfc74a,0xb5dcf34a
.long 0x35b127bd,0xb5e8d6d2,0x35a9edf8,0xb5ee29ed,0x359b0162,0xb5f822c3,0x35928b75,0xb5fd397d
.long 0x35838b1e,0xb602aa7c,0x3573abb8,0xb604ff90,0x3555ef93,0xb608286d,0x35400cb6,0xb60a2ea4
.long 0x3522f94b,0xb60c7f4d,0x350ab153,0xb60e1dfd,0x34dd43ad,0xb60fa5b5,0x34a82a0c,0xb610c47f
.long 0x34656a87,0xb61194d1,0x33e5b15b,0xb6121c09,0x3265c89b,0xb6124870,0xb3d758f4,0xb612217f
.long 0xb448d093,0xb611bf0e,0xb4a49c3e,0xb610d4d5,0xb4cf2540,0xb60ff9d3,0xb508f2af,0xb60e390d
.long 0xb51c10a8,0xb60cfc96,0xb53e5a5e,0xb60a542f,0xb54f3c7b,0xb608cdd2,0xb572099a,0xb6052f3f
.long 0xb580539b,0xb6037697,0xb591c466,0xb5fdac47,0xb597f2e0,0xb5fa04ee,0xb5a932b6,0xb5eeaf1a
.long 0xb5ae48db,0xb5eafede,0xb5bf1987,0xb5dd89a5,0xb5c32527,0xb5d9fb8d,0xb5d3462a,0xb5ca6395
.long 0xb5d65a8d,0xb5c71fd9,0xb5e589f2,0xb5b56939,0xb5e7bf6d,0xb5b294a0,0xb5f5ba9b,0xb59ecb1a
.long 0xb5f72e15,0xb59c8668,0xb601d958,0xb586bd8f,0xb602428b,0xb58524fb,0xb607a8ef,0xb55af07e
.long 0xb607d3c2,0xb559460b,0xb60c3ea0,0xb5266b46,0xb60c3ea0,0xb5266b46,0xb60f8fcf,0xb4e0c9f8
.long 0x36124925,0x80000000,0x36124925,0x80000000,0x361194d1,0xb4656a87,0x36118961,0xb46c8fad
.long 0x360f7991,0xb4e44fb9,0x360f4c0c,0xb4eb5992,0x360bfc98,0xb529dba6,0x360b9706,0xb52f0122
.long 0x3607267f,0xb55fecab,0x36067407,0xb5668aa8,0x36010332,0xb589eacf,0x35ffe10a,0xb58ddbe0
.long 0x35f343a6,0xb5a28b42,0x35f03b2c,0xb5a6fe80,0x35e22928,0xb5b99af8,0x35de1f77,0xb5be6b4d
.long 0x35cee116,0xb5cee116,0x35c9bd68,0xb5d3e4dd,0x35b99af8,0xb5e22928,0x35b34a6d,0xb5e732e4
.long 0x35a28b42,0xb5f343a6,0x359b0162,0xb5f822c3,0x3589eacf,0xb6010332,0x358121f4,0xb6034409
.long 0x355fecab,0xb607267f,0x354bdfec,0xb6091e8b,0x3529dba6,0xb60bfc98,0x3513656e,0xb60d918d
.long 0x34e44fb9,0xb60f7991,0x34b2d0fd,0xb6109166,0x34656a87,0xb61194d1,0x33f40934,0xb6121638
.long 0x1b215ccb,0xb6124925,0xb3e5b15b,0xb6121c09,0xb4656a87,0xb61194d1,0xb4af446d,0xb610a2c8
.long 0xb4e44fb9,0xb60f7991,0xb511a880,0xb60dae53,0xb529dba6,0xb60bfc98,0xb54a30e8,0xb6094668
.long 0xb55fecab,0xb607267f,0xb580539b,0xb6037697,0xb589eacf,0xb6010332,0xb59a3e50,0xb5f89c34
.long 0xb5a28b42,0xb5f343a6,0xb5b294a0,0xb5e7bf6d,0xb5b99af8,0xb5e22928,0xb5c916be,0xb5d4830e
.long 0xb5cee116,0xb5cee116,0xb5dd89a5,0xb5bf1987,0xb5e22928,0xb5b99af8,0xb5efb7ba,0xb5a7bafa
.long 0xb5f343a6,0xb5a28b42,0xb5ff7151,0xb58ea4ac,0xb6010332,0xb589eacf,0xb6064699,0xb56830c7
.long 0xb607267f,0xb55fecab,0xb60b747e,0xb530b775,0xb60bfc98,0xb529dba6,0xb60f34c5,0xb4eedda6
.long 0xb60f7991,0xb4e44fb9,0xb6117d97,0xb473b441,0xb61194d1,0xb4656a87,0xb61248f7,0xb1e5c8e2
.long 0x36124925,0x80000000,0x36124925,0x80000000,0x36112f82,0xb48f4166,0x36112145,0xb492d174
.long 0x360de6d7,0xb50e2d99,0x360dae53,0xb511a880,0x36087bc8,0xb552970b,0x3607fe41,0xb5579b11
.long 0x36010332,0xb589eacf,0x36002813,0xb58d12bd,0x35ef33b3,0xb5a8770c,0x35ec96f6,0xb5ac1d48
.long 0x35d8c7f8,0xb5c47a9d,0x35d520bc,0xb5c86f98,0x35bf1987,0xb5dd89a5,0x35ba4c5f,0xb5e1971d
.long 0x35a28b42,0xb5f343a6,0x359c8668,0xb5f72e15,0x35838b1e,0xb602aa7c,0x35788e8a,0xb6046e96
.long 0x354520f2,0xb609bc05,0x353422d2,0xb60b2e6d,0x3500349d,0xb60ebb35,0x34d9bcd9,0xb60fbb41
.long 0x34656a87,0xb61194d1,0x340f868b,0xb61202ab,0xb365c312,0xb6123ddd,0xb416b131,0xb611fb72
.long 0xb4abb772,0xb610b3d0,0xb4dd43ad,0xb60fa5b5,0xb51c10a8,0xb60cfc96,0xb535d7db,0xb60b0ae4
.long 0xb55fecab,0xb607267f,0xb57a2e49,0xb6043da0,0xb590353b,0xb5fe9006,0xb59d485a,0xb5f6b2da
.long 0xb5ae48db,0xb5eafede,0xb5bafd53,0xb5e10486,0xb5c9bd68,0xb5d3e4dd,0xb5d5bde6,0xb5c7c7f6
.long 0xb5e22928,0xb5b99af8,0xb5ed1ddb,0xb5ab6341,0xb5f72e15,0xb59c8668,0xb6005f52,0xb58c4943
.long 0xb6043da0,0xb57a2e49,0xb608286d,0xb555ef93,0xb60ae704,0xb5378c73,0xb60dcac0,0xb50feb39
.long 0xb60f7991,0xb4e44fb9,0xb6112f82,0xb48f4166,0xb611e3ac,0xb42c2ee1,0xb61248f7,0x31e5c8e2
.long 0xb6121c09,0x33e5b15b,0xb61112ae,0x34966127,0xb61021ce,0x34c81302,0xb60d918d,0x3513656e
.long 0xb60bfc98,0x3529dba6,0xb607d3c2,0x3559460b,0xb605bc5f,0x356d1fc2,0xb5ffe10a,0x358ddbe0
.long 0xb5faf267,0x3596696a,0xb5ec0f80,0x35acd6e4,0xb5e6a5cc,0x35b3ffcb,0xb5d4830e,0x35c916be
.long 0x36124925,0x80000000,0x36124925,0x80000000,0x36117d97,0xb473b441,0x36117174,0xb47ad83f
.long 0x360f1d26,0xb4f26126,0x360eecde,0xb4f96664,0x360b2e6d,0xb53422d2,0x360ac2cf,0xb539409a
.long 0x3605bc5f,0xb56d1fc2,0x3604ff90,0xb573abb8,0x35fdac47,0xb591c466,0x35fb683c,0xb595a424
.long 0x35ed1ddb,0xb5ab6341,0x35e9ebf9,0xb5afb925,0x35d9fb8d,0xb5c32527,0x35d5bde6,0xb5c7c7f6
.long 0x35c47a9d,0xb5d8c7f8,0x35bf1987,0xb5dd89a5,0x35acd6e4,0xb5ec0f80,0x35a6419f,0xb5f0be0a
.long 0x35935229,0xb5fcc616,0x358b7f72,0xb6009641,0x357066e6,0xb6055e9c,0x355e43cf,0xb607524d
.long 0x35378c73,0xb60ae704,0x3522f94b,0xb60c7f4d,0x34f96664,0xb60eecde,0x34cb9c60,0xb6100dfd
.long 0x3480fdd1,0xb61164f7,0x341ddb79,0xb611f3e0,0x3265c89b,0xb6124870,0xb3baa69f,0xb6122b5d
.long 0xb4656a87,0xb61194d1,0xb4abb772,0xb610b3d0,0xb4eb5992,0xb60f4c0c,0xb513656e,0xb60d918d
.long 0xb530b775,0xb60b747e,0xb54f3c7b,0xb608cdd2,0xb569d656,0xb60618d8,0xb5845835,0xb60276ac
.long 0xb590353b,0xb5fe9006,0xb59f8be8,0xb5f53d98,0xb5a9edf8,0xb5ee29ed,0xb5b8e91f,0xb5e2baa9
.long 0xb5c1cdce,0xb5db2d08,0xb5d0250d,0xb5cd9b20,0xb5d7924c,0xb5c5ce2f,0xb5e4fb30,0xb5b61d48
.long 0xb5eafede,0xb5ae48db,0xb5f72e15,0xb59c8668,0xb5fbdd75,0xb594de81,0xb6034409,0xb58121f4
.long 0xb604ff90,0xb573abb8,0xb6096df1,0xb5488167,0xb60a9e45,0xb53af44f,0xb60e0296,0xb50c6fa1
.long 0xb60ebb35,0xb500349d,0xb610f474,0xb49d7f75,0xb6114af0,0xb4882044,0xb6123ade,0xb3813cd8
.long 0xb6124653,0xb2e5c780,0xb611d211,0x343a80a0,0xb611aaa3,0x34571e96,0xb60fbb41,0x34d9bcd9
.long 0x36124925,0x80000000,0x36124925,0x80000000,0x361112ae,0xb4966127,0x361103be,0xb499f07e
.long 0x360d7471,0xb5152201,0x360d3932,0xb5189a11,0x36077dc8,0xb55c9a6b,0x3606fa5e,0xb56194fc
.long 0x35fe9006,0xb590353b,0x35fcc616,0xb5935229,0x35e9ebf9,0xb5afb925,0x35e732e4,0xb5b34a6d
.long 0x35d16703,0xb5cc532f,0x35cd9b20,0xb5d0250d,0x35b56939,0xb5e589f2,0x35b070a8,0xb5e961ad
.long 0x3596696a,0xb5faf267,0x3590353b,0xb5fe9006,0x3569d656,0xb60618d8,0x355af07e,0xb607a8ef
.long 0x3522f94b,0xb60c7f4d,0x3511a880,0xb60dae53,0x34b2d0fd,0xb6109166,0x348bb100,0xb6113d66
.long 0x3365c312,0xb6123ddd,0xb2e5c780,0xb6124653,0xb473b441,0xb6117d97,0xb4a82a0c,0xb610c47f
.long 0xb50733b6,0xb60e53c4,0xb51f85bf,0xb60cbe9f,0xb54f3c7b,0xb608cdd2,0xb56830c7,0xb6064699
.long 0xb589eacf,0xb6010332,0xb596696a,0xb5faf267,0xb5a9edf8,0xb5ee29ed,0xb5b61d48,0xb5e4fb30
.long 0xb5c71fd9,0xb5d65a8d,0xb5d2a6f4,0xb5cb0946,0xb5e10486,0xb5bafd53,0xb5eb8777,0xb5ad9015
.long 0xb5f72e15,0xb59c8668,0xb6002813,0xb58d12bd,0xb6049f3b,0xb576ee32,0xb6085244,0xb5544390
.long 0xb60b747e,0xb530b775,0xb60e1dfd,0xb50ab153,0xb60ff9d3,0xb4cf2540,0xb6117174,0xb47ad83f
.long 0xb6121c09,0xb3e5b15b,0xb6123ddd,0x3365c312,0xb611d211,0x343a80a0,0xb6107fab,0x34b65d1f
.long 0xb60f1d26,0x34f26126,0xb60c3ea0,0x35266b46,0xb60a08c4,0x3541be97,0xb6058da7,0x356ec39e
.long 0xb602aa7c,0x35838b1e,0xb5f9150b,0x35997ade,0xb5f24328,0x35a40897,0xb5e2baa9,0x35b8e91f
.long 0xb5db2d08,0x35c1cdce,0xb5c86f98,0x35d520bc,0xb5c07498,0x35dc5c66,0xb5aaa8d1,0x35eda42d
.long 0x36124925,0x80000000,0x36124925,0x80000000,0x361164f7,0xb480fdd1,0x36115820,0xb4848f33
.long 0x360ebb35,0xb500349d,0x360e882d,0xb503b4cc,0x360a542f,0xb53e5a5e,0x3609e28f,0xb5437001
.long 0x36043da0,0xb57a2e49,0x36037697,0xb580539b,0x35f9150b,0xb5997ade,0x35f6b2da,0xb59d485a
.long 0x35e6a5cc,0xb5b3ffcb,0x35e34b9d,0xb5b836d3,0x35d16703,0xb5cc532f,0x35ccf767,0xb5d0c649
.long 0x35b99af8,0xb5e22928,0x35b3ffcb,0xb5e6a5cc,0x359f8be8,0xb5f53d98,0x3598b70e,0xb5f98d49
.long 0x35838b1e,0xb602aa7c,0x3576ee32,0xb6049f3b,0x354bdfec,0xb6091e8b,0x3539409a,0xb60ac2cf
.long 0x350e2d99,0xb60de6d7,0x34f26126,0xb60f1d26,0x349d7f75,0xb610f474,0x345e44d3,0xb6119fe7
.long 0x3365c312,0xb6123ddd,0xb32c543e,0xb61242cc,0xb448d093,0xb611bf0e,0xb499f07e,0xb61103be
.long 0xb4e44fb9,0xb60f7991,0xb50e2d99,0xb60de6d7,0xb530b775,0xb60b747e,0xb54d8e73,0xb608f659
.long 0xb56d1fc2,0xb605bc5f,0xb58524fb,0xb602428b,0xb5935229,0xb5fcc616,0xb5a1cc01,0xb5f3c304
.long 0xb5ae48db,0xb5eafede,0xb5bc5de1,0xb5dfddb7,0xb5c71fd9,0xb5d65a8d,0xb5d4830e,0xb5c916be
.long 0xb5dd89a5,0xb5bf1987,0xb5e9ebf9,0xb5afb925,0xb5f14053,0xb5a58458,0xb5fc5213,0xb5941883
.long 0xb6010332,0xb589eacf,0xb605bc5f,0xb56d1fc2,0xb607d3c2,0xb559460b,0xb60b9706,0xb52f0122
.long 0xb60cfc96,0xb51c10a8,0xb60fa5b5,0xb4dd43ad,0xb6106d98,0xb4b9e8cf,0xb611db0c,0xb43357f8
.long 0xb6121c09,0xb3e5b15b,0xb6122fc4,0x33ac4cc4,0xb61202ab,0x340f868b,0xb610a2c8,0x34af446d
.long 0xb61021ce,0x34c81302,0xb60d3932,0x35189a11,0xb60c7f4d,0x3522f94b,0xb607fe41,0x35579b11
.long 0x36124925,0x80000000,0x36124925,0x80000000,0x3610f474,0xb49d7f75,0x3610e4d1,0xb4a10e0b
.long 0x360cfc96,0xb51c10a8,0x360cbe9f,0xb51f85bf,0x36067407,0xb5668aa8,0x3605eac5,0xb56b7b55
.long 0x35faf267,0xb596696a,0x35f9150b,0xb5997ade,0x35e46be1,0xb5b6d0e8,0x35e1971d,0xb5ba4c5f
.long 0x35c9bd68,0xb5d3e4dd,0x35c5ce2f,0xb5d7924c,0x35ab6341,0xb5ed1ddb,0x35a6419f,0xb5f0be0a
.long 0x3589eacf,0xb6010332,0x35838b1e,0xb602aa7c,0x354bdfec,0xb6091e8b,0x353ca791,0xb60a7965
.long 0x3500349d,0xb60ebb35,0x34dd43ad,0xb60fa5b5,0x3448d093,0xb611bf0e,0x33f40934,0xb6121638
.long 0xb3e5b15b,0xb6121c09,0xb448d093,0xb611bf0e,0xb4d6357f,0xb60fd075,0xb501f4dd,0xb60ea1dd
.long 0xb5378c73,0xb60ae704,0xb54f3c7b,0xb608cdd2,0xb580539b,0xb6037697,0xb58c4943,0xb6005f52
.long 0xb5a28b42,0xb5f343a6,0xb5ae48db,0xb5eafede,0xb5c1cdce,0xb5db2d08,0xb5ccf767,0xb5d0c649
.long 0xb5dd89a5,0xb5bf1987,0xb5e7bf6d,0xb5b294a0,0xb5f53d98,0xb59f8be8,0xb5fe1e75,0xb590fcfd
.long 0xb6043da0,0xb57a2e49,0xb607d3c2,0xb559460b,0xb60b747e,0xb530b775,0xb60e0296,0xb50c6fa1
.long 0xb61021ce,0xb4c81302,0xb6117d97,0xb473b441,0xb6122fc4,0xb3ac4cc4,0xb61233d2,0x339df27f
.long 0xb61194d1,0x34656a87,0xb61021ce,0x34c81302,0xb60e53c4,0x350733b6,0xb60b51a1,0x35326d5a
.long 0xb6087bc8,0x3552970b,0xb603dabe,0x357d6bf8,0xb6002813,0x358d12bd,0xb5f3c304,0x35a1cc01
.long 0xb5eafede,0x35ae48db,0xb5db2d08,0x35c1cdce,0xb5d16703,0x35cc532f,0xb5be6b4d,0x35de1f77
.long 0xb5b3ffcb,0x35e6a5cc,0xb59e09eb,0x35f63706,0xb5935229,0x35fcc616,0xb5754d41,0x3604cf8f
.long 0x36124925,0x80000000,0x36124925,0x80000000,0x36114af0,0xb4882044,0x36113d66,0xb48bb100
.long 0x360e53c4,0xb50733b6,0x360e1dfd,0xb50ab153,0x36096df1,0xb5488167,0x3608f659,0xb54d8e73
.long 0x3602aa7c,0xb5838b1e,0x3601d958,0xb586bd8f,0x35f441cc,0xb5a10c5c,0x35f1c208,0xb5a4c6aa
.long 0x35dfddb7,0xb5bc5de1,0x35dc5c66,0xb5c07498,0x35c86f98,0xb5d520bc,0x35c3d01e,0xb5d96206
.long 0x35ae48db,0xb5eafede,0x35a8770c,0xb5ef33b3,0x3591c466,0xb5fdac47,0x358ab54b,0xb600cce1
.long 0x35668aa8,0xb6067407,0x3555ef93,0xb608286d,0x35266b46,0xb60c3ea0,0x3513656e,0xb60d918d
.long 0x34c81302,0xb61021ce,0x349d7f75,0xb610f474,0x3401303c,0xb612100e,0x330f9c2b,0xb61244bd
.long 0xb40f868b,0xb61202ab,0xb473b441,0xb6117d97,0xb4cf2540,0xb60ff9d3,0xb501f4dd,0xb60ea1dd
.long 0xb529dba6,0xb60bfc98,0xb54520f2,0xb609bc05,0xb569d656,0xb60618d8,0xb582bdb6,0xb602ddfc
.long 0xb5935229,0xb5fcc616,0xb5a10c5c,0xb5f441cc,0xb5afb925,0xb5e9ebf9,0xb5bd0d7a,0xb5df4981
.long 0xb5c9bd68,0xb5d3e4dd,0xb5d65a8d,0xb5c71fd9,0xb5e10486,0xb5bafd53,0xb5ec96f6,0xb5ac1d48
.long 0xb5f53d98,0xb59f8be8,0xb5ff7151,0xb58ea4ac,0xb603112b,0xb581effd,0xb607524d,0xb55e43cf
.long 0xb609bc05,0xb54520f2,0xb60cfc96,0xb51c10a8,0xb60e882d,0xb503b4cc,0xb610a2c8,0xb4af446d
.long 0xb61164f7,0xb480fdd1,0xb6123785,0xb38f97d8,0xb6124870,0x3265c89b,0xb611b505,0x344ff7d5
.long 0xb6112f82,0x348f4166,0xb60f1d26,0x34f26126,0xb60e1dfd,0x350ab153,0xb60a7965,0x353ca791
.long 0xb6091e8b,0x354bdfec,0xb603dabe,0x357d6bf8,0xb602428b,0x358524fb,0xb5f6b2da,0x359d485a
.long 0x36124925,0x80000000,0x36124925,0x80000000,0x3610d4d5,0xb4a49c3e,0x3610c47f,0xb4a82a0c
.long 0x360c7f4d,0xb522f94b,0x360c3ea0,0xb5266b46,0x36055e9c,0xb57066e6,0x3604cf8f,0xb5754d41
.long 0x35f72e15,0xb59c8668,0x35f53d98,0xb59f8be8,0x35deb4c1,0xb5bdbc9e,0x35dbc4fb,0xb5c1216f
.long 0x35c1cdce,0xb5db2d08,0x35bdbc9e,0xb5deb4c1,0x35a10c5c,0xb5f441cc,0x359bc415,0xb5f7a8b8
.long 0x357a2e49,0xb6043da0,0x356d1fc2,0xb605bc5f,0x352d4a63,0xb60bb938,0x351dcb64,0xb60cddc6
.long 0x34b9e8cf,0xb6106d98,0x34966127,0xb61112ae,0x332c543e,0xb61242cc,0xb30f9c2b,0xb61244bd
.long 0xb48f4166,0xb6112f82,0xb4b9e8cf,0xb6106d98,0xb5189a11,0xb60d3932,0xb52f0122,0xb60b9706
.long 0xb5668aa8,0xb6067407,0xb57d6bf8,0xb603dabe,0xb597f2e0,0xb5fa04ee,0xb5a34a1f,0xb5f2c3b2
.long 0xb5b99af8,0xb5e22928,0xb5c47a9d,0xb5d8c7f8,0xb5d7924c,0xb5c5ce2f,0xb5e1971d,0xb5ba4c5f
.long 0xb5f14053,0xb5a58458,0xb5fa04ee,0xb597f2e0,0xb603112b,0xb581effd,0xb606a121,0xb564e3fb
.long 0xb60ae704,0xb5378c73,0xb60d7471,0xb5152201,0xb60ff9d3,0xb4cf2540,0xb6115820,0xb4848f33
.long 0xb6122fc4,0xb3ac4cc4,0xb6123785,0x338f97d8,0xb6117d97,0x3473b441,0xb6100dfd,0x34cb9c60
.long 0xb60de6d7,0x350e2d99,0xb60ae704,0x35378c73,0xb6077dc8,0x355c9a6b,0xb602ddfc,0x3582bdb6
.long 0xb5fcc616,0x35935229,0xb5f03b2c,0x35a6fe80,0xb5e589f2,0x35b56939,0xb5d5bde6,0x35c7c7f6
.long 0xb5c9bd68,0x35d3e4dd,0xb5b6d0e8,0x35e46be1,0xb5a9edf8,0x35ee29ed,0xb5941883,0x35fc5213
.long 0xb586bd8f,0x3601d958,0xb55c9a6b,0x36077dc8,0xb541be97,0x360a08c4,0xb50c6fa1,0x360e0296
.long 0x36124925,0x80000000,0x36124925,0x80000000,0x3610b3d0,0xb4abb772,0x3610a2c8,0xb4af446d
.long 0x360bfc98,0xb529dba6,0x360bb938,0xb52d4a63,0x36043da0,0xb57a2e49,0x3603a8d3,0xb57f09e5
.long 0x35f343a6,0xb5a28b42,0x35f14053,0xb5a58458,0x35d8c7f8,0xb5c47a9d,0x35d5bde6,0xb5c7c7f6
.long 0x35b99af8,0xb5e22928,0x35b56939,0xb5e589f2,0x3596696a,0xb5faf267,0x3590fcfd,0xb5fe1e75
.long 0x355fecab,0xb607267f,0x3552970b,0xb6087bc8,0x350e2d99,0xb60de6d7,0x34fce81d,0xb60ed436
.long 0x34656a87,0xb61194d1,0x341ddb79,0xb611f3e0,0xb3e5b15b,0xb6121c09,0xb441a8d5,0xb611c8bc
.long 0xb4e44fb9,0xb60f7991,0xb50733b6,0xb60e53c4,0xb54520f2,0xb609bc05,0xb55af07e,0xb607a8ef
.long 0xb589eacf,0xb6010332,0xb594de81,0xb5fbdd75,0xb5ae48db,0xb5eafede,0xb5b8e91f,0xb5e2baa9
.long 0xb5cee116,0xb5cee116,0xb5d8c7f8,0xb5c47a9d,0xb5eafede,0xb5ae48db,0xb5f3c304,0xb5a1cc01
.long 0xb6010332,0xb589eacf,0xb6049f3b,0xb576ee32,0xb609bc05,0xb54520f2,0xb60c5f21,0xb524b27c
.long 0xb60f7991,0xb4e44fb9,0xb610f474,0xb49d7f75,0xb6121c09,0xb3e5b15b,0xb61244bd,0x330f9c2b
.long 0xb61194d1,0x34656a87,0xb6104865,0x34c0fed7,0xb60de6d7,0x350e2d99,0xb60b0ae4,0x3535d7db
.long 0xb607267f,0x355fecab,0xb602aa7c,0x35838b1e,0xb5faf267,0x3596696a,0xb5eeaf1a,0x35a932b6
.long 0xb5e22928,0x35b99af8,0xb5d2a6f4,0x35cb0946,0xb5c47a9d,0x35d8c7f8,0xb5b1de66,0x35e84b67
.long 0xb5a28b42,0x35f343a6,0xb58d12bd,0x36002813,0xb57a2e49,0x36043da0,0xb54a30e8,0x36094668
.long 0xb529dba6,0x360bfc98,0xb4eb5992,0x360f4c0c,0xb4abb772,0x3610b3d0,0xb3f40934,0x36121638
.long 0x36124925,0x80000000,0x36124925,0x80000000,0x361021ce,0xb4c81302,0x36100dfd,0xb4cb9c60
.long 0x3609bc05,0xb54520f2,0x36096df1,0xb5488167,0x35fe9006,0xb590353b,0x35fd397d,0xb5928b75
.long 0x35e22928,0xb5b99af8,0x35dfddb7,0xb5bc5de1,0x35bf1987,0xb5dd89a5,0x35bbadd4,0xb5e07164
.long 0x3596696a,0xb5faf267,0x3591c466,0xb5fdac47,0x3552970b,0xb6087bc8,0x3546d16a,0xb6099525
.long 0x34e44fb9,0xb60f7991,0x34c81302,0xb61021ce,0x3365c312,0xb6123ddd,0xb1e5c8e2,0xb61248f7
.long 0xb4abb772,0xb610b3d0,0xb4cf2540,0xb60ff9d3,0xb5378c73,0xb60ae704,0xb54a30e8,0xb6094668
.long 0xb589eacf,0xb6010332,0xb5935229,0xb5fcc616,0xb5b3ffcb,0xb5e6a5cc,0xb5bd0d7a,0xb5df4981
.long 0xb5d8c7f8,0xb5c47a9d,0xb5e10486,0xb5bafd53,0xb5f72e15,0xb59c8668,0xb5fe1e75,0xb590fcfd
.long 0xb607267f,0xb55fecab,0xb609bc05,0xb54520f2,0xb60ebb35,0xb500349d,0xb6103546,0xb4c48929
.long 0xb6121c09,0xb3e5b15b,0xb6124870,0x3265c89b,0xb6112f82,0x348f4166,0xb60fe551,0x34d2ada0
.long 0xb60bfc98,0x3529dba6,0xb6091e8b,0x354bdfec,0xb602aa7c,0x35838b1e,0xb5fc5213,0x35941883
.long 0xb5eafede,0x35ae48db,0xb5deb4c1,0x35bdbc9e,0xb5c9bd68,0x35d3e4dd,0xb5ba4c5f,0x35e1971d
.long 0xb5a28b42,0x35f343a6,0xb590353b,0x35fe9006,0xb56d1fc2,0x3605bc5f,0xb5437001,0x3609e28f
.long 0xb50e2d99,0x360de6d7,0xb4c0fed7,0x36104865,0xb42c2ee1,0x3611e3ac,0x32ac561c,0x3612478f
.long 0x34656a87,0x361194d1,0x34d6357f,0x360fd075,0x351c10a8,0x360cfc96,0x354d8e73,0x3608f659
.long 0x357a2e49,0x36043da0,0x3594de81,0x35fbdd75,0x35a8770c,0x35ef33b3,0x35be6b4d,0x35de1f77
.long 0x36124925,0x80000000,0x36124925,0x80000000,0x36109166,0xb4b2d0fd,0x36107fab,0xb4b65d1f
.long 0x360b747e,0xb530b775,0x360b2e6d,0xb53422d2,0x3603112b,0xb581effd,0x360276ac,0xb5845835
.long 0x35ef33b3,0xb5a8770c,0x35ed1ddb,0xb5ab6341,0x35d2a6f4,0xb5cb0946,0x35cf8352,0xb5ce3e5b
.long 0x35b127bd,0xb5e8d6d2,0x35acd6e4,0xb5ec0f80,0x358b7f72,0xb6009641,0x3585f16e,0xb6020e19
.long 0x354520f2,0xb609bc05,0x35378c73,0xb60ae704,0x34dd43ad,0xb60fa5b5,0x34bd740e,0xb6105b2b
.long 0x33ac4cc4,0xb6122fc4,0x3265c89b,0xb6124870,0xb4882044,0xb6114af0,0xb4af446d,0xb610a2c8
.long 0xb51c10a8,0xb60cfc96,0xb530b775,0xb60b747e,0xb57066e6,0xb6055e9c,0xb582bdb6,0xb602ddfc
.long 0xb59f8be8,0xb5f53d98,0xb5a9edf8,0xb5ee29ed,0xb5c32527,0xb5d9fb8d,0xb5ccf767,0xb5d0c649
.long 0xb5e22928,0xb5b99af8,0xb5eafede,0xb5ae48db,0xb5fbdd75,0xb594de81,0xb601a446,0xb587895d
.long 0xb607d3c2,0xb559460b,0xb60a9e45,0xb53af44f,0xb60e882d,0xb503b4cc,0xb6103546,0xb4c48929
.long 0xb611e3ac,0xb42c2ee1,0xb6124653,0xb2e5c780,0xb611d211,0x343a80a0,0xb610c47f,0x34a82a0c
.long 0xb60e53c4,0x350733b6,0xb60bb938,0x352d4a63,0xb6077dc8,0x355c9a6b,0xb6034409,0x358121f4
.long 0xb5faf267,0x3596696a,0xb5ef33b3,0x35a8770c,0xb5e10486,0x35bafd53,0xb5d2073c,0x35cbae79
.long 0xb5c1cdce,0x35db2d08,0xb5afb925,0x35e9ebf9,0xb59e09eb,0x35f63706,0xb5891ffd,0x36013933
.long 0xb56d1fc2,0x3605bc5f,0xb53e5a5e,0x360a542f,0xb5189a11,0x360d3932,0xb4cb9c60,0x36100dfd
.long 0xb480fdd1,0x361164f7,0xb32c543e,0x361242cc,0x33c90008,0x3612269b,0x34a10e0b,0x3610e4d1
.long 0x36124925,0x80000000,0x36124925,0x80000000,0x360ff9d3,0xb4cf2540,0x360fe551,0xb4d2ada0
.long 0x36091e8b,0xb54bdfec,0x3608cdd2,0xb54f3c7b,0x35fbdd75,0xb594de81,0x35fa7bf8,0xb5972e53
.long 0x35dd89a5,0xb5bf1987,0x35db2d08,0xb5c1cdce,0x35b836d3,0xb5e34b9d,0x35b4b4b9,0xb5e61826
.long 0x358d12bd,0xb6002813,0x358854d7,0xb6016ee5,0x353af44f,0xb60a9e45,0x352f0122,0xb60b9706
.long 0x34abb772,0xb610b3d0,0x348f4166,0xb6112f82,0xb38f97d8,0xb6123785,0xb4085b8e,0xb612098a
.long 0xb4f26126,0xb60f1d26,0xb50ab153,0xb60e1dfd,0xb55c9a6b,0xb6077dc8,0xb56ec39e,0xb6058da7
.long 0xb59c8668,0xb5f72e15,0xb5a58458,0xb5f14053,0xb5c5ce2f,0xb5d7924c,0xb5ce3e5b,0xb5cf8352
.long 0xb5e8d6d2,0xb5b127bd,0xb5f03b2c,0xb5a6fe80,0xb602428b,0xb58524fb,0xb6052f3f,0xb572099a
.long 0xb60bfc98,0xb529dba6,0xb60de6d7,0xb50e2d99,0xb6114af0,0xb4882044,0xb611fb72,0xb416b131
.long 0xb61202ab,0x340f868b,0xb6114af0,0x34882044,0xb60e1dfd,0x350ab153,0xb60bdb13,0x352b933a
.long 0xb605bc5f,0x356d1fc2,0xb601d958,0x3586bd8f,0xb5f24328,0x35a40897,0xb5e732e4,0x35b34a6d
.long 0xb5d16703,0x35cc532f,0xb5c32527,0x35d9fb8d,0xb5a9edf8,0x35ee29ed,0xb598b70e,0x35f98d49
.long 0xb57a2e49,0x36043da0,0xb552970b,0x36087bc8,0xb5189a11,0x360d3932,0xb4d9bcd9,0x360fbb41
.long 0xb448d093,0x3611bf0e,0xb265c89b,0x36124870,0x34571e96,0x3611aaa3,0x34cb9c60,0x36100dfd
.long 0x351c10a8,0x360cfc96,0x354bdfec,0x36091e8b,0x357d6bf8,0x3603dabe,0x3595a424,0x35fb683c
.long 0x35ab6341,0x35ed1ddb,0x35c07498,0x35dc5c66,0x35d2a6f4,0x35cb0946,0x35e4fb30,0x35b61d48
.long 0x36124925,0x80000000,0x36124925,0x80000000,0x36106d98,0xb4b9e8cf,0x36105b2b,0xb4bd740e
.long 0x360ae704,0xb5378c73,0x360a9e45,0xb53af44f,0x3601d958,0xb586bd8f,0x36013933,0xb5891ffd
.long 0x35eafede,0xb5ae48db,0x35e8d6d2,0xb5b127bd,0x35cc532f,0xb5d16703,0x35c916be,0xb5d4830e
.long 0x35a8770c,0xb5ef33b3,0x35a40897,0xb5f24328,0x3580539b,0xb6037697,0x35754d41,0xb604cf8f
.long 0x3529dba6,0xb60bfc98,0x351c10a8,0xb60cfc96,0x349d7f75,0xb610f474,0x347ad83f,0xb6117174
.long 0xb365c312,0xb6123ddd,0xb401303c,0xb612100e,0xb4d6357f,0xb60fd075,0xb4fce81d,0xb60ed436
.long 0xb54520f2,0xb609bc05,0xb559460b,0xb607d3c2,0xb58d12bd,0xb6002813,0xb5972e53,0xb5fa7bf8
.long 0xb5b3ffcb,0xb5e6a5cc,0xb5bdbc9e,0xb5deb4c1,0xb5d65a8d,0xb5c71fd9,0xb5df4981,0xb5bd0d7a
.long 0xb5f343a6,0xb5a28b42,0xb5faf267,0xb596696a,0xb604ff90,0xb573abb8,0xb607fe41,0xb5579b11
.long 0xb60cfc96,0xb51c10a8,0xb60eecde,0xb4f96664,0xb61164f7,0xb480fdd1,0xb6121638,0xb3f40934
.long 0xb6121c09,0x33e5b15b,0xb61164f7,0x3480fdd1,0xb60f1d26,0x34f26126,0xb60cddc6,0x351dcb64
.long 0xb6087bc8,0x3552970b,0xb6049f3b,0x3576ee32,0xb5fcc616,0x35935229,0xb5f1c208,0x35a4c6aa
.long 0xb5e22928,0x35b99af8,0xb5d3e4dd,0x35c9bd68,0xb5c1cdce,0x35db2d08,0xb5b070a8,0x35e961ad
.long 0xb59c8668,0x35f72e15,0xb58854d7,0x36016ee5,0xb5668aa8,0x36067407,0xb539409a,0x360ac2cf
.long 0xb50e2d99,0x360de6d7,0xb4b9e8cf,0x36106d98,0xb448d093,0x3611bf0e,0x31e5c8e2,0x361248f7
.long 0x342c2ee1,0x3611e3ac,0x34c0fed7,0x36104865,0x350733b6,0x360e53c4,0x353ca791,0x360a7965
.long 0x36124925,0x80000000,0x36124925,0x80000000,0x360fd075,0xb4d6357f,0x360fbb41,0xb4d9bcd9
.long 0x36087bc8,0xb552970b,0x3608286d,0xb555ef93,0x35f9150b,0xb5997ade,0x35f7a8b8,0xb59bc415
.long 0x35d8c7f8,0xb5c47a9d,0x35d65a8d,0xb5c71fd9,0x35b127bd,0xb5e8d6d2,0x35ad9015,0xb5eb8777
.long 0x35838b1e,0xb602aa7c,0x357d6bf8,0xb603dabe,0x3522f94b,0xb60c7f4d,0x3516de37,0xb60d56fd
.long 0x34656a87,0xb61194d1,0x342c2ee1,0xb611e3ac,0xb448d093,0xb611bf0e,0xb4848f33,0xb6115820
.long 0xb51c10a8,0xb60cfc96,0xb52d4a63,0xb60bb938,0xb580539b,0xb6037697,0xb5891ffd,0xb6013933
.long 0xb5ae48db,0xb5eafede,0xb5b6d0e8,0xb5e46be1,0xb5d65a8d,0xb5c71fd9,0xb5de1f77,0xb5be6b4d
.long 0xb5f72e15,0xb59c8668,0xb5fdac47,0xb591c466,0xb607d3c2,0xb559460b,0xb60a2ea4,0xb5400cb6
.long 0xb60f7991,0xb4e44fb9,0xb610b3d0,0xb4abb772,0xb6124653,0xb2e5c780,0xb6122b5d,0x33baa69f
.long 0xb61021ce,0x34c81302,0xb60e882d,0x3503b4cc,0xb6091e8b,0x354bdfec,0xb605eac5,0x356b7b55
.long 0xb5faf267,0x3596696a,0xb5f14053,0x35a58458,0xb5db2d08,0x35c1cdce,0xb5ce3e5b,0x35cf8352
.long 0xb5b3ffcb,0x35e6a5cc,0xb5a40897,0x35f24328,0xb586bd8f,0x3601d958,0xb56830c7,0x36064699
.long 0xb529dba6,0x360bfc98,0xb500349d,0x360ebb35,0xb480fdd1,0x361164f7,0xb39df27f,0x361233d2
.long 0x342c2ee1,0x3611e3ac,0x34b2d0fd,0x36109166,0x35152201,0x360d7471,0x35437001,0x3609e28f
.long 0x357a2e49,0x36043da0,0x35935229,0x35fcc616,0x35ab6341,0x35ed1ddb,0x35bfc74a,0x35dcf34a
.long 0x35d3e4dd,0x35c9bd68,0x35e589f2,0x35b56939,0x35f53d98,0x359f8be8,0x3601a446,0x3587895d
.long 0x36124925,0x80000000,0x36124925,0x80000000,0x36104865,0xb4c0fed7,0x36103546,0xb4c48929
.long 0x360a542f,0xb53e5a5e,0x360a08c4,0xb541be97,0x36009641,0xb58b7f72,0x35ffe10a,0xb58ddbe0
.long 0x35e6a5cc,0xb5b3ffcb,0x35e46be1,0xb5b6d0e8,0x35c5ce2f,0xb5d7924c,0x35c279b6,0xb5da948e
.long 0x359f8be8,0xb5f53d98,0x359b0162,0xb5f822c3,0x3569d656,0xb60618d8,0x355e43cf,0xb607524d
.long 0x350e2d99,0xb60de6d7,0x3500349d,0xb60ebb35,0x343a80a0,0xb611d211,0x33f40934,0xb6121638
.long 0xb448d093,0xb611bf0e,0xb4882044,0xb6114af0,0xb511a880,0xb60dae53,0xb524b27c,0xb60c5f21
.long 0xb56d1fc2,0xb605bc5f,0xb580539b,0xb6037697,0xb5a10c5c,0xb5f441cc,0xb5aaa8d1,0xb5eda42d
.long 0xb5c71fd9,0xb5d65a8d,0xb5d0250d,0xb5cd9b20,0xb5e7bf6d,0xb5b294a0,0xb5efb7ba,0xb5a7bafa
.long 0xb6010332,0xb589eacf,0xb6043da0,0xb57a2e49,0xb60a9e45,0xb53af44f,0xb60cddc6,0xb51dcb64
.long 0xb6106d98,0xb4b9e8cf,0xb6117d97,0xb473b441,0xb6124870,0x3265c89b,0xb611fb72,0x3416b131
.long 0xb61021ce,0x34c81302,0xb60e53c4,0x350733b6,0xb60a08c4,0x3541be97,0xb606a121,0x3564e3fb
.long 0xb6002813,0x358d12bd,0xb5f63706,0x359e09eb,0xb5e589f2,0x35b56939,0xb5d82d65,0x35c524a3
.long 0xb5c47a9d,0x35d8c7f8,0xb5b3ffcb,0x35e6a5cc,0xb59e09eb,0x35f63706,0xb58ab54b,0x3600cce1
.long 0xb5668aa8,0x36067407,0xb53af44f,0x360a9e45,0xb50ab153,0x360e1dfd,0xb4b65d1f,0x36107fab
.long 0xb42c2ee1,0x3611e3ac,0x32e5c780,0x36124653,0x34571e96,0x3611aaa3,0x34d2ada0,0x360fe551
.long 0x35152201,0x360d7471,0x35488167,0x36096df1,0x357066e6,0x36055e9c,0x3590fcfd,0x35fe1e75
.long 0x36124925,0x80000000,0x36124925,0x80000000,0x360fa5b5,0xb4dd43ad,0x360f8fcf,0xb4e0c9f8
.long 0x3607d3c2,0xb559460b,0x36077dc8,0xb55c9a6b,0x35f63706,0xb59e09eb,0x35f4bffe,0xb5a04c53
.long 0x35d3e4dd,0xb5c9bd68,0x35d16703,0xb5cc532f,0x35a9edf8,0xb5ee29ed,0x35a6419f,0xb5f0be0a
.long 0x3573abb8,0xb604ff90,0x3569d656,0xb60618d8,0x350ab153,0xb60e1dfd,0x34fce81d,0xb60ed436
.long 0x33e5b15b,0xb6121c09,0x3365c312,0xb6123ddd,0xb4a49c3e,0xb610d4d5,0xb4c48929,0xb6103546
.long 0xb53e5a5e,0xb60a542f,0xb54f3c7b,0xb608cdd2,0xb591c466,0xb5fdac47,0xb59a3e50,0xb5f89c34
.long 0xb5bf1987,0xb5dd89a5,0xb5c71fd9,0xb5d65a8d,0xb5e589f2,0xb5b56939,0xb5ec96f6,0xb5ac1d48
.long 0xb601d958,0xb586bd8f,0xb6049f3b,0xb576ee32,0xb60c3ea0,0xb5266b46,0xb60e0296,0xb50c6fa1
.long 0xb61194d1,0xb4656a87,0xb6121c09,0xb3e5b15b,0xb611aaa3,0x34571e96,0xb610c47f,0x34a82a0c
.long 0xb60c7f4d,0x3522f94b,0xb60a08c4,0x3541be97,0xb602428b,0x358524fb,0xb5fc5213,0x35941883
.long 0xb5e6a5cc,0x35b3ffcb,0xb5db2d08,0x35c1cdce,0xb5c07498,0x35dc5c66,0xb5b1de66,0x35e84b67
.long 0xb5935229,0x35fcc616,0xb581effd,0x3603112b,0xb541be97,0x360a08c4,0xb51a558c,0x360d1b10
.long 0xb4abb772,0x3610b3d0,0xb42c2ee1,0x3611e3ac,0x33c90008,0x3612269b,0x348bb100,0x36113d66
.long 0x350733b6,0x360e53c4,0x353422d2,0x360b2e6d,0x357066e6,0x36055e9c,0x358ddbe0,0x35ffe10a
.long 0x35a8770c,0x35ef33b3,0x35bc5de1,0x35dfddb7,0x35d2a6f4,0x35cb0946,0x35e3dc06,0x35b78416
.long 0x35f53d98,0x359f8be8,0x36016ee5,0x358854d7,0x36077dc8,0x355c9a6b,0x360c1dc7,0x352823aa
```
